```python
import torch

def _softmax(x, axis=-1):
    return torch.softmax(x, dim=axis)

def _gelu(x):
    return torch.nn.functional.gelu(x, approximate='tanh')

def _silu(x):
    return torch.nn.functional.silu(x)

def _sigmoid(x):
    return torch.sigmoid(x)

def _layernorm(x, axis=-1, eps=1e-05):
    m = x.mean(dim=axis, keepdim=True)
    v = x.var(dim=axis, keepdim=True, unbiased=False)
    return (x - m) / torch.sqrt(v + eps)

def _scatter_add(tgt, idx, src, axis=0):
    return tgt.clone().index_add_(axis, idx, src)

def _segment_sum(src, seg, n):
    out = torch.zeros((n,) + src.shape[1:], dtype=src.dtype)
    return out.index_add_(0, seg, src)

def _pad(x, pw):
    flat = tuple((v for pair in reversed(pw) for v in pair))
    return torch.nn.functional.pad(x, flat)
kernel_name = 'interleave_layers__spectral_gfnet__memory_aug_recurrent_mem_tr__prompt'

def setup_inputs():

    _w = lambda a: (lambda t: t.to(torch.bfloat16) if t.is_floating_point() else t)(torch.as_tensor(a))

    def _A_setup():
        B, S, D = (1, 2048, 448)
        Df = D // 2 + 1
        return {'x': _w((lambda *s: torch.randn(*s, dtype=torch.bfloat16) * 0.05)(B, S, D)), 'w_r': _w((lambda *s: torch.randn(*s, dtype=torch.bfloat16) * 0.4)(S, Df) * 0.02), 'w_i': _w((lambda *s: torch.randn(*s, dtype=torch.bfloat16) * 0.4)(S, Df) * 0.02)}
    _A_in = _A_setup()

    def _B_setup():
        B, S, Dm = (1, 2048, 448)
        H, Dh = (16, 256)
        M, seg = (8, 32)
        seg = min(seg, S)
        S = S // seg * seg
        return {'x': _w((lambda *s: torch.randn(*s, dtype=torch.bfloat16) * 0.05)(B, S, Dm)), 'mem0': _w((lambda *s: torch.randn(*s, dtype=torch.bfloat16) * 0.2)(B, M, Dm)), 'Wq': _w((lambda *s: torch.randn(*s, dtype=torch.bfloat16) * 1.6)(Dm, H, Dh) * Dm ** (-0.5)), 'Wk': _w((lambda *s: torch.randn(*s, dtype=torch.bfloat16) * 1.6)(Dm, H, Dh) * Dm ** (-0.5)), 'Wv': _w((lambda *s: torch.randn(*s, dtype=torch.bfloat16) * 0.2)(Dm, H, Dh) * Dm ** (-0.5)), 'Wo': _w((lambda *s: torch.randn(*s, dtype=torch.bfloat16) * 0.2)(H, Dh, Dm) * (H * Dh) ** (-0.5)), 'seg_len': seg}
    _B_in = _B_setup()
    return {'A_x': _A_in['x'], 'A_w_r': _A_in['w_r'], 'A_w_i': _A_in['w_i'], 'B_x': _B_in['x'], 'B_mem0': _B_in['mem0'], 'B_Wq': _B_in['Wq'], 'B_Wk': _B_in['Wk'], 'B_Wv': _B_in['Wv'], 'B_Wo': _B_in['Wo'], 'B_seg_len': _B_in['seg_len']}

def reference(A_x, A_w_r, A_w_i, B_x, B_mem0, B_Wq, B_Wk, B_Wv, B_Wo, B_seg_len):

    def _A_ref(x, w_r, w_i):
        B, S, D = x.shape
        X = (lambda x, axes=(-2, -1): torch.fft.rfft2(x.float(), dim=axes))(x, axes=(-2, -1))
        W = w_r + 1j * w_i
        X = X * W
        y = (lambda x, s, axes=(-2, -1): torch.fft.irfft2(x, s=s, dim=axes).to(torch.bfloat16))(X, (S, D), axes=(-2, -1))
        return y

    def _B_ref(x, mem0, Wq, Wk, Wv, Wo, seg_len):
        B, S, Dm = x.shape
        H, Dh = (Wq.shape[1], Wq.shape[2])
        M = mem0.shape[1]
        scale = Dh ** (-0.5)
        n_seg = S // seg_len
        L = M + seg_len
        idx = torch.arange(L)
        mask = (idx[:, None] < M) | (idx[:, None] >= idx[None, :])
        mem = mem0
        outs = []
        for s in range(n_seg):
            xs = x[:, s * seg_len:(s + 1) * seg_len, :].clone()
            h = torch.concatenate([mem, xs], axis=1)
            q = torch.einsum('btd,dhe->bhte', h, Wq)
            k = torch.einsum('btd,dhe->bhte', h, Wk)
            v = torch.einsum('btd,dhe->bhte', h, Wv)
            scores = torch.einsum('bhqe,bhke->bhqk', q, k) * scale
            scores = torch.where(mask[None, None], scores, -1000000000.0)
            p = _softmax(scores, axis=-1)
            o = torch.einsum('bhqk,bhke->bhqe', p, v)
            o = torch.einsum('bhte,hed->btd', o, Wo)
            mem = o[:, :M, :].clone()
            outs.append(o[:, M:, :])
        return torch.concatenate(outs, axis=1)
    x = A_x
    x = x + _A_ref(_layernorm(x, axis=-1), A_w_r, A_w_i)
    x = x + _B_ref(_layernorm(x, axis=-1), B_mem0, B_Wq, B_Wk, B_Wv, B_Wo, B_seg_len)
    x = x + _A_ref(_layernorm(x, axis=-1), A_w_r, A_w_i)
    x = x + _B_ref(_layernorm(x, axis=-1), B_mem0, B_Wq, B_Wk, B_Wv, B_Wo, B_seg_len)
    return x
```

```asm
; @launch kernel=prep_kernel grid=(256,1,1) block=(256,1,1) lds=0
; @launch kernel=fa0_kernel grid=(480,1,1) block=(256,1,1) lds=65536
; @launch kernel=fb_kernel grid=(225,1,1) block=(64,1,1) lds=0
; @launch kernel=b0_kernel grid=(256,1,1) block=(256,1,1) lds=131072
; @launch kernel=fa1_kernel grid=(256,1,1) block=(256,1,1) lds=29568
; @launch kernel=fb_kernel grid=(225,1,1) block=(64,1,1) lds=0
; @launch kernel=b1_kernel grid=(256,1,1) block=(256,1,1) lds=131072
.amdgcn_target "amdgcn-amd-amdhsa--gfx950"
.text
.globl prep_kernel
.p2align 8
.type prep_kernel,@function
prep_kernel:
  s_cmp_ge_u32 s2, 256
  s_cbranch_scc1 P_end
  s_load_dwordx2 s[4:5], s[0:1], 96
  v_and_b32 v1, 63, v0
  v_lshrrev_b32 v2, 6, v0
  s_nop 1
  v_readfirstlane_b32 s3, v2
  s_nop 3
  s_waitcnt lgkmcnt(0)
  s_lshl_b32 s11, s2, 8
  v_add_u32 v2, s11, v0
  s_load_dwordx2 s[20:21], s[0:1], 40
  s_load_dwordx2 s[22:23], s[0:1], 48
  s_load_dwordx2 s[24:25], s[0:1], 56
  s_load_dwordx2 s[26:27], s[0:1], 64
  s_load_dwordx2 s[28:29], s[0:1], 0
  s_load_dwordx2 s[30:31], s[0:1], 8
  s_load_dwordx2 s[32:33], s[0:1], 16
  s_waitcnt lgkmcnt(0)
  v_lshlrev_b32 v40, 7, v2
  v_subrev_u32 v41, 0, v2
  v_and_b32 v41, 0xffff, v41
  v_cmp_gt_u32 vcc, 28672, v41
  s_and_saveexec_b64 s[12:13], vcc
  s_cbranch_execz P_pf0
  v_lshlrev_b32 v41, 7, v41
  global_load_dword v32, v41, s[20:21]
P_pf0:
  s_mov_b64 exec, s[12:13]
  v_subrev_u32 v41, 28672, v2
  v_and_b32 v41, 0xffff, v41
  v_cmp_gt_u32 vcc, 28672, v41
  s_and_saveexec_b64 s[12:13], vcc
  s_cbranch_execz P_pf1
  v_lshlrev_b32 v41, 7, v41
  global_load_dword v33, v41, s[22:23]
P_pf1:
  s_mov_b64 exec, s[12:13]
  v_subrev_u32 v41, 0, v2
  v_and_b32 v41, 0xffff, v41
  v_cmp_gt_u32 vcc, 28672, v41
  s_and_saveexec_b64 s[12:13], vcc
  s_cbranch_execz P_pf2
  v_lshlrev_b32 v41, 7, v41
  global_load_dword v34, v41, s[24:25]
P_pf2:
  s_mov_b64 exec, s[12:13]
  v_subrev_u32 v41, 28672, v2
  v_and_b32 v41, 0xffff, v41
  v_cmp_gt_u32 vcc, 28672, v41
  s_and_saveexec_b64 s[12:13], vcc
  s_cbranch_execz P_pf3
  v_lshlrev_b32 v41, 7, v41
  global_load_dword v35, v41, s[26:27]
P_pf3:
  s_mov_b64 exec, s[12:13]
  v_subrev_u32 v41, 43008, v2
  v_and_b32 v41, 0xffff, v41
  v_cmp_gt_u32 vcc, 14336, v41
  s_and_saveexec_b64 s[12:13], vcc
  s_cbranch_execz P_pf4
  v_lshlrev_b32 v41, 7, v41
  global_load_dword v36, v41, s[28:29]
P_pf4:
  s_mov_b64 exec, s[12:13]
  v_subrev_u32 v41, 43008, v2
  v_and_b32 v41, 0xffff, v41
  v_cmp_gt_u32 vcc, 7200, v41
  s_and_saveexec_b64 s[12:13], vcc
  s_cbranch_execz P_pf5
  v_lshlrev_b32 v41, 7, v41
  global_load_dword v37, v41, s[30:31]
P_pf5:
  s_mov_b64 exec, s[12:13]
  v_subrev_u32 v41, 57344, v2
  v_and_b32 v41, 0xffff, v41
  v_cmp_gt_u32 vcc, 7200, v41
  s_and_saveexec_b64 s[12:13], vcc
  s_cbranch_execz P_pf6
  v_lshlrev_b32 v41, 7, v41
  global_load_dword v38, v41, s[32:33]
P_pf6:
  s_mov_b64 exec, s[12:13]
  v_mov_b32 v4, 0
  v_mov_b32 v5, 0
  v_mov_b32 v6, 0
  v_mov_b32 v7, 0
  v_cmp_gt_u32 vcc, 4096, v2
  s_and_saveexec_b64 s[12:13], vcc
  s_cbranch_execz P_cnt_d
  v_lshlrev_b32 v8, 4, v2
  v_add_u32 v8, 60772352, v8
  global_store_dwordx4 v8, v[4:7], s[4:5]
P_cnt_d:
  s_mov_b64 exec, s[12:13]
  s_cmp_lg_u32 s2, 255
  s_cbranch_scc1 P_m0_skip
  s_load_dwordx2 s[40:41], s[0:1], 32
  s_waitcnt lgkmcnt(0)
  v_lshrrev_b32 v8, 2, v0
  v_and_b32 v9, 3, v0
  v_lshrrev_b32 v10, 4, v8
  v_lshrrev_b32 v11, 3, v8
  v_and_b32 v11, 1, v11
  v_and_b32 v12, 7, v8
  v_lshlrev_b32 v10, 4, v10
  v_lshl_add_u32 v10, v9, 2, v10
  v_lshl_add_u32 v10, v11, 1, v10
  v_mul_u32_u24 v12, 448, v12
  v_add_u32 v10, v10, v12
  v_lshlrev_b32 v10, 1, v10
  global_load_dword v20, v10, s[40:41] offset:0
  global_load_dword v21, v10, s[40:41] offset:128
  global_load_dword v22, v10, s[40:41] offset:256
  global_load_dword v23, v10, s[40:41] offset:384
  global_load_dword v24, v10, s[40:41] offset:512
  global_load_dword v25, v10, s[40:41] offset:640
  global_load_dword v26, v10, s[40:41] offset:768
  v_lshlrev_b32 v3, 2, v0
  s_waitcnt vmcnt(0)
  v_add_u32 v14, 57044992, v3
  global_store_dword v14, v20, s[4:5]
  v_add_u32 v14, 61902848, v3
  global_store_dword v14, v20, s[4:5]
  v_add_u32 v14, 58109952, v3
  global_store_dword v14, v20, s[4:5]
  v_add_u32 v14, 62435328, v3
  global_store_dword v14, v20, s[4:5]
  v_add_u32 v14, 57046016, v3
  global_store_dword v14, v21, s[4:5]
  v_add_u32 v14, 61903872, v3
  global_store_dword v14, v21, s[4:5]
  v_add_u32 v14, 58110976, v3
  global_store_dword v14, v21, s[4:5]
  v_add_u32 v14, 62436352, v3
  global_store_dword v14, v21, s[4:5]
  v_add_u32 v14, 57047040, v3
  global_store_dword v14, v22, s[4:5]
  v_add_u32 v14, 61904896, v3
  global_store_dword v14, v22, s[4:5]
  v_add_u32 v14, 58112000, v3
  global_store_dword v14, v22, s[4:5]
  v_add_u32 v14, 62437376, v3
  global_store_dword v14, v22, s[4:5]
  v_add_u32 v14, 57048064, v3
  global_store_dword v14, v23, s[4:5]
  v_add_u32 v14, 61905920, v3
  global_store_dword v14, v23, s[4:5]
  v_add_u32 v14, 58113024, v3
  global_store_dword v14, v23, s[4:5]
  v_add_u32 v14, 62438400, v3
  global_store_dword v14, v23, s[4:5]
  v_add_u32 v14, 57049088, v3
  global_store_dword v14, v24, s[4:5]
  v_add_u32 v14, 61906944, v3
  global_store_dword v14, v24, s[4:5]
  v_add_u32 v14, 58114048, v3
  global_store_dword v14, v24, s[4:5]
  v_add_u32 v14, 62439424, v3
  global_store_dword v14, v24, s[4:5]
  v_add_u32 v14, 57050112, v3
  global_store_dword v14, v25, s[4:5]
  v_add_u32 v14, 61907968, v3
  global_store_dword v14, v25, s[4:5]
  v_add_u32 v14, 58115072, v3
  global_store_dword v14, v25, s[4:5]
  v_add_u32 v14, 62440448, v3
  global_store_dword v14, v25, s[4:5]
  v_add_u32 v14, 57051136, v3
  global_store_dword v14, v26, s[4:5]
  v_add_u32 v14, 61908992, v3
  global_store_dword v14, v26, s[4:5]
  v_add_u32 v14, 58116096, v3
  global_store_dword v14, v26, s[4:5]
  v_add_u32 v14, 62441472, v3
  global_store_dword v14, v26, s[4:5]
  v_lshlrev_b32 v3, 4, v0
  v_mov_b32 v4, 0
  v_mov_b32 v5, 0
  v_mov_b32 v6, 0
  v_mov_b32 v7, 0
  v_and_b32 v15, 15, v0
  v_cmp_le_u32 vcc, 14, v15
  v_mov_b32 v16, -1
  s_nop 0
  v_cndmask_b32 v4, v4, v16, vcc
  v_cndmask_b32 v5, v5, v16, vcc
  v_cndmask_b32 v6, v6, v16, vcc
  v_cndmask_b32 v7, v7, v16, vcc
  v_add_u32 v14, 57053184, v3
  global_store_dwordx4 v14, v[4:7], s[4:5]
  v_add_u32 v14, 57057280, v3
  global_store_dwordx4 v14, v[4:7], s[4:5]
  v_add_u32 v14, 58118144, v3
  global_store_dwordx4 v14, v[4:7], s[4:5]
  v_add_u32 v14, 58122240, v3
  global_store_dwordx4 v14, v[4:7], s[4:5]
  v_add_u32 v3, 0, v0
  v_cmp_gt_u32 vcc, 448, v3
  s_and_saveexec_b64 s[12:13], vcc
  s_cbranch_execz P_mx0
  v_lshlrev_b32 v8, 4, v3
  global_load_dwordx4 v[16:19], v8, s[40:41]
  s_waitcnt vmcnt(0)
  v_add_u32 v14, 60837888, v8
  global_store_dwordx4 v14, v[16:19], s[4:5]
  v_add_u32 v14, 61370368, v8
  global_store_dwordx4 v14, v[16:19], s[4:5]
P_mx0:
  s_mov_b64 exec, s[12:13]
  v_add_u32 v3, 256, v0
  v_cmp_gt_u32 vcc, 448, v3
  s_and_saveexec_b64 s[12:13], vcc
  s_cbranch_execz P_mx1
  v_lshlrev_b32 v8, 4, v3
  global_load_dwordx4 v[16:19], v8, s[40:41]
  s_waitcnt vmcnt(0)
  v_add_u32 v14, 60837888, v8
  global_store_dwordx4 v14, v[16:19], s[4:5]
  v_add_u32 v14, 61370368, v8
  global_store_dwordx4 v14, v[16:19], s[4:5]
P_mx1:
  s_mov_b64 exec, s[12:13]
P_m0_skip:
  s_lshl_b32 s11, s2, 8
  v_add_u32 v2, s11, v0
  v_cmp_gt_u32 vcc, 26880, v2
  s_and_saveexec_b64 s[12:13], vcc
  s_cbranch_execz P_F_done
  v_and_b32 v4, 63, v2
  v_lshrrev_b32 v5, 6, v2
  s_mov_b32 s14, 153391690
  v_mul_hi_u32 v6, v5, s14
  v_mul_u32_u24 v7, 28, v6
  v_sub_u32 v7, v5, v7
  v_and_b32 v8, 31, v4
  v_lshrrev_b32 v9, 5, v4
  v_lshl_add_u32 v8, v6, 5, v8
  v_lshlrev_b32 v9, 3, v9
  v_lshl_add_u32 v9, v7, 4, v9
  v_mov_b32 v17, 450
  v_mov_b32 v18, 0
  v_cmp_le_u32 vcc, 225, v8
  v_subrev_u32 v11, 225, v8
  s_nop 0
  v_cndmask_b32 v11, v8, v11, vcc
  v_cmp_le_u32 s[16:17], v17, v8
  v_add_u32 v10, 0, v9
  v_mul_u32_u24 v12, v11, v10
  v_cvt_f32_u32 v12, v12
  v_mul_f32 v12, 0x3b124925, v12
  v_fract_f32 v12, v12
  v_cos_f32 v13, v12
  v_sin_f32 v14, v12
  s_nop 0
  v_sub_f32 v14, 0, v14
  v_cndmask_b32 v13, v13, v14, vcc
  v_cndmask_b32 v20, v13, v18, s[16:17]
  v_add_u32 v10, 1, v9
  v_mul_u32_u24 v12, v11, v10
  v_cvt_f32_u32 v12, v12
  v_mul_f32 v12, 0x3b124925, v12
  v_fract_f32 v12, v12
  v_cos_f32 v13, v12
  v_sin_f32 v14, v12
  s_nop 0
  v_sub_f32 v14, 0, v14
  v_cndmask_b32 v13, v13, v14, vcc
  v_cndmask_b32 v21, v13, v18, s[16:17]
  v_add_u32 v10, 2, v9
  v_mul_u32_u24 v12, v11, v10
  v_cvt_f32_u32 v12, v12
  v_mul_f32 v12, 0x3b124925, v12
  v_fract_f32 v12, v12
  v_cos_f32 v13, v12
  v_sin_f32 v14, v12
  s_nop 0
  v_sub_f32 v14, 0, v14
  v_cndmask_b32 v13, v13, v14, vcc
  v_cndmask_b32 v22, v13, v18, s[16:17]
  v_add_u32 v10, 3, v9
  v_mul_u32_u24 v12, v11, v10
  v_cvt_f32_u32 v12, v12
  v_mul_f32 v12, 0x3b124925, v12
  v_fract_f32 v12, v12
  v_cos_f32 v13, v12
  v_sin_f32 v14, v12
  s_nop 0
  v_sub_f32 v14, 0, v14
  v_cndmask_b32 v13, v13, v14, vcc
  v_cndmask_b32 v23, v13, v18, s[16:17]
  v_add_u32 v10, 4, v9
  v_mul_u32_u24 v12, v11, v10
  v_cvt_f32_u32 v12, v12
  v_mul_f32 v12, 0x3b124925, v12
  v_fract_f32 v12, v12
  v_cos_f32 v13, v12
  v_sin_f32 v14, v12
  s_nop 0
  v_sub_f32 v14, 0, v14
  v_cndmask_b32 v13, v13, v14, vcc
  v_cndmask_b32 v24, v13, v18, s[16:17]
  v_add_u32 v10, 5, v9
  v_mul_u32_u24 v12, v11, v10
  v_cvt_f32_u32 v12, v12
  v_mul_f32 v12, 0x3b124925, v12
  v_fract_f32 v12, v12
  v_cos_f32 v13, v12
  v_sin_f32 v14, v12
  s_nop 0
  v_sub_f32 v14, 0, v14
  v_cndmask_b32 v13, v13, v14, vcc
  v_cndmask_b32 v25, v13, v18, s[16:17]
  v_add_u32 v10, 6, v9
  v_mul_u32_u24 v12, v11, v10
  v_cvt_f32_u32 v12, v12
  v_mul_f32 v12, 0x3b124925, v12
  v_fract_f32 v12, v12
  v_cos_f32 v13, v12
  v_sin_f32 v14, v12
  s_nop 0
  v_sub_f32 v14, 0, v14
  v_cndmask_b32 v13, v13, v14, vcc
  v_cndmask_b32 v26, v13, v18, s[16:17]
  v_add_u32 v10, 7, v9
  v_mul_u32_u24 v12, v11, v10
  v_cvt_f32_u32 v12, v12
  v_mul_f32 v12, 0x3b124925, v12
  v_fract_f32 v12, v12
  v_cos_f32 v13, v12
  v_sin_f32 v14, v12
  s_nop 0
  v_sub_f32 v14, 0, v14
  v_cndmask_b32 v13, v13, v14, vcc
  v_cndmask_b32 v27, v13, v18, s[16:17]
  v_cvt_pk_bf16_f32 v28, v20, v21
  v_cvt_pk_bf16_f32 v29, v22, v23
  v_cvt_pk_bf16_f32 v30, v24, v25
  v_cvt_pk_bf16_f32 v31, v26, v27
  v_lshlrev_b32 v4, 4, v2
  v_add_u32 v4, 12845056, v4
  global_store_dwordx4 v4, v[28:31], s[4:5]
P_F_done:
  s_mov_b64 exec, s[12:13]
  v_subrev_u32 v3, 26880, v2
  v_cmp_gt_u32 vcc, 15360, v3
  s_and_saveexec_b64 s[12:13], vcc
  s_cbranch_execz P_G_done
  v_and_b32 v4, 63, v3
  v_lshrrev_b32 v5, 6, v3
  s_mov_b32 s14, 286331154
  v_mul_hi_u32 v6, v5, s14
  v_mul_u32_u24 v7, 15, v6
  v_sub_u32 v7, v5, v7
  v_lshrrev_b32 v15, 3, v6
  v_and_b32 v6, 7, v6
  v_and_b32 v8, 31, v4
  v_lshrrev_b32 v9, 5, v4
  v_lshl_add_u32 v8, v6, 5, v8
  v_lshlrev_b32 v9, 3, v9
  v_lshl_add_u32 v9, v7, 4, v9
  v_mov_b32 v16, 224
  v_mov_b32 v18, 0
  v_mov_b32 v19, 0x3b924925
  v_mov_b32 v17, 0x3b124925
  v_cmp_eq_u32 s[34:35], 1, v15
  v_cmp_lt_u32 s[36:37], v16, v8
  v_add_u32 v10, 0, v9
  v_mul_u32_u24 v12, v10, v8
  v_cvt_f32_u32 v12, v12
  v_mul_f32 v12, 0x3b124925, v12
  v_fract_f32 v12, v12
  v_cos_f32 v13, v12
  v_sin_f32 v14, v12
  s_nop 0
  v_cndmask_b32 v13, v13, v14, s[34:35]
  v_cmp_eq_u32 vcc, 0, v10
  v_cmp_eq_u32 s[16:17], v16, v10
  s_or_b64 vcc, vcc, s[16:17]
  s_nop 1
  v_cndmask_b32 v14, v19, v17, vcc
  v_mul_f32 v13, v13, v14
  v_cmp_lt_u32 vcc, v16, v10
  s_or_b64 vcc, vcc, s[36:37]
  s_nop 1
  v_cndmask_b32 v20, v13, v18, vcc
  v_add_u32 v10, 1, v9
  v_mul_u32_u24 v12, v10, v8
  v_cvt_f32_u32 v12, v12
  v_mul_f32 v12, 0x3b124925, v12
  v_fract_f32 v12, v12
  v_cos_f32 v13, v12
  v_sin_f32 v14, v12
  s_nop 0
  v_cndmask_b32 v13, v13, v14, s[34:35]
  v_cmp_eq_u32 vcc, 0, v10
  v_cmp_eq_u32 s[16:17], v16, v10
  s_or_b64 vcc, vcc, s[16:17]
  s_nop 1
  v_cndmask_b32 v14, v19, v17, vcc
  v_mul_f32 v13, v13, v14
  v_cmp_lt_u32 vcc, v16, v10
  s_or_b64 vcc, vcc, s[36:37]
  s_nop 1
  v_cndmask_b32 v21, v13, v18, vcc
  v_add_u32 v10, 2, v9
  v_mul_u32_u24 v12, v10, v8
  v_cvt_f32_u32 v12, v12
  v_mul_f32 v12, 0x3b124925, v12
  v_fract_f32 v12, v12
  v_cos_f32 v13, v12
  v_sin_f32 v14, v12
  s_nop 0
  v_cndmask_b32 v13, v13, v14, s[34:35]
  v_cmp_eq_u32 vcc, 0, v10
  v_cmp_eq_u32 s[16:17], v16, v10
  s_or_b64 vcc, vcc, s[16:17]
  s_nop 1
  v_cndmask_b32 v14, v19, v17, vcc
  v_mul_f32 v13, v13, v14
  v_cmp_lt_u32 vcc, v16, v10
  s_or_b64 vcc, vcc, s[36:37]
  s_nop 1
  v_cndmask_b32 v22, v13, v18, vcc
  v_add_u32 v10, 3, v9
  v_mul_u32_u24 v12, v10, v8
  v_cvt_f32_u32 v12, v12
  v_mul_f32 v12, 0x3b124925, v12
  v_fract_f32 v12, v12
  v_cos_f32 v13, v12
  v_sin_f32 v14, v12
  s_nop 0
  v_cndmask_b32 v13, v13, v14, s[34:35]
  v_cmp_eq_u32 vcc, 0, v10
  v_cmp_eq_u32 s[16:17], v16, v10
  s_or_b64 vcc, vcc, s[16:17]
  s_nop 1
  v_cndmask_b32 v14, v19, v17, vcc
  v_mul_f32 v13, v13, v14
  v_cmp_lt_u32 vcc, v16, v10
  s_or_b64 vcc, vcc, s[36:37]
  s_nop 1
  v_cndmask_b32 v23, v13, v18, vcc
  v_add_u32 v10, 4, v9
  v_mul_u32_u24 v12, v10, v8
  v_cvt_f32_u32 v12, v12
  v_mul_f32 v12, 0x3b124925, v12
  v_fract_f32 v12, v12
  v_cos_f32 v13, v12
  v_sin_f32 v14, v12
  s_nop 0
  v_cndmask_b32 v13, v13, v14, s[34:35]
  v_cmp_eq_u32 vcc, 0, v10
  v_cmp_eq_u32 s[16:17], v16, v10
  s_or_b64 vcc, vcc, s[16:17]
  s_nop 1
  v_cndmask_b32 v14, v19, v17, vcc
  v_mul_f32 v13, v13, v14
  v_cmp_lt_u32 vcc, v16, v10
  s_or_b64 vcc, vcc, s[36:37]
  s_nop 1
  v_cndmask_b32 v24, v13, v18, vcc
  v_add_u32 v10, 5, v9
  v_mul_u32_u24 v12, v10, v8
  v_cvt_f32_u32 v12, v12
  v_mul_f32 v12, 0x3b124925, v12
  v_fract_f32 v12, v12
  v_cos_f32 v13, v12
  v_sin_f32 v14, v12
  s_nop 0
  v_cndmask_b32 v13, v13, v14, s[34:35]
  v_cmp_eq_u32 vcc, 0, v10
  v_cmp_eq_u32 s[16:17], v16, v10
  s_or_b64 vcc, vcc, s[16:17]
  s_nop 1
  v_cndmask_b32 v14, v19, v17, vcc
  v_mul_f32 v13, v13, v14
  v_cmp_lt_u32 vcc, v16, v10
  s_or_b64 vcc, vcc, s[36:37]
  s_nop 1
  v_cndmask_b32 v25, v13, v18, vcc
  v_add_u32 v10, 6, v9
  v_mul_u32_u24 v12, v10, v8
  v_cvt_f32_u32 v12, v12
  v_mul_f32 v12, 0x3b124925, v12
  v_fract_f32 v12, v12
  v_cos_f32 v13, v12
  v_sin_f32 v14, v12
  s_nop 0
  v_cndmask_b32 v13, v13, v14, s[34:35]
  v_cmp_eq_u32 vcc, 0, v10
  v_cmp_eq_u32 s[16:17], v16, v10
  s_or_b64 vcc, vcc, s[16:17]
  s_nop 1
  v_cndmask_b32 v14, v19, v17, vcc
  v_mul_f32 v13, v13, v14
  v_cmp_lt_u32 vcc, v16, v10
  s_or_b64 vcc, vcc, s[36:37]
  s_nop 1
  v_cndmask_b32 v26, v13, v18, vcc
  v_add_u32 v10, 7, v9
  v_mul_u32_u24 v12, v10, v8
  v_cvt_f32_u32 v12, v12
  v_mul_f32 v12, 0x3b124925, v12
  v_fract_f32 v12, v12
  v_cos_f32 v13, v12
  v_sin_f32 v14, v12
  s_nop 0
  v_cndmask_b32 v13, v13, v14, s[34:35]
  v_cmp_eq_u32 vcc, 0, v10
  v_cmp_eq_u32 s[16:17], v16, v10
  s_or_b64 vcc, vcc, s[16:17]
  s_nop 1
  v_cndmask_b32 v14, v19, v17, vcc
  v_mul_f32 v13, v13, v14
  v_cmp_lt_u32 vcc, v16, v10
  s_or_b64 vcc, vcc, s[36:37]
  s_nop 1
  v_cndmask_b32 v27, v13, v18, vcc
  v_cvt_pk_bf16_f32 v28, v20, v21
  v_cvt_pk_bf16_f32 v29, v22, v23
  v_cvt_pk_bf16_f32 v30, v24, v25
  v_cvt_pk_bf16_f32 v31, v26, v27
  v_lshlrev_b32 v4, 4, v3
  v_add_u32 v4, 13275136, v4
  global_store_dwordx4 v4, v[28:31], s[4:5]
P_G_done:
  s_mov_b64 exec, s[12:13]
  v_subrev_u32 v3, 53248, v2
  v_cmp_gt_u32 vcc, 384, v3
  s_and_saveexec_b64 s[12:13], vcc
  s_cbranch_execz P_C32_done
  v_and_b32 v4, 63, v3
  v_lshrrev_b32 v5, 6, v3
  v_and_b32 v8, 31, v4
  v_lshrrev_b32 v9, 5, v4
  v_lshrrev_b32 v6, 1, v5
  v_and_b32 v7, 1, v5
  v_lshlrev_b32 v7, 4, v7
  v_lshl_add_u32 v7, v9, 2, v7
  v_add_u32 v10, 0, v7
  v_mul_u32_u24 v12, v10, v8
  v_cvt_f32_u32 v12, v12
  v_mul_f32 v12, 0x3d000000, v12
  v_fract_f32 v12, v12
  v_cos_f32 v13, v12
  v_sin_f32 v14, v12
  s_nop 0
  v_sub_f32 v15, 0, v14
  v_cmp_eq_u32 vcc, 1, v6
  s_nop 1
  v_cndmask_b32 v13, v13, v15, vcc
  v_cmp_eq_u32 vcc, 2, v6
  s_nop 1
  v_cndmask_b32 v20, v13, v14, vcc
  v_add_u32 v10, 1, v7
  v_mul_u32_u24 v12, v10, v8
  v_cvt_f32_u32 v12, v12
  v_mul_f32 v12, 0x3d000000, v12
  v_fract_f32 v12, v12
  v_cos_f32 v13, v12
  v_sin_f32 v14, v12
  s_nop 0
  v_sub_f32 v15, 0, v14
  v_cmp_eq_u32 vcc, 1, v6
  s_nop 1
  v_cndmask_b32 v13, v13, v15, vcc
  v_cmp_eq_u32 vcc, 2, v6
  s_nop 1
  v_cndmask_b32 v21, v13, v14, vcc
  v_add_u32 v10, 2, v7
  v_mul_u32_u24 v12, v10, v8
  v_cvt_f32_u32 v12, v12
  v_mul_f32 v12, 0x3d000000, v12
  v_fract_f32 v12, v12
  v_cos_f32 v13, v12
  v_sin_f32 v14, v12
  s_nop 0
  v_sub_f32 v15, 0, v14
  v_cmp_eq_u32 vcc, 1, v6
  s_nop 1
  v_cndmask_b32 v13, v13, v15, vcc
  v_cmp_eq_u32 vcc, 2, v6
  s_nop 1
  v_cndmask_b32 v22, v13, v14, vcc
  v_add_u32 v10, 3, v7
  v_mul_u32_u24 v12, v10, v8
  v_cvt_f32_u32 v12, v12
  v_mul_f32 v12, 0x3d000000, v12
  v_fract_f32 v12, v12
  v_cos_f32 v13, v12
  v_sin_f32 v14, v12
  s_nop 0
  v_sub_f32 v15, 0, v14
  v_cmp_eq_u32 vcc, 1, v6
  s_nop 1
  v_cndmask_b32 v13, v13, v15, vcc
  v_cmp_eq_u32 vcc, 2, v6
  s_nop 1
  v_cndmask_b32 v23, v13, v14, vcc
  v_add_u32 v10, 8, v7
  v_mul_u32_u24 v12, v10, v8
  v_cvt_f32_u32 v12, v12
  v_mul_f32 v12, 0x3d000000, v12
  v_fract_f32 v12, v12
  v_cos_f32 v13, v12
  v_sin_f32 v14, v12
  s_nop 0
  v_sub_f32 v15, 0, v14
  v_cmp_eq_u32 vcc, 1, v6
  s_nop 1
  v_cndmask_b32 v13, v13, v15, vcc
  v_cmp_eq_u32 vcc, 2, v6
  s_nop 1
  v_cndmask_b32 v24, v13, v14, vcc
  v_add_u32 v10, 9, v7
  v_mul_u32_u24 v12, v10, v8
  v_cvt_f32_u32 v12, v12
  v_mul_f32 v12, 0x3d000000, v12
  v_fract_f32 v12, v12
  v_cos_f32 v13, v12
  v_sin_f32 v14, v12
  s_nop 0
  v_sub_f32 v15, 0, v14
  v_cmp_eq_u32 vcc, 1, v6
  s_nop 1
  v_cndmask_b32 v13, v13, v15, vcc
  v_cmp_eq_u32 vcc, 2, v6
  s_nop 1
  v_cndmask_b32 v25, v13, v14, vcc
  v_add_u32 v10, 10, v7
  v_mul_u32_u24 v12, v10, v8
  v_cvt_f32_u32 v12, v12
  v_mul_f32 v12, 0x3d000000, v12
  v_fract_f32 v12, v12
  v_cos_f32 v13, v12
  v_sin_f32 v14, v12
  s_nop 0
  v_sub_f32 v15, 0, v14
  v_cmp_eq_u32 vcc, 1, v6
  s_nop 1
  v_cndmask_b32 v13, v13, v15, vcc
  v_cmp_eq_u32 vcc, 2, v6
  s_nop 1
  v_cndmask_b32 v26, v13, v14, vcc
  v_add_u32 v10, 11, v7
  v_mul_u32_u24 v12, v10, v8
  v_cvt_f32_u32 v12, v12
  v_mul_f32 v12, 0x3d000000, v12
  v_fract_f32 v12, v12
  v_cos_f32 v13, v12
  v_sin_f32 v14, v12
  s_nop 0
  v_sub_f32 v15, 0, v14
  v_cmp_eq_u32 vcc, 1, v6
  s_nop 1
  v_cndmask_b32 v13, v13, v15, vcc
  v_cmp_eq_u32 vcc, 2, v6
  s_nop 1
  v_cndmask_b32 v27, v13, v14, vcc
  v_cvt_pk_bf16_f32 v28, v20, v21
  v_cvt_pk_bf16_f32 v29, v22, v23
  v_cvt_pk_bf16_f32 v30, v24, v25
  v_cvt_pk_bf16_f32 v31, v26, v27
  v_lshlrev_b32 v4, 4, v3
  v_add_u32 v4, 13520896, v4
  global_store_dwordx4 v4, v[28:31], s[4:5]
P_C32_done:
  s_mov_b64 exec, s[12:13]
  v_subrev_u32 v3, 53760, v2
  v_cmp_gt_u32 vcc, 1536, v3
  s_and_saveexec_b64 s[12:13], vcc
  s_cbranch_execz P_C64_done
  v_and_b32 v4, 63, v3
  v_lshrrev_b32 v5, 6, v3
  v_and_b32 v8, 31, v4
  v_lshrrev_b32 v9, 5, v4
  v_lshrrev_b32 v6, 3, v5
  v_and_b32 v7, 7, v5
  v_lshrrev_b32 v10, 2, v7
  v_lshl_add_u32 v8, v10, 5, v8
  v_and_b32 v7, 3, v7
  v_lshlrev_b32 v7, 4, v7
  v_lshl_add_u32 v7, v9, 2, v7
  v_add_u32 v10, 0, v7
  v_mul_u32_u24 v12, v10, v8
  v_cvt_f32_u32 v12, v12
  v_mul_f32 v12, 0x3c800000, v12
  v_fract_f32 v12, v12
  v_cos_f32 v13, v12
  v_sin_f32 v14, v12
  s_nop 0
  v_sub_f32 v15, 0, v14
  v_cmp_eq_u32 vcc, 1, v6
  s_nop 1
  v_cndmask_b32 v13, v13, v15, vcc
  v_cmp_eq_u32 vcc, 2, v6
  s_nop 1
  v_cndmask_b32 v20, v13, v14, vcc
  v_add_u32 v10, 1, v7
  v_mul_u32_u24 v12, v10, v8
  v_cvt_f32_u32 v12, v12
  v_mul_f32 v12, 0x3c800000, v12
  v_fract_f32 v12, v12
  v_cos_f32 v13, v12
  v_sin_f32 v14, v12
  s_nop 0
  v_sub_f32 v15, 0, v14
  v_cmp_eq_u32 vcc, 1, v6
  s_nop 1
  v_cndmask_b32 v13, v13, v15, vcc
  v_cmp_eq_u32 vcc, 2, v6
  s_nop 1
  v_cndmask_b32 v21, v13, v14, vcc
  v_add_u32 v10, 2, v7
  v_mul_u32_u24 v12, v10, v8
  v_cvt_f32_u32 v12, v12
  v_mul_f32 v12, 0x3c800000, v12
  v_fract_f32 v12, v12
  v_cos_f32 v13, v12
  v_sin_f32 v14, v12
  s_nop 0
  v_sub_f32 v15, 0, v14
  v_cmp_eq_u32 vcc, 1, v6
  s_nop 1
  v_cndmask_b32 v13, v13, v15, vcc
  v_cmp_eq_u32 vcc, 2, v6
  s_nop 1
  v_cndmask_b32 v22, v13, v14, vcc
  v_add_u32 v10, 3, v7
  v_mul_u32_u24 v12, v10, v8
  v_cvt_f32_u32 v12, v12
  v_mul_f32 v12, 0x3c800000, v12
  v_fract_f32 v12, v12
  v_cos_f32 v13, v12
  v_sin_f32 v14, v12
  s_nop 0
  v_sub_f32 v15, 0, v14
  v_cmp_eq_u32 vcc, 1, v6
  s_nop 1
  v_cndmask_b32 v13, v13, v15, vcc
  v_cmp_eq_u32 vcc, 2, v6
  s_nop 1
  v_cndmask_b32 v23, v13, v14, vcc
  v_add_u32 v10, 8, v7
  v_mul_u32_u24 v12, v10, v8
  v_cvt_f32_u32 v12, v12
  v_mul_f32 v12, 0x3c800000, v12
  v_fract_f32 v12, v12
  v_cos_f32 v13, v12
  v_sin_f32 v14, v12
  s_nop 0
  v_sub_f32 v15, 0, v14
  v_cmp_eq_u32 vcc, 1, v6
  s_nop 1
  v_cndmask_b32 v13, v13, v15, vcc
  v_cmp_eq_u32 vcc, 2, v6
  s_nop 1
  v_cndmask_b32 v24, v13, v14, vcc
  v_add_u32 v10, 9, v7
  v_mul_u32_u24 v12, v10, v8
  v_cvt_f32_u32 v12, v12
  v_mul_f32 v12, 0x3c800000, v12
  v_fract_f32 v12, v12
  v_cos_f32 v13, v12
  v_sin_f32 v14, v12
  s_nop 0
  v_sub_f32 v15, 0, v14
  v_cmp_eq_u32 vcc, 1, v6
  s_nop 1
  v_cndmask_b32 v13, v13, v15, vcc
  v_cmp_eq_u32 vcc, 2, v6
  s_nop 1
  v_cndmask_b32 v25, v13, v14, vcc
  v_add_u32 v10, 10, v7
  v_mul_u32_u24 v12, v10, v8
  v_cvt_f32_u32 v12, v12
  v_mul_f32 v12, 0x3c800000, v12
  v_fract_f32 v12, v12
  v_cos_f32 v13, v12
  v_sin_f32 v14, v12
  s_nop 0
  v_sub_f32 v15, 0, v14
  v_cmp_eq_u32 vcc, 1, v6
  s_nop 1
  v_cndmask_b32 v13, v13, v15, vcc
  v_cmp_eq_u32 vcc, 2, v6
  s_nop 1
  v_cndmask_b32 v26, v13, v14, vcc
  v_add_u32 v10, 11, v7
  v_mul_u32_u24 v12, v10, v8
  v_cvt_f32_u32 v12, v12
  v_mul_f32 v12, 0x3c800000, v12
  v_fract_f32 v12, v12
  v_cos_f32 v13, v12
  v_sin_f32 v14, v12
  s_nop 0
  v_sub_f32 v15, 0, v14
  v_cmp_eq_u32 vcc, 1, v6
  s_nop 1
  v_cndmask_b32 v13, v13, v15, vcc
  v_cmp_eq_u32 vcc, 2, v6
  s_nop 1
  v_cndmask_b32 v27, v13, v14, vcc
  v_cvt_pk_bf16_f32 v28, v20, v21
  v_cvt_pk_bf16_f32 v29, v22, v23
  v_cvt_pk_bf16_f32 v30, v24, v25
  v_cvt_pk_bf16_f32 v31, v26, v27
  v_lshlrev_b32 v4, 4, v3
  v_add_u32 v4, 13529088, v4
  global_store_dwordx4 v4, v[28:31], s[4:5]
P_C64_done:
  s_mov_b64 exec, s[12:13]
  v_subrev_u32 v3, 55296, v2
  v_cmp_gt_u32 vcc, 1024, v3
  s_and_saveexec_b64 s[12:13], vcc
  s_cbranch_execz P_T1_done
  v_and_b32 v4, 63, v3
  v_lshrrev_b32 v5, 6, v3
  v_lshrrev_b32 v6, 3, v5
  v_and_b32 v7, 3, v5
  v_lshrrev_b32 v10, 2, v5
  v_and_b32 v10, 1, v10
  v_and_b32 v8, 31, v4
  v_lshrrev_b32 v9, 5, v4
  v_lshlrev_b32 v7, 3, v7
  v_lshl_add_u32 v7, v9, 2, v7
  v_lshl_add_u32 v7, v10, 5, v7
  v_add_u32 v11, 0, v7
  v_mul_u32_u24 v12, v11, v8
  v_cvt_f32_u32 v12, v12
  v_mul_f32 v12, 0x3a000000, v12
  v_fract_f32 v12, v12
  v_cos_f32 v13, v12
  v_sin_f32 v14, v12
  s_nop 0
  v_sub_f32 v14, 0, v14
  v_cmp_eq_u32 vcc, 1, v6
  s_nop 1
  v_cndmask_b32 v20, v13, v14, vcc
  v_add_u32 v11, 1, v7
  v_mul_u32_u24 v12, v11, v8
  v_cvt_f32_u32 v12, v12
  v_mul_f32 v12, 0x3a000000, v12
  v_fract_f32 v12, v12
  v_cos_f32 v13, v12
  v_sin_f32 v14, v12
  s_nop 0
  v_sub_f32 v14, 0, v14
  v_cmp_eq_u32 vcc, 1, v6
  s_nop 1
  v_cndmask_b32 v21, v13, v14, vcc
  v_add_u32 v11, 2, v7
  v_mul_u32_u24 v12, v11, v8
  v_cvt_f32_u32 v12, v12
  v_mul_f32 v12, 0x3a000000, v12
  v_fract_f32 v12, v12
  v_cos_f32 v13, v12
  v_sin_f32 v14, v12
  s_nop 0
  v_sub_f32 v14, 0, v14
  v_cmp_eq_u32 vcc, 1, v6
  s_nop 1
  v_cndmask_b32 v22, v13, v14, vcc
  v_add_u32 v11, 3, v7
  v_mul_u32_u24 v12, v11, v8
  v_cvt_f32_u32 v12, v12
  v_mul_f32 v12, 0x3a000000, v12
  v_fract_f32 v12, v12
  v_cos_f32 v13, v12
  v_sin_f32 v14, v12
  s_nop 0
  v_sub_f32 v14, 0, v14
  v_cmp_eq_u32 vcc, 1, v6
  s_nop 1
  v_cndmask_b32 v23, v13, v14, vcc
  v_lshlrev_b32 v4, 4, v3
  v_add_u32 v4, 13553664, v4
  global_store_dwordx4 v4, v[20:23], s[4:5]
P_T1_done:
  s_mov_b64 exec, s[12:13]
  v_subrev_u32 v3, 56320, v2
  v_cmp_gt_u32 vcc, 1024, v3
  s_and_saveexec_b64 s[12:13], vcc
  s_cbranch_execz P_T2_done
  v_and_b32 v4, 63, v3
  v_lshrrev_b32 v5, 6, v3
  v_lshrrev_b32 v6, 3, v5
  v_and_b32 v7, 3, v5
  v_lshrrev_b32 v10, 2, v5
  v_and_b32 v10, 1, v10
  v_and_b32 v8, 31, v4
  v_lshrrev_b32 v9, 5, v4
  v_lshlrev_b32 v7, 3, v7
  v_lshl_add_u32 v7, v9, 2, v7
  v_lshl_add_u32 v8, v10, 5, v8
  v_add_u32 v11, 0, v7
  v_mul_u32_u24 v12, v11, v8
  v_cvt_f32_u32 v12, v12
  v_mul_f32 v12, 0x3a000000, v12
  v_fract_f32 v12, v12
  v_cos_f32 v13, v12
  v_sin_f32 v14, v12
  s_nop 0
  v_cmp_eq_u32 vcc, 1, v6
  s_nop 1
  v_cndmask_b32 v20, v13, v14, vcc
  v_mul_f32 v20, 0x3a000000, v20
  v_add_u32 v11, 1, v7
  v_mul_u32_u24 v12, v11, v8
  v_cvt_f32_u32 v12, v12
  v_mul_f32 v12, 0x3a000000, v12
  v_fract_f32 v12, v12
  v_cos_f32 v13, v12
  v_sin_f32 v14, v12
  s_nop 0
  v_cmp_eq_u32 vcc, 1, v6
  s_nop 1
  v_cndmask_b32 v21, v13, v14, vcc
  v_mul_f32 v21, 0x3a000000, v21
  v_add_u32 v11, 2, v7
  v_mul_u32_u24 v12, v11, v8
  v_cvt_f32_u32 v12, v12
  v_mul_f32 v12, 0x3a000000, v12
  v_fract_f32 v12, v12
  v_cos_f32 v13, v12
  v_sin_f32 v14, v12
  s_nop 0
  v_cmp_eq_u32 vcc, 1, v6
  s_nop 1
  v_cndmask_b32 v22, v13, v14, vcc
  v_mul_f32 v22, 0x3a000000, v22
  v_add_u32 v11, 3, v7
  v_mul_u32_u24 v12, v11, v8
  v_cvt_f32_u32 v12, v12
  v_mul_f32 v12, 0x3a000000, v12
  v_fract_f32 v12, v12
  v_cos_f32 v13, v12
  v_sin_f32 v14, v12
  s_nop 0
  v_cmp_eq_u32 vcc, 1, v6
  s_nop 1
  v_cndmask_b32 v23, v13, v14, vcc
  v_mul_f32 v23, 0x3a000000, v23
  v_lshlrev_b32 v4, 4, v3
  v_add_u32 v4, 13570048, v4
  global_store_dwordx4 v4, v[20:23], s[4:5]
P_T2_done:
  s_mov_b64 exec, s[12:13]
  s_waitcnt vmcnt(0)
P_end:
  s_endpgm
.section .rodata,"a"
.p2align 6
.amdhsa_kernel prep_kernel
  .amdhsa_next_free_vgpr 48
  .amdhsa_next_free_sgpr 102
  .amdhsa_accum_offset 48
  .amdhsa_group_segment_fixed_size 0
  .amdhsa_kernarg_size 104
  .amdhsa_user_sgpr_count 2
  .amdhsa_user_sgpr_kernarg_segment_ptr 1
  .amdhsa_system_sgpr_workgroup_id_x 1
.end_amdhsa_kernel
.text

.globl fa0_kernel
.p2align 8
.type fa0_kernel,@function
fa0_kernel:
  s_mov_b32 s60, 0
  s_cmp_lt_u32 s2, 256
  s_cbranch_scc1 fa_body
  s_cmp_ge_u32 s2, 480
  s_cbranch_scc1 fa_end
  s_load_dwordx2 s[4:5], s[0:1], 96
  v_and_b32 v1, 63, v0
  v_lshrrev_b32 v2, 6, v0
  s_nop 1
  v_readfirstlane_b32 s3, v2
  s_nop 3
  s_sub_u32 s40, s2, 256
  s_waitcnt lgkmcnt(0)
  s_and_b32 s14, s40, 7
  s_lshr_b32 s15, s40, 3
  s_mul_hi_u32 s16, s15, 0x24924925
  s_mul_i32 s13, s16, 7
  s_sub_u32 s13, s15, s13
  s_lshl_b32 s14, s14, 2
  s_add_u32 s14, s14, s16
  s_lshr_b32 s10, s14, 4
  s_and_b32 s12, s14, 15
  s_cmp_eq_u32 s10, 0
  s_cselect_b32 s14, 40, 56
  s_cselect_b32 s15, 48, 64
  s_add_u32 s16, s0, s14
  s_addc_u32 s17, s1, 0
  s_add_u32 s18, s0, s15
  s_addc_u32 s19, s1, 0
  s_load_dwordx2 s[6:7], s[16:17], 0
  s_load_dwordx2 s[8:9], s[18:19], 0
  s_lshl_b32 s24, s3, 3
  v_lshrrev_b32 v3, 5, v1
  v_add_u32 v3, s24, v3
  v_add_u32 v3, 0, v3
  v_and_b32 v4, 3, v3
  v_lshlrev_b32 v4, 1, v4
  v_lshrrev_b32 v5, 3, v3
  v_and_b32 v5, 1, v5
  v_lshl_or_b32 v4, v5, 3, v4
  v_and_b32 v5, 31, v1
  v_xor_b32 v4, v4, v5
  v_lshlrev_b32 v4, 4, v4
  v_lshl_add_u32 v48, v3, 13, v4
  v_lshrrev_b32 v3, 5, v1
  v_add_u32 v3, s24, v3
  v_add_u32 v3, 2, v3
  v_and_b32 v4, 3, v3
  v_lshlrev_b32 v4, 1, v4
  v_lshrrev_b32 v5, 3, v3
  v_and_b32 v5, 1, v5
  v_lshl_or_b32 v4, v5, 3, v4
  v_and_b32 v5, 31, v1
  v_xor_b32 v4, v4, v5
  v_lshlrev_b32 v4, 4, v4
  v_lshl_add_u32 v49, v3, 13, v4
  v_lshrrev_b32 v3, 5, v1
  v_add_u32 v3, s24, v3
  v_add_u32 v3, 4, v3
  v_and_b32 v4, 3, v3
  v_lshlrev_b32 v4, 1, v4
  v_lshrrev_b32 v5, 3, v3
  v_and_b32 v5, 1, v5
  v_lshl_or_b32 v4, v5, 3, v4
  v_and_b32 v5, 31, v1
  v_xor_b32 v4, v4, v5
  v_lshlrev_b32 v4, 4, v4
  v_lshl_add_u32 v50, v3, 13, v4
  v_lshrrev_b32 v3, 5, v1
  v_add_u32 v3, s24, v3
  v_add_u32 v3, 6, v3
  v_and_b32 v4, 3, v3
  v_lshlrev_b32 v4, 1, v4
  v_lshrrev_b32 v5, 3, v3
  v_and_b32 v5, 1, v5
  v_lshl_or_b32 v4, v5, 3, v4
  v_and_b32 v5, 31, v1
  v_xor_b32 v4, v4, v5
  v_lshlrev_b32 v4, 4, v4
  v_lshl_add_u32 v51, v3, 13, v4
  s_lshl_b32 s24, s3, 12
  s_add_u32 s20, s24, 0
  s_add_u32 s21, s24, 1024
  s_add_u32 s22, s24, 2048
  s_add_u32 s23, s24, 3072
  s_waitcnt lgkmcnt(0)
  s_lshl_b32 s14, s12, 9
  s_add_u32 s6, s6, s14
  s_addc_u32 s7, s7, 0
  s_lshl_b32 s26, s13, 1
  s_mov_b32 s27, s26
  s_cmp_eq_u32 s10, 0
  s_cbranch_scc0 F_bdmaB
  v_lshrrev_b32 v3, 5, v1
  s_lshl_b32 s28, s3, 4
  v_add_u32 v3, s28, v3
  s_lshl_b32 s29, s13, 6
  v_add_u32 v6, 0, v3
  v_and_b32 v4, 3, v6
  v_lshlrev_b32 v4, 1, v4
  v_lshrrev_b32 v5, 2, v6
  v_and_b32 v5, 1, v5
  v_lshl_or_b32 v4, v5, 3, v4
  v_and_b32 v5, 31, v1
  v_xor_b32 v4, v4, v5
  v_lshlrev_b32 v4, 4, v4
  v_add_u32 v6, s29, v6
  v_lshl_add_u32 v6, v6, 13, v4
  v_add_u32 v6, s14, v6
  s_lshl_b32 s30, s3, 13
  s_add_u32 m0, s30, 32768
  s_nop 0
  global_load_lds_dwordx4 v6, s[8:9]
  v_add_u32 v6, 2, v3
  v_and_b32 v4, 3, v6
  v_lshlrev_b32 v4, 1, v4
  v_lshrrev_b32 v5, 2, v6
  v_and_b32 v5, 1, v5
  v_lshl_or_b32 v4, v5, 3, v4
  v_and_b32 v5, 31, v1
  v_xor_b32 v4, v4, v5
  v_lshlrev_b32 v4, 4, v4
  v_add_u32 v6, s29, v6
  v_lshl_add_u32 v6, v6, 13, v4
  v_add_u32 v6, s14, v6
  s_lshl_b32 s30, s3, 13
  s_add_u32 m0, s30, 33792
  s_nop 0
  global_load_lds_dwordx4 v6, s[8:9]
  v_add_u32 v6, 4, v3
  v_and_b32 v4, 3, v6
  v_lshlrev_b32 v4, 1, v4
  v_lshrrev_b32 v5, 2, v6
  v_and_b32 v5, 1, v5
  v_lshl_or_b32 v4, v5, 3, v4
  v_and_b32 v5, 31, v1
  v_xor_b32 v4, v4, v5
  v_lshlrev_b32 v4, 4, v4
  v_add_u32 v6, s29, v6
  v_lshl_add_u32 v6, v6, 13, v4
  v_add_u32 v6, s14, v6
  s_lshl_b32 s30, s3, 13
  s_add_u32 m0, s30, 34816
  s_nop 0
  global_load_lds_dwordx4 v6, s[8:9]
  v_add_u32 v6, 6, v3
  v_and_b32 v4, 3, v6
  v_lshlrev_b32 v4, 1, v4
  v_lshrrev_b32 v5, 2, v6
  v_and_b32 v5, 1, v5
  v_lshl_or_b32 v4, v5, 3, v4
  v_and_b32 v5, 31, v1
  v_xor_b32 v4, v4, v5
  v_lshlrev_b32 v4, 4, v4
  v_add_u32 v6, s29, v6
  v_lshl_add_u32 v6, v6, 13, v4
  v_add_u32 v6, s14, v6
  s_lshl_b32 s30, s3, 13
  s_add_u32 m0, s30, 35840
  s_nop 0
  global_load_lds_dwordx4 v6, s[8:9]
  v_add_u32 v6, 8, v3
  v_and_b32 v4, 3, v6
  v_lshlrev_b32 v4, 1, v4
  v_lshrrev_b32 v5, 2, v6
  v_and_b32 v5, 1, v5
  v_lshl_or_b32 v4, v5, 3, v4
  v_and_b32 v5, 31, v1
  v_xor_b32 v4, v4, v5
  v_lshlrev_b32 v4, 4, v4
  v_add_u32 v6, s29, v6
  v_lshl_add_u32 v6, v6, 13, v4
  v_add_u32 v6, s14, v6
  s_lshl_b32 s30, s3, 13
  s_add_u32 m0, s30, 36864
  s_nop 0
  global_load_lds_dwordx4 v6, s[8:9]
  v_add_u32 v6, 10, v3
  v_and_b32 v4, 3, v6
  v_lshlrev_b32 v4, 1, v4
  v_lshrrev_b32 v5, 2, v6
  v_and_b32 v5, 1, v5
  v_lshl_or_b32 v4, v5, 3, v4
  v_and_b32 v5, 31, v1
  v_xor_b32 v4, v4, v5
  v_lshlrev_b32 v4, 4, v4
  v_add_u32 v6, s29, v6
  v_lshl_add_u32 v6, v6, 13, v4
  v_add_u32 v6, s14, v6
  s_lshl_b32 s30, s3, 13
  s_add_u32 m0, s30, 37888
  s_nop 0
  global_load_lds_dwordx4 v6, s[8:9]
  v_add_u32 v6, 12, v3
  v_and_b32 v4, 3, v6
  v_lshlrev_b32 v4, 1, v4
  v_lshrrev_b32 v5, 2, v6
  v_and_b32 v5, 1, v5
  v_lshl_or_b32 v4, v5, 3, v4
  v_and_b32 v5, 31, v1
  v_xor_b32 v4, v4, v5
  v_lshlrev_b32 v4, 4, v4
  v_add_u32 v6, s29, v6
  v_lshl_add_u32 v6, v6, 13, v4
  v_add_u32 v6, s14, v6
  s_lshl_b32 s30, s3, 13
  s_add_u32 m0, s30, 38912
  s_nop 0
  global_load_lds_dwordx4 v6, s[8:9]
  v_add_u32 v6, 14, v3
  v_and_b32 v4, 3, v6
  v_lshlrev_b32 v4, 1, v4
  v_lshrrev_b32 v5, 2, v6
  v_and_b32 v5, 1, v5
  v_lshl_or_b32 v4, v5, 3, v4
  v_and_b32 v5, 31, v1
  v_xor_b32 v4, v4, v5
  v_lshlrev_b32 v4, 4, v4
  v_add_u32 v6, s29, v6
  v_lshl_add_u32 v6, v6, 13, v4
  v_add_u32 v6, s14, v6
  s_lshl_b32 s30, s3, 13
  s_add_u32 m0, s30, 39936
  s_nop 0
  global_load_lds_dwordx4 v6, s[8:9]
  s_branch F_bdmad
F_bdmaB:
  s_mul_i32 s29, s12, 229376
  s_lshl_b32 s28, s13, 7
  s_add_u32 s29, s29, s28
  v_lshrrev_b32 v3, 3, v1
  v_mul_u32_u24 v3, 896, v3
  v_and_b32 v4, 7, v1
  v_lshl_add_u32 v3, v4, 4, v3
  v_add_u32 v3, s29, v3
  s_mul_i32 s28, s3, 57344
  v_add_u32 v3, s28, v3
  s_lshl_b32 s29, s3, 13
  s_add_u32 s29, s29, 32768
  s_add_u32 m0, s29, 0
  s_nop 0
  global_load_lds_dwordx4 v3, s[8:9]
  v_add_u32 v3, 7168, v3
  s_add_u32 m0, s29, 1024
  s_nop 0
  global_load_lds_dwordx4 v3, s[8:9]
  v_add_u32 v3, 7168, v3
  s_add_u32 m0, s29, 2048
  s_nop 0
  global_load_lds_dwordx4 v3, s[8:9]
  v_add_u32 v3, 7168, v3
  s_add_u32 m0, s29, 3072
  s_nop 0
  global_load_lds_dwordx4 v3, s[8:9]
  v_add_u32 v3, 7168, v3
  s_add_u32 m0, s29, 4096
  s_nop 0
  global_load_lds_dwordx4 v3, s[8:9]
  v_add_u32 v3, 7168, v3
  s_add_u32 m0, s29, 5120
  s_nop 0
  global_load_lds_dwordx4 v3, s[8:9]
  v_add_u32 v3, 7168, v3
  s_add_u32 m0, s29, 6144
  s_nop 0
  global_load_lds_dwordx4 v3, s[8:9]
  v_add_u32 v3, 7168, v3
  s_add_u32 m0, s29, 7168
  s_nop 0
  global_load_lds_dwordx4 v3, s[8:9]
  v_add_u32 v3, 7168, v3
F_bdmad:
  s_lshl_b32 s28, s26, 18
  s_add_u32 m0, s20, 0
  v_add_u32 v2, s28, v48
  global_load_lds_dwordx4 v2, s[6:7]
  s_add_u32 m0, s21, 0
  v_add_u32 v2, s28, v49
  global_load_lds_dwordx4 v2, s[6:7]
  s_add_u32 m0, s22, 0
  v_add_u32 v2, s28, v50
  global_load_lds_dwordx4 v2, s[6:7]
  s_add_u32 m0, s23, 0
  v_add_u32 v2, s28, v51
  global_load_lds_dwordx4 v2, s[6:7]
  s_add_u32 s26, s26, 1
  s_cmp_eq_u32 s26, 14
  s_cselect_b32 s26, 0, s26
  s_lshl_b32 s28, s26, 18
  s_add_u32 m0, s20, 16384
  v_add_u32 v2, s28, v48
  global_load_lds_dwordx4 v2, s[6:7]
  s_add_u32 m0, s21, 16384
  v_add_u32 v2, s28, v49
  global_load_lds_dwordx4 v2, s[6:7]
  s_add_u32 m0, s22, 16384
  v_add_u32 v2, s28, v50
  global_load_lds_dwordx4 v2, s[6:7]
  s_add_u32 m0, s23, 16384
  v_add_u32 v2, s28, v51
  global_load_lds_dwordx4 v2, s[6:7]
  s_add_u32 s26, s26, 1
  s_cmp_eq_u32 s26, 14
  s_cselect_b32 s26, 0, s26
  s_waitcnt vmcnt(8)
  s_barrier
  s_lshr_b32 s29, s3, 1
  s_cmp_eq_u32 s10, 0
  s_cbranch_scc0 F_bopB
  v_and_b32 v3, 15, v1
  v_lshrrev_b32 v4, 4, v1
  v_and_b32 v5, 3, v3
  v_lshlrev_b32 v9, 1, v5
  v_lshrrev_b32 v5, 2, v3
  v_and_b32 v5, 1, v5
  v_lshl_or_b32 v9, v5, 3, v9
  s_lshl_b32 s28, s29, 14
  s_add_u32 s28, s28, 32768
  v_add_u32 v11, 0, v4
  v_xor_b32 v11, v11, v9
  v_lshlrev_b32 v11, 4, v11
  v_lshl_add_u32 v11, v3, 9, v11
  v_add_u32 v11, s28, v11
  ds_read_b128 v[64:67], v11 offset:0
  ds_read_b128 v[96:99], v11 offset:8192
  v_add_u32 v11, 4, v4
  v_xor_b32 v11, v11, v9
  v_lshlrev_b32 v11, 4, v11
  v_lshl_add_u32 v11, v3, 9, v11
  v_add_u32 v11, s28, v11
  ds_read_b128 v[68:71], v11 offset:0
  ds_read_b128 v[100:103], v11 offset:8192
  v_add_u32 v11, 8, v4
  v_xor_b32 v11, v11, v9
  v_lshlrev_b32 v11, 4, v11
  v_lshl_add_u32 v11, v3, 9, v11
  v_add_u32 v11, s28, v11
  ds_read_b128 v[72:75], v11 offset:0
  ds_read_b128 v[104:107], v11 offset:8192
  v_add_u32 v11, 12, v4
  v_xor_b32 v11, v11, v9
  v_lshlrev_b32 v11, 4, v11
  v_lshl_add_u32 v11, v3, 9, v11
  v_add_u32 v11, s28, v11
  ds_read_b128 v[76:79], v11 offset:0
  ds_read_b128 v[108:111], v11 offset:8192
  v_add_u32 v11, 16, v4
  v_xor_b32 v11, v11, v9
  v_lshlrev_b32 v11, 4, v11
  v_lshl_add_u32 v11, v3, 9, v11
  v_add_u32 v11, s28, v11
  ds_read_b128 v[80:83], v11 offset:0
  ds_read_b128 v[112:115], v11 offset:8192
  v_add_u32 v11, 20, v4
  v_xor_b32 v11, v11, v9
  v_lshlrev_b32 v11, 4, v11
  v_lshl_add_u32 v11, v3, 9, v11
  v_add_u32 v11, s28, v11
  ds_read_b128 v[84:87], v11 offset:0
  ds_read_b128 v[116:119], v11 offset:8192
  v_add_u32 v11, 24, v4
  v_xor_b32 v11, v11, v9
  v_lshlrev_b32 v11, 4, v11
  v_lshl_add_u32 v11, v3, 9, v11
  v_add_u32 v11, s28, v11
  ds_read_b128 v[88:91], v11 offset:0
  ds_read_b128 v[120:123], v11 offset:8192
  v_add_u32 v11, 28, v4
  v_xor_b32 v11, v11, v9
  v_lshlrev_b32 v11, 4, v11
  v_lshl_add_u32 v11, v3, 9, v11
  v_add_u32 v11, s28, v11
  ds_read_b128 v[92:95], v11 offset:0
  ds_read_b128 v[124:127], v11 offset:8192
  s_branch F_bopd
F_bopB:
  v_lshrrev_b32 v3, 4, v1
  v_lshlrev_b32 v3, 3, v3
  v_and_b32 v4, 15, v1
  v_lshrrev_b32 v5, 2, v4
  v_add_u32 v3, v3, v5
  v_lshlrev_b32 v3, 7, v3
  v_and_b32 v4, 3, v4
  v_lshl_add_u32 v3, v4, 3, v3
  s_lshl_b32 s28, s29, 6
  v_add_u32 v3, s28, v3
  v_add_u32 v3, 32768, v3
  ds_read_b64_tr_b16 v[64:65], v3 offset:0
  ds_read_b64_tr_b16 v[66:67], v3 offset:512
  ds_read_b64_tr_b16 v[68:69], v3 offset:4096
  ds_read_b64_tr_b16 v[70:71], v3 offset:4608
  ds_read_b64_tr_b16 v[72:73], v3 offset:8192
  ds_read_b64_tr_b16 v[74:75], v3 offset:8704
  ds_read_b64_tr_b16 v[76:77], v3 offset:12288
  ds_read_b64_tr_b16 v[78:79], v3 offset:12800
  ds_read_b64_tr_b16 v[80:81], v3 offset:16384
  ds_read_b64_tr_b16 v[82:83], v3 offset:16896
  ds_read_b64_tr_b16 v[84:85], v3 offset:20480
  ds_read_b64_tr_b16 v[86:87], v3 offset:20992
  ds_read_b64_tr_b16 v[88:89], v3 offset:24576
  ds_read_b64_tr_b16 v[90:91], v3 offset:25088
  ds_read_b64_tr_b16 v[92:93], v3 offset:28672
  ds_read_b64_tr_b16 v[94:95], v3 offset:29184
  s_waitcnt lgkmcnt(0)
  ds_read_b64_tr_b16 v[96:97], v3 offset:32
  ds_read_b64_tr_b16 v[98:99], v3 offset:544
  ds_read_b64_tr_b16 v[100:101], v3 offset:4128
  ds_read_b64_tr_b16 v[102:103], v3 offset:4640
  ds_read_b64_tr_b16 v[104:105], v3 offset:8224
  ds_read_b64_tr_b16 v[106:107], v3 offset:8736
  ds_read_b64_tr_b16 v[108:109], v3 offset:12320
  ds_read_b64_tr_b16 v[110:111], v3 offset:12832
  ds_read_b64_tr_b16 v[112:113], v3 offset:16416
  ds_read_b64_tr_b16 v[114:115], v3 offset:16928
  ds_read_b64_tr_b16 v[116:117], v3 offset:20512
  ds_read_b64_tr_b16 v[118:119], v3 offset:21024
  ds_read_b64_tr_b16 v[120:121], v3 offset:24608
  ds_read_b64_tr_b16 v[122:123], v3 offset:25120
  ds_read_b64_tr_b16 v[124:125], v3 offset:28704
  ds_read_b64_tr_b16 v[126:127], v3 offset:29216
  s_waitcnt lgkmcnt(0)
F_bopd:
  v_and_b32 v3, 15, v1
  v_lshrrev_b32 v4, 2, v3
  v_and_b32 v5, 3, v3
  v_lshl_add_u32 v8, v4, 3, v5
  v_lshlrev_b32 v9, 1, v5
  v_and_b32 v10, 1, v4
  v_lshl_or_b32 v9, v10, 3, v9
  v_lshrrev_b32 v10, 4, v1
  v_add_u32 v11, 0, v10
  v_xor_b32 v11, v11, v9
  v_lshlrev_b32 v11, 4, v11
  v_lshl_add_u32 v52, v8, 9, v11
  v_add_u32 v11, 4, v10
  v_xor_b32 v11, v11, v9
  v_lshlrev_b32 v11, 4, v11
  v_lshl_add_u32 v53, v8, 9, v11
  v_add_u32 v11, 8, v10
  v_xor_b32 v11, v11, v9
  v_lshlrev_b32 v11, 4, v11
  v_lshl_add_u32 v54, v8, 9, v11
  v_add_u32 v11, 12, v10
  v_xor_b32 v11, v11, v9
  v_lshlrev_b32 v11, 4, v11
  v_lshl_add_u32 v55, v8, 9, v11
  v_add_u32 v11, 16, v10
  v_xor_b32 v11, v11, v9
  v_lshlrev_b32 v11, 4, v11
  v_lshl_add_u32 v56, v8, 9, v11
  v_add_u32 v11, 20, v10
  v_xor_b32 v11, v11, v9
  v_lshlrev_b32 v11, 4, v11
  v_lshl_add_u32 v57, v8, 9, v11
  v_add_u32 v11, 24, v10
  v_xor_b32 v11, v11, v9
  v_lshlrev_b32 v11, 4, v11
  v_lshl_add_u32 v58, v8, 9, v11
  v_add_u32 v11, 28, v10
  v_xor_b32 v11, v11, v9
  v_lshlrev_b32 v11, 4, v11
  v_lshl_add_u32 v59, v8, 9, v11
  s_mul_i32 s28, s10, 6422528
  s_mul_i32 s30, s12, 401408
  s_add_u32 s28, s28, s30
  s_lshl_b32 s30, s13, 2
  s_lshl_b32 s31, s29, 1
  s_add_u32 s30, s30, s31
  s_mul_i32 s30, s30, 14336
  s_add_u32 s28, s28, s30
  s_add_u32 s28, s28, 0
  v_lshl_add_u32 v7, v1, 4, s28
  s_cmp_eq_u32 s10, 0
  s_cselect_b32 s30, 1035512379, 1.0
  s_and_b32 s29, s3, 1
  s_waitcnt lgkmcnt(0)
  s_lshl_b32 s25, s29, 14
  v_add_u32 v52, s25, v52
  v_add_u32 v53, s25, v53
  v_add_u32 v54, s25, v54
  v_add_u32 v55, s25, v55
  v_add_u32 v56, s25, v56
  v_add_u32 v57, s25, v57
  v_add_u32 v58, s25, v58
  v_add_u32 v59, s25, v59
  s_add_u32 s27, s27, s29
  s_waitcnt vmcnt(0)
  s_barrier
  ds_read_b128 v[128:131], v52 offset:0
  ds_read_b128 v[132:135], v53 offset:0
  ds_read_b128 v[136:139], v54 offset:0
  ds_read_b128 v[140:143], v55 offset:0
  ds_read_b128 v[144:147], v56 offset:0
  ds_read_b128 v[148:151], v57 offset:0
  ds_read_b128 v[152:155], v58 offset:0
  ds_read_b128 v[156:159], v59 offset:0
  ds_read_b128 v[160:163], v52 offset:2048
  ds_read_b128 v[164:167], v53 offset:2048
  ds_read_b128 v[168:171], v54 offset:2048
  ds_read_b128 v[172:175], v55 offset:2048
  ds_read_b128 v[176:179], v56 offset:2048
  ds_read_b128 v[180:183], v57 offset:2048
  ds_read_b128 v[184:187], v58 offset:2048
  ds_read_b128 v[188:191], v59 offset:2048
  s_waitcnt lgkmcnt(15)
  v_mfma_f32_16x16x32_bf16 v[192:195], v[128:131], v[64:67], 0
  s_lshl_b32 s28, s26, 18
  v_mfma_f32_16x16x32_bf16 v[200:203], v[128:131], v[96:99], 0
  s_add_u32 m0, s20, 32768
  s_waitcnt lgkmcnt(14)
  v_mfma_f32_16x16x32_bf16 v[192:195], v[132:135], v[68:71], v[192:195]
  v_add_u32 v2, s28, v48
  v_mfma_f32_16x16x32_bf16 v[200:203], v[132:135], v[100:103], v[200:203]
  global_load_lds_dwordx4 v2, s[6:7]
  s_waitcnt lgkmcnt(13)
  v_mfma_f32_16x16x32_bf16 v[192:195], v[136:139], v[72:75], v[192:195]
  s_add_u32 m0, s21, 32768
  v_mfma_f32_16x16x32_bf16 v[200:203], v[136:139], v[104:107], v[200:203]
  v_add_u32 v2, s28, v49
  s_waitcnt lgkmcnt(12)
  v_mfma_f32_16x16x32_bf16 v[192:195], v[140:143], v[76:79], v[192:195]
  global_load_lds_dwordx4 v2, s[6:7]
  v_mfma_f32_16x16x32_bf16 v[200:203], v[140:143], v[108:111], v[200:203]
  s_add_u32 m0, s22, 32768
  s_waitcnt lgkmcnt(11)
  v_mfma_f32_16x16x32_bf16 v[192:195], v[144:147], v[80:83], v[192:195]
  v_add_u32 v2, s28, v50
  v_mfma_f32_16x16x32_bf16 v[200:203], v[144:147], v[112:115], v[200:203]
  global_load_lds_dwordx4 v2, s[6:7]
  s_waitcnt lgkmcnt(10)
  v_mfma_f32_16x16x32_bf16 v[192:195], v[148:151], v[84:87], v[192:195]
  s_add_u32 m0, s23, 32768
  v_mfma_f32_16x16x32_bf16 v[200:203], v[148:151], v[116:119], v[200:203]
  v_add_u32 v2, s28, v51
  s_waitcnt lgkmcnt(9)
  v_mfma_f32_16x16x32_bf16 v[192:195], v[152:155], v[88:91], v[192:195]
  global_load_lds_dwordx4 v2, s[6:7]
  v_mfma_f32_16x16x32_bf16 v[200:203], v[152:155], v[120:123], v[200:203]
  s_add_u32 s26, s26, 1
  s_waitcnt lgkmcnt(8)
  v_mfma_f32_16x16x32_bf16 v[192:195], v[156:159], v[92:95], v[192:195]
  s_cmp_eq_u32 s26, 14
  v_mfma_f32_16x16x32_bf16 v[200:203], v[156:159], v[124:127], v[200:203]
  s_cselect_b32 s26, 0, s26
  s_waitcnt lgkmcnt(7)
  v_mfma_f32_16x16x32_bf16 v[196:199], v[160:163], v[64:67], 0
  s_lshl_b32 s28, s26, 18
  v_mfma_f32_16x16x32_bf16 v[204:207], v[160:163], v[96:99], 0
  s_add_u32 m0, s20, 49152
  s_waitcnt lgkmcnt(6)
  v_mfma_f32_16x16x32_bf16 v[196:199], v[164:167], v[68:71], v[196:199]
  v_add_u32 v2, s28, v48
  v_mfma_f32_16x16x32_bf16 v[204:207], v[164:167], v[100:103], v[204:207]
  global_load_lds_dwordx4 v2, s[6:7]
  s_waitcnt lgkmcnt(5)
  v_mfma_f32_16x16x32_bf16 v[196:199], v[168:171], v[72:75], v[196:199]
  s_add_u32 m0, s21, 49152
  v_mfma_f32_16x16x32_bf16 v[204:207], v[168:171], v[104:107], v[204:207]
  v_add_u32 v2, s28, v49
  s_waitcnt lgkmcnt(4)
  v_mfma_f32_16x16x32_bf16 v[196:199], v[172:175], v[76:79], v[196:199]
  global_load_lds_dwordx4 v2, s[6:7]
  v_mfma_f32_16x16x32_bf16 v[204:207], v[172:175], v[108:111], v[204:207]
  s_add_u32 m0, s22, 49152
  s_waitcnt lgkmcnt(3)
  v_mfma_f32_16x16x32_bf16 v[196:199], v[176:179], v[80:83], v[196:199]
  v_add_u32 v2, s28, v50
  v_mfma_f32_16x16x32_bf16 v[204:207], v[176:179], v[112:115], v[204:207]
  global_load_lds_dwordx4 v2, s[6:7]
  s_waitcnt lgkmcnt(2)
  v_mfma_f32_16x16x32_bf16 v[196:199], v[180:183], v[84:87], v[196:199]
  s_add_u32 m0, s23, 49152
  v_mfma_f32_16x16x32_bf16 v[204:207], v[180:183], v[116:119], v[204:207]
  v_add_u32 v2, s28, v51
  s_waitcnt lgkmcnt(1)
  v_mfma_f32_16x16x32_bf16 v[196:199], v[184:187], v[88:91], v[196:199]
  global_load_lds_dwordx4 v2, s[6:7]
  v_mfma_f32_16x16x32_bf16 v[204:207], v[184:187], v[120:123], v[204:207]
  s_add_u32 s26, s26, 1
  s_waitcnt lgkmcnt(0)
  v_mfma_f32_16x16x32_bf16 v[196:199], v[188:191], v[92:95], v[196:199]
  s_cmp_eq_u32 s26, 14
  v_mfma_f32_16x16x32_bf16 v[204:207], v[188:191], v[124:127], v[204:207]
  s_cselect_b32 s26, 0, s26
  s_add_u32 s31, s27, 0
  s_cmp_ge_u32 s31, 14
  s_cselect_b32 s28, 14, 0
  s_sub_u32 s31, s31, s28
  s_cmp_ge_u32 s31, 14
  s_cselect_b32 s28, 14, 0
  s_sub_u32 s31, s31, s28
  s_lshl_b32 s31, s31, 10
  v_add_u32 v6, s31, v7
  v_add_u32 v12, 14336, v6
  s_mov_b32 s31, s30
  v_pk_mul_f32 v[192:193], v[192:193], s[30:31]
  v_pk_mul_f32 v[194:195], v[194:195], s[30:31]
  v_pk_mul_f32 v[196:197], v[196:197], s[30:31]
  v_pk_mul_f32 v[198:199], v[198:199], s[30:31]
  v_pk_mul_f32 v[200:201], v[200:201], s[30:31]
  v_pk_mul_f32 v[202:203], v[202:203], s[30:31]
  v_pk_mul_f32 v[204:205], v[204:205], s[30:31]
  v_pk_mul_f32 v[206:207], v[206:207], s[30:31]
  v_cvt_pk_bf16_f32 v208, v192, v193
  v_cvt_pk_bf16_f32 v209, v194, v195
  v_cvt_pk_bf16_f32 v210, v196, v197
  v_cvt_pk_bf16_f32 v211, v198, v199
  v_cvt_pk_bf16_f32 v212, v200, v201
  v_cvt_pk_bf16_f32 v213, v202, v203
  v_cvt_pk_bf16_f32 v214, v204, v205
  v_cvt_pk_bf16_f32 v215, v206, v207
  global_store_dwordx4 v6, v[208:211], s[4:5]
  global_store_dwordx4 v12, v[212:215], s[4:5]
  s_waitcnt vmcnt(2)
  s_barrier
  ds_read_b128 v[128:131], v52 offset:32768
  ds_read_b128 v[132:135], v53 offset:32768
  ds_read_b128 v[136:139], v54 offset:32768
  ds_read_b128 v[140:143], v55 offset:32768
  ds_read_b128 v[144:147], v56 offset:32768
  ds_read_b128 v[148:151], v57 offset:32768
  ds_read_b128 v[152:155], v58 offset:32768
  ds_read_b128 v[156:159], v59 offset:32768
  ds_read_b128 v[160:163], v52 offset:34816
  ds_read_b128 v[164:167], v53 offset:34816
  ds_read_b128 v[168:171], v54 offset:34816
  ds_read_b128 v[172:175], v55 offset:34816
  ds_read_b128 v[176:179], v56 offset:34816
  ds_read_b128 v[180:183], v57 offset:34816
  ds_read_b128 v[184:187], v58 offset:34816
  ds_read_b128 v[188:191], v59 offset:34816
  s_waitcnt lgkmcnt(15)
  v_mfma_f32_16x16x32_bf16 v[192:195], v[128:131], v[64:67], 0
  s_lshl_b32 s28, s26, 18
  v_mfma_f32_16x16x32_bf16 v[200:203], v[128:131], v[96:99], 0
  s_add_u32 m0, s20, 0
  s_waitcnt lgkmcnt(14)
  v_mfma_f32_16x16x32_bf16 v[192:195], v[132:135], v[68:71], v[192:195]
  v_add_u32 v2, s28, v48
  v_mfma_f32_16x16x32_bf16 v[200:203], v[132:135], v[100:103], v[200:203]
  global_load_lds_dwordx4 v2, s[6:7]
  s_waitcnt lgkmcnt(13)
  v_mfma_f32_16x16x32_bf16 v[192:195], v[136:139], v[72:75], v[192:195]
  s_add_u32 m0, s21, 0
  v_mfma_f32_16x16x32_bf16 v[200:203], v[136:139], v[104:107], v[200:203]
  v_add_u32 v2, s28, v49
  s_waitcnt lgkmcnt(12)
  v_mfma_f32_16x16x32_bf16 v[192:195], v[140:143], v[76:79], v[192:195]
  global_load_lds_dwordx4 v2, s[6:7]
  v_mfma_f32_16x16x32_bf16 v[200:203], v[140:143], v[108:111], v[200:203]
  s_add_u32 m0, s22, 0
  s_waitcnt lgkmcnt(11)
  v_mfma_f32_16x16x32_bf16 v[192:195], v[144:147], v[80:83], v[192:195]
  v_add_u32 v2, s28, v50
  v_mfma_f32_16x16x32_bf16 v[200:203], v[144:147], v[112:115], v[200:203]
  global_load_lds_dwordx4 v2, s[6:7]
  s_waitcnt lgkmcnt(10)
  v_mfma_f32_16x16x32_bf16 v[192:195], v[148:151], v[84:87], v[192:195]
  s_add_u32 m0, s23, 0
  v_mfma_f32_16x16x32_bf16 v[200:203], v[148:151], v[116:119], v[200:203]
  v_add_u32 v2, s28, v51
  s_waitcnt lgkmcnt(9)
  v_mfma_f32_16x16x32_bf16 v[192:195], v[152:155], v[88:91], v[192:195]
  global_load_lds_dwordx4 v2, s[6:7]
  v_mfma_f32_16x16x32_bf16 v[200:203], v[152:155], v[120:123], v[200:203]
  s_add_u32 s26, s26, 1
  s_waitcnt lgkmcnt(8)
  v_mfma_f32_16x16x32_bf16 v[192:195], v[156:159], v[92:95], v[192:195]
  s_cmp_eq_u32 s26, 14
  v_mfma_f32_16x16x32_bf16 v[200:203], v[156:159], v[124:127], v[200:203]
  s_cselect_b32 s26, 0, s26
  s_waitcnt lgkmcnt(7)
  v_mfma_f32_16x16x32_bf16 v[196:199], v[160:163], v[64:67], 0
  s_lshl_b32 s28, s26, 18
  v_mfma_f32_16x16x32_bf16 v[204:207], v[160:163], v[96:99], 0
  s_add_u32 m0, s20, 16384
  s_waitcnt lgkmcnt(6)
  v_mfma_f32_16x16x32_bf16 v[196:199], v[164:167], v[68:71], v[196:199]
  v_add_u32 v2, s28, v48
  v_mfma_f32_16x16x32_bf16 v[204:207], v[164:167], v[100:103], v[204:207]
  global_load_lds_dwordx4 v2, s[6:7]
  s_waitcnt lgkmcnt(5)
  v_mfma_f32_16x16x32_bf16 v[196:199], v[168:171], v[72:75], v[196:199]
  s_add_u32 m0, s21, 16384
  v_mfma_f32_16x16x32_bf16 v[204:207], v[168:171], v[104:107], v[204:207]
  v_add_u32 v2, s28, v49
  s_waitcnt lgkmcnt(4)
  v_mfma_f32_16x16x32_bf16 v[196:199], v[172:175], v[76:79], v[196:199]
  global_load_lds_dwordx4 v2, s[6:7]
  v_mfma_f32_16x16x32_bf16 v[204:207], v[172:175], v[108:111], v[204:207]
  s_add_u32 m0, s22, 16384
  s_waitcnt lgkmcnt(3)
  v_mfma_f32_16x16x32_bf16 v[196:199], v[176:179], v[80:83], v[196:199]
  v_add_u32 v2, s28, v50
  v_mfma_f32_16x16x32_bf16 v[204:207], v[176:179], v[112:115], v[204:207]
  global_load_lds_dwordx4 v2, s[6:7]
  s_waitcnt lgkmcnt(2)
  v_mfma_f32_16x16x32_bf16 v[196:199], v[180:183], v[84:87], v[196:199]
  s_add_u32 m0, s23, 16384
  v_mfma_f32_16x16x32_bf16 v[204:207], v[180:183], v[116:119], v[204:207]
  v_add_u32 v2, s28, v51
  s_waitcnt lgkmcnt(1)
  v_mfma_f32_16x16x32_bf16 v[196:199], v[184:187], v[88:91], v[196:199]
  global_load_lds_dwordx4 v2, s[6:7]
  v_mfma_f32_16x16x32_bf16 v[204:207], v[184:187], v[120:123], v[204:207]
  s_add_u32 s26, s26, 1
  s_waitcnt lgkmcnt(0)
  v_mfma_f32_16x16x32_bf16 v[196:199], v[188:191], v[92:95], v[196:199]
  s_cmp_eq_u32 s26, 14
  v_mfma_f32_16x16x32_bf16 v[204:207], v[188:191], v[124:127], v[204:207]
  s_cselect_b32 s26, 0, s26
  s_add_u32 s31, s27, 2
  s_cmp_ge_u32 s31, 14
  s_cselect_b32 s28, 14, 0
  s_sub_u32 s31, s31, s28
  s_cmp_ge_u32 s31, 14
  s_cselect_b32 s28, 14, 0
  s_sub_u32 s31, s31, s28
  s_lshl_b32 s31, s31, 10
  v_add_u32 v6, s31, v7
  v_add_u32 v12, 14336, v6
  s_mov_b32 s31, s30
  v_pk_mul_f32 v[192:193], v[192:193], s[30:31]
  v_pk_mul_f32 v[194:195], v[194:195], s[30:31]
  v_pk_mul_f32 v[196:197], v[196:197], s[30:31]
  v_pk_mul_f32 v[198:199], v[198:199], s[30:31]
  v_pk_mul_f32 v[200:201], v[200:201], s[30:31]
  v_pk_mul_f32 v[202:203], v[202:203], s[30:31]
  v_pk_mul_f32 v[204:205], v[204:205], s[30:31]
  v_pk_mul_f32 v[206:207], v[206:207], s[30:31]
  v_cvt_pk_bf16_f32 v208, v192, v193
  v_cvt_pk_bf16_f32 v209, v194, v195
  v_cvt_pk_bf16_f32 v210, v196, v197
  v_cvt_pk_bf16_f32 v211, v198, v199
  v_cvt_pk_bf16_f32 v212, v200, v201
  v_cvt_pk_bf16_f32 v213, v202, v203
  v_cvt_pk_bf16_f32 v214, v204, v205
  v_cvt_pk_bf16_f32 v215, v206, v207
  global_store_dwordx4 v6, v[208:211], s[4:5]
  global_store_dwordx4 v12, v[212:215], s[4:5]
  s_waitcnt vmcnt(2)
  s_barrier
  ds_read_b128 v[128:131], v52 offset:0
  ds_read_b128 v[132:135], v53 offset:0
  ds_read_b128 v[136:139], v54 offset:0
  ds_read_b128 v[140:143], v55 offset:0
  ds_read_b128 v[144:147], v56 offset:0
  ds_read_b128 v[148:151], v57 offset:0
  ds_read_b128 v[152:155], v58 offset:0
  ds_read_b128 v[156:159], v59 offset:0
  ds_read_b128 v[160:163], v52 offset:2048
  ds_read_b128 v[164:167], v53 offset:2048
  ds_read_b128 v[168:171], v54 offset:2048
  ds_read_b128 v[172:175], v55 offset:2048
  ds_read_b128 v[176:179], v56 offset:2048
  ds_read_b128 v[180:183], v57 offset:2048
  ds_read_b128 v[184:187], v58 offset:2048
  ds_read_b128 v[188:191], v59 offset:2048
  s_waitcnt lgkmcnt(15)
  v_mfma_f32_16x16x32_bf16 v[192:195], v[128:131], v[64:67], 0
  s_lshl_b32 s28, s26, 18
  v_mfma_f32_16x16x32_bf16 v[200:203], v[128:131], v[96:99], 0
  s_add_u32 m0, s20, 32768
  s_waitcnt lgkmcnt(14)
  v_mfma_f32_16x16x32_bf16 v[192:195], v[132:135], v[68:71], v[192:195]
  v_add_u32 v2, s28, v48
  v_mfma_f32_16x16x32_bf16 v[200:203], v[132:135], v[100:103], v[200:203]
  global_load_lds_dwordx4 v2, s[6:7]
  s_waitcnt lgkmcnt(13)
  v_mfma_f32_16x16x32_bf16 v[192:195], v[136:139], v[72:75], v[192:195]
  s_add_u32 m0, s21, 32768
  v_mfma_f32_16x16x32_bf16 v[200:203], v[136:139], v[104:107], v[200:203]
  v_add_u32 v2, s28, v49
  s_waitcnt lgkmcnt(12)
  v_mfma_f32_16x16x32_bf16 v[192:195], v[140:143], v[76:79], v[192:195]
  global_load_lds_dwordx4 v2, s[6:7]
  v_mfma_f32_16x16x32_bf16 v[200:203], v[140:143], v[108:111], v[200:203]
  s_add_u32 m0, s22, 32768
  s_waitcnt lgkmcnt(11)
  v_mfma_f32_16x16x32_bf16 v[192:195], v[144:147], v[80:83], v[192:195]
  v_add_u32 v2, s28, v50
  v_mfma_f32_16x16x32_bf16 v[200:203], v[144:147], v[112:115], v[200:203]
  global_load_lds_dwordx4 v2, s[6:7]
  s_waitcnt lgkmcnt(10)
  v_mfma_f32_16x16x32_bf16 v[192:195], v[148:151], v[84:87], v[192:195]
  s_add_u32 m0, s23, 32768
  v_mfma_f32_16x16x32_bf16 v[200:203], v[148:151], v[116:119], v[200:203]
  v_add_u32 v2, s28, v51
  s_waitcnt lgkmcnt(9)
  v_mfma_f32_16x16x32_bf16 v[192:195], v[152:155], v[88:91], v[192:195]
  global_load_lds_dwordx4 v2, s[6:7]
  v_mfma_f32_16x16x32_bf16 v[200:203], v[152:155], v[120:123], v[200:203]
  s_add_u32 s26, s26, 1
  s_waitcnt lgkmcnt(8)
  v_mfma_f32_16x16x32_bf16 v[192:195], v[156:159], v[92:95], v[192:195]
  s_cmp_eq_u32 s26, 14
  v_mfma_f32_16x16x32_bf16 v[200:203], v[156:159], v[124:127], v[200:203]
  s_cselect_b32 s26, 0, s26
  s_waitcnt lgkmcnt(7)
  v_mfma_f32_16x16x32_bf16 v[196:199], v[160:163], v[64:67], 0
  s_lshl_b32 s28, s26, 18
  v_mfma_f32_16x16x32_bf16 v[204:207], v[160:163], v[96:99], 0
  s_add_u32 m0, s20, 49152
  s_waitcnt lgkmcnt(6)
  v_mfma_f32_16x16x32_bf16 v[196:199], v[164:167], v[68:71], v[196:199]
  v_add_u32 v2, s28, v48
  v_mfma_f32_16x16x32_bf16 v[204:207], v[164:167], v[100:103], v[204:207]
  global_load_lds_dwordx4 v2, s[6:7]
  s_waitcnt lgkmcnt(5)
  v_mfma_f32_16x16x32_bf16 v[196:199], v[168:171], v[72:75], v[196:199]
  s_add_u32 m0, s21, 49152
  v_mfma_f32_16x16x32_bf16 v[204:207], v[168:171], v[104:107], v[204:207]
  v_add_u32 v2, s28, v49
  s_waitcnt lgkmcnt(4)
  v_mfma_f32_16x16x32_bf16 v[196:199], v[172:175], v[76:79], v[196:199]
  global_load_lds_dwordx4 v2, s[6:7]
  v_mfma_f32_16x16x32_bf16 v[204:207], v[172:175], v[108:111], v[204:207]
  s_add_u32 m0, s22, 49152
  s_waitcnt lgkmcnt(3)
  v_mfma_f32_16x16x32_bf16 v[196:199], v[176:179], v[80:83], v[196:199]
  v_add_u32 v2, s28, v50
  v_mfma_f32_16x16x32_bf16 v[204:207], v[176:179], v[112:115], v[204:207]
  global_load_lds_dwordx4 v2, s[6:7]
  s_waitcnt lgkmcnt(2)
  v_mfma_f32_16x16x32_bf16 v[196:199], v[180:183], v[84:87], v[196:199]
  s_add_u32 m0, s23, 49152
  v_mfma_f32_16x16x32_bf16 v[204:207], v[180:183], v[116:119], v[204:207]
  v_add_u32 v2, s28, v51
  s_waitcnt lgkmcnt(1)
  v_mfma_f32_16x16x32_bf16 v[196:199], v[184:187], v[88:91], v[196:199]
  global_load_lds_dwordx4 v2, s[6:7]
  v_mfma_f32_16x16x32_bf16 v[204:207], v[184:187], v[120:123], v[204:207]
  s_add_u32 s26, s26, 1
  s_waitcnt lgkmcnt(0)
  v_mfma_f32_16x16x32_bf16 v[196:199], v[188:191], v[92:95], v[196:199]
  s_cmp_eq_u32 s26, 14
  v_mfma_f32_16x16x32_bf16 v[204:207], v[188:191], v[124:127], v[204:207]
  s_cselect_b32 s26, 0, s26
  s_add_u32 s31, s27, 4
  s_cmp_ge_u32 s31, 14
  s_cselect_b32 s28, 14, 0
  s_sub_u32 s31, s31, s28
  s_cmp_ge_u32 s31, 14
  s_cselect_b32 s28, 14, 0
  s_sub_u32 s31, s31, s28
  s_lshl_b32 s31, s31, 10
  v_add_u32 v6, s31, v7
  v_add_u32 v12, 14336, v6
  s_mov_b32 s31, s30
  v_pk_mul_f32 v[192:193], v[192:193], s[30:31]
  v_pk_mul_f32 v[194:195], v[194:195], s[30:31]
  v_pk_mul_f32 v[196:197], v[196:197], s[30:31]
  v_pk_mul_f32 v[198:199], v[198:199], s[30:31]
  v_pk_mul_f32 v[200:201], v[200:201], s[30:31]
  v_pk_mul_f32 v[202:203], v[202:203], s[30:31]
  v_pk_mul_f32 v[204:205], v[204:205], s[30:31]
  v_pk_mul_f32 v[206:207], v[206:207], s[30:31]
  v_cvt_pk_bf16_f32 v208, v192, v193
  v_cvt_pk_bf16_f32 v209, v194, v195
  v_cvt_pk_bf16_f32 v210, v196, v197
  v_cvt_pk_bf16_f32 v211, v198, v199
  v_cvt_pk_bf16_f32 v212, v200, v201
  v_cvt_pk_bf16_f32 v213, v202, v203
  v_cvt_pk_bf16_f32 v214, v204, v205
  v_cvt_pk_bf16_f32 v215, v206, v207
  global_store_dwordx4 v6, v[208:211], s[4:5]
  global_store_dwordx4 v12, v[212:215], s[4:5]
  s_waitcnt vmcnt(2)
  s_barrier
  ds_read_b128 v[128:131], v52 offset:32768
  ds_read_b128 v[132:135], v53 offset:32768
  ds_read_b128 v[136:139], v54 offset:32768
  ds_read_b128 v[140:143], v55 offset:32768
  ds_read_b128 v[144:147], v56 offset:32768
  ds_read_b128 v[148:151], v57 offset:32768
  ds_read_b128 v[152:155], v58 offset:32768
  ds_read_b128 v[156:159], v59 offset:32768
  ds_read_b128 v[160:163], v52 offset:34816
  ds_read_b128 v[164:167], v53 offset:34816
  ds_read_b128 v[168:171], v54 offset:34816
  ds_read_b128 v[172:175], v55 offset:34816
  ds_read_b128 v[176:179], v56 offset:34816
  ds_read_b128 v[180:183], v57 offset:34816
  ds_read_b128 v[184:187], v58 offset:34816
  ds_read_b128 v[188:191], v59 offset:34816
  s_waitcnt lgkmcnt(15)
  v_mfma_f32_16x16x32_bf16 v[192:195], v[128:131], v[64:67], 0
  s_lshl_b32 s28, s26, 18
  v_mfma_f32_16x16x32_bf16 v[200:203], v[128:131], v[96:99], 0
  s_add_u32 m0, s20, 0
  s_waitcnt lgkmcnt(14)
  v_mfma_f32_16x16x32_bf16 v[192:195], v[132:135], v[68:71], v[192:195]
  v_add_u32 v2, s28, v48
  v_mfma_f32_16x16x32_bf16 v[200:203], v[132:135], v[100:103], v[200:203]
  global_load_lds_dwordx4 v2, s[6:7]
  s_waitcnt lgkmcnt(13)
  v_mfma_f32_16x16x32_bf16 v[192:195], v[136:139], v[72:75], v[192:195]
  s_add_u32 m0, s21, 0
  v_mfma_f32_16x16x32_bf16 v[200:203], v[136:139], v[104:107], v[200:203]
  v_add_u32 v2, s28, v49
  s_waitcnt lgkmcnt(12)
  v_mfma_f32_16x16x32_bf16 v[192:195], v[140:143], v[76:79], v[192:195]
  global_load_lds_dwordx4 v2, s[6:7]
  v_mfma_f32_16x16x32_bf16 v[200:203], v[140:143], v[108:111], v[200:203]
  s_add_u32 m0, s22, 0
  s_waitcnt lgkmcnt(11)
  v_mfma_f32_16x16x32_bf16 v[192:195], v[144:147], v[80:83], v[192:195]
  v_add_u32 v2, s28, v50
  v_mfma_f32_16x16x32_bf16 v[200:203], v[144:147], v[112:115], v[200:203]
  global_load_lds_dwordx4 v2, s[6:7]
  s_waitcnt lgkmcnt(10)
  v_mfma_f32_16x16x32_bf16 v[192:195], v[148:151], v[84:87], v[192:195]
  s_add_u32 m0, s23, 0
  v_mfma_f32_16x16x32_bf16 v[200:203], v[148:151], v[116:119], v[200:203]
  v_add_u32 v2, s28, v51
  s_waitcnt lgkmcnt(9)
  v_mfma_f32_16x16x32_bf16 v[192:195], v[152:155], v[88:91], v[192:195]
  global_load_lds_dwordx4 v2, s[6:7]
  v_mfma_f32_16x16x32_bf16 v[200:203], v[152:155], v[120:123], v[200:203]
  s_add_u32 s26, s26, 1
  s_waitcnt lgkmcnt(8)
  v_mfma_f32_16x16x32_bf16 v[192:195], v[156:159], v[92:95], v[192:195]
  s_cmp_eq_u32 s26, 14
  v_mfma_f32_16x16x32_bf16 v[200:203], v[156:159], v[124:127], v[200:203]
  s_cselect_b32 s26, 0, s26
  s_waitcnt lgkmcnt(7)
  v_mfma_f32_16x16x32_bf16 v[196:199], v[160:163], v[64:67], 0
  s_lshl_b32 s28, s26, 18
  v_mfma_f32_16x16x32_bf16 v[204:207], v[160:163], v[96:99], 0
  s_add_u32 m0, s20, 16384
  s_waitcnt lgkmcnt(6)
  v_mfma_f32_16x16x32_bf16 v[196:199], v[164:167], v[68:71], v[196:199]
  v_add_u32 v2, s28, v48
  v_mfma_f32_16x16x32_bf16 v[204:207], v[164:167], v[100:103], v[204:207]
  global_load_lds_dwordx4 v2, s[6:7]
  s_waitcnt lgkmcnt(5)
  v_mfma_f32_16x16x32_bf16 v[196:199], v[168:171], v[72:75], v[196:199]
  s_add_u32 m0, s21, 16384
  v_mfma_f32_16x16x32_bf16 v[204:207], v[168:171], v[104:107], v[204:207]
  v_add_u32 v2, s28, v49
  s_waitcnt lgkmcnt(4)
  v_mfma_f32_16x16x32_bf16 v[196:199], v[172:175], v[76:79], v[196:199]
  global_load_lds_dwordx4 v2, s[6:7]
  v_mfma_f32_16x16x32_bf16 v[204:207], v[172:175], v[108:111], v[204:207]
  s_add_u32 m0, s22, 16384
  s_waitcnt lgkmcnt(3)
  v_mfma_f32_16x16x32_bf16 v[196:199], v[176:179], v[80:83], v[196:199]
  v_add_u32 v2, s28, v50
  v_mfma_f32_16x16x32_bf16 v[204:207], v[176:179], v[112:115], v[204:207]
  global_load_lds_dwordx4 v2, s[6:7]
  s_waitcnt lgkmcnt(2)
  v_mfma_f32_16x16x32_bf16 v[196:199], v[180:183], v[84:87], v[196:199]
  s_add_u32 m0, s23, 16384
  v_mfma_f32_16x16x32_bf16 v[204:207], v[180:183], v[116:119], v[204:207]
  v_add_u32 v2, s28, v51
  s_waitcnt lgkmcnt(1)
  v_mfma_f32_16x16x32_bf16 v[196:199], v[184:187], v[88:91], v[196:199]
  global_load_lds_dwordx4 v2, s[6:7]
  v_mfma_f32_16x16x32_bf16 v[204:207], v[184:187], v[120:123], v[204:207]
  s_add_u32 s26, s26, 1
  s_waitcnt lgkmcnt(0)
  v_mfma_f32_16x16x32_bf16 v[196:199], v[188:191], v[92:95], v[196:199]
  s_cmp_eq_u32 s26, 14
  v_mfma_f32_16x16x32_bf16 v[204:207], v[188:191], v[124:127], v[204:207]
  s_cselect_b32 s26, 0, s26
  s_add_u32 s31, s27, 6
  s_cmp_ge_u32 s31, 14
  s_cselect_b32 s28, 14, 0
  s_sub_u32 s31, s31, s28
  s_cmp_ge_u32 s31, 14
  s_cselect_b32 s28, 14, 0
  s_sub_u32 s31, s31, s28
  s_lshl_b32 s31, s31, 10
  v_add_u32 v6, s31, v7
  v_add_u32 v12, 14336, v6
  s_mov_b32 s31, s30
  v_pk_mul_f32 v[192:193], v[192:193], s[30:31]
  v_pk_mul_f32 v[194:195], v[194:195], s[30:31]
  v_pk_mul_f32 v[196:197], v[196:197], s[30:31]
  v_pk_mul_f32 v[198:199], v[198:199], s[30:31]
  v_pk_mul_f32 v[200:201], v[200:201], s[30:31]
  v_pk_mul_f32 v[202:203], v[202:203], s[30:31]
  v_pk_mul_f32 v[204:205], v[204:205], s[30:31]
  v_pk_mul_f32 v[206:207], v[206:207], s[30:31]
  v_cvt_pk_bf16_f32 v208, v192, v193
  v_cvt_pk_bf16_f32 v209, v194, v195
  v_cvt_pk_bf16_f32 v210, v196, v197
  v_cvt_pk_bf16_f32 v211, v198, v199
  v_cvt_pk_bf16_f32 v212, v200, v201
  v_cvt_pk_bf16_f32 v213, v202, v203
  v_cvt_pk_bf16_f32 v214, v204, v205
  v_cvt_pk_bf16_f32 v215, v206, v207
  global_store_dwordx4 v6, v[208:211], s[4:5]
  global_store_dwordx4 v12, v[212:215], s[4:5]
  s_waitcnt vmcnt(2)
  s_barrier
  ds_read_b128 v[128:131], v52 offset:0
  ds_read_b128 v[132:135], v53 offset:0
  ds_read_b128 v[136:139], v54 offset:0
  ds_read_b128 v[140:143], v55 offset:0
  ds_read_b128 v[144:147], v56 offset:0
  ds_read_b128 v[148:151], v57 offset:0
  ds_read_b128 v[152:155], v58 offset:0
  ds_read_b128 v[156:159], v59 offset:0
  ds_read_b128 v[160:163], v52 offset:2048
  ds_read_b128 v[164:167], v53 offset:2048
  ds_read_b128 v[168:171], v54 offset:2048
  ds_read_b128 v[172:175], v55 offset:2048
  ds_read_b128 v[176:179], v56 offset:2048
  ds_read_b128 v[180:183], v57 offset:2048
  ds_read_b128 v[184:187], v58 offset:2048
  ds_read_b128 v[188:191], v59 offset:2048
  s_waitcnt lgkmcnt(15)
  v_mfma_f32_16x16x32_bf16 v[192:195], v[128:131], v[64:67], 0
  s_lshl_b32 s28, s26, 18
  v_mfma_f32_16x16x32_bf16 v[200:203], v[128:131], v[96:99], 0
  s_add_u32 m0, s20, 32768
  s_waitcnt lgkmcnt(14)
  v_mfma_f32_16x16x32_bf16 v[192:195], v[132:135], v[68:71], v[192:195]
  v_add_u32 v2, s28, v48
  v_mfma_f32_16x16x32_bf16 v[200:203], v[132:135], v[100:103], v[200:203]
  global_load_lds_dwordx4 v2, s[6:7]
  s_waitcnt lgkmcnt(13)
  v_mfma_f32_16x16x32_bf16 v[192:195], v[136:139], v[72:75], v[192:195]
  s_add_u32 m0, s21, 32768
  v_mfma_f32_16x16x32_bf16 v[200:203], v[136:139], v[104:107], v[200:203]
  v_add_u32 v2, s28, v49
  s_waitcnt lgkmcnt(12)
  v_mfma_f32_16x16x32_bf16 v[192:195], v[140:143], v[76:79], v[192:195]
  global_load_lds_dwordx4 v2, s[6:7]
  v_mfma_f32_16x16x32_bf16 v[200:203], v[140:143], v[108:111], v[200:203]
  s_add_u32 m0, s22, 32768
  s_waitcnt lgkmcnt(11)
  v_mfma_f32_16x16x32_bf16 v[192:195], v[144:147], v[80:83], v[192:195]
  v_add_u32 v2, s28, v50
  v_mfma_f32_16x16x32_bf16 v[200:203], v[144:147], v[112:115], v[200:203]
  global_load_lds_dwordx4 v2, s[6:7]
  s_waitcnt lgkmcnt(10)
  v_mfma_f32_16x16x32_bf16 v[192:195], v[148:151], v[84:87], v[192:195]
  s_add_u32 m0, s23, 32768
  v_mfma_f32_16x16x32_bf16 v[200:203], v[148:151], v[116:119], v[200:203]
  v_add_u32 v2, s28, v51
  s_waitcnt lgkmcnt(9)
  v_mfma_f32_16x16x32_bf16 v[192:195], v[152:155], v[88:91], v[192:195]
  global_load_lds_dwordx4 v2, s[6:7]
  v_mfma_f32_16x16x32_bf16 v[200:203], v[152:155], v[120:123], v[200:203]
  s_add_u32 s26, s26, 1
  s_waitcnt lgkmcnt(8)
  v_mfma_f32_16x16x32_bf16 v[192:195], v[156:159], v[92:95], v[192:195]
  s_cmp_eq_u32 s26, 14
  v_mfma_f32_16x16x32_bf16 v[200:203], v[156:159], v[124:127], v[200:203]
  s_cselect_b32 s26, 0, s26
  s_waitcnt lgkmcnt(7)
  v_mfma_f32_16x16x32_bf16 v[196:199], v[160:163], v[64:67], 0
  s_lshl_b32 s28, s26, 18
  v_mfma_f32_16x16x32_bf16 v[204:207], v[160:163], v[96:99], 0
  s_add_u32 m0, s20, 49152
  s_waitcnt lgkmcnt(6)
  v_mfma_f32_16x16x32_bf16 v[196:199], v[164:167], v[68:71], v[196:199]
  v_add_u32 v2, s28, v48
  v_mfma_f32_16x16x32_bf16 v[204:207], v[164:167], v[100:103], v[204:207]
  global_load_lds_dwordx4 v2, s[6:7]
  s_waitcnt lgkmcnt(5)
  v_mfma_f32_16x16x32_bf16 v[196:199], v[168:171], v[72:75], v[196:199]
  s_add_u32 m0, s21, 49152
  v_mfma_f32_16x16x32_bf16 v[204:207], v[168:171], v[104:107], v[204:207]
  v_add_u32 v2, s28, v49
  s_waitcnt lgkmcnt(4)
  v_mfma_f32_16x16x32_bf16 v[196:199], v[172:175], v[76:79], v[196:199]
  global_load_lds_dwordx4 v2, s[6:7]
  v_mfma_f32_16x16x32_bf16 v[204:207], v[172:175], v[108:111], v[204:207]
  s_add_u32 m0, s22, 49152
  s_waitcnt lgkmcnt(3)
  v_mfma_f32_16x16x32_bf16 v[196:199], v[176:179], v[80:83], v[196:199]
  v_add_u32 v2, s28, v50
  v_mfma_f32_16x16x32_bf16 v[204:207], v[176:179], v[112:115], v[204:207]
  global_load_lds_dwordx4 v2, s[6:7]
  s_waitcnt lgkmcnt(2)
  v_mfma_f32_16x16x32_bf16 v[196:199], v[180:183], v[84:87], v[196:199]
  s_add_u32 m0, s23, 49152
  v_mfma_f32_16x16x32_bf16 v[204:207], v[180:183], v[116:119], v[204:207]
  v_add_u32 v2, s28, v51
  s_waitcnt lgkmcnt(1)
  v_mfma_f32_16x16x32_bf16 v[196:199], v[184:187], v[88:91], v[196:199]
  global_load_lds_dwordx4 v2, s[6:7]
  v_mfma_f32_16x16x32_bf16 v[204:207], v[184:187], v[120:123], v[204:207]
  s_add_u32 s26, s26, 1
  s_waitcnt lgkmcnt(0)
  v_mfma_f32_16x16x32_bf16 v[196:199], v[188:191], v[92:95], v[196:199]
  s_cmp_eq_u32 s26, 14
  v_mfma_f32_16x16x32_bf16 v[204:207], v[188:191], v[124:127], v[204:207]
  s_cselect_b32 s26, 0, s26
  s_add_u32 s31, s27, 8
  s_cmp_ge_u32 s31, 14
  s_cselect_b32 s28, 14, 0
  s_sub_u32 s31, s31, s28
  s_cmp_ge_u32 s31, 14
  s_cselect_b32 s28, 14, 0
  s_sub_u32 s31, s31, s28
  s_lshl_b32 s31, s31, 10
  v_add_u32 v6, s31, v7
  v_add_u32 v12, 14336, v6
  s_mov_b32 s31, s30
  v_pk_mul_f32 v[192:193], v[192:193], s[30:31]
  v_pk_mul_f32 v[194:195], v[194:195], s[30:31]
  v_pk_mul_f32 v[196:197], v[196:197], s[30:31]
  v_pk_mul_f32 v[198:199], v[198:199], s[30:31]
  v_pk_mul_f32 v[200:201], v[200:201], s[30:31]
  v_pk_mul_f32 v[202:203], v[202:203], s[30:31]
  v_pk_mul_f32 v[204:205], v[204:205], s[30:31]
  v_pk_mul_f32 v[206:207], v[206:207], s[30:31]
  v_cvt_pk_bf16_f32 v208, v192, v193
  v_cvt_pk_bf16_f32 v209, v194, v195
  v_cvt_pk_bf16_f32 v210, v196, v197
  v_cvt_pk_bf16_f32 v211, v198, v199
  v_cvt_pk_bf16_f32 v212, v200, v201
  v_cvt_pk_bf16_f32 v213, v202, v203
  v_cvt_pk_bf16_f32 v214, v204, v205
  v_cvt_pk_bf16_f32 v215, v206, v207
  global_store_dwordx4 v6, v[208:211], s[4:5]
  global_store_dwordx4 v12, v[212:215], s[4:5]
  s_waitcnt vmcnt(2)
  s_barrier
  ds_read_b128 v[128:131], v52 offset:32768
  ds_read_b128 v[132:135], v53 offset:32768
  ds_read_b128 v[136:139], v54 offset:32768
  ds_read_b128 v[140:143], v55 offset:32768
  ds_read_b128 v[144:147], v56 offset:32768
  ds_read_b128 v[148:151], v57 offset:32768
  ds_read_b128 v[152:155], v58 offset:32768
  ds_read_b128 v[156:159], v59 offset:32768
  ds_read_b128 v[160:163], v52 offset:34816
  ds_read_b128 v[164:167], v53 offset:34816
  ds_read_b128 v[168:171], v54 offset:34816
  ds_read_b128 v[172:175], v55 offset:34816
  ds_read_b128 v[176:179], v56 offset:34816
  ds_read_b128 v[180:183], v57 offset:34816
  ds_read_b128 v[184:187], v58 offset:34816
  ds_read_b128 v[188:191], v59 offset:34816
  s_waitcnt lgkmcnt(15)
  v_mfma_f32_16x16x32_bf16 v[192:195], v[128:131], v[64:67], 0
  s_lshl_b32 s28, s26, 18
  v_mfma_f32_16x16x32_bf16 v[200:203], v[128:131], v[96:99], 0
  s_add_u32 m0, s20, 0
  s_waitcnt lgkmcnt(14)
  v_mfma_f32_16x16x32_bf16 v[192:195], v[132:135], v[68:71], v[192:195]
  v_add_u32 v2, s28, v48
  v_mfma_f32_16x16x32_bf16 v[200:203], v[132:135], v[100:103], v[200:203]
  global_load_lds_dwordx4 v2, s[6:7]
  s_waitcnt lgkmcnt(13)
  v_mfma_f32_16x16x32_bf16 v[192:195], v[136:139], v[72:75], v[192:195]
  s_add_u32 m0, s21, 0
  v_mfma_f32_16x16x32_bf16 v[200:203], v[136:139], v[104:107], v[200:203]
  v_add_u32 v2, s28, v49
  s_waitcnt lgkmcnt(12)
  v_mfma_f32_16x16x32_bf16 v[192:195], v[140:143], v[76:79], v[192:195]
  global_load_lds_dwordx4 v2, s[6:7]
  v_mfma_f32_16x16x32_bf16 v[200:203], v[140:143], v[108:111], v[200:203]
  s_add_u32 m0, s22, 0
  s_waitcnt lgkmcnt(11)
  v_mfma_f32_16x16x32_bf16 v[192:195], v[144:147], v[80:83], v[192:195]
  v_add_u32 v2, s28, v50
  v_mfma_f32_16x16x32_bf16 v[200:203], v[144:147], v[112:115], v[200:203]
  global_load_lds_dwordx4 v2, s[6:7]
  s_waitcnt lgkmcnt(10)
  v_mfma_f32_16x16x32_bf16 v[192:195], v[148:151], v[84:87], v[192:195]
  s_add_u32 m0, s23, 0
  v_mfma_f32_16x16x32_bf16 v[200:203], v[148:151], v[116:119], v[200:203]
  v_add_u32 v2, s28, v51
  s_waitcnt lgkmcnt(9)
  v_mfma_f32_16x16x32_bf16 v[192:195], v[152:155], v[88:91], v[192:195]
  global_load_lds_dwordx4 v2, s[6:7]
  v_mfma_f32_16x16x32_bf16 v[200:203], v[152:155], v[120:123], v[200:203]
  s_add_u32 s26, s26, 1
  s_waitcnt lgkmcnt(8)
  v_mfma_f32_16x16x32_bf16 v[192:195], v[156:159], v[92:95], v[192:195]
  s_cmp_eq_u32 s26, 14
  v_mfma_f32_16x16x32_bf16 v[200:203], v[156:159], v[124:127], v[200:203]
  s_cselect_b32 s26, 0, s26
  s_waitcnt lgkmcnt(7)
  v_mfma_f32_16x16x32_bf16 v[196:199], v[160:163], v[64:67], 0
  s_lshl_b32 s28, s26, 18
  v_mfma_f32_16x16x32_bf16 v[204:207], v[160:163], v[96:99], 0
  s_add_u32 m0, s20, 16384
  s_waitcnt lgkmcnt(6)
  v_mfma_f32_16x16x32_bf16 v[196:199], v[164:167], v[68:71], v[196:199]
  v_add_u32 v2, s28, v48
  v_mfma_f32_16x16x32_bf16 v[204:207], v[164:167], v[100:103], v[204:207]
  global_load_lds_dwordx4 v2, s[6:7]
  s_waitcnt lgkmcnt(5)
  v_mfma_f32_16x16x32_bf16 v[196:199], v[168:171], v[72:75], v[196:199]
  s_add_u32 m0, s21, 16384
  v_mfma_f32_16x16x32_bf16 v[204:207], v[168:171], v[104:107], v[204:207]
  v_add_u32 v2, s28, v49
  s_waitcnt lgkmcnt(4)
  v_mfma_f32_16x16x32_bf16 v[196:199], v[172:175], v[76:79], v[196:199]
  global_load_lds_dwordx4 v2, s[6:7]
  v_mfma_f32_16x16x32_bf16 v[204:207], v[172:175], v[108:111], v[204:207]
  s_add_u32 m0, s22, 16384
  s_waitcnt lgkmcnt(3)
  v_mfma_f32_16x16x32_bf16 v[196:199], v[176:179], v[80:83], v[196:199]
  v_add_u32 v2, s28, v50
  v_mfma_f32_16x16x32_bf16 v[204:207], v[176:179], v[112:115], v[204:207]
  global_load_lds_dwordx4 v2, s[6:7]
  s_waitcnt lgkmcnt(2)
  v_mfma_f32_16x16x32_bf16 v[196:199], v[180:183], v[84:87], v[196:199]
  s_add_u32 m0, s23, 16384
  v_mfma_f32_16x16x32_bf16 v[204:207], v[180:183], v[116:119], v[204:207]
  v_add_u32 v2, s28, v51
  s_waitcnt lgkmcnt(1)
  v_mfma_f32_16x16x32_bf16 v[196:199], v[184:187], v[88:91], v[196:199]
  global_load_lds_dwordx4 v2, s[6:7]
  v_mfma_f32_16x16x32_bf16 v[204:207], v[184:187], v[120:123], v[204:207]
  s_add_u32 s26, s26, 1
  s_waitcnt lgkmcnt(0)
  v_mfma_f32_16x16x32_bf16 v[196:199], v[188:191], v[92:95], v[196:199]
  s_cmp_eq_u32 s26, 14
  v_mfma_f32_16x16x32_bf16 v[204:207], v[188:191], v[124:127], v[204:207]
  s_cselect_b32 s26, 0, s26
  s_add_u32 s31, s27, 10
  s_cmp_ge_u32 s31, 14
  s_cselect_b32 s28, 14, 0
  s_sub_u32 s31, s31, s28
  s_cmp_ge_u32 s31, 14
  s_cselect_b32 s28, 14, 0
  s_sub_u32 s31, s31, s28
  s_lshl_b32 s31, s31, 10
  v_add_u32 v6, s31, v7
  v_add_u32 v12, 14336, v6
  s_mov_b32 s31, s30
  v_pk_mul_f32 v[192:193], v[192:193], s[30:31]
  v_pk_mul_f32 v[194:195], v[194:195], s[30:31]
  v_pk_mul_f32 v[196:197], v[196:197], s[30:31]
  v_pk_mul_f32 v[198:199], v[198:199], s[30:31]
  v_pk_mul_f32 v[200:201], v[200:201], s[30:31]
  v_pk_mul_f32 v[202:203], v[202:203], s[30:31]
  v_pk_mul_f32 v[204:205], v[204:205], s[30:31]
  v_pk_mul_f32 v[206:207], v[206:207], s[30:31]
  v_cvt_pk_bf16_f32 v208, v192, v193
  v_cvt_pk_bf16_f32 v209, v194, v195
  v_cvt_pk_bf16_f32 v210, v196, v197
  v_cvt_pk_bf16_f32 v211, v198, v199
  v_cvt_pk_bf16_f32 v212, v200, v201
  v_cvt_pk_bf16_f32 v213, v202, v203
  v_cvt_pk_bf16_f32 v214, v204, v205
  v_cvt_pk_bf16_f32 v215, v206, v207
  global_store_dwordx4 v6, v[208:211], s[4:5]
  global_store_dwordx4 v12, v[212:215], s[4:5]
  s_waitcnt vmcnt(2)
  s_barrier
  ds_read_b128 v[128:131], v52 offset:0
  ds_read_b128 v[132:135], v53 offset:0
  ds_read_b128 v[136:139], v54 offset:0
  ds_read_b128 v[140:143], v55 offset:0
  ds_read_b128 v[144:147], v56 offset:0
  ds_read_b128 v[148:151], v57 offset:0
  ds_read_b128 v[152:155], v58 offset:0
  ds_read_b128 v[156:159], v59 offset:0
  ds_read_b128 v[160:163], v52 offset:2048
  ds_read_b128 v[164:167], v53 offset:2048
  ds_read_b128 v[168:171], v54 offset:2048
  ds_read_b128 v[172:175], v55 offset:2048
  ds_read_b128 v[176:179], v56 offset:2048
  ds_read_b128 v[180:183], v57 offset:2048
  ds_read_b128 v[184:187], v58 offset:2048
  ds_read_b128 v[188:191], v59 offset:2048
  s_waitcnt lgkmcnt(15)
  v_mfma_f32_16x16x32_bf16 v[192:195], v[128:131], v[64:67], 0
  v_mfma_f32_16x16x32_bf16 v[200:203], v[128:131], v[96:99], 0
  s_waitcnt lgkmcnt(14)
  v_mfma_f32_16x16x32_bf16 v[192:195], v[132:135], v[68:71], v[192:195]
  v_mfma_f32_16x16x32_bf16 v[200:203], v[132:135], v[100:103], v[200:203]
  s_waitcnt lgkmcnt(13)
  v_mfma_f32_16x16x32_bf16 v[192:195], v[136:139], v[72:75], v[192:195]
  v_mfma_f32_16x16x32_bf16 v[200:203], v[136:139], v[104:107], v[200:203]
  s_waitcnt lgkmcnt(12)
  v_mfma_f32_16x16x32_bf16 v[192:195], v[140:143], v[76:79], v[192:195]
  v_mfma_f32_16x16x32_bf16 v[200:203], v[140:143], v[108:111], v[200:203]
  s_waitcnt lgkmcnt(11)
  v_mfma_f32_16x16x32_bf16 v[192:195], v[144:147], v[80:83], v[192:195]
  v_mfma_f32_16x16x32_bf16 v[200:203], v[144:147], v[112:115], v[200:203]
  s_waitcnt lgkmcnt(10)
  v_mfma_f32_16x16x32_bf16 v[192:195], v[148:151], v[84:87], v[192:195]
  v_mfma_f32_16x16x32_bf16 v[200:203], v[148:151], v[116:119], v[200:203]
  s_waitcnt lgkmcnt(9)
  v_mfma_f32_16x16x32_bf16 v[192:195], v[152:155], v[88:91], v[192:195]
  v_mfma_f32_16x16x32_bf16 v[200:203], v[152:155], v[120:123], v[200:203]
  s_waitcnt lgkmcnt(8)
  v_mfma_f32_16x16x32_bf16 v[192:195], v[156:159], v[92:95], v[192:195]
  v_mfma_f32_16x16x32_bf16 v[200:203], v[156:159], v[124:127], v[200:203]
  s_waitcnt lgkmcnt(7)
  v_mfma_f32_16x16x32_bf16 v[196:199], v[160:163], v[64:67], 0
  v_mfma_f32_16x16x32_bf16 v[204:207], v[160:163], v[96:99], 0
  s_waitcnt lgkmcnt(6)
  v_mfma_f32_16x16x32_bf16 v[196:199], v[164:167], v[68:71], v[196:199]
  v_mfma_f32_16x16x32_bf16 v[204:207], v[164:167], v[100:103], v[204:207]
  s_waitcnt lgkmcnt(5)
  v_mfma_f32_16x16x32_bf16 v[196:199], v[168:171], v[72:75], v[196:199]
  v_mfma_f32_16x16x32_bf16 v[204:207], v[168:171], v[104:107], v[204:207]
  s_waitcnt lgkmcnt(4)
  v_mfma_f32_16x16x32_bf16 v[196:199], v[172:175], v[76:79], v[196:199]
  v_mfma_f32_16x16x32_bf16 v[204:207], v[172:175], v[108:111], v[204:207]
  s_waitcnt lgkmcnt(3)
  v_mfma_f32_16x16x32_bf16 v[196:199], v[176:179], v[80:83], v[196:199]
  v_mfma_f32_16x16x32_bf16 v[204:207], v[176:179], v[112:115], v[204:207]
  s_waitcnt lgkmcnt(2)
  v_mfma_f32_16x16x32_bf16 v[196:199], v[180:183], v[84:87], v[196:199]
  v_mfma_f32_16x16x32_bf16 v[204:207], v[180:183], v[116:119], v[204:207]
  s_waitcnt lgkmcnt(1)
  v_mfma_f32_16x16x32_bf16 v[196:199], v[184:187], v[88:91], v[196:199]
  v_mfma_f32_16x16x32_bf16 v[204:207], v[184:187], v[120:123], v[204:207]
  s_waitcnt lgkmcnt(0)
  v_mfma_f32_16x16x32_bf16 v[196:199], v[188:191], v[92:95], v[196:199]
  v_mfma_f32_16x16x32_bf16 v[204:207], v[188:191], v[124:127], v[204:207]
  s_add_u32 s31, s27, 12
  s_cmp_ge_u32 s31, 14
  s_cselect_b32 s28, 14, 0
  s_sub_u32 s31, s31, s28
  s_cmp_ge_u32 s31, 14
  s_cselect_b32 s28, 14, 0
  s_sub_u32 s31, s31, s28
  s_lshl_b32 s31, s31, 10
  v_add_u32 v6, s31, v7
  v_add_u32 v12, 14336, v6
  s_mov_b32 s31, s30
  v_pk_mul_f32 v[192:193], v[192:193], s[30:31]
  v_pk_mul_f32 v[194:195], v[194:195], s[30:31]
  v_pk_mul_f32 v[196:197], v[196:197], s[30:31]
  v_pk_mul_f32 v[198:199], v[198:199], s[30:31]
  v_pk_mul_f32 v[200:201], v[200:201], s[30:31]
  v_pk_mul_f32 v[202:203], v[202:203], s[30:31]
  v_pk_mul_f32 v[204:205], v[204:205], s[30:31]
  v_pk_mul_f32 v[206:207], v[206:207], s[30:31]
  v_cvt_pk_bf16_f32 v208, v192, v193
  v_cvt_pk_bf16_f32 v209, v194, v195
  v_cvt_pk_bf16_f32 v210, v196, v197
  v_cvt_pk_bf16_f32 v211, v198, v199
  v_cvt_pk_bf16_f32 v212, v200, v201
  v_cvt_pk_bf16_f32 v213, v202, v203
  v_cvt_pk_bf16_f32 v214, v204, v205
  v_cvt_pk_bf16_f32 v215, v206, v207
  global_store_dwordx4 v6, v[208:211], s[4:5]
  global_store_dwordx4 v12, v[212:215], s[4:5]
  s_endpgm
.globl fa1_kernel
.p2align 8
.type fa1_kernel,@function
fa1_kernel:
  s_mov_b32 s60, 1
fa_body:
  s_cmp_ge_u32 s2, 256
  s_cbranch_scc1 fa_end
  s_load_dwordx2 s[4:5], s[0:1], 96
  s_load_dwordx2 s[6:7], s[0:1], 0
  v_and_b32 v1, 63, v0
  v_lshrrev_b32 v2, 6, v0
  s_nop 1
  v_readfirstlane_b32 s3, v2
  s_nop 3
  s_waitcnt lgkmcnt(0)
  s_add_u32 s8, s4, 21131264
  s_addc_u32 s9, s5, 0
  s_cmp_eq_u32 s60, 0
  s_cselect_b32 s6, s6, s8
  s_cselect_b32 s7, s7, s9
  s_and_b32 s10, s2, 63
  s_lshr_b32 s11, s2, 6
  s_lshl_b32 s12, s11, 2
  s_add_u32 s12, s12, s3
  v_lshrrev_b32 v2, 3, v0
  v_and_b32 v3, 7, v0
  v_lshlrev_b32 v4, 6, v2
  v_add_u32 v4, s10, v4
  v_mul_u32_u24 v4, 896, v4
  v_lshl_add_u32 v4, v3, 4, v4
  global_load_dwordx4 v[8:11], v4, s[6:7] offset:0
  global_load_dwordx4 v[12:15], v4, s[6:7] offset:128
  global_load_dwordx4 v[16:19], v4, s[6:7] offset:256
  global_load_dwordx4 v[20:23], v4, s[6:7] offset:384
  global_load_dwordx4 v[24:27], v4, s[6:7] offset:512
  global_load_dwordx4 v[28:31], v4, s[6:7] offset:640
  global_load_dwordx4 v[32:35], v4, s[6:7] offset:768
  s_min_u32 s13, s12, 14
  s_mul_i32 s13, s13, 28672
  s_add_u32 s13, s13, 12845056
  v_lshl_add_u32 v5, v1, 4, s13
  global_load_dwordx4 v[64:67], v5, s[4:5] offset:0
  global_load_dwordx4 v[68:71], v5, s[4:5] offset:1024
  global_load_dwordx4 v[72:75], v5, s[4:5] offset:2048
  global_load_dwordx4 v[76:79], v5, s[4:5] offset:3072
  v_add_u32 v5, 4096, v5
  global_load_dwordx4 v[80:83], v5, s[4:5] offset:0
  global_load_dwordx4 v[84:87], v5, s[4:5] offset:1024
  global_load_dwordx4 v[88:91], v5, s[4:5] offset:2048
  global_load_dwordx4 v[92:95], v5, s[4:5] offset:3072
  v_add_u32 v5, 4096, v5
  global_load_dwordx4 v[96:99], v5, s[4:5] offset:0
  global_load_dwordx4 v[100:103], v5, s[4:5] offset:1024
  global_load_dwordx4 v[104:107], v5, s[4:5] offset:2048
  global_load_dwordx4 v[108:111], v5, s[4:5] offset:3072
  v_add_u32 v5, 4096, v5
  global_load_dwordx4 v[112:115], v5, s[4:5] offset:0
  global_load_dwordx4 v[116:119], v5, s[4:5] offset:1024
  global_load_dwordx4 v[120:123], v5, s[4:5] offset:2048
  global_load_dwordx4 v[124:127], v5, s[4:5] offset:3072
  v_add_u32 v5, 4096, v5
  global_load_dwordx4 v[128:131], v5, s[4:5] offset:0
  global_load_dwordx4 v[132:135], v5, s[4:5] offset:1024
  global_load_dwordx4 v[136:139], v5, s[4:5] offset:2048
  global_load_dwordx4 v[140:143], v5, s[4:5] offset:3072
  v_add_u32 v5, 4096, v5
  global_load_dwordx4 v[144:147], v5, s[4:5] offset:0
  global_load_dwordx4 v[148:151], v5, s[4:5] offset:1024
  global_load_dwordx4 v[152:155], v5, s[4:5] offset:2048
  global_load_dwordx4 v[156:159], v5, s[4:5] offset:3072
  v_add_u32 v5, 4096, v5
  global_load_dwordx4 v[160:163], v5, s[4:5] offset:0
  global_load_dwordx4 v[164:167], v5, s[4:5] offset:1024
  global_load_dwordx4 v[168:171], v5, s[4:5] offset:2048
  global_load_dwordx4 v[172:175], v5, s[4:5] offset:3072
  v_add_u32 v5, 4096, v5
  s_waitcnt vmcnt(28)
  v_lshlrev_b32 v176, 16, v8
  v_and_b32 v177, 0xffff0000, v8
  v_lshlrev_b32 v178, 16, v9
  v_and_b32 v179, 0xffff0000, v9
  v_lshlrev_b32 v180, 16, v10
  v_and_b32 v181, 0xffff0000, v10
  v_lshlrev_b32 v182, 16, v11
  v_and_b32 v183, 0xffff0000, v11
  v_lshlrev_b32 v184, 16, v12
  v_and_b32 v185, 0xffff0000, v12
  v_lshlrev_b32 v186, 16, v13
  v_and_b32 v187, 0xffff0000, v13
  v_lshlrev_b32 v188, 16, v14
  v_and_b32 v189, 0xffff0000, v14
  v_lshlrev_b32 v190, 16, v15
  v_and_b32 v191, 0xffff0000, v15
  v_lshlrev_b32 v192, 16, v16
  v_and_b32 v193, 0xffff0000, v16
  v_lshlrev_b32 v194, 16, v17
  v_and_b32 v195, 0xffff0000, v17
  v_lshlrev_b32 v196, 16, v18
  v_and_b32 v197, 0xffff0000, v18
  v_lshlrev_b32 v198, 16, v19
  v_and_b32 v199, 0xffff0000, v19
  v_lshlrev_b32 v200, 16, v20
  v_and_b32 v201, 0xffff0000, v20
  v_lshlrev_b32 v202, 16, v21
  v_and_b32 v203, 0xffff0000, v21
  v_lshlrev_b32 v204, 16, v22
  v_and_b32 v205, 0xffff0000, v22
  v_lshlrev_b32 v206, 16, v23
  v_and_b32 v207, 0xffff0000, v23
  v_lshlrev_b32 v208, 16, v24
  v_and_b32 v209, 0xffff0000, v24
  v_lshlrev_b32 v210, 16, v25
  v_and_b32 v211, 0xffff0000, v25
  v_lshlrev_b32 v212, 16, v26
  v_and_b32 v213, 0xffff0000, v26
  v_lshlrev_b32 v214, 16, v27
  v_and_b32 v215, 0xffff0000, v27
  v_lshlrev_b32 v216, 16, v28
  v_and_b32 v217, 0xffff0000, v28
  v_lshlrev_b32 v218, 16, v29
  v_and_b32 v219, 0xffff0000, v29
  v_lshlrev_b32 v220, 16, v30
  v_and_b32 v221, 0xffff0000, v30
  v_lshlrev_b32 v222, 16, v31
  v_and_b32 v223, 0xffff0000, v31
  v_lshlrev_b32 v224, 16, v32
  v_and_b32 v225, 0xffff0000, v32
  v_lshlrev_b32 v226, 16, v33
  v_and_b32 v227, 0xffff0000, v33
  v_lshlrev_b32 v228, 16, v34
  v_and_b32 v229, 0xffff0000, v34
  v_lshlrev_b32 v230, 16, v35
  v_and_b32 v231, 0xffff0000, v35
  v_pk_add_f32 v[40:41], v[176:177], v[178:179]
  v_pk_add_f32 v[42:43], v[180:181], v[182:183]
  v_pk_add_f32 v[40:41], v[40:41], v[184:185]
  v_pk_add_f32 v[42:43], v[42:43], v[186:187]
  v_pk_add_f32 v[40:41], v[40:41], v[188:189]
  v_pk_add_f32 v[42:43], v[42:43], v[190:191]
  v_pk_add_f32 v[40:41], v[40:41], v[192:193]
  v_pk_add_f32 v[42:43], v[42:43], v[194:195]
  v_pk_add_f32 v[40:41], v[40:41], v[196:197]
  v_pk_add_f32 v[42:43], v[42:43], v[198:199]
  v_pk_add_f32 v[40:41], v[40:41], v[200:201]
  v_pk_add_f32 v[42:43], v[42:43], v[202:203]
  v_pk_add_f32 v[40:41], v[40:41], v[204:205]
  v_pk_add_f32 v[42:43], v[42:43], v[206:207]
  v_pk_add_f32 v[40:41], v[40:41], v[208:209]
  v_pk_add_f32 v[42:43], v[42:43], v[210:211]
  v_pk_add_f32 v[40:41], v[40:41], v[212:213]
  v_pk_add_f32 v[42:43], v[42:43], v[214:215]
  v_pk_add_f32 v[40:41], v[40:41], v[216:217]
  v_pk_add_f32 v[42:43], v[42:43], v[218:219]
  v_pk_add_f32 v[40:41], v[40:41], v[220:221]
  v_pk_add_f32 v[42:43], v[42:43], v[222:223]
  v_pk_add_f32 v[40:41], v[40:41], v[224:225]
  v_pk_add_f32 v[42:43], v[42:43], v[226:227]
  v_pk_add_f32 v[40:41], v[40:41], v[228:229]
  v_pk_add_f32 v[42:43], v[42:43], v[230:231]
  v_pk_add_f32 v[40:41], v[40:41], v[42:43]
  v_add_f32 v44, v40, v41
  s_nop 1
  v_add_f32_dpp v44, v44, v44 quad_perm:[1,0,3,2] row_mask:0xf bank_mask:0xf
  s_nop 1
  v_add_f32_dpp v44, v44, v44 quad_perm:[2,3,0,1] row_mask:0xf bank_mask:0xf
  s_nop 1
  v_add_f32_dpp v44, v44, v44 row_half_mirror row_mask:0xf bank_mask:0xf
  v_mul_f32 v44, 0x3b124925, v44
  v_mov_b64 v[40:41], 0
  v_mov_b64 v[42:43], 0
  v_pk_add_f32 v[48:49], v[176:177], v[44:45] op_sel_hi:[1,0] neg_lo:[0,1] neg_hi:[0,1]
  v_pk_fma_f32 v[40:41], v[48:49], v[48:49], v[40:41]
  v_pk_add_f32 v[50:51], v[178:179], v[44:45] op_sel_hi:[1,0] neg_lo:[0,1] neg_hi:[0,1]
  v_pk_fma_f32 v[42:43], v[50:51], v[50:51], v[42:43]
  v_pk_add_f32 v[48:49], v[180:181], v[44:45] op_sel_hi:[1,0] neg_lo:[0,1] neg_hi:[0,1]
  v_pk_fma_f32 v[40:41], v[48:49], v[48:49], v[40:41]
  v_pk_add_f32 v[50:51], v[182:183], v[44:45] op_sel_hi:[1,0] neg_lo:[0,1] neg_hi:[0,1]
  v_pk_fma_f32 v[42:43], v[50:51], v[50:51], v[42:43]
  v_pk_add_f32 v[48:49], v[184:185], v[44:45] op_sel_hi:[1,0] neg_lo:[0,1] neg_hi:[0,1]
  v_pk_fma_f32 v[40:41], v[48:49], v[48:49], v[40:41]
  v_pk_add_f32 v[50:51], v[186:187], v[44:45] op_sel_hi:[1,0] neg_lo:[0,1] neg_hi:[0,1]
  v_pk_fma_f32 v[42:43], v[50:51], v[50:51], v[42:43]
  v_pk_add_f32 v[48:49], v[188:189], v[44:45] op_sel_hi:[1,0] neg_lo:[0,1] neg_hi:[0,1]
  v_pk_fma_f32 v[40:41], v[48:49], v[48:49], v[40:41]
  v_pk_add_f32 v[50:51], v[190:191], v[44:45] op_sel_hi:[1,0] neg_lo:[0,1] neg_hi:[0,1]
  v_pk_fma_f32 v[42:43], v[50:51], v[50:51], v[42:43]
  v_pk_add_f32 v[48:49], v[192:193], v[44:45] op_sel_hi:[1,0] neg_lo:[0,1] neg_hi:[0,1]
  v_pk_fma_f32 v[40:41], v[48:49], v[48:49], v[40:41]
  v_pk_add_f32 v[50:51], v[194:195], v[44:45] op_sel_hi:[1,0] neg_lo:[0,1] neg_hi:[0,1]
  v_pk_fma_f32 v[42:43], v[50:51], v[50:51], v[42:43]
  v_pk_add_f32 v[48:49], v[196:197], v[44:45] op_sel_hi:[1,0] neg_lo:[0,1] neg_hi:[0,1]
  v_pk_fma_f32 v[40:41], v[48:49], v[48:49], v[40:41]
  v_pk_add_f32 v[50:51], v[198:199], v[44:45] op_sel_hi:[1,0] neg_lo:[0,1] neg_hi:[0,1]
  v_pk_fma_f32 v[42:43], v[50:51], v[50:51], v[42:43]
  v_pk_add_f32 v[48:49], v[200:201], v[44:45] op_sel_hi:[1,0] neg_lo:[0,1] neg_hi:[0,1]
  v_pk_fma_f32 v[40:41], v[48:49], v[48:49], v[40:41]
  v_pk_add_f32 v[50:51], v[202:203], v[44:45] op_sel_hi:[1,0] neg_lo:[0,1] neg_hi:[0,1]
  v_pk_fma_f32 v[42:43], v[50:51], v[50:51], v[42:43]
  v_pk_add_f32 v[48:49], v[204:205], v[44:45] op_sel_hi:[1,0] neg_lo:[0,1] neg_hi:[0,1]
  v_pk_fma_f32 v[40:41], v[48:49], v[48:49], v[40:41]
  v_pk_add_f32 v[50:51], v[206:207], v[44:45] op_sel_hi:[1,0] neg_lo:[0,1] neg_hi:[0,1]
  v_pk_fma_f32 v[42:43], v[50:51], v[50:51], v[42:43]
  v_pk_add_f32 v[48:49], v[208:209], v[44:45] op_sel_hi:[1,0] neg_lo:[0,1] neg_hi:[0,1]
  v_pk_fma_f32 v[40:41], v[48:49], v[48:49], v[40:41]
  v_pk_add_f32 v[50:51], v[210:211], v[44:45] op_sel_hi:[1,0] neg_lo:[0,1] neg_hi:[0,1]
  v_pk_fma_f32 v[42:43], v[50:51], v[50:51], v[42:43]
  v_pk_add_f32 v[48:49], v[212:213], v[44:45] op_sel_hi:[1,0] neg_lo:[0,1] neg_hi:[0,1]
  v_pk_fma_f32 v[40:41], v[48:49], v[48:49], v[40:41]
  v_pk_add_f32 v[50:51], v[214:215], v[44:45] op_sel_hi:[1,0] neg_lo:[0,1] neg_hi:[0,1]
  v_pk_fma_f32 v[42:43], v[50:51], v[50:51], v[42:43]
  v_pk_add_f32 v[48:49], v[216:217], v[44:45] op_sel_hi:[1,0] neg_lo:[0,1] neg_hi:[0,1]
  v_pk_fma_f32 v[40:41], v[48:49], v[48:49], v[40:41]
  v_pk_add_f32 v[50:51], v[218:219], v[44:45] op_sel_hi:[1,0] neg_lo:[0,1] neg_hi:[0,1]
  v_pk_fma_f32 v[42:43], v[50:51], v[50:51], v[42:43]
  v_pk_add_f32 v[48:49], v[220:221], v[44:45] op_sel_hi:[1,0] neg_lo:[0,1] neg_hi:[0,1]
  v_pk_fma_f32 v[40:41], v[48:49], v[48:49], v[40:41]
  v_pk_add_f32 v[50:51], v[222:223], v[44:45] op_sel_hi:[1,0] neg_lo:[0,1] neg_hi:[0,1]
  v_pk_fma_f32 v[42:43], v[50:51], v[50:51], v[42:43]
  v_pk_add_f32 v[48:49], v[224:225], v[44:45] op_sel_hi:[1,0] neg_lo:[0,1] neg_hi:[0,1]
  v_pk_fma_f32 v[40:41], v[48:49], v[48:49], v[40:41]
  v_pk_add_f32 v[50:51], v[226:227], v[44:45] op_sel_hi:[1,0] neg_lo:[0,1] neg_hi:[0,1]
  v_pk_fma_f32 v[42:43], v[50:51], v[50:51], v[42:43]
  v_pk_add_f32 v[48:49], v[228:229], v[44:45] op_sel_hi:[1,0] neg_lo:[0,1] neg_hi:[0,1]
  v_pk_fma_f32 v[40:41], v[48:49], v[48:49], v[40:41]
  v_pk_add_f32 v[50:51], v[230:231], v[44:45] op_sel_hi:[1,0] neg_lo:[0,1] neg_hi:[0,1]
  v_pk_fma_f32 v[42:43], v[50:51], v[50:51], v[42:43]
  v_pk_add_f32 v[40:41], v[40:41], v[42:43]
  v_add_f32 v40, v40, v41
  s_nop 1
  v_add_f32_dpp v40, v40, v40 quad_perm:[1,0,3,2] row_mask:0xf bank_mask:0xf
  s_nop 1
  v_add_f32_dpp v40, v40, v40 quad_perm:[2,3,0,1] row_mask:0xf bank_mask:0xf
  s_nop 1
  v_add_f32_dpp v40, v40, v40 row_half_mirror row_mask:0xf bank_mask:0xf
  v_mul_f32 v40, 0x3b124925, v40
  v_cvt_pk_bf16_f32 v42, v44, v44
  v_lshlrev_b32 v42, 16, v42
  v_cvt_pk_bf16_f32 v43, v40, v40
  v_lshlrev_b32 v43, 16, v43
  v_add_f32 v43, 0x3727c5ac, v43
  v_cvt_pk_bf16_f32 v43, v43, v43
  v_lshlrev_b32 v43, 16, v43
  v_sqrt_f32 v43, v43
  s_nop 0
  v_cvt_pk_bf16_f32 v43, v43, v43
  v_lshlrev_b32 v43, 16, v43
  v_rcp_f32 v46, v43
  s_nop 0
  v_fma_f32 v43, -v43, v46, 2.0
  v_mul_f32 v46, v46, v43
  v_pk_add_f32 v[48:49], v[176:177], v[42:43] op_sel_hi:[1,0] neg_lo:[0,1] neg_hi:[0,1]
  v_cvt_pk_bf16_f32 v40, v48, v49
  v_lshlrev_b32 v48, 16, v40
  v_and_b32 v49, 0xffff0000, v40
  v_pk_mul_f32 v[48:49], v[48:49], v[46:47] op_sel_hi:[1,0]
  v_cvt_pk_bf16_f32 v8, v48, v49
  v_pk_add_f32 v[50:51], v[178:179], v[42:43] op_sel_hi:[1,0] neg_lo:[0,1] neg_hi:[0,1]
  v_cvt_pk_bf16_f32 v40, v50, v51
  v_lshlrev_b32 v50, 16, v40
  v_and_b32 v51, 0xffff0000, v40
  v_pk_mul_f32 v[50:51], v[50:51], v[46:47] op_sel_hi:[1,0]
  v_cvt_pk_bf16_f32 v9, v50, v51
  v_pk_add_f32 v[48:49], v[180:181], v[42:43] op_sel_hi:[1,0] neg_lo:[0,1] neg_hi:[0,1]
  v_cvt_pk_bf16_f32 v40, v48, v49
  v_lshlrev_b32 v48, 16, v40
  v_and_b32 v49, 0xffff0000, v40
  v_pk_mul_f32 v[48:49], v[48:49], v[46:47] op_sel_hi:[1,0]
  v_cvt_pk_bf16_f32 v10, v48, v49
  v_pk_add_f32 v[50:51], v[182:183], v[42:43] op_sel_hi:[1,0] neg_lo:[0,1] neg_hi:[0,1]
  v_cvt_pk_bf16_f32 v40, v50, v51
  v_lshlrev_b32 v50, 16, v40
  v_and_b32 v51, 0xffff0000, v40
  v_pk_mul_f32 v[50:51], v[50:51], v[46:47] op_sel_hi:[1,0]
  v_cvt_pk_bf16_f32 v11, v50, v51
  v_pk_add_f32 v[48:49], v[184:185], v[42:43] op_sel_hi:[1,0] neg_lo:[0,1] neg_hi:[0,1]
  v_cvt_pk_bf16_f32 v40, v48, v49
  v_lshlrev_b32 v48, 16, v40
  v_and_b32 v49, 0xffff0000, v40
  v_pk_mul_f32 v[48:49], v[48:49], v[46:47] op_sel_hi:[1,0]
  v_cvt_pk_bf16_f32 v12, v48, v49
  v_pk_add_f32 v[50:51], v[186:187], v[42:43] op_sel_hi:[1,0] neg_lo:[0,1] neg_hi:[0,1]
  v_cvt_pk_bf16_f32 v40, v50, v51
  v_lshlrev_b32 v50, 16, v40
  v_and_b32 v51, 0xffff0000, v40
  v_pk_mul_f32 v[50:51], v[50:51], v[46:47] op_sel_hi:[1,0]
  v_cvt_pk_bf16_f32 v13, v50, v51
  v_pk_add_f32 v[48:49], v[188:189], v[42:43] op_sel_hi:[1,0] neg_lo:[0,1] neg_hi:[0,1]
  v_cvt_pk_bf16_f32 v40, v48, v49
  v_lshlrev_b32 v48, 16, v40
  v_and_b32 v49, 0xffff0000, v40
  v_pk_mul_f32 v[48:49], v[48:49], v[46:47] op_sel_hi:[1,0]
  v_cvt_pk_bf16_f32 v14, v48, v49
  v_pk_add_f32 v[50:51], v[190:191], v[42:43] op_sel_hi:[1,0] neg_lo:[0,1] neg_hi:[0,1]
  v_cvt_pk_bf16_f32 v40, v50, v51
  v_lshlrev_b32 v50, 16, v40
  v_and_b32 v51, 0xffff0000, v40
  v_pk_mul_f32 v[50:51], v[50:51], v[46:47] op_sel_hi:[1,0]
  v_cvt_pk_bf16_f32 v15, v50, v51
  v_pk_add_f32 v[48:49], v[192:193], v[42:43] op_sel_hi:[1,0] neg_lo:[0,1] neg_hi:[0,1]
  v_cvt_pk_bf16_f32 v40, v48, v49
  v_lshlrev_b32 v48, 16, v40
  v_and_b32 v49, 0xffff0000, v40
  v_pk_mul_f32 v[48:49], v[48:49], v[46:47] op_sel_hi:[1,0]
  v_cvt_pk_bf16_f32 v16, v48, v49
  v_pk_add_f32 v[50:51], v[194:195], v[42:43] op_sel_hi:[1,0] neg_lo:[0,1] neg_hi:[0,1]
  v_cvt_pk_bf16_f32 v40, v50, v51
  v_lshlrev_b32 v50, 16, v40
  v_and_b32 v51, 0xffff0000, v40
  v_pk_mul_f32 v[50:51], v[50:51], v[46:47] op_sel_hi:[1,0]
  v_cvt_pk_bf16_f32 v17, v50, v51
  v_pk_add_f32 v[48:49], v[196:197], v[42:43] op_sel_hi:[1,0] neg_lo:[0,1] neg_hi:[0,1]
  v_cvt_pk_bf16_f32 v40, v48, v49
  v_lshlrev_b32 v48, 16, v40
  v_and_b32 v49, 0xffff0000, v40
  v_pk_mul_f32 v[48:49], v[48:49], v[46:47] op_sel_hi:[1,0]
  v_cvt_pk_bf16_f32 v18, v48, v49
  v_pk_add_f32 v[50:51], v[198:199], v[42:43] op_sel_hi:[1,0] neg_lo:[0,1] neg_hi:[0,1]
  v_cvt_pk_bf16_f32 v40, v50, v51
  v_lshlrev_b32 v50, 16, v40
  v_and_b32 v51, 0xffff0000, v40
  v_pk_mul_f32 v[50:51], v[50:51], v[46:47] op_sel_hi:[1,0]
  v_cvt_pk_bf16_f32 v19, v50, v51
  v_pk_add_f32 v[48:49], v[200:201], v[42:43] op_sel_hi:[1,0] neg_lo:[0,1] neg_hi:[0,1]
  v_cvt_pk_bf16_f32 v40, v48, v49
  v_lshlrev_b32 v48, 16, v40
  v_and_b32 v49, 0xffff0000, v40
  v_pk_mul_f32 v[48:49], v[48:49], v[46:47] op_sel_hi:[1,0]
  v_cvt_pk_bf16_f32 v20, v48, v49
  v_pk_add_f32 v[50:51], v[202:203], v[42:43] op_sel_hi:[1,0] neg_lo:[0,1] neg_hi:[0,1]
  v_cvt_pk_bf16_f32 v40, v50, v51
  v_lshlrev_b32 v50, 16, v40
  v_and_b32 v51, 0xffff0000, v40
  v_pk_mul_f32 v[50:51], v[50:51], v[46:47] op_sel_hi:[1,0]
  v_cvt_pk_bf16_f32 v21, v50, v51
  v_pk_add_f32 v[48:49], v[204:205], v[42:43] op_sel_hi:[1,0] neg_lo:[0,1] neg_hi:[0,1]
  v_cvt_pk_bf16_f32 v40, v48, v49
  v_lshlrev_b32 v48, 16, v40
  v_and_b32 v49, 0xffff0000, v40
  v_pk_mul_f32 v[48:49], v[48:49], v[46:47] op_sel_hi:[1,0]
  v_cvt_pk_bf16_f32 v22, v48, v49
  v_pk_add_f32 v[50:51], v[206:207], v[42:43] op_sel_hi:[1,0] neg_lo:[0,1] neg_hi:[0,1]
  v_cvt_pk_bf16_f32 v40, v50, v51
  v_lshlrev_b32 v50, 16, v40
  v_and_b32 v51, 0xffff0000, v40
  v_pk_mul_f32 v[50:51], v[50:51], v[46:47] op_sel_hi:[1,0]
  v_cvt_pk_bf16_f32 v23, v50, v51
  v_pk_add_f32 v[48:49], v[208:209], v[42:43] op_sel_hi:[1,0] neg_lo:[0,1] neg_hi:[0,1]
  v_cvt_pk_bf16_f32 v40, v48, v49
  v_lshlrev_b32 v48, 16, v40
  v_and_b32 v49, 0xffff0000, v40
  v_pk_mul_f32 v[48:49], v[48:49], v[46:47] op_sel_hi:[1,0]
  v_cvt_pk_bf16_f32 v24, v48, v49
  v_pk_add_f32 v[50:51], v[210:211], v[42:43] op_sel_hi:[1,0] neg_lo:[0,1] neg_hi:[0,1]
  v_cvt_pk_bf16_f32 v40, v50, v51
  v_lshlrev_b32 v50, 16, v40
  v_and_b32 v51, 0xffff0000, v40
  v_pk_mul_f32 v[50:51], v[50:51], v[46:47] op_sel_hi:[1,0]
  v_cvt_pk_bf16_f32 v25, v50, v51
  v_pk_add_f32 v[48:49], v[212:213], v[42:43] op_sel_hi:[1,0] neg_lo:[0,1] neg_hi:[0,1]
  v_cvt_pk_bf16_f32 v40, v48, v49
  v_lshlrev_b32 v48, 16, v40
  v_and_b32 v49, 0xffff0000, v40
  v_pk_mul_f32 v[48:49], v[48:49], v[46:47] op_sel_hi:[1,0]
  v_cvt_pk_bf16_f32 v26, v48, v49
  v_pk_add_f32 v[50:51], v[214:215], v[42:43] op_sel_hi:[1,0] neg_lo:[0,1] neg_hi:[0,1]
  v_cvt_pk_bf16_f32 v40, v50, v51
  v_lshlrev_b32 v50, 16, v40
  v_and_b32 v51, 0xffff0000, v40
  v_pk_mul_f32 v[50:51], v[50:51], v[46:47] op_sel_hi:[1,0]
  v_cvt_pk_bf16_f32 v27, v50, v51
  v_pk_add_f32 v[48:49], v[216:217], v[42:43] op_sel_hi:[1,0] neg_lo:[0,1] neg_hi:[0,1]
  v_cvt_pk_bf16_f32 v40, v48, v49
  v_lshlrev_b32 v48, 16, v40
  v_and_b32 v49, 0xffff0000, v40
  v_pk_mul_f32 v[48:49], v[48:49], v[46:47] op_sel_hi:[1,0]
  v_cvt_pk_bf16_f32 v28, v48, v49
  v_pk_add_f32 v[50:51], v[218:219], v[42:43] op_sel_hi:[1,0] neg_lo:[0,1] neg_hi:[0,1]
  v_cvt_pk_bf16_f32 v40, v50, v51
  v_lshlrev_b32 v50, 16, v40
  v_and_b32 v51, 0xffff0000, v40
  v_pk_mul_f32 v[50:51], v[50:51], v[46:47] op_sel_hi:[1,0]
  v_cvt_pk_bf16_f32 v29, v50, v51
  v_pk_add_f32 v[48:49], v[220:221], v[42:43] op_sel_hi:[1,0] neg_lo:[0,1] neg_hi:[0,1]
  v_cvt_pk_bf16_f32 v40, v48, v49
  v_lshlrev_b32 v48, 16, v40
  v_and_b32 v49, 0xffff0000, v40
  v_pk_mul_f32 v[48:49], v[48:49], v[46:47] op_sel_hi:[1,0]
  v_cvt_pk_bf16_f32 v30, v48, v49
  v_pk_add_f32 v[50:51], v[222:223], v[42:43] op_sel_hi:[1,0] neg_lo:[0,1] neg_hi:[0,1]
  v_cvt_pk_bf16_f32 v40, v50, v51
  v_lshlrev_b32 v50, 16, v40
  v_and_b32 v51, 0xffff0000, v40
  v_pk_mul_f32 v[50:51], v[50:51], v[46:47] op_sel_hi:[1,0]
  v_cvt_pk_bf16_f32 v31, v50, v51
  v_pk_add_f32 v[48:49], v[224:225], v[42:43] op_sel_hi:[1,0] neg_lo:[0,1] neg_hi:[0,1]
  v_cvt_pk_bf16_f32 v40, v48, v49
  v_lshlrev_b32 v48, 16, v40
  v_and_b32 v49, 0xffff0000, v40
  v_pk_mul_f32 v[48:49], v[48:49], v[46:47] op_sel_hi:[1,0]
  v_cvt_pk_bf16_f32 v32, v48, v49
  v_pk_add_f32 v[50:51], v[226:227], v[42:43] op_sel_hi:[1,0] neg_lo:[0,1] neg_hi:[0,1]
  v_cvt_pk_bf16_f32 v40, v50, v51
  v_lshlrev_b32 v50, 16, v40
  v_and_b32 v51, 0xffff0000, v40
  v_pk_mul_f32 v[50:51], v[50:51], v[46:47] op_sel_hi:[1,0]
  v_cvt_pk_bf16_f32 v33, v50, v51
  v_pk_add_f32 v[48:49], v[228:229], v[42:43] op_sel_hi:[1,0] neg_lo:[0,1] neg_hi:[0,1]
  v_cvt_pk_bf16_f32 v40, v48, v49
  v_lshlrev_b32 v48, 16, v40
  v_and_b32 v49, 0xffff0000, v40
  v_pk_mul_f32 v[48:49], v[48:49], v[46:47] op_sel_hi:[1,0]
  v_cvt_pk_bf16_f32 v34, v48, v49
  v_pk_add_f32 v[50:51], v[230:231], v[42:43] op_sel_hi:[1,0] neg_lo:[0,1] neg_hi:[0,1]
  v_cvt_pk_bf16_f32 v40, v50, v51
  v_lshlrev_b32 v50, 16, v40
  v_and_b32 v51, 0xffff0000, v40
  v_pk_mul_f32 v[50:51], v[50:51], v[46:47] op_sel_hi:[1,0]
  v_cvt_pk_bf16_f32 v35, v50, v51
  v_lshrrev_b32 v5, 1, v3
  v_mul_u32_u24 v5, 1056, v5
  v_and_b32 v6, 1, v3
  v_mul_u32_u24 v6, 528, v6
  v_add_u32 v5, v5, v6
  v_lshl_add_u32 v5, v2, 4, v5
  ds_write_b128 v5, v[8:11] offset:0
  ds_write_b128 v5, v[12:15] offset:4224
  ds_write_b128 v5, v[16:19] offset:8448
  ds_write_b128 v5, v[20:23] offset:12672
  ds_write_b128 v5, v[24:27] offset:16896
  ds_write_b128 v5, v[28:31] offset:21120
  ds_write_b128 v5, v[32:35] offset:25344
  s_waitcnt lgkmcnt(0)
  s_barrier
  s_cmp_ge_u32 s12, 15
  s_cbranch_scc1 fa_side
  v_and_b32 v5, 31, v1
  v_lshrrev_b32 v6, 5, v1
  v_mul_u32_u24 v6, 528, v6
  v_lshl_add_u32 v5, v5, 4, v6
  ds_read_b128 v[8:11], v5 offset:0
  ds_read_b128 v[12:15], v5 offset:1056
  ds_read_b128 v[16:19], v5 offset:2112
  ds_read_b128 v[20:23], v5 offset:3168
  ds_read_b128 v[24:27], v5 offset:4224
  ds_read_b128 v[28:31], v5 offset:5280
  ds_read_b128 v[32:35], v5 offset:6336
  ds_read_b128 v[36:39], v5 offset:7392
  s_waitcnt vmcnt(0)
  s_waitcnt lgkmcnt(7)
  v_mfma_f32_32x32x16_bf16 v[240:255], v[8:11], v[64:67], 0
  ds_read_b128 v[8:11], v5 offset:8448
  s_waitcnt lgkmcnt(7)
  v_mfma_f32_32x32x16_bf16 v[240:255], v[12:15], v[68:71], v[240:255]
  ds_read_b128 v[12:15], v5 offset:9504
  s_waitcnt lgkmcnt(7)
  v_mfma_f32_32x32x16_bf16 v[240:255], v[16:19], v[72:75], v[240:255]
  ds_read_b128 v[16:19], v5 offset:10560
  s_waitcnt lgkmcnt(7)
  v_mfma_f32_32x32x16_bf16 v[240:255], v[20:23], v[76:79], v[240:255]
  ds_read_b128 v[20:23], v5 offset:11616
  s_waitcnt lgkmcnt(7)
  v_mfma_f32_32x32x16_bf16 v[240:255], v[24:27], v[80:83], v[240:255]
  ds_read_b128 v[24:27], v5 offset:12672
  s_waitcnt lgkmcnt(7)
  v_mfma_f32_32x32x16_bf16 v[240:255], v[28:31], v[84:87], v[240:255]
  ds_read_b128 v[28:31], v5 offset:13728
  s_waitcnt lgkmcnt(7)
  v_mfma_f32_32x32x16_bf16 v[240:255], v[32:35], v[88:91], v[240:255]
  ds_read_b128 v[32:35], v5 offset:14784
  s_waitcnt lgkmcnt(7)
  v_mfma_f32_32x32x16_bf16 v[240:255], v[36:39], v[92:95], v[240:255]
  ds_read_b128 v[36:39], v5 offset:15840
  s_waitcnt lgkmcnt(7)
  v_mfma_f32_32x32x16_bf16 v[240:255], v[8:11], v[96:99], v[240:255]
  ds_read_b128 v[8:11], v5 offset:16896
  s_waitcnt lgkmcnt(7)
  v_mfma_f32_32x32x16_bf16 v[240:255], v[12:15], v[100:103], v[240:255]
  ds_read_b128 v[12:15], v5 offset:17952
  s_waitcnt lgkmcnt(7)
  v_mfma_f32_32x32x16_bf16 v[240:255], v[16:19], v[104:107], v[240:255]
  ds_read_b128 v[16:19], v5 offset:19008
  s_waitcnt lgkmcnt(7)
  v_mfma_f32_32x32x16_bf16 v[240:255], v[20:23], v[108:111], v[240:255]
  ds_read_b128 v[20:23], v5 offset:20064
  s_waitcnt lgkmcnt(7)
  v_mfma_f32_32x32x16_bf16 v[240:255], v[24:27], v[112:115], v[240:255]
  ds_read_b128 v[24:27], v5 offset:21120
  s_waitcnt lgkmcnt(7)
  v_mfma_f32_32x32x16_bf16 v[240:255], v[28:31], v[116:119], v[240:255]
  ds_read_b128 v[28:31], v5 offset:22176
  s_waitcnt lgkmcnt(7)
  v_mfma_f32_32x32x16_bf16 v[240:255], v[32:35], v[120:123], v[240:255]
  ds_read_b128 v[32:35], v5 offset:23232
  s_waitcnt lgkmcnt(7)
  v_mfma_f32_32x32x16_bf16 v[240:255], v[36:39], v[124:127], v[240:255]
  ds_read_b128 v[36:39], v5 offset:24288
  s_waitcnt lgkmcnt(7)
  v_mfma_f32_32x32x16_bf16 v[240:255], v[8:11], v[128:131], v[240:255]
  ds_read_b128 v[8:11], v5 offset:25344
  s_waitcnt lgkmcnt(7)
  v_mfma_f32_32x32x16_bf16 v[240:255], v[12:15], v[132:135], v[240:255]
  ds_read_b128 v[12:15], v5 offset:26400
  s_waitcnt lgkmcnt(7)
  v_mfma_f32_32x32x16_bf16 v[240:255], v[16:19], v[136:139], v[240:255]
  ds_read_b128 v[16:19], v5 offset:27456
  s_waitcnt lgkmcnt(7)
  v_mfma_f32_32x32x16_bf16 v[240:255], v[20:23], v[140:143], v[240:255]
  ds_read_b128 v[20:23], v5 offset:28512
  s_waitcnt lgkmcnt(7)
  v_mfma_f32_32x32x16_bf16 v[240:255], v[24:27], v[144:147], v[240:255]
  s_waitcnt lgkmcnt(6)
  v_mfma_f32_32x32x16_bf16 v[240:255], v[28:31], v[148:151], v[240:255]
  s_waitcnt lgkmcnt(5)
  v_mfma_f32_32x32x16_bf16 v[240:255], v[32:35], v[152:155], v[240:255]
  s_waitcnt lgkmcnt(4)
  v_mfma_f32_32x32x16_bf16 v[240:255], v[36:39], v[156:159], v[240:255]
  s_waitcnt lgkmcnt(3)
  v_mfma_f32_32x32x16_bf16 v[240:255], v[8:11], v[160:163], v[240:255]
  s_waitcnt lgkmcnt(2)
  v_mfma_f32_32x32x16_bf16 v[240:255], v[12:15], v[164:167], v[240:255]
  s_waitcnt lgkmcnt(1)
  v_mfma_f32_32x32x16_bf16 v[240:255], v[16:19], v[168:171], v[240:255]
  s_waitcnt lgkmcnt(0)
  v_mfma_f32_32x32x16_bf16 v[240:255], v[20:23], v[172:175], v[240:255]
  v_and_b32 v5, 31, v1
  s_lshl_b32 s13, s12, 5
  v_add_u32 v5, s13, v5
  v_lshlrev_b32 v5, 12, v5
  v_lshrrev_b32 v6, 5, v1
  v_lshl_add_u32 v5, v6, 9, v5
  s_lshr_b32 s13, s10, 5
  s_lshl_b32 s13, s13, 11
  s_and_b32 s14, s10, 31
  s_lshl_b32 s14, s14, 4
  s_add_u32 s13, s13, s14
  s_add_u32 s13, s13, 15429632
  v_add_u32 v5, s13, v5
  s_nop 5
  v_cvt_pk_bf16_f32 v8, v240, v241
  v_cvt_pk_bf16_f32 v9, v242, v243
  v_cvt_pk_bf16_f32 v10, v244, v245
  v_cvt_pk_bf16_f32 v11, v246, v247
  v_cvt_pk_bf16_f32 v12, v248, v249
  v_cvt_pk_bf16_f32 v13, v250, v251
  v_cvt_pk_bf16_f32 v14, v252, v253
  v_cvt_pk_bf16_f32 v15, v254, v255
  global_store_dwordx2 v5, v[8:9], s[4:5] offset:0
  global_store_dwordx2 v5, v[10:11], s[4:5] offset:8
  global_store_dwordx2 v5, v[12:13], s[4:5] offset:1024
  global_store_dwordx2 v5, v[14:15], s[4:5] offset:1032
fa_side:
  s_cmp_lg_u32 s60, 0
  s_cbranch_scc1 fa_end
  s_cmp_ge_u32 s2, 232
  s_cbranch_scc1 P_wt_skip1
  s_cmp_lg_u32 s3, 0
  s_cbranch_scc1 P_wt_skip1
  s_load_dwordx2 s[40:41], s[0:1], 8
  s_load_dwordx2 s[42:43], s[0:1], 16
  s_lshr_b32 s11, s2, 3
  s_lshl_b32 s11, s11, 3
  s_min_u32 s44, s11, 217
  s_and_b32 s45, s2, 7
  v_and_b32 v2, 31, v1
  v_lshrrev_b32 v3, 5, v1
  v_lshlrev_b32 v3, 7, v3
  v_add_u32 v2, v2, v3
  s_lshl_b32 s11, s45, 8
  v_add_u32 v2, s11, v2
  v_mul_u32_u24 v2, 450, v2
  s_lshl_b32 s11, s44, 1
  v_add_u32 v2, s11, v2
  s_waitcnt lgkmcnt(0)
  v_add_u32 v5, 0, v2
  global_load_dwordx4 v[128:131], v5, s[40:41]
  global_load_dwordx4 v[144:147], v5, s[42:43]
  v_add_u32 v5, 14400, v2
  global_load_dwordx4 v[132:135], v5, s[40:41]
  global_load_dwordx4 v[148:151], v5, s[42:43]
  v_add_u32 v5, 28800, v2
  global_load_dwordx4 v[136:139], v5, s[40:41]
  global_load_dwordx4 v[152:155], v5, s[42:43]
  v_add_u32 v5, 43200, v2
  global_load_dwordx4 v[140:143], v5, s[40:41]
  global_load_dwordx4 v[156:159], v5, s[42:43]
P_wt_skip1:
  s_lshl_b32 s11, s2, 8
  v_add_u32 v2, s11, v0
  v_mov_b32 v4, -1
  v_mov_b32 v5, -1
  v_mov_b32 v6, -1
  v_mov_b32 v7, -1
  v_add_u32 v8, 0, v2
  v_lshlrev_b32 v8, 4, v8
  v_add_u32 v8, 57061376, v8
  global_store_dwordx4 v8, v[4:7], s[4:5]
  v_add_u32 v8, 0, v2
  v_cmp_gt_u32 vcc, 49920, v8
  s_and_saveexec_b64 s[12:13], vcc
  s_cbranch_execz fa_f1_0
  v_lshlrev_b32 v8, 4, v8
  v_add_u32 v8, 59174912, v8
  global_store_dwordx4 v8, v[4:7], s[4:5]
fa_f1_0:
  s_mov_b64 exec, s[12:13]
  v_add_u32 v8, 0, v2
  v_cmp_gt_u32 vcc, 32768, v8
  s_and_saveexec_b64 s[12:13], vcc
  s_cbranch_execz fa_f2_0
  v_lshlrev_b32 v8, 4, v8
  v_add_u32 v8, 60846080, v8
  global_store_dwordx4 v8, v[4:7], s[4:5]
fa_f2_0:
  s_mov_b64 exec, s[12:13]
  v_add_u32 v8, 0, v2
  v_cmp_gt_u32 vcc, 32768, v8
  s_and_saveexec_b64 s[12:13], vcc
  s_cbranch_execz fa_f3_0
  v_lshlrev_b32 v8, 4, v8
  v_add_u32 v8, 61911040, v8
  global_store_dwordx4 v8, v[4:7], s[4:5]
fa_f3_0:
  s_mov_b64 exec, s[12:13]
  s_cmp_ge_u32 s2, 232
  s_cbranch_scc1 P_wt_skip2
  s_cmp_lg_u32 s3, 0
  s_cbranch_scc1 P_wt_skip2
  s_mul_i32 s11, s44, 8192
  s_lshl_b32 s14, s45, 10
  s_add_u32 s11, s11, s14
  s_add_u32 s11, s11, 13586432
  v_lshl_add_u32 v4, v1, 4, s11
  s_mov_b32 s46, 0x05040100
  s_mov_b32 s47, 0x07060302
  s_waitcnt vmcnt(0)
  v_perm_b32 v160, v144, v128, s46
  v_perm_b32 v161, v148, v132, s46
  v_perm_b32 v162, v152, v136, s46
  v_perm_b32 v163, v156, v140, s46
  global_store_dwordx4 v4, v[160:163], s[4:5]
  v_add_u32 v4, 8192, v4
  s_nop 0
  v_perm_b32 v160, v144, v128, s47
  v_perm_b32 v161, v148, v132, s47
  v_perm_b32 v162, v152, v136, s47
  v_perm_b32 v163, v156, v140, s47
  global_store_dwordx4 v4, v[160:163], s[4:5]
  v_add_u32 v4, 8192, v4
  s_nop 0
  v_perm_b32 v160, v145, v129, s46
  v_perm_b32 v161, v149, v133, s46
  v_perm_b32 v162, v153, v137, s46
  v_perm_b32 v163, v157, v141, s46
  global_store_dwordx4 v4, v[160:163], s[4:5]
  v_add_u32 v4, 8192, v4
  s_nop 0
  v_perm_b32 v160, v145, v129, s47
  v_perm_b32 v161, v149, v133, s47
  v_perm_b32 v162, v153, v137, s47
  v_perm_b32 v163, v157, v141, s47
  global_store_dwordx4 v4, v[160:163], s[4:5]
  v_add_u32 v4, 8192, v4
  s_nop 0
  v_perm_b32 v160, v146, v130, s46
  v_perm_b32 v161, v150, v134, s46
  v_perm_b32 v162, v154, v138, s46
  v_perm_b32 v163, v158, v142, s46
  global_store_dwordx4 v4, v[160:163], s[4:5]
  v_add_u32 v4, 8192, v4
  s_nop 0
  v_perm_b32 v160, v146, v130, s47
  v_perm_b32 v161, v150, v134, s47
  v_perm_b32 v162, v154, v138, s47
  v_perm_b32 v163, v158, v142, s47
  global_store_dwordx4 v4, v[160:163], s[4:5]
  v_add_u32 v4, 8192, v4
  s_nop 0
  v_perm_b32 v160, v147, v131, s46
  v_perm_b32 v161, v151, v135, s46
  v_perm_b32 v162, v155, v139, s46
  v_perm_b32 v163, v159, v143, s46
  global_store_dwordx4 v4, v[160:163], s[4:5]
  v_add_u32 v4, 8192, v4
  s_nop 0
  v_perm_b32 v160, v147, v131, s47
  v_perm_b32 v161, v151, v135, s47
  v_perm_b32 v162, v155, v139, s47
  v_perm_b32 v163, v159, v143, s47
  global_store_dwordx4 v4, v[160:163], s[4:5]
  v_add_u32 v4, 8192, v4
  s_nop 0
P_wt_skip2:
fa_end:
  s_endpgm
.section .rodata,"a"
.p2align 6
.amdhsa_kernel fa0_kernel
  .amdhsa_next_free_vgpr 256
  .amdhsa_next_free_sgpr 102
  .amdhsa_accum_offset 256
  .amdhsa_group_segment_fixed_size 0
  .amdhsa_kernarg_size 104
  .amdhsa_user_sgpr_count 2
  .amdhsa_user_sgpr_kernarg_segment_ptr 1
  .amdhsa_system_sgpr_workgroup_id_x 1
.end_amdhsa_kernel
.text

.section .rodata,"a"
.p2align 6
.amdhsa_kernel fa1_kernel
  .amdhsa_next_free_vgpr 256
  .amdhsa_next_free_sgpr 102
  .amdhsa_accum_offset 256
  .amdhsa_group_segment_fixed_size 0
  .amdhsa_kernarg_size 104
  .amdhsa_user_sgpr_count 2
  .amdhsa_user_sgpr_kernarg_segment_ptr 1
  .amdhsa_system_sgpr_workgroup_id_x 1
.end_amdhsa_kernel
.text

.globl fb_kernel
.p2align 8
.type fb_kernel,@function
fb_kernel:
  s_cmp_ge_u32 s2, 225
  s_cbranch_scc1 fb_end
  s_load_dwordx2 s[4:5], s[0:1], 96
  v_lshlrev_b32 v1, 4, v0
  s_waitcnt lgkmcnt(0)
  s_lshl_b32 s10, s2, 12
  s_add_u32 s10, s10, 15429632
  v_add_u32 v2, s10, v1
  global_load_dwordx4 a[120:123], v2, s[4:5] offset:0
  global_load_dwordx4 a[124:127], v2, s[4:5] offset:1024
  global_load_dwordx4 a[128:131], v2, s[4:5] offset:2048
  global_load_dwordx4 a[132:135], v2, s[4:5] offset:3072
  v_add_u32 v2, 921600, v2
  global_load_dwordx4 a[136:139], v2, s[4:5] offset:0
  global_load_dwordx4 a[140:143], v2, s[4:5] offset:1024
  global_load_dwordx4 a[144:147], v2, s[4:5] offset:2048
  global_load_dwordx4 a[148:151], v2, s[4:5] offset:3072
  v_add_u32 v2, 13520896, v1
  global_load_dwordx4 a[0:3], v2, s[4:5] offset:0
  global_load_dwordx4 a[4:7], v2, s[4:5] offset:1024
  global_load_dwordx4 a[8:11], v2, s[4:5] offset:2048
  global_load_dwordx4 a[12:15], v2, s[4:5] offset:3072
  v_add_u32 v2, 4096, v2
  global_load_dwordx4 a[16:19], v2, s[4:5] offset:0
  global_load_dwordx4 a[20:23], v2, s[4:5] offset:1024
  v_add_u32 v2, 13553664, v1
  global_load_dwordx4 v[72:75], v2, s[4:5] offset:0
  global_load_dwordx4 v[76:79], v2, s[4:5] offset:1024
  global_load_dwordx4 v[80:83], v2, s[4:5] offset:2048
  global_load_dwordx4 v[84:87], v2, s[4:5] offset:3072
  v_add_u32 v2, 4096, v2
  global_load_dwordx4 v[88:91], v2, s[4:5] offset:0
  global_load_dwordx4 v[92:95], v2, s[4:5] offset:1024
  global_load_dwordx4 v[96:99], v2, s[4:5] offset:2048
  global_load_dwordx4 v[100:103], v2, s[4:5] offset:3072
  v_add_u32 v2, 4096, v2
  global_load_dwordx4 v[104:107], v2, s[4:5] offset:0
  global_load_dwordx4 v[108:111], v2, s[4:5] offset:1024
  global_load_dwordx4 v[112:115], v2, s[4:5] offset:2048
  global_load_dwordx4 v[116:119], v2, s[4:5] offset:3072
  v_add_u32 v2, 4096, v2
  global_load_dwordx4 v[120:123], v2, s[4:5] offset:0
  global_load_dwordx4 v[124:127], v2, s[4:5] offset:1024
  global_load_dwordx4 v[128:131], v2, s[4:5] offset:2048
  global_load_dwordx4 v[132:135], v2, s[4:5] offset:3072
  v_add_u32 v2, 4096, v2
  v_add_u32 v2, 13529088, v1
  global_load_dwordx4 a[24:27], v2, s[4:5] offset:0
  global_load_dwordx4 a[28:31], v2, s[4:5] offset:1024
  global_load_dwordx4 a[32:35], v2, s[4:5] offset:2048
  global_load_dwordx4 a[36:39], v2, s[4:5] offset:3072
  v_add_u32 v2, 4096, v2
  global_load_dwordx4 a[40:43], v2, s[4:5] offset:0
  global_load_dwordx4 a[44:47], v2, s[4:5] offset:1024
  global_load_dwordx4 a[48:51], v2, s[4:5] offset:2048
  global_load_dwordx4 a[52:55], v2, s[4:5] offset:3072
  v_add_u32 v2, 4096, v2
  global_load_dwordx4 a[56:59], v2, s[4:5] offset:0
  global_load_dwordx4 a[60:63], v2, s[4:5] offset:1024
  global_load_dwordx4 a[64:67], v2, s[4:5] offset:2048
  global_load_dwordx4 a[68:71], v2, s[4:5] offset:3072
  v_add_u32 v2, 4096, v2
  global_load_dwordx4 a[72:75], v2, s[4:5] offset:0
  global_load_dwordx4 a[76:79], v2, s[4:5] offset:1024
  global_load_dwordx4 a[80:83], v2, s[4:5] offset:2048
  global_load_dwordx4 a[84:87], v2, s[4:5] offset:3072
  v_add_u32 v2, 4096, v2
  global_load_dwordx4 a[88:91], v2, s[4:5] offset:0
  global_load_dwordx4 a[92:95], v2, s[4:5] offset:1024
  global_load_dwordx4 a[96:99], v2, s[4:5] offset:2048
  global_load_dwordx4 a[100:103], v2, s[4:5] offset:3072
  v_add_u32 v2, 4096, v2
  global_load_dwordx4 a[104:107], v2, s[4:5] offset:0
  global_load_dwordx4 a[108:111], v2, s[4:5] offset:1024
  global_load_dwordx4 a[112:115], v2, s[4:5] offset:2048
  global_load_dwordx4 a[116:119], v2, s[4:5] offset:3072
  v_add_u32 v2, 4096, v2
  s_lshl_b32 s10, s2, 13
  s_add_u32 s10, s10, 13586432
  v_add_u32 v2, s10, v1
  global_load_dwordx4 v[136:139], v2, s[4:5] offset:0
  global_load_dwordx4 v[140:143], v2, s[4:5] offset:1024
  global_load_dwordx4 v[144:147], v2, s[4:5] offset:2048
  global_load_dwordx4 v[148:151], v2, s[4:5] offset:3072
  v_add_u32 v2, 4096, v2
  global_load_dwordx4 v[152:155], v2, s[4:5] offset:0
  global_load_dwordx4 v[156:159], v2, s[4:5] offset:1024
  global_load_dwordx4 v[160:163], v2, s[4:5] offset:2048
  global_load_dwordx4 v[164:167], v2, s[4:5] offset:3072
  s_waitcnt vmcnt(48)
  v_mfma_f32_32x32x16_bf16 v[4:19], a[120:123], a[0:3], 0
  v_mfma_f32_32x32x16_bf16 v[36:51], a[120:123], a[8:11], 0
  v_mfma_f32_32x32x16_bf16 v[4:19], a[124:127], a[4:7], v[4:19]
  v_mfma_f32_32x32x16_bf16 v[36:51], a[124:127], a[12:15], v[36:51]
  v_mfma_f32_32x32x16_bf16 v[4:19], a[136:139], a[16:19], v[4:19]
  v_mfma_f32_32x32x16_bf16 v[36:51], a[136:139], a[0:3], v[36:51]
  v_mfma_f32_32x32x16_bf16 v[4:19], a[140:143], a[20:23], v[4:19]
  v_mfma_f32_32x32x16_bf16 v[36:51], a[140:143], a[4:7], v[36:51]
  v_mfma_f32_32x32x16_bf16 v[20:35], a[128:131], a[0:3], 0
  v_mfma_f32_32x32x16_bf16 v[52:67], a[128:131], a[8:11], 0
  v_mfma_f32_32x32x16_bf16 v[20:35], a[132:135], a[4:7], v[20:35]
  v_mfma_f32_32x32x16_bf16 v[52:67], a[132:135], a[12:15], v[52:67]
  v_mfma_f32_32x32x16_bf16 v[20:35], a[144:147], a[16:19], v[20:35]
  v_mfma_f32_32x32x16_bf16 v[52:67], a[144:147], a[0:3], v[52:67]
  v_mfma_f32_32x32x16_bf16 v[20:35], a[148:151], a[20:23], v[20:35]
  v_mfma_f32_32x32x16_bf16 v[52:67], a[148:151], a[4:7], v[52:67]
  s_waitcnt vmcnt(32)
  s_nop 11
  v_pk_mul_f32 v[200:201], v[4:5], v[72:73]
  v_pk_mul_f32 v[202:203], v[4:5], v[104:105]
  v_pk_fma_f32 v[200:201], v[36:37], v[104:105], v[200:201] neg_lo:[1,0,0] neg_hi:[1,0,0]
  v_pk_fma_f32 v[202:203], v[36:37], v[72:73], v[202:203]
  v_cvt_pk_bf16_f32 v168, v200, v201
  v_cvt_pk_bf16_f32 v184, v202, v203
  v_pk_mul_f32 v[200:201], v[6:7], v[74:75]
  v_pk_mul_f32 v[202:203], v[6:7], v[106:107]
  v_pk_fma_f32 v[200:201], v[38:39], v[106:107], v[200:201] neg_lo:[1,0,0] neg_hi:[1,0,0]
  v_pk_fma_f32 v[202:203], v[38:39], v[74:75], v[202:203]
  v_cvt_pk_bf16_f32 v169, v200, v201
  v_cvt_pk_bf16_f32 v185, v202, v203
  v_pk_mul_f32 v[200:201], v[8:9], v[76:77]
  v_pk_mul_f32 v[202:203], v[8:9], v[108:109]
  v_pk_fma_f32 v[200:201], v[40:41], v[108:109], v[200:201] neg_lo:[1,0,0] neg_hi:[1,0,0]
  v_pk_fma_f32 v[202:203], v[40:41], v[76:77], v[202:203]
  v_cvt_pk_bf16_f32 v170, v200, v201
  v_cvt_pk_bf16_f32 v186, v202, v203
  v_pk_mul_f32 v[200:201], v[10:11], v[78:79]
  v_pk_mul_f32 v[202:203], v[10:11], v[110:111]
  v_pk_fma_f32 v[200:201], v[42:43], v[110:111], v[200:201] neg_lo:[1,0,0] neg_hi:[1,0,0]
  v_pk_fma_f32 v[202:203], v[42:43], v[78:79], v[202:203]
  v_cvt_pk_bf16_f32 v171, v200, v201
  v_cvt_pk_bf16_f32 v187, v202, v203
  v_pk_mul_f32 v[200:201], v[12:13], v[80:81]
  v_pk_mul_f32 v[202:203], v[12:13], v[112:113]
  v_pk_fma_f32 v[200:201], v[44:45], v[112:113], v[200:201] neg_lo:[1,0,0] neg_hi:[1,0,0]
  v_pk_fma_f32 v[202:203], v[44:45], v[80:81], v[202:203]
  v_cvt_pk_bf16_f32 v172, v200, v201
  v_cvt_pk_bf16_f32 v188, v202, v203
  v_pk_mul_f32 v[200:201], v[14:15], v[82:83]
  v_pk_mul_f32 v[202:203], v[14:15], v[114:115]
  v_pk_fma_f32 v[200:201], v[46:47], v[114:115], v[200:201] neg_lo:[1,0,0] neg_hi:[1,0,0]
  v_pk_fma_f32 v[202:203], v[46:47], v[82:83], v[202:203]
  v_cvt_pk_bf16_f32 v173, v200, v201
  v_cvt_pk_bf16_f32 v189, v202, v203
  v_pk_mul_f32 v[200:201], v[16:17], v[84:85]
  v_pk_mul_f32 v[202:203], v[16:17], v[116:117]
  v_pk_fma_f32 v[200:201], v[48:49], v[116:117], v[200:201] neg_lo:[1,0,0] neg_hi:[1,0,0]
  v_pk_fma_f32 v[202:203], v[48:49], v[84:85], v[202:203]
  v_cvt_pk_bf16_f32 v174, v200, v201
  v_cvt_pk_bf16_f32 v190, v202, v203
  v_pk_mul_f32 v[200:201], v[18:19], v[86:87]
  v_pk_mul_f32 v[202:203], v[18:19], v[118:119]
  v_pk_fma_f32 v[200:201], v[50:51], v[118:119], v[200:201] neg_lo:[1,0,0] neg_hi:[1,0,0]
  v_pk_fma_f32 v[202:203], v[50:51], v[86:87], v[202:203]
  v_cvt_pk_bf16_f32 v175, v200, v201
  v_cvt_pk_bf16_f32 v191, v202, v203
  v_pk_mul_f32 v[200:201], v[20:21], v[88:89]
  v_pk_mul_f32 v[202:203], v[20:21], v[120:121]
  v_pk_fma_f32 v[200:201], v[52:53], v[120:121], v[200:201] neg_lo:[1,0,0] neg_hi:[1,0,0]
  v_pk_fma_f32 v[202:203], v[52:53], v[88:89], v[202:203]
  v_cvt_pk_bf16_f32 v176, v200, v201
  v_cvt_pk_bf16_f32 v192, v202, v203
  v_pk_mul_f32 v[200:201], v[22:23], v[90:91]
  v_pk_mul_f32 v[202:203], v[22:23], v[122:123]
  v_pk_fma_f32 v[200:201], v[54:55], v[122:123], v[200:201] neg_lo:[1,0,0] neg_hi:[1,0,0]
  v_pk_fma_f32 v[202:203], v[54:55], v[90:91], v[202:203]
  v_cvt_pk_bf16_f32 v177, v200, v201
  v_cvt_pk_bf16_f32 v193, v202, v203
  v_pk_mul_f32 v[200:201], v[24:25], v[92:93]
  v_pk_mul_f32 v[202:203], v[24:25], v[124:125]
  v_pk_fma_f32 v[200:201], v[56:57], v[124:125], v[200:201] neg_lo:[1,0,0] neg_hi:[1,0,0]
  v_pk_fma_f32 v[202:203], v[56:57], v[92:93], v[202:203]
  v_cvt_pk_bf16_f32 v178, v200, v201
  v_cvt_pk_bf16_f32 v194, v202, v203
  v_pk_mul_f32 v[200:201], v[26:27], v[94:95]
  v_pk_mul_f32 v[202:203], v[26:27], v[126:127]
  v_pk_fma_f32 v[200:201], v[58:59], v[126:127], v[200:201] neg_lo:[1,0,0] neg_hi:[1,0,0]
  v_pk_fma_f32 v[202:203], v[58:59], v[94:95], v[202:203]
  v_cvt_pk_bf16_f32 v179, v200, v201
  v_cvt_pk_bf16_f32 v195, v202, v203
  v_pk_mul_f32 v[200:201], v[28:29], v[96:97]
  v_pk_mul_f32 v[202:203], v[28:29], v[128:129]
  v_pk_fma_f32 v[200:201], v[60:61], v[128:129], v[200:201] neg_lo:[1,0,0] neg_hi:[1,0,0]
  v_pk_fma_f32 v[202:203], v[60:61], v[96:97], v[202:203]
  v_cvt_pk_bf16_f32 v180, v200, v201
  v_cvt_pk_bf16_f32 v196, v202, v203
  v_pk_mul_f32 v[200:201], v[30:31], v[98:99]
  v_pk_mul_f32 v[202:203], v[30:31], v[130:131]
  v_pk_fma_f32 v[200:201], v[62:63], v[130:131], v[200:201] neg_lo:[1,0,0] neg_hi:[1,0,0]
  v_pk_fma_f32 v[202:203], v[62:63], v[98:99], v[202:203]
  v_cvt_pk_bf16_f32 v181, v200, v201
  v_cvt_pk_bf16_f32 v197, v202, v203
  v_pk_mul_f32 v[200:201], v[32:33], v[100:101]
  v_pk_mul_f32 v[202:203], v[32:33], v[132:133]
  v_pk_fma_f32 v[200:201], v[64:65], v[132:133], v[200:201] neg_lo:[1,0,0] neg_hi:[1,0,0]
  v_pk_fma_f32 v[202:203], v[64:65], v[100:101], v[202:203]
  v_cvt_pk_bf16_f32 v182, v200, v201
  v_cvt_pk_bf16_f32 v198, v202, v203
  v_pk_mul_f32 v[200:201], v[34:35], v[102:103]
  v_pk_mul_f32 v[202:203], v[34:35], v[134:135]
  v_pk_fma_f32 v[200:201], v[66:67], v[134:135], v[200:201] neg_lo:[1,0,0] neg_hi:[1,0,0]
  v_pk_fma_f32 v[202:203], v[66:67], v[102:103], v[202:203]
  v_cvt_pk_bf16_f32 v183, v200, v201
  v_cvt_pk_bf16_f32 v199, v202, v203
  v_add_u32 v2, 13570048, v1
  global_load_dwordx4 v[72:75], v2, s[4:5] offset:0
  global_load_dwordx4 v[76:79], v2, s[4:5] offset:1024
  global_load_dwordx4 v[80:83], v2, s[4:5] offset:2048
  global_load_dwordx4 v[84:87], v2, s[4:5] offset:3072
  v_add_u32 v2, 4096, v2
  global_load_dwordx4 v[88:91], v2, s[4:5] offset:0
  global_load_dwordx4 v[92:95], v2, s[4:5] offset:1024
  global_load_dwordx4 v[96:99], v2, s[4:5] offset:2048
  global_load_dwordx4 v[100:103], v2, s[4:5] offset:3072
  v_add_u32 v2, 4096, v2
  global_load_dwordx4 v[104:107], v2, s[4:5] offset:0
  global_load_dwordx4 v[108:111], v2, s[4:5] offset:1024
  global_load_dwordx4 v[112:115], v2, s[4:5] offset:2048
  global_load_dwordx4 v[116:119], v2, s[4:5] offset:3072
  v_add_u32 v2, 4096, v2
  global_load_dwordx4 v[120:123], v2, s[4:5] offset:0
  global_load_dwordx4 v[124:127], v2, s[4:5] offset:1024
  global_load_dwordx4 v[128:131], v2, s[4:5] offset:2048
  global_load_dwordx4 v[132:135], v2, s[4:5] offset:3072
  v_add_u32 v2, 4096, v2
  s_waitcnt vmcnt(24)
  v_mfma_f32_32x32x16_bf16 v[4:19], a[24:27], v[168:171], 0
  v_mfma_f32_32x32x16_bf16 v[36:51], a[56:59], v[168:171], 0
  v_mfma_f32_32x32x16_bf16 v[4:19], a[88:91], v[184:187], v[4:19]
  v_mfma_f32_32x32x16_bf16 v[36:51], a[24:27], v[184:187], v[36:51]
  v_mfma_f32_32x32x16_bf16 v[4:19], a[28:31], v[172:175], v[4:19]
  v_mfma_f32_32x32x16_bf16 v[36:51], a[60:63], v[172:175], v[36:51]
  v_mfma_f32_32x32x16_bf16 v[4:19], a[92:95], v[188:191], v[4:19]
  v_mfma_f32_32x32x16_bf16 v[36:51], a[28:31], v[188:191], v[36:51]
  v_mfma_f32_32x32x16_bf16 v[4:19], a[32:35], v[176:179], v[4:19]
  v_mfma_f32_32x32x16_bf16 v[36:51], a[64:67], v[176:179], v[36:51]
  v_mfma_f32_32x32x16_bf16 v[4:19], a[96:99], v[192:195], v[4:19]
  v_mfma_f32_32x32x16_bf16 v[36:51], a[32:35], v[192:195], v[36:51]
  v_mfma_f32_32x32x16_bf16 v[4:19], a[36:39], v[180:183], v[4:19]
  v_mfma_f32_32x32x16_bf16 v[36:51], a[68:71], v[180:183], v[36:51]
  v_mfma_f32_32x32x16_bf16 v[4:19], a[100:103], v[196:199], v[4:19]
  v_mfma_f32_32x32x16_bf16 v[36:51], a[36:39], v[196:199], v[36:51]
  v_mfma_f32_32x32x16_bf16 v[20:35], a[40:43], v[168:171], 0
  v_mfma_f32_32x32x16_bf16 v[52:67], a[72:75], v[168:171], 0
  v_mfma_f32_32x32x16_bf16 v[20:35], a[104:107], v[184:187], v[20:35]
  v_mfma_f32_32x32x16_bf16 v[52:67], a[40:43], v[184:187], v[52:67]
  v_mfma_f32_32x32x16_bf16 v[20:35], a[44:47], v[172:175], v[20:35]
  v_mfma_f32_32x32x16_bf16 v[52:67], a[76:79], v[172:175], v[52:67]
  v_mfma_f32_32x32x16_bf16 v[20:35], a[108:111], v[188:191], v[20:35]
  v_mfma_f32_32x32x16_bf16 v[52:67], a[44:47], v[188:191], v[52:67]
  v_mfma_f32_32x32x16_bf16 v[20:35], a[48:51], v[176:179], v[20:35]
  v_mfma_f32_32x32x16_bf16 v[52:67], a[80:83], v[176:179], v[52:67]
  v_mfma_f32_32x32x16_bf16 v[20:35], a[112:115], v[192:195], v[20:35]
  v_mfma_f32_32x32x16_bf16 v[52:67], a[48:51], v[192:195], v[52:67]
  v_mfma_f32_32x32x16_bf16 v[20:35], a[52:55], v[180:183], v[20:35]
  v_mfma_f32_32x32x16_bf16 v[52:67], a[84:87], v[180:183], v[52:67]
  v_mfma_f32_32x32x16_bf16 v[20:35], a[116:119], v[196:199], v[20:35]
  v_mfma_f32_32x32x16_bf16 v[52:67], a[52:55], v[196:199], v[52:67]
  s_waitcnt vmcnt(16)
  s_nop 11
  v_lshlrev_b32 v204, 16, v136
  v_lshlrev_b32 v205, 16, v137
  v_and_b32 v206, 0xffff0000, v136
  v_and_b32 v207, 0xffff0000, v137
  v_pk_mul_f32 v[200:201], v[4:5], v[204:205]
  v_pk_mul_f32 v[202:203], v[4:5], v[206:207]
  v_pk_fma_f32 v[200:201], v[36:37], v[206:207], v[200:201] neg_lo:[1,0,0] neg_hi:[1,0,0]
  v_pk_fma_f32 v[202:203], v[36:37], v[204:205], v[202:203]
  v_cvt_pk_bf16_f32 v168, v200, v201
  v_cvt_pk_bf16_f32 v184, v202, v203
  v_lshlrev_b32 v204, 16, v138
  v_lshlrev_b32 v205, 16, v139
  v_and_b32 v206, 0xffff0000, v138
  v_and_b32 v207, 0xffff0000, v139
  v_pk_mul_f32 v[200:201], v[6:7], v[204:205]
  v_pk_mul_f32 v[202:203], v[6:7], v[206:207]
  v_pk_fma_f32 v[200:201], v[38:39], v[206:207], v[200:201] neg_lo:[1,0,0] neg_hi:[1,0,0]
  v_pk_fma_f32 v[202:203], v[38:39], v[204:205], v[202:203]
  v_cvt_pk_bf16_f32 v169, v200, v201
  v_cvt_pk_bf16_f32 v185, v202, v203
  v_lshlrev_b32 v204, 16, v140
  v_lshlrev_b32 v205, 16, v141
  v_and_b32 v206, 0xffff0000, v140
  v_and_b32 v207, 0xffff0000, v141
  v_pk_mul_f32 v[200:201], v[8:9], v[204:205]
  v_pk_mul_f32 v[202:203], v[8:9], v[206:207]
  v_pk_fma_f32 v[200:201], v[40:41], v[206:207], v[200:201] neg_lo:[1,0,0] neg_hi:[1,0,0]
  v_pk_fma_f32 v[202:203], v[40:41], v[204:205], v[202:203]
  v_cvt_pk_bf16_f32 v170, v200, v201
  v_cvt_pk_bf16_f32 v186, v202, v203
  v_lshlrev_b32 v204, 16, v142
  v_lshlrev_b32 v205, 16, v143
  v_and_b32 v206, 0xffff0000, v142
  v_and_b32 v207, 0xffff0000, v143
  v_pk_mul_f32 v[200:201], v[10:11], v[204:205]
  v_pk_mul_f32 v[202:203], v[10:11], v[206:207]
  v_pk_fma_f32 v[200:201], v[42:43], v[206:207], v[200:201] neg_lo:[1,0,0] neg_hi:[1,0,0]
  v_pk_fma_f32 v[202:203], v[42:43], v[204:205], v[202:203]
  v_cvt_pk_bf16_f32 v171, v200, v201
  v_cvt_pk_bf16_f32 v187, v202, v203
  v_lshlrev_b32 v204, 16, v144
  v_lshlrev_b32 v205, 16, v145
  v_and_b32 v206, 0xffff0000, v144
  v_and_b32 v207, 0xffff0000, v145
  v_pk_mul_f32 v[200:201], v[12:13], v[204:205]
  v_pk_mul_f32 v[202:203], v[12:13], v[206:207]
  v_pk_fma_f32 v[200:201], v[44:45], v[206:207], v[200:201] neg_lo:[1,0,0] neg_hi:[1,0,0]
  v_pk_fma_f32 v[202:203], v[44:45], v[204:205], v[202:203]
  v_cvt_pk_bf16_f32 v172, v200, v201
  v_cvt_pk_bf16_f32 v188, v202, v203
  v_lshlrev_b32 v204, 16, v146
  v_lshlrev_b32 v205, 16, v147
  v_and_b32 v206, 0xffff0000, v146
  v_and_b32 v207, 0xffff0000, v147
  v_pk_mul_f32 v[200:201], v[14:15], v[204:205]
  v_pk_mul_f32 v[202:203], v[14:15], v[206:207]
  v_pk_fma_f32 v[200:201], v[46:47], v[206:207], v[200:201] neg_lo:[1,0,0] neg_hi:[1,0,0]
  v_pk_fma_f32 v[202:203], v[46:47], v[204:205], v[202:203]
  v_cvt_pk_bf16_f32 v173, v200, v201
  v_cvt_pk_bf16_f32 v189, v202, v203
  v_lshlrev_b32 v204, 16, v148
  v_lshlrev_b32 v205, 16, v149
  v_and_b32 v206, 0xffff0000, v148
  v_and_b32 v207, 0xffff0000, v149
  v_pk_mul_f32 v[200:201], v[16:17], v[204:205]
  v_pk_mul_f32 v[202:203], v[16:17], v[206:207]
  v_pk_fma_f32 v[200:201], v[48:49], v[206:207], v[200:201] neg_lo:[1,0,0] neg_hi:[1,0,0]
  v_pk_fma_f32 v[202:203], v[48:49], v[204:205], v[202:203]
  v_cvt_pk_bf16_f32 v174, v200, v201
  v_cvt_pk_bf16_f32 v190, v202, v203
  v_lshlrev_b32 v204, 16, v150
  v_lshlrev_b32 v205, 16, v151
  v_and_b32 v206, 0xffff0000, v150
  v_and_b32 v207, 0xffff0000, v151
  v_pk_mul_f32 v[200:201], v[18:19], v[204:205]
  v_pk_mul_f32 v[202:203], v[18:19], v[206:207]
  v_pk_fma_f32 v[200:201], v[50:51], v[206:207], v[200:201] neg_lo:[1,0,0] neg_hi:[1,0,0]
  v_pk_fma_f32 v[202:203], v[50:51], v[204:205], v[202:203]
  v_cvt_pk_bf16_f32 v175, v200, v201
  v_cvt_pk_bf16_f32 v191, v202, v203
  v_lshlrev_b32 v204, 16, v152
  v_lshlrev_b32 v205, 16, v153
  v_and_b32 v206, 0xffff0000, v152
  v_and_b32 v207, 0xffff0000, v153
  v_pk_mul_f32 v[200:201], v[20:21], v[204:205]
  v_pk_mul_f32 v[202:203], v[20:21], v[206:207]
  v_pk_fma_f32 v[200:201], v[52:53], v[206:207], v[200:201] neg_lo:[1,0,0] neg_hi:[1,0,0]
  v_pk_fma_f32 v[202:203], v[52:53], v[204:205], v[202:203]
  v_cvt_pk_bf16_f32 v176, v200, v201
  v_cvt_pk_bf16_f32 v192, v202, v203
  v_lshlrev_b32 v204, 16, v154
  v_lshlrev_b32 v205, 16, v155
  v_and_b32 v206, 0xffff0000, v154
  v_and_b32 v207, 0xffff0000, v155
  v_pk_mul_f32 v[200:201], v[22:23], v[204:205]
  v_pk_mul_f32 v[202:203], v[22:23], v[206:207]
  v_pk_fma_f32 v[200:201], v[54:55], v[206:207], v[200:201] neg_lo:[1,0,0] neg_hi:[1,0,0]
  v_pk_fma_f32 v[202:203], v[54:55], v[204:205], v[202:203]
  v_cvt_pk_bf16_f32 v177, v200, v201
  v_cvt_pk_bf16_f32 v193, v202, v203
  v_lshlrev_b32 v204, 16, v156
  v_lshlrev_b32 v205, 16, v157
  v_and_b32 v206, 0xffff0000, v156
  v_and_b32 v207, 0xffff0000, v157
  v_pk_mul_f32 v[200:201], v[24:25], v[204:205]
  v_pk_mul_f32 v[202:203], v[24:25], v[206:207]
  v_pk_fma_f32 v[200:201], v[56:57], v[206:207], v[200:201] neg_lo:[1,0,0] neg_hi:[1,0,0]
  v_pk_fma_f32 v[202:203], v[56:57], v[204:205], v[202:203]
  v_cvt_pk_bf16_f32 v178, v200, v201
  v_cvt_pk_bf16_f32 v194, v202, v203
  v_lshlrev_b32 v204, 16, v158
  v_lshlrev_b32 v205, 16, v159
  v_and_b32 v206, 0xffff0000, v158
  v_and_b32 v207, 0xffff0000, v159
  v_pk_mul_f32 v[200:201], v[26:27], v[204:205]
  v_pk_mul_f32 v[202:203], v[26:27], v[206:207]
  v_pk_fma_f32 v[200:201], v[58:59], v[206:207], v[200:201] neg_lo:[1,0,0] neg_hi:[1,0,0]
  v_pk_fma_f32 v[202:203], v[58:59], v[204:205], v[202:203]
  v_cvt_pk_bf16_f32 v179, v200, v201
  v_cvt_pk_bf16_f32 v195, v202, v203
  v_lshlrev_b32 v204, 16, v160
  v_lshlrev_b32 v205, 16, v161
  v_and_b32 v206, 0xffff0000, v160
  v_and_b32 v207, 0xffff0000, v161
  v_pk_mul_f32 v[200:201], v[28:29], v[204:205]
  v_pk_mul_f32 v[202:203], v[28:29], v[206:207]
  v_pk_fma_f32 v[200:201], v[60:61], v[206:207], v[200:201] neg_lo:[1,0,0] neg_hi:[1,0,0]
  v_pk_fma_f32 v[202:203], v[60:61], v[204:205], v[202:203]
  v_cvt_pk_bf16_f32 v180, v200, v201
  v_cvt_pk_bf16_f32 v196, v202, v203
  v_lshlrev_b32 v204, 16, v162
  v_lshlrev_b32 v205, 16, v163
  v_and_b32 v206, 0xffff0000, v162
  v_and_b32 v207, 0xffff0000, v163
  v_pk_mul_f32 v[200:201], v[30:31], v[204:205]
  v_pk_mul_f32 v[202:203], v[30:31], v[206:207]
  v_pk_fma_f32 v[200:201], v[62:63], v[206:207], v[200:201] neg_lo:[1,0,0] neg_hi:[1,0,0]
  v_pk_fma_f32 v[202:203], v[62:63], v[204:205], v[202:203]
  v_cvt_pk_bf16_f32 v181, v200, v201
  v_cvt_pk_bf16_f32 v197, v202, v203
  v_lshlrev_b32 v204, 16, v164
  v_lshlrev_b32 v205, 16, v165
  v_and_b32 v206, 0xffff0000, v164
  v_and_b32 v207, 0xffff0000, v165
  v_pk_mul_f32 v[200:201], v[32:33], v[204:205]
  v_pk_mul_f32 v[202:203], v[32:33], v[206:207]
  v_pk_fma_f32 v[200:201], v[64:65], v[206:207], v[200:201] neg_lo:[1,0,0] neg_hi:[1,0,0]
  v_pk_fma_f32 v[202:203], v[64:65], v[204:205], v[202:203]
  v_cvt_pk_bf16_f32 v182, v200, v201
  v_cvt_pk_bf16_f32 v198, v202, v203
  v_lshlrev_b32 v204, 16, v166
  v_lshlrev_b32 v205, 16, v167
  v_and_b32 v206, 0xffff0000, v166
  v_and_b32 v207, 0xffff0000, v167
  v_pk_mul_f32 v[200:201], v[34:35], v[204:205]
  v_pk_mul_f32 v[202:203], v[34:35], v[206:207]
  v_pk_fma_f32 v[200:201], v[66:67], v[206:207], v[200:201] neg_lo:[1,0,0] neg_hi:[1,0,0]
  v_pk_fma_f32 v[202:203], v[66:67], v[204:205], v[202:203]
  v_cvt_pk_bf16_f32 v183, v200, v201
  v_cvt_pk_bf16_f32 v199, v202, v203
  s_nop 1
  v_mfma_f32_32x32x16_bf16 v[4:19], v[168:171], a[24:27], 0
  v_mfma_f32_32x32x16_bf16 v[36:51], v[184:187], a[24:27], 0
  v_mfma_f32_32x32x16_bf16 v[4:19], v[184:187], a[56:59], v[4:19]
  v_mfma_f32_32x32x16_bf16 v[36:51], v[168:171], a[88:91], v[36:51]
  v_mfma_f32_32x32x16_bf16 v[4:19], v[172:175], a[28:31], v[4:19]
  v_mfma_f32_32x32x16_bf16 v[36:51], v[188:191], a[28:31], v[36:51]
  v_mfma_f32_32x32x16_bf16 v[4:19], v[188:191], a[60:63], v[4:19]
  v_mfma_f32_32x32x16_bf16 v[36:51], v[172:175], a[92:95], v[36:51]
  v_mfma_f32_32x32x16_bf16 v[4:19], v[176:179], a[32:35], v[4:19]
  v_mfma_f32_32x32x16_bf16 v[36:51], v[192:195], a[32:35], v[36:51]
  v_mfma_f32_32x32x16_bf16 v[4:19], v[192:195], a[64:67], v[4:19]
  v_mfma_f32_32x32x16_bf16 v[36:51], v[176:179], a[96:99], v[36:51]
  v_mfma_f32_32x32x16_bf16 v[4:19], v[180:183], a[36:39], v[4:19]
  v_mfma_f32_32x32x16_bf16 v[36:51], v[196:199], a[36:39], v[36:51]
  v_mfma_f32_32x32x16_bf16 v[4:19], v[196:199], a[68:71], v[4:19]
  v_mfma_f32_32x32x16_bf16 v[36:51], v[180:183], a[100:103], v[36:51]
  v_mfma_f32_32x32x16_bf16 v[20:35], v[168:171], a[40:43], 0
  v_mfma_f32_32x32x16_bf16 v[52:67], v[184:187], a[40:43], 0
  v_mfma_f32_32x32x16_bf16 v[20:35], v[184:187], a[72:75], v[20:35]
  v_mfma_f32_32x32x16_bf16 v[52:67], v[168:171], a[104:107], v[52:67]
  v_mfma_f32_32x32x16_bf16 v[20:35], v[172:175], a[44:47], v[20:35]
  v_mfma_f32_32x32x16_bf16 v[52:67], v[188:191], a[44:47], v[52:67]
  v_mfma_f32_32x32x16_bf16 v[20:35], v[188:191], a[76:79], v[20:35]
  v_mfma_f32_32x32x16_bf16 v[52:67], v[172:175], a[108:111], v[52:67]
  v_mfma_f32_32x32x16_bf16 v[20:35], v[176:179], a[48:51], v[20:35]
  v_mfma_f32_32x32x16_bf16 v[52:67], v[192:195], a[48:51], v[52:67]
  v_mfma_f32_32x32x16_bf16 v[20:35], v[192:195], a[80:83], v[20:35]
  v_mfma_f32_32x32x16_bf16 v[52:67], v[176:179], a[112:115], v[52:67]
  v_mfma_f32_32x32x16_bf16 v[20:35], v[180:183], a[52:55], v[20:35]
  v_mfma_f32_32x32x16_bf16 v[52:67], v[196:199], a[52:55], v[52:67]
  v_mfma_f32_32x32x16_bf16 v[20:35], v[196:199], a[84:87], v[20:35]
  v_mfma_f32_32x32x16_bf16 v[52:67], v[180:183], a[116:119], v[52:67]
  s_waitcnt vmcnt(0)
  s_nop 11
  v_pk_mul_f32 v[200:201], v[4:5], v[72:73]
  v_pk_mul_f32 v[202:203], v[4:5], v[104:105]
  v_pk_fma_f32 v[200:201], v[36:37], v[104:105], v[200:201] neg_lo:[1,0,0] neg_hi:[1,0,0]
  v_pk_fma_f32 v[202:203], v[36:37], v[72:73], v[202:203]
  v_cvt_pk_bf16_f32 v168, v200, v201
  v_cvt_pk_bf16_f32 v184, v202, v203
  v_pk_mul_f32 v[200:201], v[6:7], v[74:75]
  v_pk_mul_f32 v[202:203], v[6:7], v[106:107]
  v_pk_fma_f32 v[200:201], v[38:39], v[106:107], v[200:201] neg_lo:[1,0,0] neg_hi:[1,0,0]
  v_pk_fma_f32 v[202:203], v[38:39], v[74:75], v[202:203]
  v_cvt_pk_bf16_f32 v169, v200, v201
  v_cvt_pk_bf16_f32 v185, v202, v203
  v_pk_mul_f32 v[200:201], v[8:9], v[76:77]
  v_pk_mul_f32 v[202:203], v[8:9], v[108:109]
  v_pk_fma_f32 v[200:201], v[40:41], v[108:109], v[200:201] neg_lo:[1,0,0] neg_hi:[1,0,0]
  v_pk_fma_f32 v[202:203], v[40:41], v[76:77], v[202:203]
  v_cvt_pk_bf16_f32 v170, v200, v201
  v_cvt_pk_bf16_f32 v186, v202, v203
  v_pk_mul_f32 v[200:201], v[10:11], v[78:79]
  v_pk_mul_f32 v[202:203], v[10:11], v[110:111]
  v_pk_fma_f32 v[200:201], v[42:43], v[110:111], v[200:201] neg_lo:[1,0,0] neg_hi:[1,0,0]
  v_pk_fma_f32 v[202:203], v[42:43], v[78:79], v[202:203]
  v_cvt_pk_bf16_f32 v171, v200, v201
  v_cvt_pk_bf16_f32 v187, v202, v203
  v_pk_mul_f32 v[200:201], v[12:13], v[80:81]
  v_pk_mul_f32 v[202:203], v[12:13], v[112:113]
  v_pk_fma_f32 v[200:201], v[44:45], v[112:113], v[200:201] neg_lo:[1,0,0] neg_hi:[1,0,0]
  v_pk_fma_f32 v[202:203], v[44:45], v[80:81], v[202:203]
  v_cvt_pk_bf16_f32 v172, v200, v201
  v_cvt_pk_bf16_f32 v188, v202, v203
  v_pk_mul_f32 v[200:201], v[14:15], v[82:83]
  v_pk_mul_f32 v[202:203], v[14:15], v[114:115]
  v_pk_fma_f32 v[200:201], v[46:47], v[114:115], v[200:201] neg_lo:[1,0,0] neg_hi:[1,0,0]
  v_pk_fma_f32 v[202:203], v[46:47], v[82:83], v[202:203]
  v_cvt_pk_bf16_f32 v173, v200, v201
  v_cvt_pk_bf16_f32 v189, v202, v203
  v_pk_mul_f32 v[200:201], v[16:17], v[84:85]
  v_pk_mul_f32 v[202:203], v[16:17], v[116:117]
  v_pk_fma_f32 v[200:201], v[48:49], v[116:117], v[200:201] neg_lo:[1,0,0] neg_hi:[1,0,0]
  v_pk_fma_f32 v[202:203], v[48:49], v[84:85], v[202:203]
  v_cvt_pk_bf16_f32 v174, v200, v201
  v_cvt_pk_bf16_f32 v190, v202, v203
  v_pk_mul_f32 v[200:201], v[18:19], v[86:87]
  v_pk_mul_f32 v[202:203], v[18:19], v[118:119]
  v_pk_fma_f32 v[200:201], v[50:51], v[118:119], v[200:201] neg_lo:[1,0,0] neg_hi:[1,0,0]
  v_pk_fma_f32 v[202:203], v[50:51], v[86:87], v[202:203]
  v_cvt_pk_bf16_f32 v175, v200, v201
  v_cvt_pk_bf16_f32 v191, v202, v203
  v_pk_mul_f32 v[200:201], v[20:21], v[88:89]
  v_pk_mul_f32 v[202:203], v[20:21], v[120:121]
  v_pk_fma_f32 v[200:201], v[52:53], v[120:121], v[200:201] neg_lo:[1,0,0] neg_hi:[1,0,0]
  v_pk_fma_f32 v[202:203], v[52:53], v[88:89], v[202:203]
  v_cvt_pk_bf16_f32 v176, v200, v201
  v_cvt_pk_bf16_f32 v192, v202, v203
  v_pk_mul_f32 v[200:201], v[22:23], v[90:91]
  v_pk_mul_f32 v[202:203], v[22:23], v[122:123]
  v_pk_fma_f32 v[200:201], v[54:55], v[122:123], v[200:201] neg_lo:[1,0,0] neg_hi:[1,0,0]
  v_pk_fma_f32 v[202:203], v[54:55], v[90:91], v[202:203]
  v_cvt_pk_bf16_f32 v177, v200, v201
  v_cvt_pk_bf16_f32 v193, v202, v203
  v_pk_mul_f32 v[200:201], v[24:25], v[92:93]
  v_pk_mul_f32 v[202:203], v[24:25], v[124:125]
  v_pk_fma_f32 v[200:201], v[56:57], v[124:125], v[200:201] neg_lo:[1,0,0] neg_hi:[1,0,0]
  v_pk_fma_f32 v[202:203], v[56:57], v[92:93], v[202:203]
  v_cvt_pk_bf16_f32 v178, v200, v201
  v_cvt_pk_bf16_f32 v194, v202, v203
  v_pk_mul_f32 v[200:201], v[26:27], v[94:95]
  v_pk_mul_f32 v[202:203], v[26:27], v[126:127]
  v_pk_fma_f32 v[200:201], v[58:59], v[126:127], v[200:201] neg_lo:[1,0,0] neg_hi:[1,0,0]
  v_pk_fma_f32 v[202:203], v[58:59], v[94:95], v[202:203]
  v_cvt_pk_bf16_f32 v179, v200, v201
  v_cvt_pk_bf16_f32 v195, v202, v203
  v_pk_mul_f32 v[200:201], v[28:29], v[96:97]
  v_pk_mul_f32 v[202:203], v[28:29], v[128:129]
  v_pk_fma_f32 v[200:201], v[60:61], v[128:129], v[200:201] neg_lo:[1,0,0] neg_hi:[1,0,0]
  v_pk_fma_f32 v[202:203], v[60:61], v[96:97], v[202:203]
  v_cvt_pk_bf16_f32 v180, v200, v201
  v_cvt_pk_bf16_f32 v196, v202, v203
  v_pk_mul_f32 v[200:201], v[30:31], v[98:99]
  v_pk_mul_f32 v[202:203], v[30:31], v[130:131]
  v_pk_fma_f32 v[200:201], v[62:63], v[130:131], v[200:201] neg_lo:[1,0,0] neg_hi:[1,0,0]
  v_pk_fma_f32 v[202:203], v[62:63], v[98:99], v[202:203]
  v_cvt_pk_bf16_f32 v181, v200, v201
  v_cvt_pk_bf16_f32 v197, v202, v203
  v_pk_mul_f32 v[200:201], v[32:33], v[100:101]
  v_pk_mul_f32 v[202:203], v[32:33], v[132:133]
  v_pk_fma_f32 v[200:201], v[64:65], v[132:133], v[200:201] neg_lo:[1,0,0] neg_hi:[1,0,0]
  v_pk_fma_f32 v[202:203], v[64:65], v[100:101], v[202:203]
  v_cvt_pk_bf16_f32 v182, v200, v201
  v_cvt_pk_bf16_f32 v198, v202, v203
  v_pk_mul_f32 v[200:201], v[34:35], v[102:103]
  v_pk_mul_f32 v[202:203], v[34:35], v[134:135]
  v_pk_fma_f32 v[200:201], v[66:67], v[134:135], v[200:201] neg_lo:[1,0,0] neg_hi:[1,0,0]
  v_pk_fma_f32 v[202:203], v[66:67], v[102:103], v[202:203]
  v_cvt_pk_bf16_f32 v183, v200, v201
  v_cvt_pk_bf16_f32 v199, v202, v203
  s_nop 1
  v_mfma_f32_32x32x16_bf16 v[4:19], a[0:3], v[168:171], 0
  v_mfma_f32_32x32x16_bf16 v[36:51], a[0:3], v[184:187], 0
  v_mfma_f32_32x32x16_bf16 v[4:19], a[4:7], v[172:175], v[4:19]
  v_mfma_f32_32x32x16_bf16 v[36:51], a[4:7], v[188:191], v[36:51]
  v_mfma_f32_32x32x16_bf16 v[4:19], a[8:11], v[184:187], v[4:19]
  v_mfma_f32_32x32x16_bf16 v[36:51], a[16:19], v[168:171], v[36:51]
  v_mfma_f32_32x32x16_bf16 v[4:19], a[12:15], v[188:191], v[4:19]
  v_mfma_f32_32x32x16_bf16 v[36:51], a[20:23], v[172:175], v[36:51]
  v_mfma_f32_32x32x16_bf16 v[20:35], a[0:3], v[176:179], 0
  v_mfma_f32_32x32x16_bf16 v[52:67], a[0:3], v[192:195], 0
  v_mfma_f32_32x32x16_bf16 v[20:35], a[4:7], v[180:183], v[20:35]
  v_mfma_f32_32x32x16_bf16 v[52:67], a[4:7], v[196:199], v[52:67]
  v_mfma_f32_32x32x16_bf16 v[20:35], a[8:11], v[192:195], v[20:35]
  v_mfma_f32_32x32x16_bf16 v[52:67], a[16:19], v[176:179], v[52:67]
  v_mfma_f32_32x32x16_bf16 v[20:35], a[12:15], v[196:199], v[20:35]
  v_mfma_f32_32x32x16_bf16 v[52:67], a[20:23], v[180:183], v[52:67]
  v_and_b32 v2, 31, v0
  v_lshlrev_b32 v2, 2, v2
  v_lshrrev_b32 v3, 5, v0
  v_lshl_add_u32 v2, v3, 9, v2
  s_lshl_b32 s10, s2, 12
  s_add_u32 s10, s10, 17395712
  v_add_u32 v2, s10, v2
  v_add_u32 v3, 921600, v2
  s_nop 7
  v_cvt_pk_bf16_f32 v200, v4, v5
  global_store_dword v2, v200, s[4:5] offset:0
  v_cvt_pk_bf16_f32 v201, v6, v7
  global_store_dword v2, v201, s[4:5] offset:256
  v_cvt_pk_bf16_f32 v202, v8, v9
  global_store_dword v2, v202, s[4:5] offset:1024
  v_cvt_pk_bf16_f32 v203, v10, v11
  global_store_dword v2, v203, s[4:5] offset:1280
  v_cvt_pk_bf16_f32 v200, v12, v13
  global_store_dword v2, v200, s[4:5] offset:2048
  v_cvt_pk_bf16_f32 v201, v14, v15
  global_store_dword v2, v201, s[4:5] offset:2304
  v_cvt_pk_bf16_f32 v202, v16, v17
  global_store_dword v2, v202, s[4:5] offset:3072
  v_cvt_pk_bf16_f32 v203, v18, v19
  global_store_dword v2, v203, s[4:5] offset:3328
  v_cvt_pk_bf16_f32 v200, v20, v21
  global_store_dword v2, v200, s[4:5] offset:128
  v_cvt_pk_bf16_f32 v201, v22, v23
  global_store_dword v2, v201, s[4:5] offset:384
  v_cvt_pk_bf16_f32 v202, v24, v25
  global_store_dword v2, v202, s[4:5] offset:1152
  v_cvt_pk_bf16_f32 v203, v26, v27
  global_store_dword v2, v203, s[4:5] offset:1408
  v_cvt_pk_bf16_f32 v200, v28, v29
  global_store_dword v2, v200, s[4:5] offset:2176
  v_cvt_pk_bf16_f32 v201, v30, v31
  global_store_dword v2, v201, s[4:5] offset:2432
  v_cvt_pk_bf16_f32 v202, v32, v33
  global_store_dword v2, v202, s[4:5] offset:3200
  v_cvt_pk_bf16_f32 v203, v34, v35
  global_store_dword v2, v203, s[4:5] offset:3456
  v_cvt_pk_bf16_f32 v200, v36, v37
  global_store_dword v3, v200, s[4:5] offset:0
  v_cvt_pk_bf16_f32 v201, v38, v39
  global_store_dword v3, v201, s[4:5] offset:256
  v_cvt_pk_bf16_f32 v202, v40, v41
  global_store_dword v3, v202, s[4:5] offset:1024
  v_cvt_pk_bf16_f32 v203, v42, v43
  global_store_dword v3, v203, s[4:5] offset:1280
  v_cvt_pk_bf16_f32 v200, v44, v45
  global_store_dword v3, v200, s[4:5] offset:2048
  v_cvt_pk_bf16_f32 v201, v46, v47
  global_store_dword v3, v201, s[4:5] offset:2304
  v_cvt_pk_bf16_f32 v202, v48, v49
  global_store_dword v3, v202, s[4:5] offset:3072
  v_cvt_pk_bf16_f32 v203, v50, v51
  global_store_dword v3, v203, s[4:5] offset:3328
  v_cvt_pk_bf16_f32 v200, v52, v53
  global_store_dword v3, v200, s[4:5] offset:128
  v_cvt_pk_bf16_f32 v201, v54, v55
  global_store_dword v3, v201, s[4:5] offset:384
  v_cvt_pk_bf16_f32 v202, v56, v57
  global_store_dword v3, v202, s[4:5] offset:1152
  v_cvt_pk_bf16_f32 v203, v58, v59
  global_store_dword v3, v203, s[4:5] offset:1408
  v_cvt_pk_bf16_f32 v200, v60, v61
  global_store_dword v3, v200, s[4:5] offset:2176
  v_cvt_pk_bf16_f32 v201, v62, v63
  global_store_dword v3, v201, s[4:5] offset:2432
  v_cvt_pk_bf16_f32 v202, v64, v65
  global_store_dword v3, v202, s[4:5] offset:3200
  v_cvt_pk_bf16_f32 v203, v66, v67
  global_store_dword v3, v203, s[4:5] offset:3456
fb_end:
  s_endpgm
.section .rodata,"a"
.p2align 6
.amdhsa_kernel fb_kernel
  .amdhsa_next_free_vgpr 512
  .amdhsa_next_free_sgpr 102
  .amdhsa_accum_offset 256
  .amdhsa_group_segment_fixed_size 0
  .amdhsa_kernarg_size 104
  .amdhsa_user_sgpr_count 2
  .amdhsa_user_sgpr_kernarg_segment_ptr 1
  .amdhsa_system_sgpr_workgroup_id_x 1
.end_amdhsa_kernel
.text

.globl b0_kernel
.p2align 8
.type b0_kernel,@function
b0_kernel:
  s_mov_b32 s60, 0
  s_branch b_body
.globl b1_kernel
.p2align 8
.type b1_kernel,@function
b1_kernel:
  s_mov_b32 s60, 1
b_body:
  s_cmp_ge_u32 s2, 256
  s_cbranch_scc1 b_end
  s_load_dwordx2 s[4:5], s[0:1], 96
  s_load_dwordx2 s[34:35], s[0:1], 80
  v_and_b32 v1, 63, v0
  v_lshrrev_b32 v4, 6, v0
  s_nop 1
  v_readfirstlane_b32 s23, v4
  s_nop 3
  v_lshlrev_b32 v2, 4, v1
  s_getreg_b32 s40, hwreg(HW_REG_XCC_ID)
  s_and_b32 s40, s40, 15
  s_waitcnt lgkmcnt(0)
  s_mul_i32 s26, s60, 32768
  s_add_u32 s26, s26, 60772352
  s_add_u32 s16, s4, s26
  s_addc_u32 s17, s5, 0
  s_add_u32 s6, s4, 0
  s_addc_u32 s7, s5, 0
  s_add_u32 s8, s4, 24801280
  s_addc_u32 s9, s5, 0
  s_add_u32 s10, s4, 26636288
  s_addc_u32 s11, s5, 0
  s_add_u32 s20, s4, 62967808
  s_addc_u32 s21, s5, 0
  s_add_u32 s38, s4, 77647872
  s_addc_u32 s39, s5, 0
  s_cmp_eq_u32 s60, 0
  s_mov_b32 s27, 58113024
  s_cselect_b32 s26, 57048064, s27
  s_add_u32 s12, s4, s26
  s_addc_u32 s13, s5, 0
  s_cmp_eq_u32 s60, 0
  s_mov_b32 s27, 59973632
  s_cselect_b32 s26, 59174912, s27
  s_add_u32 s14, s4, s26
  s_addc_u32 s15, s5, 0
  s_cmp_eq_u32 s60, 0
  s_mov_b32 s27, 61370368
  s_cselect_b32 s26, 60837888, s27
  s_add_u32 s18, s4, s26
  s_addc_u32 s19, s5, 0
  s_cmp_eq_u32 s60, 0
  s_mov_b32 s27, 22966272
  s_cselect_b32 s26, 19296256, s27
  s_add_u32 s36, s4, s26
  s_addc_u32 s37, s5, 0
  s_cmp_eq_u32 s60, 0
  s_mov_b32 s27, 62435328
  s_cselect_b32 s26, 61902848, s27
  s_add_u32 s52, s4, s26
  s_addc_u32 s53, s5, 0
  s_add_u32 s26, s4, 21131264
  s_addc_u32 s27, s5, 0
  s_cmp_eq_u32 s60, 0
  s_cselect_b32 s34, s26, s34
  s_cselect_b32 s35, s27, s35
  s_mov_b32 s25, 4000000
  s_mov_b32 s24, 0
  s_mov_b32 s30, -1
  s_mov_b32 s31, 0x00ffffff
  s_mov_b32 s56, -1
  s_mov_b32 s57, 0x01ffffff
  s_cmp_lg_u32 s23, 0
  s_cbranch_scc1 b_el_wait
  s_mov_b64 exec, 1
  s_lshl_b32 s26, s40, 7
  v_mov_b32 v4, s26
  v_mov_b32 v5, 1
  global_atomic_add v6, v4, v5, s[16:17] sc0 sc1
  s_waitcnt vmcnt(0)
  v_cmp_eq_u32 vcc, 31, v6
  s_cbranch_vccz b_el_poll
  s_add_u32 s26, s40, 1
  v_mov_b32 v8, s26
  v_mov_b32 v9, 0
  v_mov_b32 v4, 1024
  global_atomic_cmpswap v4, v[8:9], s[16:17] sc1
b_el_poll:
  v_mov_b32 v4, 1024
  global_load_dword v7, v4, s[16:17] sc1
  s_sub_u32 s25, s25, 1
  s_cbranch_scc1 b_fail
  s_waitcnt vmcnt(0)
  v_cmp_eq_u32 vcc, 0, v7
  s_cbranch_vccnz b_el_poll
  s_add_u32 s26, s40, 1
  v_cmp_eq_u32 vcc, s26, v7
  v_cmp_ge_u32 s[50:51], 31, v6
  s_and_b64 vcc, vcc, s[50:51]
  s_cbranch_vccnz b_el_chain
  v_mov_b32 v4, 1152
  v_mov_b32 v5, 1
  global_atomic_add v6, v4, v5, s[16:17] sc0 sc1
  s_waitcnt vmcnt(0)
  v_add_u32 v6, 32, v6
b_el_chain:
  v_mov_b32 v4, 0
  ds_write_b32 v4, v6
  s_waitcnt lgkmcnt(0)
  s_mov_b64 exec, -1
b_el_wait:
  s_barrier
  v_mov_b32 v4, 0
  ds_read_b32 v6, v4
  s_waitcnt lgkmcnt(0)
  v_readfirstlane_b32 s22, v6
  s_nop 3
  s_barrier
  v_and_b32 v4, 8, v1
  v_cmp_ne_u32 vcc, 0, v4
  v_mov_b32 v5, 0x4444
  v_mov_b32 v6, 0xeeee
  s_nop 1
  v_cndmask_b32 v3, v5, v6, vcc
  s_cmp_ge_u32 s22, 32
  s_cbranch_scc1 b_worker
  s_cmp_eq_u32 s22, 30
  s_cbranch_scc1 b_helper
  s_cmp_eq_u32 s22, 31
  s_cbranch_scc1 b_pub
  s_cmp_ge_u32 s22, 16
  s_cbranch_scc1 b_value
  s_mul_i32 s26, s22, 401408
  s_add_u32 s6, s6, s26
  s_addc_u32 s7, s7, 0
  s_cmp_eq_u32 s23, 0
  s_cbranch_scc1 b_sp0
  s_cmp_eq_u32 s23, 1
  s_cbranch_scc1 b_sp1
  s_cmp_eq_u32 s23, 2
  s_cbranch_scc1 b_sp2
  s_branch b_sw
b_value:
  s_sub_u32 s26, s22, 16
  s_mul_i32 s26, s26, 28672
  s_add_u32 s26, s26, 6422528
  s_add_u32 s6, s6, s26
  s_addc_u32 s7, s7, 0
  s_cmp_eq_u32 s23, 0
  s_cbranch_scc1 b_vw0
  s_cmp_eq_u32 s23, 1
  s_cbranch_scc1 b_vw1
  s_cmp_eq_u32 s23, 2
  s_cbranch_scc1 b_vw2
  s_branch b_vw3
b_worker:
  s_sub_u32 s22, s22, 32
  s_cmp_lt_u32 s22, 64
  s_cbranch_scc1 b_fcpv
  s_sub_u32 s22, s22, 64
  s_cmp_lt_u32 s22, 32
  s_cbranch_scc1 b_uw
  s_sub_u32 s22, s22, 32
  s_cmp_lt_u32 s22, 32
  s_cbranch_scc1 b_zw
  s_sub_u32 s22, s22, 32
  s_cmp_lt_u32 s22, 48
  s_cbranch_scc1 b_pw
  s_cmp_lg_u32 s60, 0
  s_cbranch_scc1 b_end
  s_sub_u32 s22, s22, 48
  s_lshl_b32 s26, s22, 8
  v_add_u32 v2, s26, v0
  v_mov_b32 v4, -1
  v_mov_b32 v5, -1
  v_mov_b32 v6, -1
  v_mov_b32 v7, -1
  v_add_u32 v8, 0, v2
  v_lshlrev_b32 v8, 4, v8
  v_add_u32 v8, 58126336, v8
  global_store_dwordx4 v8, v[4:7], s[4:5]
  v_add_u32 v8, 12288, v2
  v_lshlrev_b32 v8, 4, v8
  v_add_u32 v8, 58126336, v8
  global_store_dwordx4 v8, v[4:7], s[4:5]
  v_add_u32 v8, 24576, v2
  v_lshlrev_b32 v8, 4, v8
  v_add_u32 v8, 58126336, v8
  global_store_dwordx4 v8, v[4:7], s[4:5]
  v_add_u32 v8, 36864, v2
  v_lshlrev_b32 v8, 4, v8
  v_add_u32 v8, 58126336, v8
  global_store_dwordx4 v8, v[4:7], s[4:5]
  v_add_u32 v8, 49152, v2
  v_lshlrev_b32 v8, 4, v8
  v_add_u32 v8, 58126336, v8
  global_store_dwordx4 v8, v[4:7], s[4:5]
  v_add_u32 v8, 61440, v2
  v_cmp_gt_u32 vcc, 65536, v8
  s_and_saveexec_b64 s[12:13], vcc
  s_cbranch_execz bfill_f0_5
  v_lshlrev_b32 v8, 4, v8
  v_add_u32 v8, 58126336, v8
  global_store_dwordx4 v8, v[4:7], s[4:5]
bfill_f0_5:
  s_mov_b64 exec, s[12:13]
  v_add_u32 v8, 0, v2
  v_lshlrev_b32 v8, 4, v8
  v_add_u32 v8, 59973632, v8
  global_store_dwordx4 v8, v[4:7], s[4:5]
  v_add_u32 v8, 12288, v2
  v_lshlrev_b32 v8, 4, v8
  v_add_u32 v8, 59973632, v8
  global_store_dwordx4 v8, v[4:7], s[4:5]
  v_add_u32 v8, 24576, v2
  v_lshlrev_b32 v8, 4, v8
  v_add_u32 v8, 59973632, v8
  global_store_dwordx4 v8, v[4:7], s[4:5]
  v_add_u32 v8, 36864, v2
  v_lshlrev_b32 v8, 4, v8
  v_add_u32 v8, 59973632, v8
  global_store_dwordx4 v8, v[4:7], s[4:5]
  v_add_u32 v8, 49152, v2
  v_cmp_gt_u32 vcc, 49920, v8
  s_and_saveexec_b64 s[12:13], vcc
  s_cbranch_execz bfill_f1_4
  v_lshlrev_b32 v8, 4, v8
  v_add_u32 v8, 59973632, v8
  global_store_dwordx4 v8, v[4:7], s[4:5]
bfill_f1_4:
  s_mov_b64 exec, s[12:13]
  v_add_u32 v8, 0, v2
  v_lshlrev_b32 v8, 4, v8
  v_add_u32 v8, 61378560, v8
  global_store_dwordx4 v8, v[4:7], s[4:5]
  v_add_u32 v8, 12288, v2
  v_lshlrev_b32 v8, 4, v8
  v_add_u32 v8, 61378560, v8
  global_store_dwordx4 v8, v[4:7], s[4:5]
  v_add_u32 v8, 24576, v2
  v_cmp_gt_u32 vcc, 32768, v8
  s_and_saveexec_b64 s[12:13], vcc
  s_cbranch_execz bfill_f2_2
  v_lshlrev_b32 v8, 4, v8
  v_add_u32 v8, 61378560, v8
  global_store_dwordx4 v8, v[4:7], s[4:5]
bfill_f2_2:
  s_mov_b64 exec, s[12:13]
  v_add_u32 v8, 0, v2
  v_lshlrev_b32 v8, 4, v8
  v_add_u32 v8, 62443520, v8
  global_store_dwordx4 v8, v[4:7], s[4:5]
  v_add_u32 v8, 12288, v2
  v_lshlrev_b32 v8, 4, v8
  v_add_u32 v8, 62443520, v8
  global_store_dwordx4 v8, v[4:7], s[4:5]
  v_add_u32 v8, 24576, v2
  v_cmp_gt_u32 vcc, 32768, v8
  s_and_saveexec_b64 s[12:13], vcc
  s_cbranch_execz bfill_f3_2
  v_lshlrev_b32 v8, 4, v8
  v_add_u32 v8, 62443520, v8
  global_store_dwordx4 v8, v[4:7], s[4:5]
bfill_f3_2:
  s_mov_b64 exec, s[12:13]
  s_endpgm
b_sp0:
  v_add_u32 v4, 57344, v2
  global_load_dwordx4 v[60:63], v4, s[6:7]
  v_add_u32 v4, 58368, v2
  global_load_dwordx4 v[64:67], v4, s[6:7]
  v_add_u32 v4, 59392, v2
  global_load_dwordx4 v[68:71], v4, s[6:7]
  v_add_u32 v4, 60416, v2
  global_load_dwordx4 v[72:75], v4, s[6:7]
  v_add_u32 v4, 61440, v2
  global_load_dwordx4 v[76:79], v4, s[6:7]
  v_add_u32 v4, 62464, v2
  global_load_dwordx4 v[80:83], v4, s[6:7]
  v_add_u32 v4, 63488, v2
  global_load_dwordx4 v[84:87], v4, s[6:7]
  v_add_u32 v4, 64512, v2
  global_load_dwordx4 v[88:91], v4, s[6:7]
  v_add_u32 v4, 65536, v2
  global_load_dwordx4 v[92:95], v4, s[6:7]
  v_add_u32 v4, 66560, v2
  global_load_dwordx4 v[96:99], v4, s[6:7]
  v_add_u32 v4, 67584, v2
  global_load_dwordx4 v[100:103], v4, s[6:7]
  v_add_u32 v4, 68608, v2
  global_load_dwordx4 v[104:107], v4, s[6:7]
  v_add_u32 v4, 69632, v2
  global_load_dwordx4 v[108:111], v4, s[6:7]
  v_add_u32 v4, 70656, v2
  global_load_dwordx4 v[112:115], v4, s[6:7]
  v_add_u32 v5, 0, v2
  s_waitcnt vmcnt(0)
  ds_write_b128 v5, v[60:63] offset:0
  ds_write_b128 v5, v[64:67] offset:1024
  ds_write_b128 v5, v[68:71] offset:2048
  ds_write_b128 v5, v[72:75] offset:3072
  ds_write_b128 v5, v[76:79] offset:4096
  ds_write_b128 v5, v[80:83] offset:5120
  ds_write_b128 v5, v[84:87] offset:6144
  ds_write_b128 v5, v[88:91] offset:7168
  ds_write_b128 v5, v[92:95] offset:8192
  ds_write_b128 v5, v[96:99] offset:9216
  ds_write_b128 v5, v[100:103] offset:10240
  ds_write_b128 v5, v[104:107] offset:11264
  ds_write_b128 v5, v[108:111] offset:12288
  ds_write_b128 v5, v[112:115] offset:13312
  s_waitcnt lgkmcnt(0)
  v_add_u32 v4, 100352, v2
  global_load_dwordx4 a[0:3], v4, s[6:7]
  global_load_dwordx4 a[4:7], v4, s[6:7] offset:1024
  v_add_u32 v4, 102400, v2
  global_load_dwordx4 a[8:11], v4, s[6:7]
  global_load_dwordx4 a[12:15], v4, s[6:7] offset:1024
  v_add_u32 v4, 104448, v2
  global_load_dwordx4 a[16:19], v4, s[6:7]
  global_load_dwordx4 a[20:23], v4, s[6:7] offset:1024
  v_add_u32 v4, 106496, v2
  global_load_dwordx4 a[24:27], v4, s[6:7]
  global_load_dwordx4 a[28:31], v4, s[6:7] offset:1024
  v_add_u32 v4, 108544, v2
  global_load_dwordx4 a[32:35], v4, s[6:7]
  global_load_dwordx4 a[36:39], v4, s[6:7] offset:1024
  v_add_u32 v4, 110592, v2
  global_load_dwordx4 a[40:43], v4, s[6:7]
  global_load_dwordx4 a[44:47], v4, s[6:7] offset:1024
  v_add_u32 v4, 112640, v2
  global_load_dwordx4 a[48:51], v4, s[6:7]
  global_load_dwordx4 a[52:55], v4, s[6:7] offset:1024
  v_add_u32 v4, 143360, v2
  global_load_dwordx4 a[56:59], v4, s[6:7]
  global_load_dwordx4 a[60:63], v4, s[6:7] offset:1024
  v_add_u32 v4, 145408, v2
  global_load_dwordx4 a[64:67], v4, s[6:7]
  global_load_dwordx4 a[68:71], v4, s[6:7] offset:1024
  v_add_u32 v4, 147456, v2
  global_load_dwordx4 a[72:75], v4, s[6:7]
  global_load_dwordx4 a[76:79], v4, s[6:7] offset:1024
  v_add_u32 v4, 149504, v2
  global_load_dwordx4 a[80:83], v4, s[6:7]
  global_load_dwordx4 a[84:87], v4, s[6:7] offset:1024
  v_add_u32 v4, 151552, v2
  global_load_dwordx4 a[88:91], v4, s[6:7]
  global_load_dwordx4 a[92:95], v4, s[6:7] offset:1024
  v_add_u32 v4, 153600, v2
  global_load_dwordx4 a[96:99], v4, s[6:7]
  global_load_dwordx4 a[100:103], v4, s[6:7] offset:1024
  v_add_u32 v4, 155648, v2
  global_load_dwordx4 a[104:107], v4, s[6:7]
  global_load_dwordx4 a[108:111], v4, s[6:7] offset:1024
  v_add_u32 v4, 186368, v2
  global_load_dwordx4 a[112:115], v4, s[6:7]
  global_load_dwordx4 a[116:119], v4, s[6:7] offset:1024
  v_add_u32 v4, 188416, v2
  global_load_dwordx4 a[120:123], v4, s[6:7]
  global_load_dwordx4 a[124:127], v4, s[6:7] offset:1024
  s_waitcnt vmcnt(32)
  v_add_u32 v4, 190464, v2
  global_load_dwordx4 a[128:131], v4, s[6:7]
  global_load_dwordx4 a[132:135], v4, s[6:7] offset:1024
  v_add_u32 v4, 192512, v2
  global_load_dwordx4 a[136:139], v4, s[6:7]
  global_load_dwordx4 a[140:143], v4, s[6:7] offset:1024
  v_add_u32 v4, 194560, v2
  global_load_dwordx4 a[144:147], v4, s[6:7]
  global_load_dwordx4 a[148:151], v4, s[6:7] offset:1024
  v_add_u32 v4, 196608, v2
  global_load_dwordx4 a[152:155], v4, s[6:7]
  global_load_dwordx4 a[156:159], v4, s[6:7] offset:1024
  v_add_u32 v4, 198656, v2
  global_load_dwordx4 a[160:163], v4, s[6:7]
  global_load_dwordx4 a[164:167], v4, s[6:7] offset:1024
  v_add_u32 v4, 229376, v2
  global_load_dwordx4 a[168:171], v4, s[6:7]
  global_load_dwordx4 a[172:175], v4, s[6:7] offset:1024
  v_add_u32 v4, 231424, v2
  global_load_dwordx4 a[176:179], v4, s[6:7]
  global_load_dwordx4 a[180:183], v4, s[6:7] offset:1024
  v_add_u32 v4, 233472, v2
  global_load_dwordx4 a[184:187], v4, s[6:7]
  global_load_dwordx4 a[188:191], v4, s[6:7] offset:1024
  v_add_u32 v4, 235520, v2
  global_load_dwordx4 a[192:195], v4, s[6:7]
  global_load_dwordx4 a[196:199], v4, s[6:7] offset:1024
  v_add_u32 v4, 237568, v2
  global_load_dwordx4 a[200:203], v4, s[6:7]
  global_load_dwordx4 a[204:207], v4, s[6:7] offset:1024
  v_add_u32 v4, 239616, v2
  global_load_dwordx4 a[208:211], v4, s[6:7]
  global_load_dwordx4 a[212:215], v4, s[6:7] offset:1024
  v_add_u32 v4, 241664, v2
  global_load_dwordx4 a[216:219], v4, s[6:7]
  global_load_dwordx4 a[220:223], v4, s[6:7] offset:1024
  v_add_u32 v4, 272384, v2
  global_load_dwordx4 a[224:227], v4, s[6:7]
  global_load_dwordx4 a[228:231], v4, s[6:7] offset:1024
  v_add_u32 v4, 274432, v2
  global_load_dwordx4 a[232:235], v4, s[6:7]
  global_load_dwordx4 a[236:239], v4, s[6:7] offset:1024
  v_add_u32 v4, 276480, v2
  global_load_dwordx4 a[240:243], v4, s[6:7]
  global_load_dwordx4 a[244:247], v4, s[6:7] offset:1024
  v_add_u32 v4, 278528, v2
  global_load_dwordx4 a[248:251], v4, s[6:7]
  global_load_dwordx4 a[252:255], v4, s[6:7] offset:1024
  s_waitcnt vmcnt(32)
  v_add_u32 v4, 280576, v2
  global_load_dwordx4 v[120:123], v4, s[6:7]
  global_load_dwordx4 v[124:127], v4, s[6:7] offset:1024
  v_add_u32 v4, 282624, v2
  global_load_dwordx4 v[128:131], v4, s[6:7]
  global_load_dwordx4 v[132:135], v4, s[6:7] offset:1024
  v_add_u32 v4, 284672, v2
  global_load_dwordx4 v[136:139], v4, s[6:7]
  global_load_dwordx4 v[140:143], v4, s[6:7] offset:1024
  v_add_u32 v4, 315392, v2
  global_load_dwordx4 v[144:147], v4, s[6:7]
  global_load_dwordx4 v[148:151], v4, s[6:7] offset:1024
  v_add_u32 v4, 317440, v2
  global_load_dwordx4 v[152:155], v4, s[6:7]
  global_load_dwordx4 v[156:159], v4, s[6:7] offset:1024
  v_add_u32 v4, 319488, v2
  global_load_dwordx4 v[160:163], v4, s[6:7]
  global_load_dwordx4 v[164:167], v4, s[6:7] offset:1024
  v_add_u32 v4, 321536, v2
  global_load_dwordx4 v[168:171], v4, s[6:7]
  global_load_dwordx4 v[172:175], v4, s[6:7] offset:1024
  v_add_u32 v4, 323584, v2
  global_load_dwordx4 v[176:179], v4, s[6:7]
  global_load_dwordx4 v[180:183], v4, s[6:7] offset:1024
  v_add_u32 v4, 325632, v2
  global_load_dwordx4 v[184:187], v4, s[6:7]
  global_load_dwordx4 v[188:191], v4, s[6:7] offset:1024
  v_add_u32 v4, 327680, v2
  global_load_dwordx4 v[192:195], v4, s[6:7]
  global_load_dwordx4 v[196:199], v4, s[6:7] offset:1024
  v_add_u32 v4, 358400, v2
  global_load_dwordx4 v[200:203], v4, s[6:7]
  global_load_dwordx4 v[204:207], v4, s[6:7] offset:1024
  v_add_u32 v4, 360448, v2
  global_load_dwordx4 v[208:211], v4, s[6:7]
  global_load_dwordx4 v[212:215], v4, s[6:7] offset:1024
  v_add_u32 v4, 362496, v2
  global_load_dwordx4 v[216:219], v4, s[6:7]
  global_load_dwordx4 v[220:223], v4, s[6:7] offset:1024
  v_add_u32 v4, 364544, v2
  global_load_dwordx4 v[224:227], v4, s[6:7]
  global_load_dwordx4 v[228:231], v4, s[6:7] offset:1024
  v_add_u32 v4, 366592, v2
  global_load_dwordx4 v[232:235], v4, s[6:7]
  global_load_dwordx4 v[236:239], v4, s[6:7] offset:1024
  v_add_u32 v4, 368640, v2
  global_load_dwordx4 v[240:243], v4, s[6:7]
  global_load_dwordx4 v[244:247], v4, s[6:7] offset:1024
  s_waitcnt vmcnt(32)
  v_add_u32 v4, 370688, v2
  global_load_dwordx4 v[248:251], v4, s[6:7]
  global_load_dwordx4 v[252:255], v4, s[6:7] offset:1024
  s_waitcnt vmcnt(0)
  v_and_b32 v8, 15, v1
  v_lshrrev_b32 v9, 4, v1
  v_lshrrev_b32 v10, 2, v8
  v_xor_b32 v9, v9, v10
  v_lshlrev_b32 v9, 3, v9
  v_lshl_add_u32 v9, v8, 5, v9
  v_lshrrev_b32 v10, 3, v8
  v_lshl_add_u32 v4, v10, 7, v9
  v_add_u32 v4, 43008, v4
  v_lshlrev_b32 v5, 2, v1
  v_add_u32 v5, 64512, v5
  v_mov_b32 v0, 0
  ds_write_b32 v5, v0 offset:0
  ds_write_b32 v5, v0 offset:1024
  ds_write_b32 v5, v0 offset:2048
  ds_write_b32 v5, v0 offset:3072
  ds_write_b32 v5, v0 offset:4096
  v_min_u32 v1, 55, v1
  v_lshlrev_b32 v1, 2, v1
  s_and_b32 s26, s22, 7
  s_lshl_b32 s26, s26, 8
  s_add_u32 s26, s26, 5120
  v_add_u32 v1, s26, v1
  ds_read_b128 v[60:63], v2 offset:0
  ds_read_b128 v[64:67], v2 offset:1024
  ds_read_b128 v[68:71], v2 offset:2048
  ds_read_b128 v[72:75], v2 offset:3072
  ds_read_b128 v[76:79], v2 offset:4096
  ds_read_b128 v[80:83], v2 offset:5120
  ds_read_b128 v[84:87], v2 offset:6144
  ds_read_b128 v[88:91], v2 offset:7168
  ds_read_b128 v[92:95], v2 offset:8192
  ds_read_b128 v[96:99], v2 offset:9216
  ds_read_b128 v[100:103], v2 offset:10240
  ds_read_b128 v[104:107], v2 offset:11264
  ds_read_b128 v[108:111], v2 offset:12288
  ds_read_b128 v[112:115], v2 offset:13312
  v_mov_b64 v[40:41], 0
  v_mov_b64 v[42:43], 0
  v_mov_b64 v[44:45], 0
  v_mov_b64 v[46:47], 0
  v_mov_b64 v[48:49], 0
  v_mov_b64 v[50:51], 0
  v_mov_b64 v[52:53], 0
  v_mov_b64 v[54:55], 0
  v_mov_b64 v[56:57], 0
  v_mov_b64 v[58:59], 0
  v_mov_b64 v[116:117], 0
  v_mov_b64 v[118:119], 0
  s_waitcnt lgkmcnt(0)
  s_barrier
b_sp0_step:
  v_add_u32 v0, 1, v0
  s_mov_b64 exec, s[30:31]
  global_load_dword v6, v1, s[12:13] sc1
  s_nop 15
  s_nop 4
  global_load_dword v7, v1, s[12:13] sc1
  s_nop 15
  s_nop 4
b_sp0_bell:
  global_load_dword v8, v1, s[12:13] sc1
  s_waitcnt vmcnt(2)
  v_cmp_eq_u32 vcc, -1, v6
  s_cbranch_vccz b_sp0_bell_ok
  global_load_dword v6, v1, s[12:13] sc1
  s_waitcnt vmcnt(2)
  v_cmp_eq_u32 vcc, -1, v7
  s_cbranch_vccz b_sp0_bell_ok
  global_load_dword v7, v1, s[12:13] sc1
  s_waitcnt vmcnt(2)
  v_cmp_eq_u32 vcc, -1, v8
  s_sub_u32 s25, s25, 1
  s_cbranch_scc1 b_fail
  s_cbranch_vccz b_sp0_bell_ok
  s_branch b_sp0_bell
b_sp0_bell_ok:
  s_mov_b64 exec, -1
b_sp0_gather:
  global_load_dwordx4 v[12:15], v2, s[12:13] offset:-3072 sc1
  s_nop 11
  global_load_dwordx4 v[16:19], v2, s[12:13] offset:-2048 sc1
  s_nop 11
  global_load_dwordx4 v[20:23], v2, s[12:13] offset:-1024 sc1
  s_nop 11
  global_load_dwordx4 v[24:27], v2, s[12:13] offset:0 sc1
  s_sub_u32 s25, s25, 1
  s_cbranch_scc1 b_fail
  s_waitcnt vmcnt(3)
  v_smfmac_f32_16x16x64_bf16 v[40:43], v[12:15], v[60:67], v3
  global_load_dwordx4 v[28:31], v2, s[12:13] offset:1024 sc1
  v_smfmac_f32_16x16x64_bf16 v[44:47], v[12:15], a[0:7], v3
  v_max3_u32 v6, v12, v13, v14
  v_smfmac_f32_16x16x64_bf16 v[48:51], v[12:15], a[56:63], v3
  v_smfmac_f32_16x16x64_bf16 v[52:55], v[12:15], a[112:119], v3
  s_waitcnt vmcnt(3)
  v_smfmac_f32_16x16x64_bf16 v[40:43], v[16:19], v[68:75], v3
  global_load_dwordx4 v[32:35], v2, s[12:13] offset:2048 sc1
  v_smfmac_f32_16x16x64_bf16 v[44:47], v[16:19], a[8:15], v3
  v_max3_u32 v6, v6, v15, v16
  v_smfmac_f32_16x16x64_bf16 v[48:51], v[16:19], a[64:71], v3
  v_max3_u32 v6, v6, v17, v18
  v_smfmac_f32_16x16x64_bf16 v[52:55], v[16:19], a[120:127], v3
  s_waitcnt vmcnt(3)
  v_smfmac_f32_16x16x64_bf16 v[40:43], v[20:23], v[76:83], v3
  global_load_dwordx4 v[36:39], v2, s[12:13] offset:3072 sc1
  v_smfmac_f32_16x16x64_bf16 v[44:47], v[20:23], a[16:23], v3
  v_max3_u32 v6, v6, v19, v20
  v_smfmac_f32_16x16x64_bf16 v[48:51], v[20:23], a[72:79], v3
  v_max3_u32 v6, v6, v21, v22
  v_smfmac_f32_16x16x64_bf16 v[52:55], v[20:23], a[128:135], v3
  s_waitcnt vmcnt(3)
  v_smfmac_f32_16x16x64_bf16 v[40:43], v[24:27], v[84:91], v3
  v_max3_u32 v6, v6, v23, v24
  v_smfmac_f32_16x16x64_bf16 v[44:47], v[24:27], a[24:31], v3
  v_max3_u32 v6, v6, v25, v26
  v_smfmac_f32_16x16x64_bf16 v[48:51], v[24:27], a[80:87], v3
  v_smfmac_f32_16x16x64_bf16 v[52:55], v[24:27], a[136:143], v3
  s_waitcnt vmcnt(2)
  v_smfmac_f32_16x16x64_bf16 v[40:43], v[28:31], v[92:99], v3
  v_max3_u32 v6, v6, v27, v28
  v_smfmac_f32_16x16x64_bf16 v[44:47], v[28:31], a[32:39], v3
  v_max3_u32 v6, v6, v29, v30
  v_smfmac_f32_16x16x64_bf16 v[48:51], v[28:31], a[88:95], v3
  v_smfmac_f32_16x16x64_bf16 v[52:55], v[28:31], a[144:151], v3
  s_waitcnt vmcnt(1)
  v_smfmac_f32_16x16x64_bf16 v[40:43], v[32:35], v[100:107], v3
  v_max3_u32 v6, v6, v31, v32
  v_smfmac_f32_16x16x64_bf16 v[44:47], v[32:35], a[40:47], v3
  v_max3_u32 v6, v6, v33, v34
  v_smfmac_f32_16x16x64_bf16 v[48:51], v[32:35], a[96:103], v3
  v_smfmac_f32_16x16x64_bf16 v[52:55], v[32:35], a[152:159], v3
  s_waitcnt vmcnt(0)
  v_smfmac_f32_16x16x64_bf16 v[40:43], v[36:39], v[108:115], v3
  v_max3_u32 v6, v6, v35, v36
  v_smfmac_f32_16x16x64_bf16 v[44:47], v[36:39], a[48:55], v3
  v_max3_u32 v6, v6, v37, v38
  v_smfmac_f32_16x16x64_bf16 v[48:51], v[36:39], a[104:111], v3
  v_max_u32 v6, v6, v39
  v_smfmac_f32_16x16x64_bf16 v[52:55], v[36:39], a[160:167], v3
  v_cmp_eq_u32 vcc, -1, v6
  s_nop 2
  v_cvt_pk_bf16_f32 v6, v40, v41
  v_cvt_pk_bf16_f32 v7, v42, v43
  ds_write_b64 v4, v[6:7] offset:3072
  v_cvt_pk_bf16_f32 v8, v44, v45
  v_cvt_pk_bf16_f32 v9, v46, v47
  ds_write_b64 v4, v[8:9] offset:5376
  s_cbranch_vccnz b_sp0_redo
  ds_write_b32 v5, v0 offset:0
  v_smfmac_f32_16x16x64_bf16 v[56:59], v[12:15], a[168:175], v3
  v_cvt_pk_bf16_f32 v6, v48, v49
  v_cvt_pk_bf16_f32 v7, v50, v51
  v_smfmac_f32_16x16x64_bf16 v[56:59], v[16:19], a[176:183], v3
  ds_write_b64 v4, v[6:7] offset:7680
  v_smfmac_f32_16x16x64_bf16 v[56:59], v[20:23], a[184:191], v3
  ds_write_b32 v5, v0 offset:1024
  v_smfmac_f32_16x16x64_bf16 v[56:59], v[24:27], a[192:199], v3
  v_cvt_pk_bf16_f32 v8, v52, v53
  v_smfmac_f32_16x16x64_bf16 v[56:59], v[28:31], a[200:207], v3
  v_cvt_pk_bf16_f32 v9, v54, v55
  v_smfmac_f32_16x16x64_bf16 v[56:59], v[32:35], a[208:215], v3
  ds_write_b64 v4, v[8:9] offset:9984
  v_smfmac_f32_16x16x64_bf16 v[56:59], v[36:39], a[216:223], v3
  ds_write_b32 v5, v0 offset:2048
  v_smfmac_f32_16x16x64_bf16 v[116:119], v[12:15], a[224:231], v3
  v_mov_b64 v[40:41], 0
  v_smfmac_f32_16x16x64_bf16 v[116:119], v[16:19], a[232:239], v3
  v_mov_b64 v[42:43], 0
  v_smfmac_f32_16x16x64_bf16 v[116:119], v[20:23], a[240:247], v3
  v_cvt_pk_bf16_f32 v6, v56, v57
  v_smfmac_f32_16x16x64_bf16 v[116:119], v[24:27], a[248:255], v3
  v_cvt_pk_bf16_f32 v7, v58, v59
  v_smfmac_f32_16x16x64_bf16 v[116:119], v[28:31], v[120:127], v3
  ds_write_b64 v4, v[6:7] offset:12288
  v_smfmac_f32_16x16x64_bf16 v[116:119], v[32:35], v[128:135], v3
  v_smfmac_f32_16x16x64_bf16 v[116:119], v[36:39], v[136:143], v3
  v_smfmac_f32_16x16x64_bf16 v[40:43], v[12:15], v[144:151], v3
  v_mov_b64 v[44:45], 0
  v_smfmac_f32_16x16x64_bf16 v[40:43], v[16:19], v[152:159], v3
  v_mov_b64 v[46:47], 0
  v_smfmac_f32_16x16x64_bf16 v[40:43], v[20:23], v[160:167], v3
  v_cvt_pk_bf16_f32 v8, v116, v117
  v_smfmac_f32_16x16x64_bf16 v[40:43], v[24:27], v[168:175], v3
  v_cvt_pk_bf16_f32 v9, v118, v119
  v_smfmac_f32_16x16x64_bf16 v[40:43], v[28:31], v[176:183], v3
  ds_write_b64 v4, v[8:9] offset:14592
  v_smfmac_f32_16x16x64_bf16 v[40:43], v[32:35], v[184:191], v3
  ds_write_b32 v5, v0 offset:3072
  v_smfmac_f32_16x16x64_bf16 v[40:43], v[36:39], v[192:199], v3
  v_smfmac_f32_16x16x64_bf16 v[44:47], v[12:15], v[200:207], v3
  v_smfmac_f32_16x16x64_bf16 v[44:47], v[16:19], v[208:215], v3
  v_smfmac_f32_16x16x64_bf16 v[44:47], v[20:23], v[216:223], v3
  v_cvt_pk_bf16_f32 v6, v40, v41
  v_smfmac_f32_16x16x64_bf16 v[44:47], v[24:27], v[224:231], v3
  v_cvt_pk_bf16_f32 v7, v42, v43
  v_smfmac_f32_16x16x64_bf16 v[44:47], v[28:31], v[232:239], v3
  ds_write_b64 v4, v[6:7] offset:16896
  v_smfmac_f32_16x16x64_bf16 v[44:47], v[32:35], v[240:247], v3
  ds_write_b32 v5, v0 offset:4096
  v_smfmac_f32_16x16x64_bf16 v[44:47], v[36:39], v[248:255], v3
  s_nop 7
  v_cvt_pk_bf16_f32 v6, v44, v45
  v_cvt_pk_bf16_f32 v7, v46, v47
  ds_write_b64 v4, v[6:7] offset:19200
  s_waitcnt lgkmcnt(0)
  s_barrier
  ds_read_b128 v[60:63], v2 offset:0
  ds_read_b128 v[64:67], v2 offset:1024
  ds_read_b128 v[68:71], v2 offset:2048
  ds_read_b128 v[72:75], v2 offset:3072
  ds_read_b128 v[76:79], v2 offset:4096
  ds_read_b128 v[80:83], v2 offset:5120
  ds_read_b128 v[84:87], v2 offset:6144
  ds_read_b128 v[88:91], v2 offset:7168
  ds_read_b128 v[92:95], v2 offset:8192
  ds_read_b128 v[96:99], v2 offset:9216
  ds_read_b128 v[100:103], v2 offset:10240
  ds_read_b128 v[104:107], v2 offset:11264
  ds_read_b128 v[108:111], v2 offset:12288
  ds_read_b128 v[112:115], v2 offset:13312
  v_mov_b64 v[40:41], 0
  v_mov_b64 v[42:43], 0
  v_mov_b64 v[44:45], 0
  v_mov_b64 v[46:47], 0
  v_mov_b64 v[48:49], 0
  v_mov_b64 v[50:51], 0
  v_mov_b64 v[52:53], 0
  v_mov_b64 v[54:55], 0
  v_mov_b64 v[56:57], 0
  v_mov_b64 v[58:59], 0
  v_mov_b64 v[116:117], 0
  v_mov_b64 v[118:119], 0
  s_add_u32 s12, s12, 16384
  s_addc_u32 s13, s13, 0
  s_add_u32 s24, s24, 1
  s_cmp_lt_u32 s24, 63
  s_waitcnt lgkmcnt(0)
  s_cbranch_scc1 b_sp0_step
  s_endpgm
b_sp0_redo:
  s_nop 7
  v_mov_b64 v[40:41], 0
  v_mov_b64 v[42:43], 0
  v_mov_b64 v[44:45], 0
  v_mov_b64 v[46:47], 0
  v_mov_b64 v[48:49], 0
  v_mov_b64 v[50:51], 0
  v_mov_b64 v[52:53], 0
  v_mov_b64 v[54:55], 0
  v_mov_b64 v[56:57], 0
  v_mov_b64 v[58:59], 0
  s_branch b_sp0_gather
b_sp1:
  v_add_u32 v4, 71680, v2
  global_load_dwordx4 v[60:63], v4, s[6:7]
  v_add_u32 v4, 72704, v2
  global_load_dwordx4 v[64:67], v4, s[6:7]
  v_add_u32 v4, 73728, v2
  global_load_dwordx4 v[68:71], v4, s[6:7]
  v_add_u32 v4, 74752, v2
  global_load_dwordx4 v[72:75], v4, s[6:7]
  v_add_u32 v4, 75776, v2
  global_load_dwordx4 v[76:79], v4, s[6:7]
  v_add_u32 v4, 76800, v2
  global_load_dwordx4 v[80:83], v4, s[6:7]
  v_add_u32 v4, 77824, v2
  global_load_dwordx4 v[84:87], v4, s[6:7]
  v_add_u32 v4, 78848, v2
  global_load_dwordx4 v[88:91], v4, s[6:7]
  v_add_u32 v4, 79872, v2
  global_load_dwordx4 v[92:95], v4, s[6:7]
  v_add_u32 v4, 80896, v2
  global_load_dwordx4 v[96:99], v4, s[6:7]
  v_add_u32 v4, 81920, v2
  global_load_dwordx4 v[100:103], v4, s[6:7]
  v_add_u32 v4, 82944, v2
  global_load_dwordx4 v[104:107], v4, s[6:7]
  v_add_u32 v4, 83968, v2
  global_load_dwordx4 v[108:111], v4, s[6:7]
  v_add_u32 v4, 84992, v2
  global_load_dwordx4 v[112:115], v4, s[6:7]
  v_add_u32 v5, 14336, v2
  s_waitcnt vmcnt(0)
  ds_write_b128 v5, v[60:63] offset:0
  ds_write_b128 v5, v[64:67] offset:1024
  ds_write_b128 v5, v[68:71] offset:2048
  ds_write_b128 v5, v[72:75] offset:3072
  ds_write_b128 v5, v[76:79] offset:4096
  ds_write_b128 v5, v[80:83] offset:5120
  ds_write_b128 v5, v[84:87] offset:6144
  ds_write_b128 v5, v[88:91] offset:7168
  ds_write_b128 v5, v[92:95] offset:8192
  ds_write_b128 v5, v[96:99] offset:9216
  ds_write_b128 v5, v[100:103] offset:10240
  ds_write_b128 v5, v[104:107] offset:11264
  ds_write_b128 v5, v[108:111] offset:12288
  ds_write_b128 v5, v[112:115] offset:13312
  s_waitcnt lgkmcnt(0)
  v_add_u32 v4, 114688, v2
  global_load_dwordx4 a[0:3], v4, s[6:7]
  global_load_dwordx4 a[4:7], v4, s[6:7] offset:1024
  v_add_u32 v4, 116736, v2
  global_load_dwordx4 a[8:11], v4, s[6:7]
  global_load_dwordx4 a[12:15], v4, s[6:7] offset:1024
  v_add_u32 v4, 118784, v2
  global_load_dwordx4 a[16:19], v4, s[6:7]
  global_load_dwordx4 a[20:23], v4, s[6:7] offset:1024
  v_add_u32 v4, 120832, v2
  global_load_dwordx4 a[24:27], v4, s[6:7]
  global_load_dwordx4 a[28:31], v4, s[6:7] offset:1024
  v_add_u32 v4, 122880, v2
  global_load_dwordx4 a[32:35], v4, s[6:7]
  global_load_dwordx4 a[36:39], v4, s[6:7] offset:1024
  v_add_u32 v4, 124928, v2
  global_load_dwordx4 a[40:43], v4, s[6:7]
  global_load_dwordx4 a[44:47], v4, s[6:7] offset:1024
  v_add_u32 v4, 126976, v2
  global_load_dwordx4 a[48:51], v4, s[6:7]
  global_load_dwordx4 a[52:55], v4, s[6:7] offset:1024
  v_add_u32 v4, 157696, v2
  global_load_dwordx4 a[56:59], v4, s[6:7]
  global_load_dwordx4 a[60:63], v4, s[6:7] offset:1024
  v_add_u32 v4, 159744, v2
  global_load_dwordx4 a[64:67], v4, s[6:7]
  global_load_dwordx4 a[68:71], v4, s[6:7] offset:1024
  v_add_u32 v4, 161792, v2
  global_load_dwordx4 a[72:75], v4, s[6:7]
  global_load_dwordx4 a[76:79], v4, s[6:7] offset:1024
  v_add_u32 v4, 163840, v2
  global_load_dwordx4 a[80:83], v4, s[6:7]
  global_load_dwordx4 a[84:87], v4, s[6:7] offset:1024
  v_add_u32 v4, 165888, v2
  global_load_dwordx4 a[88:91], v4, s[6:7]
  global_load_dwordx4 a[92:95], v4, s[6:7] offset:1024
  v_add_u32 v4, 167936, v2
  global_load_dwordx4 a[96:99], v4, s[6:7]
  global_load_dwordx4 a[100:103], v4, s[6:7] offset:1024
  v_add_u32 v4, 169984, v2
  global_load_dwordx4 a[104:107], v4, s[6:7]
  global_load_dwordx4 a[108:111], v4, s[6:7] offset:1024
  v_add_u32 v4, 200704, v2
  global_load_dwordx4 a[112:115], v4, s[6:7]
  global_load_dwordx4 a[116:119], v4, s[6:7] offset:1024
  v_add_u32 v4, 202752, v2
  global_load_dwordx4 a[120:123], v4, s[6:7]
  global_load_dwordx4 a[124:127], v4, s[6:7] offset:1024
  s_waitcnt vmcnt(32)
  v_add_u32 v4, 204800, v2
  global_load_dwordx4 a[128:131], v4, s[6:7]
  global_load_dwordx4 a[132:135], v4, s[6:7] offset:1024
  v_add_u32 v4, 206848, v2
  global_load_dwordx4 a[136:139], v4, s[6:7]
  global_load_dwordx4 a[140:143], v4, s[6:7] offset:1024
  v_add_u32 v4, 208896, v2
  global_load_dwordx4 a[144:147], v4, s[6:7]
  global_load_dwordx4 a[148:151], v4, s[6:7] offset:1024
  v_add_u32 v4, 210944, v2
  global_load_dwordx4 a[152:155], v4, s[6:7]
  global_load_dwordx4 a[156:159], v4, s[6:7] offset:1024
  v_add_u32 v4, 212992, v2
  global_load_dwordx4 a[160:163], v4, s[6:7]
  global_load_dwordx4 a[164:167], v4, s[6:7] offset:1024
  v_add_u32 v4, 243712, v2
  global_load_dwordx4 a[168:171], v4, s[6:7]
  global_load_dwordx4 a[172:175], v4, s[6:7] offset:1024
  v_add_u32 v4, 245760, v2
  global_load_dwordx4 a[176:179], v4, s[6:7]
  global_load_dwordx4 a[180:183], v4, s[6:7] offset:1024
  v_add_u32 v4, 247808, v2
  global_load_dwordx4 a[184:187], v4, s[6:7]
  global_load_dwordx4 a[188:191], v4, s[6:7] offset:1024
  v_add_u32 v4, 249856, v2
  global_load_dwordx4 a[192:195], v4, s[6:7]
  global_load_dwordx4 a[196:199], v4, s[6:7] offset:1024
  v_add_u32 v4, 251904, v2
  global_load_dwordx4 a[200:203], v4, s[6:7]
  global_load_dwordx4 a[204:207], v4, s[6:7] offset:1024
  v_add_u32 v4, 253952, v2
  global_load_dwordx4 a[208:211], v4, s[6:7]
  global_load_dwordx4 a[212:215], v4, s[6:7] offset:1024
  v_add_u32 v4, 256000, v2
  global_load_dwordx4 a[216:219], v4, s[6:7]
  global_load_dwordx4 a[220:223], v4, s[6:7] offset:1024
  v_add_u32 v4, 286720, v2
  global_load_dwordx4 a[224:227], v4, s[6:7]
  global_load_dwordx4 a[228:231], v4, s[6:7] offset:1024
  v_add_u32 v4, 288768, v2
  global_load_dwordx4 a[232:235], v4, s[6:7]
  global_load_dwordx4 a[236:239], v4, s[6:7] offset:1024
  v_add_u32 v4, 290816, v2
  global_load_dwordx4 a[240:243], v4, s[6:7]
  global_load_dwordx4 a[244:247], v4, s[6:7] offset:1024
  v_add_u32 v4, 292864, v2
  global_load_dwordx4 a[248:251], v4, s[6:7]
  global_load_dwordx4 a[252:255], v4, s[6:7] offset:1024
  s_waitcnt vmcnt(32)
  v_add_u32 v4, 294912, v2
  global_load_dwordx4 v[120:123], v4, s[6:7]
  global_load_dwordx4 v[124:127], v4, s[6:7] offset:1024
  v_add_u32 v4, 296960, v2
  global_load_dwordx4 v[128:131], v4, s[6:7]
  global_load_dwordx4 v[132:135], v4, s[6:7] offset:1024
  v_add_u32 v4, 299008, v2
  global_load_dwordx4 v[136:139], v4, s[6:7]
  global_load_dwordx4 v[140:143], v4, s[6:7] offset:1024
  v_add_u32 v4, 329728, v2
  global_load_dwordx4 v[144:147], v4, s[6:7]
  global_load_dwordx4 v[148:151], v4, s[6:7] offset:1024
  v_add_u32 v4, 331776, v2
  global_load_dwordx4 v[152:155], v4, s[6:7]
  global_load_dwordx4 v[156:159], v4, s[6:7] offset:1024
  v_add_u32 v4, 333824, v2
  global_load_dwordx4 v[160:163], v4, s[6:7]
  global_load_dwordx4 v[164:167], v4, s[6:7] offset:1024
  v_add_u32 v4, 335872, v2
  global_load_dwordx4 v[168:171], v4, s[6:7]
  global_load_dwordx4 v[172:175], v4, s[6:7] offset:1024
  v_add_u32 v4, 337920, v2
  global_load_dwordx4 v[176:179], v4, s[6:7]
  global_load_dwordx4 v[180:183], v4, s[6:7] offset:1024
  v_add_u32 v4, 339968, v2
  global_load_dwordx4 v[184:187], v4, s[6:7]
  global_load_dwordx4 v[188:191], v4, s[6:7] offset:1024
  v_add_u32 v4, 342016, v2
  global_load_dwordx4 v[192:195], v4, s[6:7]
  global_load_dwordx4 v[196:199], v4, s[6:7] offset:1024
  v_add_u32 v4, 372736, v2
  global_load_dwordx4 v[200:203], v4, s[6:7]
  global_load_dwordx4 v[204:207], v4, s[6:7] offset:1024
  v_add_u32 v4, 374784, v2
  global_load_dwordx4 v[208:211], v4, s[6:7]
  global_load_dwordx4 v[212:215], v4, s[6:7] offset:1024
  v_add_u32 v4, 376832, v2
  global_load_dwordx4 v[216:219], v4, s[6:7]
  global_load_dwordx4 v[220:223], v4, s[6:7] offset:1024
  v_add_u32 v4, 378880, v2
  global_load_dwordx4 v[224:227], v4, s[6:7]
  global_load_dwordx4 v[228:231], v4, s[6:7] offset:1024
  v_add_u32 v4, 380928, v2
  global_load_dwordx4 v[232:235], v4, s[6:7]
  global_load_dwordx4 v[236:239], v4, s[6:7] offset:1024
  v_add_u32 v4, 382976, v2
  global_load_dwordx4 v[240:243], v4, s[6:7]
  global_load_dwordx4 v[244:247], v4, s[6:7] offset:1024
  s_waitcnt vmcnt(32)
  v_add_u32 v4, 385024, v2
  global_load_dwordx4 v[248:251], v4, s[6:7]
  global_load_dwordx4 v[252:255], v4, s[6:7] offset:1024
  s_waitcnt vmcnt(0)
  v_and_b32 v8, 15, v1
  v_lshrrev_b32 v9, 4, v1
  v_lshrrev_b32 v10, 2, v8
  v_xor_b32 v9, v9, v10
  v_lshlrev_b32 v9, 3, v9
  v_lshl_add_u32 v9, v8, 5, v9
  v_lshrrev_b32 v10, 3, v8
  v_lshl_add_u32 v4, v10, 7, v9
  v_add_u32 v4, 43008, v4
  v_lshlrev_b32 v5, 2, v1
  v_add_u32 v5, 64768, v5
  v_mov_b32 v0, 0
  ds_write_b32 v5, v0 offset:0
  ds_write_b32 v5, v0 offset:1024
  ds_write_b32 v5, v0 offset:2048
  ds_write_b32 v5, v0 offset:3072
  ds_write_b32 v5, v0 offset:4096
  v_min_u32 v1, 55, v1
  v_lshlrev_b32 v1, 2, v1
  s_and_b32 s26, s22, 7
  s_lshl_b32 s26, s26, 8
  s_add_u32 s26, s26, 5120
  v_add_u32 v1, s26, v1
  ds_read_b128 v[60:63], v2 offset:14336
  ds_read_b128 v[64:67], v2 offset:15360
  ds_read_b128 v[68:71], v2 offset:16384
  ds_read_b128 v[72:75], v2 offset:17408
  ds_read_b128 v[76:79], v2 offset:18432
  ds_read_b128 v[80:83], v2 offset:19456
  ds_read_b128 v[84:87], v2 offset:20480
  ds_read_b128 v[88:91], v2 offset:21504
  ds_read_b128 v[92:95], v2 offset:22528
  ds_read_b128 v[96:99], v2 offset:23552
  ds_read_b128 v[100:103], v2 offset:24576
  ds_read_b128 v[104:107], v2 offset:25600
  ds_read_b128 v[108:111], v2 offset:26624
  ds_read_b128 v[112:115], v2 offset:27648
  v_mov_b64 v[40:41], 0
  v_mov_b64 v[42:43], 0
  v_mov_b64 v[44:45], 0
  v_mov_b64 v[46:47], 0
  v_mov_b64 v[48:49], 0
  v_mov_b64 v[50:51], 0
  v_mov_b64 v[52:53], 0
  v_mov_b64 v[54:55], 0
  v_mov_b64 v[56:57], 0
  v_mov_b64 v[58:59], 0
  v_mov_b64 v[116:117], 0
  v_mov_b64 v[118:119], 0
  s_waitcnt lgkmcnt(0)
  s_barrier
b_sp1_step:
  v_add_u32 v0, 1, v0
  s_mov_b64 exec, s[30:31]
  global_load_dword v6, v1, s[12:13] sc1
  s_nop 15
  s_nop 4
  global_load_dword v7, v1, s[12:13] sc1
  s_nop 15
  s_nop 4
b_sp1_bell:
  global_load_dword v8, v1, s[12:13] sc1
  s_waitcnt vmcnt(2)
  v_cmp_eq_u32 vcc, -1, v6
  s_cbranch_vccz b_sp1_bell_ok
  global_load_dword v6, v1, s[12:13] sc1
  s_waitcnt vmcnt(2)
  v_cmp_eq_u32 vcc, -1, v7
  s_cbranch_vccz b_sp1_bell_ok
  global_load_dword v7, v1, s[12:13] sc1
  s_waitcnt vmcnt(2)
  v_cmp_eq_u32 vcc, -1, v8
  s_sub_u32 s25, s25, 1
  s_cbranch_scc1 b_fail
  s_cbranch_vccz b_sp1_bell_ok
  s_branch b_sp1_bell
b_sp1_bell_ok:
  s_mov_b64 exec, -1
b_sp1_gather:
  global_load_dwordx4 v[12:15], v2, s[12:13] offset:-3072 sc1
  s_nop 11
  global_load_dwordx4 v[16:19], v2, s[12:13] offset:-2048 sc1
  s_nop 11
  global_load_dwordx4 v[20:23], v2, s[12:13] offset:-1024 sc1
  s_nop 11
  global_load_dwordx4 v[24:27], v2, s[12:13] offset:0 sc1
  s_sub_u32 s25, s25, 1
  s_cbranch_scc1 b_fail
  s_waitcnt vmcnt(3)
  v_smfmac_f32_16x16x64_bf16 v[40:43], v[12:15], v[60:67], v3
  global_load_dwordx4 v[28:31], v2, s[12:13] offset:1024 sc1
  v_smfmac_f32_16x16x64_bf16 v[44:47], v[12:15], a[0:7], v3
  v_max3_u32 v6, v12, v13, v14
  v_smfmac_f32_16x16x64_bf16 v[48:51], v[12:15], a[56:63], v3
  v_smfmac_f32_16x16x64_bf16 v[52:55], v[12:15], a[112:119], v3
  s_waitcnt vmcnt(3)
  v_smfmac_f32_16x16x64_bf16 v[40:43], v[16:19], v[68:75], v3
  global_load_dwordx4 v[32:35], v2, s[12:13] offset:2048 sc1
  v_smfmac_f32_16x16x64_bf16 v[44:47], v[16:19], a[8:15], v3
  v_max3_u32 v6, v6, v15, v16
  v_smfmac_f32_16x16x64_bf16 v[48:51], v[16:19], a[64:71], v3
  v_max3_u32 v6, v6, v17, v18
  v_smfmac_f32_16x16x64_bf16 v[52:55], v[16:19], a[120:127], v3
  s_waitcnt vmcnt(3)
  v_smfmac_f32_16x16x64_bf16 v[40:43], v[20:23], v[76:83], v3
  global_load_dwordx4 v[36:39], v2, s[12:13] offset:3072 sc1
  v_smfmac_f32_16x16x64_bf16 v[44:47], v[20:23], a[16:23], v3
  v_max3_u32 v6, v6, v19, v20
  v_smfmac_f32_16x16x64_bf16 v[48:51], v[20:23], a[72:79], v3
  v_max3_u32 v6, v6, v21, v22
  v_smfmac_f32_16x16x64_bf16 v[52:55], v[20:23], a[128:135], v3
  s_waitcnt vmcnt(3)
  v_smfmac_f32_16x16x64_bf16 v[40:43], v[24:27], v[84:91], v3
  v_max3_u32 v6, v6, v23, v24
  v_smfmac_f32_16x16x64_bf16 v[44:47], v[24:27], a[24:31], v3
  v_max3_u32 v6, v6, v25, v26
  v_smfmac_f32_16x16x64_bf16 v[48:51], v[24:27], a[80:87], v3
  v_smfmac_f32_16x16x64_bf16 v[52:55], v[24:27], a[136:143], v3
  s_waitcnt vmcnt(2)
  v_smfmac_f32_16x16x64_bf16 v[40:43], v[28:31], v[92:99], v3
  v_max3_u32 v6, v6, v27, v28
  v_smfmac_f32_16x16x64_bf16 v[44:47], v[28:31], a[32:39], v3
  v_max3_u32 v6, v6, v29, v30
  v_smfmac_f32_16x16x64_bf16 v[48:51], v[28:31], a[88:95], v3
  v_smfmac_f32_16x16x64_bf16 v[52:55], v[28:31], a[144:151], v3
  s_waitcnt vmcnt(1)
  v_smfmac_f32_16x16x64_bf16 v[40:43], v[32:35], v[100:107], v3
  v_max3_u32 v6, v6, v31, v32
  v_smfmac_f32_16x16x64_bf16 v[44:47], v[32:35], a[40:47], v3
  v_max3_u32 v6, v6, v33, v34
  v_smfmac_f32_16x16x64_bf16 v[48:51], v[32:35], a[96:103], v3
  v_smfmac_f32_16x16x64_bf16 v[52:55], v[32:35], a[152:159], v3
  s_waitcnt vmcnt(0)
  v_smfmac_f32_16x16x64_bf16 v[40:43], v[36:39], v[108:115], v3
  v_max3_u32 v6, v6, v35, v36
  v_smfmac_f32_16x16x64_bf16 v[44:47], v[36:39], a[48:55], v3
  v_max3_u32 v6, v6, v37, v38
  v_smfmac_f32_16x16x64_bf16 v[48:51], v[36:39], a[104:111], v3
  v_max_u32 v6, v6, v39
  v_smfmac_f32_16x16x64_bf16 v[52:55], v[36:39], a[160:167], v3
  v_cmp_eq_u32 vcc, -1, v6
  s_nop 2
  v_cvt_pk_bf16_f32 v6, v40, v41
  v_cvt_pk_bf16_f32 v7, v42, v43
  ds_write_b64 v4, v[6:7] offset:3840
  v_cvt_pk_bf16_f32 v8, v44, v45
  v_cvt_pk_bf16_f32 v9, v46, v47
  ds_write_b64 v4, v[8:9] offset:6144
  s_cbranch_vccnz b_sp1_redo
  ds_write_b32 v5, v0 offset:0
  v_smfmac_f32_16x16x64_bf16 v[56:59], v[12:15], a[168:175], v3
  v_cvt_pk_bf16_f32 v6, v48, v49
  v_cvt_pk_bf16_f32 v7, v50, v51
  v_smfmac_f32_16x16x64_bf16 v[56:59], v[16:19], a[176:183], v3
  ds_write_b64 v4, v[6:7] offset:8448
  v_smfmac_f32_16x16x64_bf16 v[56:59], v[20:23], a[184:191], v3
  ds_write_b32 v5, v0 offset:1024
  v_smfmac_f32_16x16x64_bf16 v[56:59], v[24:27], a[192:199], v3
  v_cvt_pk_bf16_f32 v8, v52, v53
  v_smfmac_f32_16x16x64_bf16 v[56:59], v[28:31], a[200:207], v3
  v_cvt_pk_bf16_f32 v9, v54, v55
  v_smfmac_f32_16x16x64_bf16 v[56:59], v[32:35], a[208:215], v3
  ds_write_b64 v4, v[8:9] offset:10752
  v_smfmac_f32_16x16x64_bf16 v[56:59], v[36:39], a[216:223], v3
  ds_write_b32 v5, v0 offset:2048
  v_smfmac_f32_16x16x64_bf16 v[116:119], v[12:15], a[224:231], v3
  v_mov_b64 v[40:41], 0
  v_smfmac_f32_16x16x64_bf16 v[116:119], v[16:19], a[232:239], v3
  v_mov_b64 v[42:43], 0
  v_smfmac_f32_16x16x64_bf16 v[116:119], v[20:23], a[240:247], v3
  v_cvt_pk_bf16_f32 v6, v56, v57
  v_smfmac_f32_16x16x64_bf16 v[116:119], v[24:27], a[248:255], v3
  v_cvt_pk_bf16_f32 v7, v58, v59
  v_smfmac_f32_16x16x64_bf16 v[116:119], v[28:31], v[120:127], v3
  ds_write_b64 v4, v[6:7] offset:13056
  v_smfmac_f32_16x16x64_bf16 v[116:119], v[32:35], v[128:135], v3
  v_smfmac_f32_16x16x64_bf16 v[116:119], v[36:39], v[136:143], v3
  v_smfmac_f32_16x16x64_bf16 v[40:43], v[12:15], v[144:151], v3
  v_mov_b64 v[44:45], 0
  v_smfmac_f32_16x16x64_bf16 v[40:43], v[16:19], v[152:159], v3
  v_mov_b64 v[46:47], 0
  v_smfmac_f32_16x16x64_bf16 v[40:43], v[20:23], v[160:167], v3
  v_cvt_pk_bf16_f32 v8, v116, v117
  v_smfmac_f32_16x16x64_bf16 v[40:43], v[24:27], v[168:175], v3
  v_cvt_pk_bf16_f32 v9, v118, v119
  v_smfmac_f32_16x16x64_bf16 v[40:43], v[28:31], v[176:183], v3
  ds_write_b64 v4, v[8:9] offset:15360
  v_smfmac_f32_16x16x64_bf16 v[40:43], v[32:35], v[184:191], v3
  ds_write_b32 v5, v0 offset:3072
  v_smfmac_f32_16x16x64_bf16 v[40:43], v[36:39], v[192:199], v3
  v_smfmac_f32_16x16x64_bf16 v[44:47], v[12:15], v[200:207], v3
  v_smfmac_f32_16x16x64_bf16 v[44:47], v[16:19], v[208:215], v3
  v_smfmac_f32_16x16x64_bf16 v[44:47], v[20:23], v[216:223], v3
  v_cvt_pk_bf16_f32 v6, v40, v41
  v_smfmac_f32_16x16x64_bf16 v[44:47], v[24:27], v[224:231], v3
  v_cvt_pk_bf16_f32 v7, v42, v43
  v_smfmac_f32_16x16x64_bf16 v[44:47], v[28:31], v[232:239], v3
  ds_write_b64 v4, v[6:7] offset:17664
  v_smfmac_f32_16x16x64_bf16 v[44:47], v[32:35], v[240:247], v3
  ds_write_b32 v5, v0 offset:4096
  v_smfmac_f32_16x16x64_bf16 v[44:47], v[36:39], v[248:255], v3
  s_nop 7
  v_cvt_pk_bf16_f32 v6, v44, v45
  v_cvt_pk_bf16_f32 v7, v46, v47
  ds_write_b64 v4, v[6:7] offset:19968
  s_waitcnt lgkmcnt(0)
  s_barrier
  ds_read_b128 v[60:63], v2 offset:14336
  ds_read_b128 v[64:67], v2 offset:15360
  ds_read_b128 v[68:71], v2 offset:16384
  ds_read_b128 v[72:75], v2 offset:17408
  ds_read_b128 v[76:79], v2 offset:18432
  ds_read_b128 v[80:83], v2 offset:19456
  ds_read_b128 v[84:87], v2 offset:20480
  ds_read_b128 v[88:91], v2 offset:21504
  ds_read_b128 v[92:95], v2 offset:22528
  ds_read_b128 v[96:99], v2 offset:23552
  ds_read_b128 v[100:103], v2 offset:24576
  ds_read_b128 v[104:107], v2 offset:25600
  ds_read_b128 v[108:111], v2 offset:26624
  ds_read_b128 v[112:115], v2 offset:27648
  v_mov_b64 v[40:41], 0
  v_mov_b64 v[42:43], 0
  v_mov_b64 v[44:45], 0
  v_mov_b64 v[46:47], 0
  v_mov_b64 v[48:49], 0
  v_mov_b64 v[50:51], 0
  v_mov_b64 v[52:53], 0
  v_mov_b64 v[54:55], 0
  v_mov_b64 v[56:57], 0
  v_mov_b64 v[58:59], 0
  v_mov_b64 v[116:117], 0
  v_mov_b64 v[118:119], 0
  s_add_u32 s12, s12, 16384
  s_addc_u32 s13, s13, 0
  s_add_u32 s24, s24, 1
  s_cmp_lt_u32 s24, 63
  s_waitcnt lgkmcnt(0)
  s_cbranch_scc1 b_sp1_step
  s_endpgm
b_sp1_redo:
  s_nop 7
  v_mov_b64 v[40:41], 0
  v_mov_b64 v[42:43], 0
  v_mov_b64 v[44:45], 0
  v_mov_b64 v[46:47], 0
  v_mov_b64 v[48:49], 0
  v_mov_b64 v[50:51], 0
  v_mov_b64 v[52:53], 0
  v_mov_b64 v[54:55], 0
  v_mov_b64 v[56:57], 0
  v_mov_b64 v[58:59], 0
  s_branch b_sp1_gather
b_sp2:
  v_add_u32 v4, 86016, v2
  global_load_dwordx4 v[60:63], v4, s[6:7]
  v_add_u32 v4, 87040, v2
  global_load_dwordx4 v[64:67], v4, s[6:7]
  v_add_u32 v4, 88064, v2
  global_load_dwordx4 v[68:71], v4, s[6:7]
  v_add_u32 v4, 89088, v2
  global_load_dwordx4 v[72:75], v4, s[6:7]
  v_add_u32 v4, 90112, v2
  global_load_dwordx4 v[76:79], v4, s[6:7]
  v_add_u32 v4, 91136, v2
  global_load_dwordx4 v[80:83], v4, s[6:7]
  v_add_u32 v4, 92160, v2
  global_load_dwordx4 v[84:87], v4, s[6:7]
  v_add_u32 v4, 93184, v2
  global_load_dwordx4 v[88:91], v4, s[6:7]
  v_add_u32 v4, 94208, v2
  global_load_dwordx4 v[92:95], v4, s[6:7]
  v_add_u32 v4, 95232, v2
  global_load_dwordx4 v[96:99], v4, s[6:7]
  v_add_u32 v4, 96256, v2
  global_load_dwordx4 v[100:103], v4, s[6:7]
  v_add_u32 v4, 97280, v2
  global_load_dwordx4 v[104:107], v4, s[6:7]
  v_add_u32 v4, 98304, v2
  global_load_dwordx4 v[108:111], v4, s[6:7]
  v_add_u32 v4, 99328, v2
  global_load_dwordx4 v[112:115], v4, s[6:7]
  v_add_u32 v5, 28672, v2
  s_waitcnt vmcnt(0)
  ds_write_b128 v5, v[60:63] offset:0
  ds_write_b128 v5, v[64:67] offset:1024
  ds_write_b128 v5, v[68:71] offset:2048
  ds_write_b128 v5, v[72:75] offset:3072
  ds_write_b128 v5, v[76:79] offset:4096
  ds_write_b128 v5, v[80:83] offset:5120
  ds_write_b128 v5, v[84:87] offset:6144
  ds_write_b128 v5, v[88:91] offset:7168
  ds_write_b128 v5, v[92:95] offset:8192
  ds_write_b128 v5, v[96:99] offset:9216
  ds_write_b128 v5, v[100:103] offset:10240
  ds_write_b128 v5, v[104:107] offset:11264
  ds_write_b128 v5, v[108:111] offset:12288
  ds_write_b128 v5, v[112:115] offset:13312
  s_waitcnt lgkmcnt(0)
  v_add_u32 v4, 129024, v2
  global_load_dwordx4 a[0:3], v4, s[6:7]
  global_load_dwordx4 a[4:7], v4, s[6:7] offset:1024
  v_add_u32 v4, 131072, v2
  global_load_dwordx4 a[8:11], v4, s[6:7]
  global_load_dwordx4 a[12:15], v4, s[6:7] offset:1024
  v_add_u32 v4, 133120, v2
  global_load_dwordx4 a[16:19], v4, s[6:7]
  global_load_dwordx4 a[20:23], v4, s[6:7] offset:1024
  v_add_u32 v4, 135168, v2
  global_load_dwordx4 a[24:27], v4, s[6:7]
  global_load_dwordx4 a[28:31], v4, s[6:7] offset:1024
  v_add_u32 v4, 137216, v2
  global_load_dwordx4 a[32:35], v4, s[6:7]
  global_load_dwordx4 a[36:39], v4, s[6:7] offset:1024
  v_add_u32 v4, 139264, v2
  global_load_dwordx4 a[40:43], v4, s[6:7]
  global_load_dwordx4 a[44:47], v4, s[6:7] offset:1024
  v_add_u32 v4, 141312, v2
  global_load_dwordx4 a[48:51], v4, s[6:7]
  global_load_dwordx4 a[52:55], v4, s[6:7] offset:1024
  v_add_u32 v4, 172032, v2
  global_load_dwordx4 a[56:59], v4, s[6:7]
  global_load_dwordx4 a[60:63], v4, s[6:7] offset:1024
  v_add_u32 v4, 174080, v2
  global_load_dwordx4 a[64:67], v4, s[6:7]
  global_load_dwordx4 a[68:71], v4, s[6:7] offset:1024
  v_add_u32 v4, 176128, v2
  global_load_dwordx4 a[72:75], v4, s[6:7]
  global_load_dwordx4 a[76:79], v4, s[6:7] offset:1024
  v_add_u32 v4, 178176, v2
  global_load_dwordx4 a[80:83], v4, s[6:7]
  global_load_dwordx4 a[84:87], v4, s[6:7] offset:1024
  v_add_u32 v4, 180224, v2
  global_load_dwordx4 a[88:91], v4, s[6:7]
  global_load_dwordx4 a[92:95], v4, s[6:7] offset:1024
  v_add_u32 v4, 182272, v2
  global_load_dwordx4 a[96:99], v4, s[6:7]
  global_load_dwordx4 a[100:103], v4, s[6:7] offset:1024
  v_add_u32 v4, 184320, v2
  global_load_dwordx4 a[104:107], v4, s[6:7]
  global_load_dwordx4 a[108:111], v4, s[6:7] offset:1024
  v_add_u32 v4, 215040, v2
  global_load_dwordx4 a[112:115], v4, s[6:7]
  global_load_dwordx4 a[116:119], v4, s[6:7] offset:1024
  v_add_u32 v4, 217088, v2
  global_load_dwordx4 a[120:123], v4, s[6:7]
  global_load_dwordx4 a[124:127], v4, s[6:7] offset:1024
  s_waitcnt vmcnt(32)
  v_add_u32 v4, 219136, v2
  global_load_dwordx4 a[128:131], v4, s[6:7]
  global_load_dwordx4 a[132:135], v4, s[6:7] offset:1024
  v_add_u32 v4, 221184, v2
  global_load_dwordx4 a[136:139], v4, s[6:7]
  global_load_dwordx4 a[140:143], v4, s[6:7] offset:1024
  v_add_u32 v4, 223232, v2
  global_load_dwordx4 a[144:147], v4, s[6:7]
  global_load_dwordx4 a[148:151], v4, s[6:7] offset:1024
  v_add_u32 v4, 225280, v2
  global_load_dwordx4 a[152:155], v4, s[6:7]
  global_load_dwordx4 a[156:159], v4, s[6:7] offset:1024
  v_add_u32 v4, 227328, v2
  global_load_dwordx4 a[160:163], v4, s[6:7]
  global_load_dwordx4 a[164:167], v4, s[6:7] offset:1024
  v_add_u32 v4, 258048, v2
  global_load_dwordx4 a[168:171], v4, s[6:7]
  global_load_dwordx4 a[172:175], v4, s[6:7] offset:1024
  v_add_u32 v4, 260096, v2
  global_load_dwordx4 a[176:179], v4, s[6:7]
  global_load_dwordx4 a[180:183], v4, s[6:7] offset:1024
  v_add_u32 v4, 262144, v2
  global_load_dwordx4 a[184:187], v4, s[6:7]
  global_load_dwordx4 a[188:191], v4, s[6:7] offset:1024
  v_add_u32 v4, 264192, v2
  global_load_dwordx4 a[192:195], v4, s[6:7]
  global_load_dwordx4 a[196:199], v4, s[6:7] offset:1024
  v_add_u32 v4, 266240, v2
  global_load_dwordx4 a[200:203], v4, s[6:7]
  global_load_dwordx4 a[204:207], v4, s[6:7] offset:1024
  v_add_u32 v4, 268288, v2
  global_load_dwordx4 a[208:211], v4, s[6:7]
  global_load_dwordx4 a[212:215], v4, s[6:7] offset:1024
  v_add_u32 v4, 270336, v2
  global_load_dwordx4 a[216:219], v4, s[6:7]
  global_load_dwordx4 a[220:223], v4, s[6:7] offset:1024
  v_add_u32 v4, 301056, v2
  global_load_dwordx4 a[224:227], v4, s[6:7]
  global_load_dwordx4 a[228:231], v4, s[6:7] offset:1024
  v_add_u32 v4, 303104, v2
  global_load_dwordx4 a[232:235], v4, s[6:7]
  global_load_dwordx4 a[236:239], v4, s[6:7] offset:1024
  v_add_u32 v4, 305152, v2
  global_load_dwordx4 a[240:243], v4, s[6:7]
  global_load_dwordx4 a[244:247], v4, s[6:7] offset:1024
  v_add_u32 v4, 307200, v2
  global_load_dwordx4 a[248:251], v4, s[6:7]
  global_load_dwordx4 a[252:255], v4, s[6:7] offset:1024
  s_waitcnt vmcnt(32)
  v_add_u32 v4, 309248, v2
  global_load_dwordx4 v[120:123], v4, s[6:7]
  global_load_dwordx4 v[124:127], v4, s[6:7] offset:1024
  v_add_u32 v4, 311296, v2
  global_load_dwordx4 v[128:131], v4, s[6:7]
  global_load_dwordx4 v[132:135], v4, s[6:7] offset:1024
  v_add_u32 v4, 313344, v2
  global_load_dwordx4 v[136:139], v4, s[6:7]
  global_load_dwordx4 v[140:143], v4, s[6:7] offset:1024
  v_add_u32 v4, 344064, v2
  global_load_dwordx4 v[144:147], v4, s[6:7]
  global_load_dwordx4 v[148:151], v4, s[6:7] offset:1024
  v_add_u32 v4, 346112, v2
  global_load_dwordx4 v[152:155], v4, s[6:7]
  global_load_dwordx4 v[156:159], v4, s[6:7] offset:1024
  v_add_u32 v4, 348160, v2
  global_load_dwordx4 v[160:163], v4, s[6:7]
  global_load_dwordx4 v[164:167], v4, s[6:7] offset:1024
  v_add_u32 v4, 350208, v2
  global_load_dwordx4 v[168:171], v4, s[6:7]
  global_load_dwordx4 v[172:175], v4, s[6:7] offset:1024
  v_add_u32 v4, 352256, v2
  global_load_dwordx4 v[176:179], v4, s[6:7]
  global_load_dwordx4 v[180:183], v4, s[6:7] offset:1024
  v_add_u32 v4, 354304, v2
  global_load_dwordx4 v[184:187], v4, s[6:7]
  global_load_dwordx4 v[188:191], v4, s[6:7] offset:1024
  v_add_u32 v4, 356352, v2
  global_load_dwordx4 v[192:195], v4, s[6:7]
  global_load_dwordx4 v[196:199], v4, s[6:7] offset:1024
  v_add_u32 v4, 387072, v2
  global_load_dwordx4 v[200:203], v4, s[6:7]
  global_load_dwordx4 v[204:207], v4, s[6:7] offset:1024
  v_add_u32 v4, 389120, v2
  global_load_dwordx4 v[208:211], v4, s[6:7]
  global_load_dwordx4 v[212:215], v4, s[6:7] offset:1024
  v_add_u32 v4, 391168, v2
  global_load_dwordx4 v[216:219], v4, s[6:7]
  global_load_dwordx4 v[220:223], v4, s[6:7] offset:1024
  v_add_u32 v4, 393216, v2
  global_load_dwordx4 v[224:227], v4, s[6:7]
  global_load_dwordx4 v[228:231], v4, s[6:7] offset:1024
  v_add_u32 v4, 395264, v2
  global_load_dwordx4 v[232:235], v4, s[6:7]
  global_load_dwordx4 v[236:239], v4, s[6:7] offset:1024
  v_add_u32 v4, 397312, v2
  global_load_dwordx4 v[240:243], v4, s[6:7]
  global_load_dwordx4 v[244:247], v4, s[6:7] offset:1024
  s_waitcnt vmcnt(32)
  v_add_u32 v4, 399360, v2
  global_load_dwordx4 v[248:251], v4, s[6:7]
  global_load_dwordx4 v[252:255], v4, s[6:7] offset:1024
  s_waitcnt vmcnt(0)
  v_and_b32 v8, 15, v1
  v_lshrrev_b32 v9, 4, v1
  v_lshrrev_b32 v10, 2, v8
  v_xor_b32 v9, v9, v10
  v_lshlrev_b32 v9, 3, v9
  v_lshl_add_u32 v9, v8, 5, v9
  v_lshrrev_b32 v10, 3, v8
  v_lshl_add_u32 v4, v10, 7, v9
  v_add_u32 v4, 43008, v4
  v_lshlrev_b32 v5, 2, v1
  v_add_u32 v5, 65024, v5
  v_mov_b32 v0, 0
  ds_write_b32 v5, v0 offset:0
  ds_write_b32 v5, v0 offset:1024
  ds_write_b32 v5, v0 offset:2048
  ds_write_b32 v5, v0 offset:3072
  ds_write_b32 v5, v0 offset:4096
  v_min_u32 v1, 55, v1
  v_lshlrev_b32 v1, 2, v1
  s_and_b32 s26, s22, 7
  s_lshl_b32 s26, s26, 8
  s_add_u32 s26, s26, 5120
  v_add_u32 v1, s26, v1
  ds_read_b128 v[60:63], v2 offset:28672
  ds_read_b128 v[64:67], v2 offset:29696
  ds_read_b128 v[68:71], v2 offset:30720
  ds_read_b128 v[72:75], v2 offset:31744
  ds_read_b128 v[76:79], v2 offset:32768
  ds_read_b128 v[80:83], v2 offset:33792
  ds_read_b128 v[84:87], v2 offset:34816
  ds_read_b128 v[88:91], v2 offset:35840
  ds_read_b128 v[92:95], v2 offset:36864
  ds_read_b128 v[96:99], v2 offset:37888
  ds_read_b128 v[100:103], v2 offset:38912
  ds_read_b128 v[104:107], v2 offset:39936
  ds_read_b128 v[108:111], v2 offset:40960
  ds_read_b128 v[112:115], v2 offset:41984
  v_mov_b64 v[40:41], 0
  v_mov_b64 v[42:43], 0
  v_mov_b64 v[44:45], 0
  v_mov_b64 v[46:47], 0
  v_mov_b64 v[48:49], 0
  v_mov_b64 v[50:51], 0
  v_mov_b64 v[52:53], 0
  v_mov_b64 v[54:55], 0
  v_mov_b64 v[56:57], 0
  v_mov_b64 v[58:59], 0
  v_mov_b64 v[116:117], 0
  v_mov_b64 v[118:119], 0
  s_waitcnt lgkmcnt(0)
  s_barrier
b_sp2_step:
  v_add_u32 v0, 1, v0
  s_mov_b64 exec, s[30:31]
  global_load_dword v6, v1, s[12:13] sc1
  s_nop 15
  s_nop 4
  global_load_dword v7, v1, s[12:13] sc1
  s_nop 15
  s_nop 4
b_sp2_bell:
  global_load_dword v8, v1, s[12:13] sc1
  s_waitcnt vmcnt(2)
  v_cmp_eq_u32 vcc, -1, v6
  s_cbranch_vccz b_sp2_bell_ok
  global_load_dword v6, v1, s[12:13] sc1
  s_waitcnt vmcnt(2)
  v_cmp_eq_u32 vcc, -1, v7
  s_cbranch_vccz b_sp2_bell_ok
  global_load_dword v7, v1, s[12:13] sc1
  s_waitcnt vmcnt(2)
  v_cmp_eq_u32 vcc, -1, v8
  s_sub_u32 s25, s25, 1
  s_cbranch_scc1 b_fail
  s_cbranch_vccz b_sp2_bell_ok
  s_branch b_sp2_bell
b_sp2_bell_ok:
  s_mov_b64 exec, -1
b_sp2_gather:
  global_load_dwordx4 v[12:15], v2, s[12:13] offset:-3072 sc1
  s_nop 11
  global_load_dwordx4 v[16:19], v2, s[12:13] offset:-2048 sc1
  s_nop 11
  global_load_dwordx4 v[20:23], v2, s[12:13] offset:-1024 sc1
  s_nop 11
  global_load_dwordx4 v[24:27], v2, s[12:13] offset:0 sc1
  s_sub_u32 s25, s25, 1
  s_cbranch_scc1 b_fail
  s_waitcnt vmcnt(3)
  v_smfmac_f32_16x16x64_bf16 v[40:43], v[12:15], v[60:67], v3
  global_load_dwordx4 v[28:31], v2, s[12:13] offset:1024 sc1
  v_smfmac_f32_16x16x64_bf16 v[44:47], v[12:15], a[0:7], v3
  v_max3_u32 v6, v12, v13, v14
  v_smfmac_f32_16x16x64_bf16 v[48:51], v[12:15], a[56:63], v3
  v_smfmac_f32_16x16x64_bf16 v[52:55], v[12:15], a[112:119], v3
  s_waitcnt vmcnt(3)
  v_smfmac_f32_16x16x64_bf16 v[40:43], v[16:19], v[68:75], v3
  global_load_dwordx4 v[32:35], v2, s[12:13] offset:2048 sc1
  v_smfmac_f32_16x16x64_bf16 v[44:47], v[16:19], a[8:15], v3
  v_max3_u32 v6, v6, v15, v16
  v_smfmac_f32_16x16x64_bf16 v[48:51], v[16:19], a[64:71], v3
  v_max3_u32 v6, v6, v17, v18
  v_smfmac_f32_16x16x64_bf16 v[52:55], v[16:19], a[120:127], v3
  s_waitcnt vmcnt(3)
  v_smfmac_f32_16x16x64_bf16 v[40:43], v[20:23], v[76:83], v3
  global_load_dwordx4 v[36:39], v2, s[12:13] offset:3072 sc1
  v_smfmac_f32_16x16x64_bf16 v[44:47], v[20:23], a[16:23], v3
  v_max3_u32 v6, v6, v19, v20
  v_smfmac_f32_16x16x64_bf16 v[48:51], v[20:23], a[72:79], v3
  v_max3_u32 v6, v6, v21, v22
  v_smfmac_f32_16x16x64_bf16 v[52:55], v[20:23], a[128:135], v3
  s_waitcnt vmcnt(3)
  v_smfmac_f32_16x16x64_bf16 v[40:43], v[24:27], v[84:91], v3
  v_max3_u32 v6, v6, v23, v24
  v_smfmac_f32_16x16x64_bf16 v[44:47], v[24:27], a[24:31], v3
  v_max3_u32 v6, v6, v25, v26
  v_smfmac_f32_16x16x64_bf16 v[48:51], v[24:27], a[80:87], v3
  v_smfmac_f32_16x16x64_bf16 v[52:55], v[24:27], a[136:143], v3
  s_waitcnt vmcnt(2)
  v_smfmac_f32_16x16x64_bf16 v[40:43], v[28:31], v[92:99], v3
  v_max3_u32 v6, v6, v27, v28
  v_smfmac_f32_16x16x64_bf16 v[44:47], v[28:31], a[32:39], v3
  v_max3_u32 v6, v6, v29, v30
  v_smfmac_f32_16x16x64_bf16 v[48:51], v[28:31], a[88:95], v3
  v_smfmac_f32_16x16x64_bf16 v[52:55], v[28:31], a[144:151], v3
  s_waitcnt vmcnt(1)
  v_smfmac_f32_16x16x64_bf16 v[40:43], v[32:35], v[100:107], v3
  v_max3_u32 v6, v6, v31, v32
  v_smfmac_f32_16x16x64_bf16 v[44:47], v[32:35], a[40:47], v3
  v_max3_u32 v6, v6, v33, v34
  v_smfmac_f32_16x16x64_bf16 v[48:51], v[32:35], a[96:103], v3
  v_smfmac_f32_16x16x64_bf16 v[52:55], v[32:35], a[152:159], v3
  s_waitcnt vmcnt(0)
  v_smfmac_f32_16x16x64_bf16 v[40:43], v[36:39], v[108:115], v3
  v_max3_u32 v6, v6, v35, v36
  v_smfmac_f32_16x16x64_bf16 v[44:47], v[36:39], a[48:55], v3
  v_max3_u32 v6, v6, v37, v38
  v_smfmac_f32_16x16x64_bf16 v[48:51], v[36:39], a[104:111], v3
  v_max_u32 v6, v6, v39
  v_smfmac_f32_16x16x64_bf16 v[52:55], v[36:39], a[160:167], v3
  v_cmp_eq_u32 vcc, -1, v6
  s_nop 2
  v_cvt_pk_bf16_f32 v6, v40, v41
  v_cvt_pk_bf16_f32 v7, v42, v43
  ds_write_b64 v4, v[6:7] offset:4608
  v_cvt_pk_bf16_f32 v8, v44, v45
  v_cvt_pk_bf16_f32 v9, v46, v47
  ds_write_b64 v4, v[8:9] offset:6912
  s_cbranch_vccnz b_sp2_redo
  ds_write_b32 v5, v0 offset:0
  v_smfmac_f32_16x16x64_bf16 v[56:59], v[12:15], a[168:175], v3
  v_cvt_pk_bf16_f32 v6, v48, v49
  v_cvt_pk_bf16_f32 v7, v50, v51
  v_smfmac_f32_16x16x64_bf16 v[56:59], v[16:19], a[176:183], v3
  ds_write_b64 v4, v[6:7] offset:9216
  v_smfmac_f32_16x16x64_bf16 v[56:59], v[20:23], a[184:191], v3
  ds_write_b32 v5, v0 offset:1024
  v_smfmac_f32_16x16x64_bf16 v[56:59], v[24:27], a[192:199], v3
  v_cvt_pk_bf16_f32 v8, v52, v53
  v_smfmac_f32_16x16x64_bf16 v[56:59], v[28:31], a[200:207], v3
  v_cvt_pk_bf16_f32 v9, v54, v55
  v_smfmac_f32_16x16x64_bf16 v[56:59], v[32:35], a[208:215], v3
  ds_write_b64 v4, v[8:9] offset:11520
  v_smfmac_f32_16x16x64_bf16 v[56:59], v[36:39], a[216:223], v3
  ds_write_b32 v5, v0 offset:2048
  v_smfmac_f32_16x16x64_bf16 v[116:119], v[12:15], a[224:231], v3
  v_mov_b64 v[40:41], 0
  v_smfmac_f32_16x16x64_bf16 v[116:119], v[16:19], a[232:239], v3
  v_mov_b64 v[42:43], 0
  v_smfmac_f32_16x16x64_bf16 v[116:119], v[20:23], a[240:247], v3
  v_cvt_pk_bf16_f32 v6, v56, v57
  v_smfmac_f32_16x16x64_bf16 v[116:119], v[24:27], a[248:255], v3
  v_cvt_pk_bf16_f32 v7, v58, v59
  v_smfmac_f32_16x16x64_bf16 v[116:119], v[28:31], v[120:127], v3
  ds_write_b64 v4, v[6:7] offset:13824
  v_smfmac_f32_16x16x64_bf16 v[116:119], v[32:35], v[128:135], v3
  v_smfmac_f32_16x16x64_bf16 v[116:119], v[36:39], v[136:143], v3
  v_smfmac_f32_16x16x64_bf16 v[40:43], v[12:15], v[144:151], v3
  v_mov_b64 v[44:45], 0
  v_smfmac_f32_16x16x64_bf16 v[40:43], v[16:19], v[152:159], v3
  v_mov_b64 v[46:47], 0
  v_smfmac_f32_16x16x64_bf16 v[40:43], v[20:23], v[160:167], v3
  v_cvt_pk_bf16_f32 v8, v116, v117
  v_smfmac_f32_16x16x64_bf16 v[40:43], v[24:27], v[168:175], v3
  v_cvt_pk_bf16_f32 v9, v118, v119
  v_smfmac_f32_16x16x64_bf16 v[40:43], v[28:31], v[176:183], v3
  ds_write_b64 v4, v[8:9] offset:16128
  v_smfmac_f32_16x16x64_bf16 v[40:43], v[32:35], v[184:191], v3
  ds_write_b32 v5, v0 offset:3072
  v_smfmac_f32_16x16x64_bf16 v[40:43], v[36:39], v[192:199], v3
  v_smfmac_f32_16x16x64_bf16 v[44:47], v[12:15], v[200:207], v3
  v_smfmac_f32_16x16x64_bf16 v[44:47], v[16:19], v[208:215], v3
  v_smfmac_f32_16x16x64_bf16 v[44:47], v[20:23], v[216:223], v3
  v_cvt_pk_bf16_f32 v6, v40, v41
  v_smfmac_f32_16x16x64_bf16 v[44:47], v[24:27], v[224:231], v3
  v_cvt_pk_bf16_f32 v7, v42, v43
  v_smfmac_f32_16x16x64_bf16 v[44:47], v[28:31], v[232:239], v3
  ds_write_b64 v4, v[6:7] offset:18432
  v_smfmac_f32_16x16x64_bf16 v[44:47], v[32:35], v[240:247], v3
  ds_write_b32 v5, v0 offset:4096
  v_smfmac_f32_16x16x64_bf16 v[44:47], v[36:39], v[248:255], v3
  s_nop 7
  v_cvt_pk_bf16_f32 v6, v44, v45
  v_cvt_pk_bf16_f32 v7, v46, v47
  ds_write_b64 v4, v[6:7] offset:20736
  s_waitcnt lgkmcnt(0)
  s_barrier
  ds_read_b128 v[60:63], v2 offset:28672
  ds_read_b128 v[64:67], v2 offset:29696
  ds_read_b128 v[68:71], v2 offset:30720
  ds_read_b128 v[72:75], v2 offset:31744
  ds_read_b128 v[76:79], v2 offset:32768
  ds_read_b128 v[80:83], v2 offset:33792
  ds_read_b128 v[84:87], v2 offset:34816
  ds_read_b128 v[88:91], v2 offset:35840
  ds_read_b128 v[92:95], v2 offset:36864
  ds_read_b128 v[96:99], v2 offset:37888
  ds_read_b128 v[100:103], v2 offset:38912
  ds_read_b128 v[104:107], v2 offset:39936
  ds_read_b128 v[108:111], v2 offset:40960
  ds_read_b128 v[112:115], v2 offset:41984
  v_mov_b64 v[40:41], 0
  v_mov_b64 v[42:43], 0
  v_mov_b64 v[44:45], 0
  v_mov_b64 v[46:47], 0
  v_mov_b64 v[48:49], 0
  v_mov_b64 v[50:51], 0
  v_mov_b64 v[52:53], 0
  v_mov_b64 v[54:55], 0
  v_mov_b64 v[56:57], 0
  v_mov_b64 v[58:59], 0
  v_mov_b64 v[116:117], 0
  v_mov_b64 v[118:119], 0
  s_add_u32 s12, s12, 16384
  s_addc_u32 s13, s13, 0
  s_add_u32 s24, s24, 1
  s_cmp_lt_u32 s24, 63
  s_waitcnt lgkmcnt(0)
  s_cbranch_scc1 b_sp2_step
  s_endpgm
b_sp2_redo:
  s_nop 7
  v_mov_b64 v[40:41], 0
  v_mov_b64 v[42:43], 0
  v_mov_b64 v[44:45], 0
  v_mov_b64 v[46:47], 0
  v_mov_b64 v[48:49], 0
  v_mov_b64 v[50:51], 0
  v_mov_b64 v[52:53], 0
  v_mov_b64 v[54:55], 0
  v_mov_b64 v[56:57], 0
  v_mov_b64 v[58:59], 0
  s_branch b_sp2_gather
b_sw:
  v_add_u32 v4, 0, v2
  global_load_dwordx4 a[0:3], v4, s[6:7]
  global_load_dwordx4 a[4:7], v4, s[6:7] offset:1024
  v_add_u32 v4, 2048, v2
  global_load_dwordx4 a[8:11], v4, s[6:7]
  global_load_dwordx4 a[12:15], v4, s[6:7] offset:1024
  v_add_u32 v4, 4096, v2
  global_load_dwordx4 a[16:19], v4, s[6:7]
  global_load_dwordx4 a[20:23], v4, s[6:7] offset:1024
  v_add_u32 v4, 6144, v2
  global_load_dwordx4 a[24:27], v4, s[6:7]
  global_load_dwordx4 a[28:31], v4, s[6:7] offset:1024
  v_add_u32 v4, 8192, v2
  global_load_dwordx4 a[32:35], v4, s[6:7]
  global_load_dwordx4 a[36:39], v4, s[6:7] offset:1024
  v_add_u32 v4, 10240, v2
  global_load_dwordx4 a[40:43], v4, s[6:7]
  global_load_dwordx4 a[44:47], v4, s[6:7] offset:1024
  v_add_u32 v4, 12288, v2
  global_load_dwordx4 a[48:51], v4, s[6:7]
  global_load_dwordx4 a[52:55], v4, s[6:7] offset:1024
  v_add_u32 v4, 14336, v2
  global_load_dwordx4 a[56:59], v4, s[6:7]
  global_load_dwordx4 a[60:63], v4, s[6:7] offset:1024
  v_add_u32 v4, 16384, v2
  global_load_dwordx4 a[64:67], v4, s[6:7]
  global_load_dwordx4 a[68:71], v4, s[6:7] offset:1024
  v_add_u32 v4, 18432, v2
  global_load_dwordx4 a[72:75], v4, s[6:7]
  global_load_dwordx4 a[76:79], v4, s[6:7] offset:1024
  v_add_u32 v4, 20480, v2
  global_load_dwordx4 a[80:83], v4, s[6:7]
  global_load_dwordx4 a[84:87], v4, s[6:7] offset:1024
  v_add_u32 v4, 22528, v2
  global_load_dwordx4 a[88:91], v4, s[6:7]
  global_load_dwordx4 a[92:95], v4, s[6:7] offset:1024
  v_add_u32 v4, 24576, v2
  global_load_dwordx4 a[96:99], v4, s[6:7]
  global_load_dwordx4 a[100:103], v4, s[6:7] offset:1024
  v_add_u32 v4, 26624, v2
  global_load_dwordx4 a[104:107], v4, s[6:7]
  global_load_dwordx4 a[108:111], v4, s[6:7] offset:1024
  v_add_u32 v4, 28672, v2
  global_load_dwordx4 a[112:115], v4, s[6:7]
  global_load_dwordx4 a[116:119], v4, s[6:7] offset:1024
  v_add_u32 v4, 30720, v2
  global_load_dwordx4 a[120:123], v4, s[6:7]
  global_load_dwordx4 a[124:127], v4, s[6:7] offset:1024
  s_waitcnt vmcnt(32)
  v_add_u32 v4, 32768, v2
  global_load_dwordx4 a[128:131], v4, s[6:7]
  global_load_dwordx4 a[132:135], v4, s[6:7] offset:1024
  v_add_u32 v4, 34816, v2
  global_load_dwordx4 a[136:139], v4, s[6:7]
  global_load_dwordx4 a[140:143], v4, s[6:7] offset:1024
  v_add_u32 v4, 36864, v2
  global_load_dwordx4 a[144:147], v4, s[6:7]
  global_load_dwordx4 a[148:151], v4, s[6:7] offset:1024
  v_add_u32 v4, 38912, v2
  global_load_dwordx4 a[152:155], v4, s[6:7]
  global_load_dwordx4 a[156:159], v4, s[6:7] offset:1024
  v_add_u32 v4, 40960, v2
  global_load_dwordx4 a[160:163], v4, s[6:7]
  global_load_dwordx4 a[164:167], v4, s[6:7] offset:1024
  v_add_u32 v4, 43008, v2
  global_load_dwordx4 a[168:171], v4, s[6:7]
  global_load_dwordx4 a[172:175], v4, s[6:7] offset:1024
  v_add_u32 v4, 45056, v2
  global_load_dwordx4 a[176:179], v4, s[6:7]
  global_load_dwordx4 a[180:183], v4, s[6:7] offset:1024
  v_add_u32 v4, 47104, v2
  global_load_dwordx4 a[184:187], v4, s[6:7]
  global_load_dwordx4 a[188:191], v4, s[6:7] offset:1024
  v_add_u32 v4, 49152, v2
  global_load_dwordx4 a[192:195], v4, s[6:7]
  global_load_dwordx4 a[196:199], v4, s[6:7] offset:1024
  v_add_u32 v4, 51200, v2
  global_load_dwordx4 a[200:203], v4, s[6:7]
  global_load_dwordx4 a[204:207], v4, s[6:7] offset:1024
  v_add_u32 v4, 53248, v2
  global_load_dwordx4 a[208:211], v4, s[6:7]
  global_load_dwordx4 a[212:215], v4, s[6:7] offset:1024
  v_add_u32 v4, 55296, v2
  global_load_dwordx4 a[216:219], v4, s[6:7]
  global_load_dwordx4 a[220:223], v4, s[6:7] offset:1024
  s_waitcnt vmcnt(0)
  v_and_b32 v61, 15, v1
  v_lshrrev_b32 v62, 4, v1
  v_lshrrev_b32 v63, 2, v61
  v_xor_b32 v62, v62, v63
  v_lshlrev_b32 v62, 3, v62
  v_lshl_add_u32 v62, v61, 5, v62
  v_lshrrev_b32 v63, 3, v61
  v_lshl_add_u32 v4, v63, 7, v62
  v_add_u32 v4, 43008, v4
  v_and_b32 v66, 15, v1
  v_lshrrev_b32 v65, 4, v1
  v_lshrrev_b32 v61, 2, v66
  v_mul_u32_u24 v62, 384, v65
  v_lshl_add_u32 v62, v61, 5, v62
  v_and_b32 v63, 3, v66
  v_lshlrev_b32 v64, 1, v65
  v_and_b32 v64, 3, v64
  v_xor_b32 v60, v63, v64
  v_lshl_add_u32 v5, v60, 3, v62
  v_add_u32 v5, 43008, v5
  v_xor_b32 v60, 1, v60
  v_lshl_add_u32 v6, v60, 3, v62
  v_add_u32 v6, 43136, v6
  v_and_b32 v61, 3, v1
  v_min_u32 v61, 2, v61
  v_lshlrev_b32 v7, 8, v61
  v_add_u32 v7, 64512, v7
  s_lshl_b32 s26, s22, 9
  v_lshrrev_b32 v62, 3, v66
  v_and_b32 v61, 7, v1
  v_lshrrev_b32 v64, 1, v65
  v_and_b32 v60, 1, v65
  v_lshlrev_b32 v63, 4, v61
  v_lshl_add_u32 v63, v64, 8, v63
  v_lshl_add_u32 v63, v60, 3, v63
  v_lshl_add_u32 v10, v62, 2, v63
  v_add_u32 v10, s26, v10
  s_lshr_b32 s26, s22, 1
  s_lshl_b32 s26, s26, 8
  s_and_b32 s27, s22, 1
  s_lshl_b32 s27, s27, 2
  s_add_u32 s26, s26, s27
  s_add_u32 s26, s26, 8192
  v_lshlrev_b32 v63, 4, v61
  v_lshl_add_u32 v63, v64, 7, v63
  v_lshl_add_u32 v11, v60, 3, v63
  v_add_u32 v11, s26, v11
  s_lshr_b32 s26, s22, 2
  s_lshl_b32 s26, s26, 9
  s_and_b32 s27, s22, 3
  s_lshl_b32 s27, s27, 2
  s_add_u32 s26, s26, s27
  s_add_u32 s26, s26, 10240
  v_and_b32 v61, 3, v1
  v_lshlrev_b32 v122, 7, v61
  v_add_u32 v122, s26, v122
  v_min_u32 v1, 55, v1
  v_lshlrev_b32 v1, 2, v1
  s_and_b32 s26, s22, 7
  s_lshl_b32 s26, s26, 8
  s_add_u32 s26, s26, 5120
  v_add_u32 v1, s26, v1
  v_add_u32 v120, 4096, v2
  v_add_u32 v121, 12288, v2
  v_add_u32 v104, 20480, v2
  v_add_u32 v105, 28672, v2
  v_mov_b32 v102, 16384
  s_mov_b64 exec, 1
b_sw_x0:
  global_load_dword v103, v102, s[16:17] sc1
  s_sub_u32 s25, s25, 1
  s_cbranch_scc1 b_fail
  s_waitcnt vmcnt(0)
  v_cmp_ne_u32 vcc, 2, v103
  s_cbranch_vccz b_sw_x0_got
  s_sleep 4
  s_branch b_sw_x0
b_sw_x0_got:
  s_mov_b64 exec, -1
  global_load_dwordx4 v[144:147], v120, s[8:9] offset:-4096
  global_load_dwordx4 v[200:203], v121, s[8:9] offset:2048
  global_load_dwordx4 v[148:151], v120, s[8:9] offset:-3072
  global_load_dwordx4 v[204:207], v121, s[8:9] offset:3072
  global_load_dwordx4 v[152:155], v120, s[8:9] offset:-2048
  global_load_dwordx4 v[208:211], v104, s[8:9] offset:-4096
  global_load_dwordx4 v[156:159], v120, s[8:9] offset:-1024
  global_load_dwordx4 v[212:215], v104, s[8:9] offset:-3072
  global_load_dwordx4 v[160:163], v120, s[8:9] offset:0
  global_load_dwordx4 v[216:219], v104, s[8:9] offset:-2048
  global_load_dwordx4 v[164:167], v120, s[8:9] offset:1024
  global_load_dwordx4 v[220:223], v104, s[8:9] offset:-1024
  global_load_dwordx4 v[168:171], v120, s[8:9] offset:2048
  global_load_dwordx4 v[224:227], v104, s[8:9] offset:0
  global_load_dwordx4 v[172:175], v120, s[8:9] offset:3072
  global_load_dwordx4 v[228:231], v104, s[8:9] offset:1024
  global_load_dwordx4 v[176:179], v121, s[8:9] offset:-4096
  global_load_dwordx4 v[232:235], v104, s[8:9] offset:2048
  global_load_dwordx4 v[180:183], v121, s[8:9] offset:-3072
  global_load_dwordx4 v[236:239], v104, s[8:9] offset:3072
  global_load_dwordx4 v[184:187], v121, s[8:9] offset:-2048
  global_load_dwordx4 v[240:243], v105, s[8:9] offset:-4096
  global_load_dwordx4 v[188:191], v121, s[8:9] offset:-1024
  global_load_dwordx4 v[244:247], v105, s[8:9] offset:-3072
  global_load_dwordx4 v[192:195], v121, s[8:9] offset:0
  global_load_dwordx4 v[248:251], v105, s[8:9] offset:-2048
  global_load_dwordx4 v[196:199], v121, s[8:9] offset:1024
  global_load_dwordx4 v[252:255], v105, s[8:9] offset:-1024
  v_mov_b64 v[40:41], 0
  v_mov_b64 v[42:43], 0
  v_mov_b64 v[44:45], 0
  v_mov_b64 v[46:47], 0
  v_mov_b64 v[48:49], 0
  v_mov_b64 v[50:51], 0
  v_mov_b64 v[52:53], 0
  v_mov_b64 v[54:55], 0
  v_mov_b64 v[108:109], 0
  v_mov_b64 v[110:111], 0
  v_mov_b32 v0, 0
  v_mov_b32 v106, 0.5
  s_waitcnt vmcnt(0)
  s_barrier
b_sw_step:
  v_add_u32 v0, 1, v0
  s_add_u32 s29, s24, 1
  s_mov_b64 exec, s[30:31]
  global_load_dword v124, v1, s[12:13] sc1
  s_nop 15
  s_nop 4
  global_load_dword v125, v1, s[12:13] sc1
  s_nop 15
  s_nop 4
b_sw_bell:
  global_load_dword v100, v1, s[12:13] sc1
  s_waitcnt vmcnt(2)
  v_cmp_eq_u32 vcc, -1, v124
  s_cbranch_vccz b_sw_bell_ok
  global_load_dword v124, v1, s[12:13] sc1
  s_waitcnt vmcnt(2)
  v_cmp_eq_u32 vcc, -1, v125
  s_cbranch_vccz b_sw_bell_ok
  global_load_dword v125, v1, s[12:13] sc1
  s_waitcnt vmcnt(2)
  v_cmp_eq_u32 vcc, -1, v100
  s_sub_u32 s25, s25, 1
  s_cbranch_scc1 b_fail
  s_cbranch_vccz b_sw_bell_ok
  s_branch b_sw_bell
b_sw_bell_ok:
  s_mov_b64 exec, -1
b_sw_gather:
  global_load_dwordx4 v[12:15], v2, s[12:13] offset:-3072 sc1
  s_nop 11
  global_load_dwordx4 v[16:19], v2, s[12:13] offset:-2048 sc1
  s_nop 11
  global_load_dwordx4 v[20:23], v2, s[12:13] offset:-1024 sc1
  s_nop 11
  global_load_dwordx4 v[24:27], v2, s[12:13] offset:0 sc1
  s_sub_u32 s25, s25, 1
  s_cbranch_scc1 b_fail
  s_waitcnt vmcnt(3)
  v_smfmac_f32_16x16x64_bf16 v[40:43], v[12:15], a[0:7], v3
  global_load_dwordx4 v[28:31], v2, s[12:13] offset:1024 sc1
  v_smfmac_f32_16x16x64_bf16 v[44:47], v[12:15], a[56:63], v3
  v_max3_u32 v8, v12, v13, v14
  v_smfmac_f32_16x16x64_bf16 v[48:51], v[12:15], a[112:119], v3
  v_smfmac_f32_16x16x64_bf16 v[52:55], v[12:15], a[168:175], v3
  s_waitcnt vmcnt(3)
  v_smfmac_f32_16x16x64_bf16 v[40:43], v[16:19], a[8:15], v3
  global_load_dwordx4 v[32:35], v2, s[12:13] offset:2048 sc1
  v_smfmac_f32_16x16x64_bf16 v[44:47], v[16:19], a[64:71], v3
  v_max3_u32 v8, v8, v15, v16
  v_smfmac_f32_16x16x64_bf16 v[48:51], v[16:19], a[120:127], v3
  v_max3_u32 v8, v8, v17, v18
  v_smfmac_f32_16x16x64_bf16 v[52:55], v[16:19], a[176:183], v3
  s_waitcnt vmcnt(3)
  v_smfmac_f32_16x16x64_bf16 v[40:43], v[20:23], a[16:23], v3
  global_load_dwordx4 v[36:39], v2, s[12:13] offset:3072 sc1
  v_smfmac_f32_16x16x64_bf16 v[44:47], v[20:23], a[72:79], v3
  v_max3_u32 v8, v8, v19, v20
  v_smfmac_f32_16x16x64_bf16 v[48:51], v[20:23], a[128:135], v3
  v_max3_u32 v8, v8, v21, v22
  v_smfmac_f32_16x16x64_bf16 v[52:55], v[20:23], a[184:191], v3
  s_waitcnt vmcnt(3)
  v_smfmac_f32_16x16x64_bf16 v[40:43], v[24:27], a[24:31], v3
  v_max3_u32 v8, v8, v23, v24
  v_smfmac_f32_16x16x64_bf16 v[44:47], v[24:27], a[80:87], v3
  v_max3_u32 v8, v8, v25, v26
  v_smfmac_f32_16x16x64_bf16 v[48:51], v[24:27], a[136:143], v3
  v_smfmac_f32_16x16x64_bf16 v[52:55], v[24:27], a[192:199], v3
  s_waitcnt vmcnt(2)
  v_smfmac_f32_16x16x64_bf16 v[40:43], v[28:31], a[32:39], v3
  v_max3_u32 v8, v8, v27, v28
  v_smfmac_f32_16x16x64_bf16 v[44:47], v[28:31], a[88:95], v3
  v_max3_u32 v8, v8, v29, v30
  v_smfmac_f32_16x16x64_bf16 v[48:51], v[28:31], a[144:151], v3
  v_smfmac_f32_16x16x64_bf16 v[52:55], v[28:31], a[200:207], v3
  s_waitcnt vmcnt(1)
  v_smfmac_f32_16x16x64_bf16 v[40:43], v[32:35], a[40:47], v3
  v_max3_u32 v8, v8, v31, v32
  v_smfmac_f32_16x16x64_bf16 v[44:47], v[32:35], a[96:103], v3
  v_max3_u32 v8, v8, v33, v34
  v_smfmac_f32_16x16x64_bf16 v[48:51], v[32:35], a[152:159], v3
  v_smfmac_f32_16x16x64_bf16 v[52:55], v[32:35], a[208:215], v3
  s_waitcnt vmcnt(0)
  v_smfmac_f32_16x16x64_bf16 v[40:43], v[36:39], a[48:55], v3
  v_max3_u32 v8, v8, v35, v36
  v_smfmac_f32_16x16x64_bf16 v[44:47], v[36:39], a[104:111], v3
  v_max3_u32 v8, v8, v37, v38
  v_smfmac_f32_16x16x64_bf16 v[48:51], v[36:39], a[160:167], v3
  v_max_u32 v8, v8, v39
  v_smfmac_f32_16x16x64_bf16 v[52:55], v[36:39], a[216:223], v3
  v_cmp_eq_u32 vcc, -1, v8
  s_nop 3
  v_cvt_pk_bf16_f32 v8, v40, v41
  v_cvt_pk_bf16_f32 v9, v42, v43
  ds_write_b64 v4, v[8:9] offset:0
  v_cvt_pk_bf16_f32 v56, v44, v45
  v_cvt_pk_bf16_f32 v57, v46, v47
  ds_write_b64 v4, v[56:57] offset:768
  s_cbranch_vccnz b_sw_redo
  v_cvt_pk_bf16_f32 v8, v48, v49
  v_cvt_pk_bf16_f32 v9, v50, v51
  ds_write_b64 v4, v[8:9] offset:1536
  v_cvt_pk_bf16_f32 v56, v52, v53
  v_cvt_pk_bf16_f32 v57, v54, v55
  ds_write_b64 v4, v[56:57] offset:2304
  ds_read_b64_tr_b16 v[60:61], v5 offset:0
  ds_read_b64_tr_b16 v[62:63], v6 offset:0
  ds_read_b64_tr_b16 v[64:65], v5 offset:1536
  ds_read_b64_tr_b16 v[66:67], v6 offset:1536
  ds_read_b32 v85, v7 offset:0
  ds_read_b64_tr_b16 v[68:69], v5 offset:3072
  ds_read_b64_tr_b16 v[70:71], v6 offset:3072
  ds_read_b64_tr_b16 v[72:73], v5 offset:4608
  ds_read_b64_tr_b16 v[74:75], v6 offset:4608
  s_waitcnt lgkmcnt(0)
  v_cmp_gt_u32 vcc, s29, v85
  s_cbranch_vccnz b_sw_cp1_retry
b_sw_cp1_ok:
  v_smfmac_f32_16x16x64_bf16 v[108:111], v[12:15], v[60:67], v3
  ds_read_b32 v86, v7 offset:1024
  v_mfma_f32_16x16x32_bf16 v[112:115], v[144:147], v[60:63], 0
  ds_read_b64_tr_b16 v[76:77], v5 offset:6144
  ds_read_b64_tr_b16 v[78:79], v6 offset:6144
  v_mfma_f32_16x16x32_bf16 v[116:119], v[200:203], v[60:63], 0
  ds_read_b64_tr_b16 v[80:81], v5 offset:7680
  ds_read_b64_tr_b16 v[82:83], v6 offset:7680
  v_mfma_f32_16x16x32_bf16 v[112:115], v[148:151], v[64:67], v[112:115]
  v_mfma_f32_16x16x32_bf16 v[116:119], v[204:207], v[64:67], v[116:119]
  v_smfmac_f32_16x16x64_bf16 v[108:111], v[16:19], v[68:75], v3
  ds_read_b32 v84, v7 offset:2048
  v_mfma_f32_16x16x32_bf16 v[112:115], v[152:155], v[68:71], v[112:115]
  ds_read_b64_tr_b16 v[60:61], v5 offset:9216
  ds_read_b64_tr_b16 v[62:63], v6 offset:9216
  v_mfma_f32_16x16x32_bf16 v[116:119], v[208:211], v[68:71], v[116:119]
  ds_read_b64_tr_b16 v[64:65], v5 offset:10752
  ds_read_b64_tr_b16 v[66:67], v6 offset:10752
  s_waitcnt lgkmcnt(5)
  v_cmp_gt_u32 vcc, s29, v86
  v_mfma_f32_16x16x32_bf16 v[112:115], v[156:159], v[72:75], v[112:115]
  v_mfma_f32_16x16x32_bf16 v[116:119], v[212:215], v[72:75], v[116:119]
  s_cbranch_vccnz b_sw_cp2_retry
b_sw_cp2_ok:
  v_smfmac_f32_16x16x64_bf16 v[108:111], v[20:23], v[76:83], v3
  v_mfma_f32_16x16x32_bf16 v[112:115], v[160:163], v[76:79], v[112:115]
  v_mfma_f32_16x16x32_bf16 v[116:119], v[216:219], v[76:79], v[116:119]
  s_waitcnt lgkmcnt(0)
  v_cmp_gt_u32 vcc, s29, v84
  v_mfma_f32_16x16x32_bf16 v[112:115], v[164:167], v[80:83], v[112:115]
  v_mfma_f32_16x16x32_bf16 v[116:119], v[220:223], v[80:83], v[116:119]
  s_cbranch_vccnz b_sw_cp3_retry
b_sw_cp3_ok:
  v_smfmac_f32_16x16x64_bf16 v[108:111], v[24:27], v[60:67], v3
  ds_read_b32 v85, v7 offset:3072
  v_mfma_f32_16x16x32_bf16 v[112:115], v[168:171], v[60:63], v[112:115]
  ds_read_b64_tr_b16 v[68:69], v5 offset:12288
  ds_read_b64_tr_b16 v[70:71], v6 offset:12288
  v_mfma_f32_16x16x32_bf16 v[116:119], v[224:227], v[60:63], v[116:119]
  ds_read_b64_tr_b16 v[72:73], v5 offset:13824
  ds_read_b64_tr_b16 v[74:75], v6 offset:13824
  v_mfma_f32_16x16x32_bf16 v[112:115], v[172:175], v[64:67], v[112:115]
  s_waitcnt lgkmcnt(0)
  v_cmp_gt_u32 vcc, s29, v85
  v_mfma_f32_16x16x32_bf16 v[116:119], v[228:231], v[64:67], v[116:119]
  s_cbranch_vccnz b_sw_cp4_retry
b_sw_cp4_ok:
  v_smfmac_f32_16x16x64_bf16 v[108:111], v[28:31], v[68:75], v3
  ds_read_b32 v86, v7 offset:4096
  v_mfma_f32_16x16x32_bf16 v[112:115], v[176:179], v[68:71], v[112:115]
  ds_read_b64_tr_b16 v[76:77], v5 offset:15360
  ds_read_b64_tr_b16 v[78:79], v6 offset:15360
  v_mfma_f32_16x16x32_bf16 v[116:119], v[232:235], v[68:71], v[116:119]
  ds_read_b64_tr_b16 v[80:81], v5 offset:16896
  ds_read_b64_tr_b16 v[82:83], v6 offset:16896
  v_mfma_f32_16x16x32_bf16 v[112:115], v[180:183], v[72:75], v[112:115]
  s_waitcnt lgkmcnt(0)
  v_cmp_gt_u32 vcc, s29, v86
  v_mfma_f32_16x16x32_bf16 v[116:119], v[236:239], v[72:75], v[116:119]
  s_cbranch_vccnz b_sw_cp5_retry
b_sw_cp5_ok:
  s_barrier
  v_smfmac_f32_16x16x64_bf16 v[108:111], v[32:35], v[76:83], v3
  ds_read_b64_tr_b16 v[60:61], v5 offset:18432
  v_mfma_f32_16x16x32_bf16 v[112:115], v[184:187], v[76:79], v[112:115]
  ds_read_b64_tr_b16 v[62:63], v6 offset:18432
  ds_read_b64_tr_b16 v[64:65], v5 offset:19968
  v_mfma_f32_16x16x32_bf16 v[116:119], v[240:243], v[76:79], v[116:119]
  ds_read_b64_tr_b16 v[66:67], v6 offset:19968
  v_mfma_f32_16x16x32_bf16 v[112:115], v[188:191], v[80:83], v[112:115]
  v_mfma_f32_16x16x32_bf16 v[116:119], v[244:247], v[80:83], v[116:119]
  s_waitcnt lgkmcnt(0)
  v_smfmac_f32_16x16x64_bf16 v[108:111], v[36:39], v[60:67], v3
  v_mfma_f32_16x16x32_bf16 v[112:115], v[192:195], v[60:63], v[112:115]
  v_mfma_f32_16x16x32_bf16 v[116:119], v[248:251], v[60:63], v[116:119]
  v_mfma_f32_16x16x32_bf16 v[112:115], v[196:199], v[64:67], v[112:115]
  v_mfma_f32_16x16x32_bf16 v[116:119], v[252:255], v[64:67], v[116:119]
  v_permlane32_swap_b32 v108, v110
  v_permlane32_swap_b32 v109, v111
  v_add_f32 v108, v108, v110
  v_add_f32 v109, v109, v111
  s_nop 0
  v_add_f32_dpp v130, v108, v108 row_ror:8 row_mask:0xf bank_mask:0xf
  v_add_f32_dpp v131, v109, v109 row_ror:8 row_mask:0xf bank_mask:0xf
  v_add_f32_dpp v126, v112, v112 row_ror:8 row_mask:0xf bank_mask:0x3
  v_add_f32_dpp v127, v113, v113 row_ror:8 row_mask:0xf bank_mask:0x3
  v_add_f32_dpp v128, v114, v114 row_ror:8 row_mask:0xf bank_mask:0x3
  v_add_f32_dpp v129, v115, v115 row_ror:8 row_mask:0xf bank_mask:0x3
  v_add_f32_dpp v126, v116, v116 row_ror:8 row_mask:0xf bank_mask:0xc
  v_add_f32_dpp v127, v117, v117 row_ror:8 row_mask:0xf bank_mask:0xc
  v_add_f32_dpp v128, v118, v118 row_ror:8 row_mask:0xf bank_mask:0xc
  v_add_f32_dpp v129, v119, v119 row_ror:8 row_mask:0xf bank_mask:0xc
  v_max3_f32 v142, v126, v127, v128
  v_max3_f32 v142, v142, v129, v130
  v_max_f32 v142, v142, v131
  v_pk_add_f32 v[132:133], v[126:127], v[142:143] op_sel_hi:[1,0] neg_lo:[0,1] neg_hi:[0,1]
  v_pk_add_f32 v[134:135], v[128:129], v[142:143] op_sel_hi:[1,0] neg_lo:[0,1] neg_hi:[0,1]
  v_max_f32_dpp v138, v142, v142 row_ror:8 row_mask:0xf bank_mask:0xf
  v_pk_add_f32 v[136:137], v[130:131], v[142:143] op_sel_hi:[1,0] neg_lo:[0,1] neg_hi:[0,1]
  v_mov_b32 v139, v138
  v_exp_f32 v132, v132
  v_exp_f32 v133, v133
  v_permlane16_swap_b32 v138, v139
  v_exp_f32 v134, v134
  v_max_f32 v138, v138, v139
  v_exp_f32 v135, v135
  v_mov_b32 v139, v138
  v_exp_f32 v136, v136
  v_exp_f32 v137, v137
  v_permlane32_swap_b32 v138, v139
  v_pk_add_f32 v[126:127], v[132:133], v[134:135]
  v_max_f32 v138, v138, v139
  v_pk_fma_f32 v[126:127], v[136:137], v[106:107], v[126:127] op_sel_hi:[1,0,1]
  v_sub_f32 v143, v142, v138
  s_mov_b64 exec, 15
  global_store_dword v122, v0, s[14:15]
  s_mov_b64 exec, -1
  v_add_f32 v141, v126, v127
  v_exp_f32 v143, v143
  s_nop 0
  v_mul_f32 v141, v141, v143
  s_nop 1
  v_add_f32_dpp v141, v141, v141 row_ror:8 row_mask:0xf bank_mask:0xf
  v_mov_b32 v139, v141
  s_nop 1
  v_permlane16_swap_b32 v141, v139
  v_add_f32 v141, v141, v139
  v_mov_b32 v139, v141
  s_nop 1
  v_permlane32_swap_b32 v141, v139
  v_add_f32 v141, v141, v139
  v_rcp_f32 v140, v141
  s_nop 0
  v_mul_f32 v140, v140, v143
  v_pk_mul_f32 v[132:133], v[132:133], v[140:141] op_sel_hi:[1,0]
  v_pk_mul_f32 v[134:135], v[134:135], v[140:141] op_sel_hi:[1,0]
  v_pk_mul_f32 v[136:137], v[136:137], v[140:141] op_sel_hi:[1,0]
  v_cvt_pk_bf16_f32 v58, v132, v133
  v_cvt_pk_bf16_f32 v59, v134, v135
  v_cvt_pk_bf16_f32 v8, v136, v137
  global_store_dword v10, v58, s[14:15]
  global_store_dword v10, v59, s[14:15] offset:128
  global_store_dword v11, v8, s[14:15]
  s_add_u32 s8, s8, 28672
  s_addc_u32 s9, s9, 0
  s_cmp_lg_u32 s24, 0
  s_cbranch_scc1 b_sw_xk
  v_mov_b32 v102, 1280
  s_mov_b64 exec, 1
b_sw_xall:
  global_load_dword v103, v102, s[16:17] sc1
  s_sub_u32 s25, s25, 1
  s_cbranch_scc1 b_fail
  s_waitcnt vmcnt(0)
  v_cmp_ne_u32 vcc, 64, v103
  s_cbranch_vccz b_sw_xall_got
  s_sleep 4
  s_branch b_sw_xall
b_sw_xall_got:
  s_mov_b64 exec, -1
b_sw_xk:
  s_sleep 5
  global_load_dwordx4 v[144:147], v120, s[8:9] offset:-4096
  global_load_dwordx4 v[200:203], v121, s[8:9] offset:2048
  global_load_dwordx4 v[148:151], v120, s[8:9] offset:-3072
  global_load_dwordx4 v[204:207], v121, s[8:9] offset:3072
  global_load_dwordx4 v[152:155], v120, s[8:9] offset:-2048
  global_load_dwordx4 v[208:211], v104, s[8:9] offset:-4096
  global_load_dwordx4 v[156:159], v120, s[8:9] offset:-1024
  global_load_dwordx4 v[212:215], v104, s[8:9] offset:-3072
  global_load_dwordx4 v[160:163], v120, s[8:9] offset:0
  global_load_dwordx4 v[216:219], v104, s[8:9] offset:-2048
  global_load_dwordx4 v[164:167], v120, s[8:9] offset:1024
  global_load_dwordx4 v[220:223], v104, s[8:9] offset:-1024
  global_load_dwordx4 v[168:171], v120, s[8:9] offset:2048
  global_load_dwordx4 v[224:227], v104, s[8:9] offset:0
  global_load_dwordx4 v[172:175], v120, s[8:9] offset:3072
  global_load_dwordx4 v[228:231], v104, s[8:9] offset:1024
  global_load_dwordx4 v[176:179], v121, s[8:9] offset:-4096
  global_load_dwordx4 v[232:235], v104, s[8:9] offset:2048
  global_load_dwordx4 v[180:183], v121, s[8:9] offset:-3072
  global_load_dwordx4 v[236:239], v104, s[8:9] offset:3072
  global_load_dwordx4 v[184:187], v121, s[8:9] offset:-2048
  global_load_dwordx4 v[240:243], v105, s[8:9] offset:-4096
  global_load_dwordx4 v[188:191], v121, s[8:9] offset:-1024
  global_load_dwordx4 v[244:247], v105, s[8:9] offset:-3072
  global_load_dwordx4 v[192:195], v121, s[8:9] offset:0
  global_load_dwordx4 v[248:251], v105, s[8:9] offset:-2048
  global_load_dwordx4 v[196:199], v121, s[8:9] offset:1024
  global_load_dwordx4 v[252:255], v105, s[8:9] offset:-1024
  v_mov_b64 v[40:41], 0
  v_mov_b64 v[42:43], 0
  v_mov_b64 v[44:45], 0
  v_mov_b64 v[46:47], 0
  v_mov_b64 v[48:49], 0
  v_mov_b64 v[50:51], 0
  v_mov_b64 v[52:53], 0
  v_mov_b64 v[54:55], 0
  v_mov_b64 v[108:109], 0
  v_mov_b64 v[110:111], 0
  s_add_u32 s14, s14, 12288
  s_addc_u32 s15, s15, 0
  s_add_u32 s12, s12, 16384
  s_addc_u32 s13, s13, 0
  s_add_u32 s24, s24, 1
  s_cmp_lt_u32 s24, 63
  s_cbranch_scc1 b_sw_step
  s_endpgm
b_sw_redo:
  s_nop 7
  v_mov_b64 v[40:41], 0
  v_mov_b64 v[42:43], 0
  v_mov_b64 v[44:45], 0
  v_mov_b64 v[46:47], 0
  v_mov_b64 v[48:49], 0
  v_mov_b64 v[50:51], 0
  v_mov_b64 v[52:53], 0
  v_mov_b64 v[54:55], 0
  s_branch b_sw_gather
b_sw_cp1_retry:
  ds_read_b32 v85, v7 offset:0
  ds_read_b64_tr_b16 v[68:69], v5 offset:3072
  ds_read_b64_tr_b16 v[70:71], v6 offset:3072
  ds_read_b64_tr_b16 v[72:73], v5 offset:4608
  ds_read_b64_tr_b16 v[74:75], v6 offset:4608
  s_sub_u32 s25, s25, 1
  s_cbranch_scc1 b_fail
  s_waitcnt lgkmcnt(0)
  v_cmp_gt_u32 vcc, s29, v85
  s_cbranch_vccnz b_sw_cp1_retry
  s_branch b_sw_cp1_ok
b_sw_cp2_retry:
  ds_read_b32 v86, v7 offset:1024
  ds_read_b64_tr_b16 v[76:77], v5 offset:6144
  ds_read_b64_tr_b16 v[78:79], v6 offset:6144
  ds_read_b64_tr_b16 v[80:81], v5 offset:7680
  ds_read_b64_tr_b16 v[82:83], v6 offset:7680
  s_sub_u32 s25, s25, 1
  s_cbranch_scc1 b_fail
  s_waitcnt lgkmcnt(0)
  v_cmp_gt_u32 vcc, s29, v86
  s_cbranch_vccnz b_sw_cp2_retry
  s_branch b_sw_cp2_ok
b_sw_cp3_retry:
  ds_read_b32 v84, v7 offset:2048
  ds_read_b64_tr_b16 v[60:61], v5 offset:9216
  ds_read_b64_tr_b16 v[62:63], v6 offset:9216
  ds_read_b64_tr_b16 v[64:65], v5 offset:10752
  ds_read_b64_tr_b16 v[66:67], v6 offset:10752
  s_sub_u32 s25, s25, 1
  s_cbranch_scc1 b_fail
  s_waitcnt lgkmcnt(0)
  v_cmp_gt_u32 vcc, s29, v84
  s_cbranch_vccnz b_sw_cp3_retry
  s_branch b_sw_cp3_ok
b_sw_cp4_retry:
  ds_read_b32 v85, v7 offset:3072
  ds_read_b64_tr_b16 v[68:69], v5 offset:12288
  ds_read_b64_tr_b16 v[70:71], v6 offset:12288
  ds_read_b64_tr_b16 v[72:73], v5 offset:13824
  ds_read_b64_tr_b16 v[74:75], v6 offset:13824
  s_sub_u32 s25, s25, 1
  s_cbranch_scc1 b_fail
  s_waitcnt lgkmcnt(0)
  v_cmp_gt_u32 vcc, s29, v85
  s_cbranch_vccnz b_sw_cp4_retry
  s_branch b_sw_cp4_ok
b_sw_cp5_retry:
  ds_read_b32 v86, v7 offset:4096
  ds_read_b64_tr_b16 v[76:77], v5 offset:15360
  ds_read_b64_tr_b16 v[78:79], v6 offset:15360
  ds_read_b64_tr_b16 v[80:81], v5 offset:16896
  ds_read_b64_tr_b16 v[82:83], v6 offset:16896
  s_sub_u32 s25, s25, 1
  s_cbranch_scc1 b_fail
  s_waitcnt lgkmcnt(0)
  v_cmp_gt_u32 vcc, s29, v86
  s_cbranch_vccnz b_sw_cp5_retry
  s_branch b_sw_cp5_ok
b_vw0:
  v_add_u32 v4, 0, v2
  global_load_dwordx4 v[52:55], v4, s[6:7]
  v_add_u32 v4, 1024, v2
  global_load_dwordx4 v[56:59], v4, s[6:7]
  v_add_u32 v4, 2048, v2
  global_load_dwordx4 v[60:63], v4, s[6:7]
  v_add_u32 v4, 3072, v2
  global_load_dwordx4 v[64:67], v4, s[6:7]
  v_add_u32 v4, 4096, v2
  global_load_dwordx4 v[68:71], v4, s[6:7]
  v_add_u32 v4, 5120, v2
  global_load_dwordx4 v[72:75], v4, s[6:7]
  v_add_u32 v4, 6144, v2
  global_load_dwordx4 v[76:79], v4, s[6:7]
  v_add_u32 v4, 7168, v2
  global_load_dwordx4 v[80:83], v4, s[6:7]
  v_add_u32 v4, 8192, v2
  global_load_dwordx4 v[84:87], v4, s[6:7]
  v_add_u32 v4, 9216, v2
  global_load_dwordx4 v[88:91], v4, s[6:7]
  v_add_u32 v4, 10240, v2
  global_load_dwordx4 v[92:95], v4, s[6:7]
  v_add_u32 v4, 11264, v2
  global_load_dwordx4 v[96:99], v4, s[6:7]
  v_add_u32 v4, 12288, v2
  global_load_dwordx4 v[100:103], v4, s[6:7]
  v_add_u32 v4, 13312, v2
  global_load_dwordx4 v[104:107], v4, s[6:7]
  v_add_u32 v5, 16384, v2
  s_waitcnt vmcnt(0)
  ds_write_b128 v5, v[52:55] offset:0
  ds_write_b128 v5, v[56:59] offset:1024
  ds_write_b128 v5, v[60:63] offset:2048
  ds_write_b128 v5, v[64:67] offset:3072
  ds_write_b128 v5, v[68:71] offset:4096
  ds_write_b128 v5, v[72:75] offset:5120
  ds_write_b128 v5, v[76:79] offset:6144
  ds_write_b128 v5, v[80:83] offset:7168
  ds_write_b128 v5, v[84:87] offset:8192
  ds_write_b128 v5, v[88:91] offset:9216
  ds_write_b128 v5, v[92:95] offset:10240
  ds_write_b128 v5, v[96:99] offset:11264
  ds_write_b128 v5, v[100:103] offset:12288
  ds_write_b128 v5, v[104:107] offset:13312
  s_waitcnt lgkmcnt(0)
  v_add_u32 v4, 14336, v2
  global_load_dwordx4 v[52:55], v4, s[6:7]
  v_add_u32 v4, 15360, v2
  global_load_dwordx4 v[56:59], v4, s[6:7]
  v_add_u32 v4, 16384, v2
  global_load_dwordx4 v[60:63], v4, s[6:7]
  v_add_u32 v4, 17408, v2
  global_load_dwordx4 v[64:67], v4, s[6:7]
  v_add_u32 v4, 18432, v2
  global_load_dwordx4 v[68:71], v4, s[6:7]
  v_add_u32 v4, 19456, v2
  global_load_dwordx4 v[72:75], v4, s[6:7]
  v_add_u32 v4, 20480, v2
  global_load_dwordx4 v[76:79], v4, s[6:7]
  v_add_u32 v4, 21504, v2
  global_load_dwordx4 v[80:83], v4, s[6:7]
  v_add_u32 v4, 22528, v2
  global_load_dwordx4 v[84:87], v4, s[6:7]
  v_add_u32 v4, 23552, v2
  global_load_dwordx4 v[88:91], v4, s[6:7]
  v_add_u32 v4, 24576, v2
  global_load_dwordx4 v[92:95], v4, s[6:7]
  v_add_u32 v4, 25600, v2
  global_load_dwordx4 v[96:99], v4, s[6:7]
  v_add_u32 v4, 26624, v2
  global_load_dwordx4 v[100:103], v4, s[6:7]
  v_add_u32 v4, 27648, v2
  global_load_dwordx4 v[104:107], v4, s[6:7]
  v_add_u32 v5, 30720, v2
  s_waitcnt vmcnt(0)
  ds_write_b128 v5, v[52:55] offset:0
  ds_write_b128 v5, v[56:59] offset:1024
  ds_write_b128 v5, v[60:63] offset:2048
  ds_write_b128 v5, v[64:67] offset:3072
  ds_write_b128 v5, v[68:71] offset:4096
  ds_write_b128 v5, v[72:75] offset:5120
  ds_write_b128 v5, v[76:79] offset:6144
  ds_write_b128 v5, v[80:83] offset:7168
  ds_write_b128 v5, v[84:87] offset:8192
  ds_write_b128 v5, v[88:91] offset:9216
  ds_write_b128 v5, v[92:95] offset:10240
  ds_write_b128 v5, v[96:99] offset:11264
  ds_write_b128 v5, v[100:103] offset:12288
  ds_write_b128 v5, v[104:107] offset:13312
  s_waitcnt lgkmcnt(0)
  v_add_u32 v4, 401408, v2
  global_load_dwordx4 a[0:3], v4, s[6:7]
  global_load_dwordx4 a[4:7], v4, s[6:7] offset:1024
  v_add_u32 v4, 403456, v2
  global_load_dwordx4 a[8:11], v4, s[6:7]
  global_load_dwordx4 a[12:15], v4, s[6:7] offset:1024
  v_add_u32 v4, 405504, v2
  global_load_dwordx4 a[16:19], v4, s[6:7]
  global_load_dwordx4 a[20:23], v4, s[6:7] offset:1024
  v_add_u32 v4, 407552, v2
  global_load_dwordx4 a[24:27], v4, s[6:7]
  global_load_dwordx4 a[28:31], v4, s[6:7] offset:1024
  v_add_u32 v4, 409600, v2
  global_load_dwordx4 a[32:35], v4, s[6:7]
  global_load_dwordx4 a[36:39], v4, s[6:7] offset:1024
  v_add_u32 v4, 411648, v2
  global_load_dwordx4 a[40:43], v4, s[6:7]
  global_load_dwordx4 a[44:47], v4, s[6:7] offset:1024
  v_add_u32 v4, 413696, v2
  global_load_dwordx4 a[48:51], v4, s[6:7]
  global_load_dwordx4 a[52:55], v4, s[6:7] offset:1024
  v_add_u32 v4, 415744, v2
  global_load_dwordx4 a[56:59], v4, s[6:7]
  global_load_dwordx4 a[60:63], v4, s[6:7] offset:1024
  v_add_u32 v4, 417792, v2
  global_load_dwordx4 a[64:67], v4, s[6:7]
  global_load_dwordx4 a[68:71], v4, s[6:7] offset:1024
  v_add_u32 v4, 419840, v2
  global_load_dwordx4 a[72:75], v4, s[6:7]
  global_load_dwordx4 a[76:79], v4, s[6:7] offset:1024
  v_add_u32 v4, 421888, v2
  global_load_dwordx4 a[80:83], v4, s[6:7]
  global_load_dwordx4 a[84:87], v4, s[6:7] offset:1024
  v_add_u32 v4, 423936, v2
  global_load_dwordx4 a[88:91], v4, s[6:7]
  global_load_dwordx4 a[92:95], v4, s[6:7] offset:1024
  v_add_u32 v4, 425984, v2
  global_load_dwordx4 a[96:99], v4, s[6:7]
  global_load_dwordx4 a[100:103], v4, s[6:7] offset:1024
  v_add_u32 v4, 428032, v2
  global_load_dwordx4 a[104:107], v4, s[6:7]
  global_load_dwordx4 a[108:111], v4, s[6:7] offset:1024
  v_add_u32 v4, 802816, v2
  global_load_dwordx4 a[112:115], v4, s[6:7]
  global_load_dwordx4 a[116:119], v4, s[6:7] offset:1024
  v_add_u32 v4, 804864, v2
  global_load_dwordx4 a[120:123], v4, s[6:7]
  global_load_dwordx4 a[124:127], v4, s[6:7] offset:1024
  s_waitcnt vmcnt(32)
  v_add_u32 v4, 806912, v2
  global_load_dwordx4 a[128:131], v4, s[6:7]
  global_load_dwordx4 a[132:135], v4, s[6:7] offset:1024
  v_add_u32 v4, 808960, v2
  global_load_dwordx4 a[136:139], v4, s[6:7]
  global_load_dwordx4 a[140:143], v4, s[6:7] offset:1024
  v_add_u32 v4, 811008, v2
  global_load_dwordx4 a[144:147], v4, s[6:7]
  global_load_dwordx4 a[148:151], v4, s[6:7] offset:1024
  v_add_u32 v4, 813056, v2
  global_load_dwordx4 a[152:155], v4, s[6:7]
  global_load_dwordx4 a[156:159], v4, s[6:7] offset:1024
  v_add_u32 v4, 815104, v2
  global_load_dwordx4 a[160:163], v4, s[6:7]
  global_load_dwordx4 a[164:167], v4, s[6:7] offset:1024
  v_add_u32 v4, 817152, v2
  global_load_dwordx4 a[168:171], v4, s[6:7]
  global_load_dwordx4 a[172:175], v4, s[6:7] offset:1024
  v_add_u32 v4, 819200, v2
  global_load_dwordx4 a[176:179], v4, s[6:7]
  global_load_dwordx4 a[180:183], v4, s[6:7] offset:1024
  v_add_u32 v4, 821248, v2
  global_load_dwordx4 a[184:187], v4, s[6:7]
  global_load_dwordx4 a[188:191], v4, s[6:7] offset:1024
  v_add_u32 v4, 823296, v2
  global_load_dwordx4 a[192:195], v4, s[6:7]
  global_load_dwordx4 a[196:199], v4, s[6:7] offset:1024
  v_add_u32 v4, 825344, v2
  global_load_dwordx4 a[200:203], v4, s[6:7]
  global_load_dwordx4 a[204:207], v4, s[6:7] offset:1024
  v_add_u32 v4, 827392, v2
  global_load_dwordx4 a[208:211], v4, s[6:7]
  global_load_dwordx4 a[212:215], v4, s[6:7] offset:1024
  v_add_u32 v4, 829440, v2
  global_load_dwordx4 a[216:219], v4, s[6:7]
  global_load_dwordx4 a[220:223], v4, s[6:7] offset:1024
  v_add_u32 v4, 1204224, v2
  global_load_dwordx4 a[224:227], v4, s[6:7]
  global_load_dwordx4 a[228:231], v4, s[6:7] offset:1024
  v_add_u32 v4, 1206272, v2
  global_load_dwordx4 a[232:235], v4, s[6:7]
  global_load_dwordx4 a[236:239], v4, s[6:7] offset:1024
  v_add_u32 v4, 1208320, v2
  global_load_dwordx4 a[240:243], v4, s[6:7]
  global_load_dwordx4 a[244:247], v4, s[6:7] offset:1024
  v_add_u32 v4, 1210368, v2
  global_load_dwordx4 a[248:251], v4, s[6:7]
  global_load_dwordx4 a[252:255], v4, s[6:7] offset:1024
  s_waitcnt vmcnt(32)
  v_add_u32 v4, 1212416, v2
  global_load_dwordx4 v[176:179], v4, s[6:7]
  global_load_dwordx4 v[180:183], v4, s[6:7] offset:1024
  v_add_u32 v4, 1214464, v2
  global_load_dwordx4 v[184:187], v4, s[6:7]
  global_load_dwordx4 v[188:191], v4, s[6:7] offset:1024
  v_add_u32 v4, 1216512, v2
  global_load_dwordx4 v[192:195], v4, s[6:7]
  global_load_dwordx4 v[196:199], v4, s[6:7] offset:1024
  v_add_u32 v4, 1218560, v2
  global_load_dwordx4 v[200:203], v4, s[6:7]
  global_load_dwordx4 v[204:207], v4, s[6:7] offset:1024
  v_add_u32 v4, 1220608, v2
  global_load_dwordx4 v[208:211], v4, s[6:7]
  global_load_dwordx4 v[212:215], v4, s[6:7] offset:1024
  v_add_u32 v4, 1222656, v2
  global_load_dwordx4 v[216:219], v4, s[6:7]
  global_load_dwordx4 v[220:223], v4, s[6:7] offset:1024
  v_add_u32 v4, 1224704, v2
  global_load_dwordx4 v[224:227], v4, s[6:7]
  global_load_dwordx4 v[228:231], v4, s[6:7] offset:1024
  v_add_u32 v4, 1226752, v2
  global_load_dwordx4 v[232:235], v4, s[6:7]
  global_load_dwordx4 v[236:239], v4, s[6:7] offset:1024
  v_add_u32 v4, 1228800, v2
  global_load_dwordx4 v[240:243], v4, s[6:7]
  global_load_dwordx4 v[244:247], v4, s[6:7] offset:1024
  v_add_u32 v4, 1230848, v2
  global_load_dwordx4 v[248:251], v4, s[6:7]
  global_load_dwordx4 v[252:255], v4, s[6:7] offset:1024
  s_waitcnt vmcnt(0)
  v_add_u32 v4, 16384, v2
  v_add_u32 v5, 30720, v2
  v_add_u32 v156, 8192, v2
  v_lshrrev_b32 v8, 3, v1
  v_and_b32 v9, 7, v1
  v_lshrrev_b32 v10, 1, v9
  v_lshlrev_b32 v10, 2, v10
  v_and_b32 v9, 1, v9
  v_add_u32 v10, v10, v9
  v_add_u32 v10, 0, v10
  s_sub_u32 s26, s22, 16
  s_lshl_b32 s27, s26, 6
  s_add_u32 s27, s27, 516096
  v_mul_u32_u24 v163, 896, v8
  v_lshl_add_u32 v163, v10, 1, v163
  v_add_u32 v163, s27, v163
  v_lshrrev_b32 v11, 2, v8
  v_lshl_add_u32 v10, v11, 4, v10
  v_lshlrev_b32 v10, 4, v10
  v_and_b32 v8, 3, v8
  v_lshl_add_u32 v157, v8, 2, v10
  v_add_u32 v157, 8192, v157
  s_lshr_b32 s27, s26, 1
  s_lshl_b32 s27, s27, 10
  s_and_b32 s28, s26, 1
  s_lshl_b32 s28, s28, 9
  s_add_u32 s27, s27, s28
  s_add_u32 s27, s27, 13312
  v_lshl_add_u32 v158, v1, 1, s27
  v_add_u32 v167, 502784, v158
  s_lshl_b32 s27, s26, 15
  s_add_u32 s27, s27, 4096
  v_add_u32 v159, s27, v2
  v_add_u32 v160, 0, v2
  v_lshrrev_b32 v8, 5, v1
  v_lshlrev_b32 v8, 8, v8
  v_and_b32 v9, 15, v1
  v_lshl_add_u32 v161, v9, 4, v8
  v_add_u32 v161, 8192, v161
  s_and_b32 s27, s26, 3
  s_lshl_b32 s27, s27, 7
  s_add_u32 s27, s27, 10240
  v_and_b32 v8, 3, v1
  v_lshl_add_u32 v164, v8, 2, s27
  v_min_u32 v165, 56, v1
  v_lshlrev_b32 v165, 2, v165
  s_and_b32 s26, s22, 7
  s_lshl_b32 s26, s26, 8
  s_add_u32 s26, s26, 5120
  v_add_u32 v165, s26, v165
  s_sub_u32 s26, s22, 16
  s_lshl_b32 s27, s26, 4
  s_add_u32 s27, s27, 21504
  v_and_b32 v8, 7, v1
  v_lshlrev_b32 v8, 8, v8
  v_add_u32 v166, s27, v8
  s_mov_b32 s32, 0x55555555
  s_mov_b32 s33, 0x55555555
  ds_read_b128 v[52:55], v4 offset:0
  ds_read_b128 v[56:59], v4 offset:1024
  ds_read_b128 v[60:63], v4 offset:2048
  ds_read_b128 v[64:67], v4 offset:3072
  ds_read_b128 v[68:71], v4 offset:4096
  ds_read_b128 v[72:75], v4 offset:5120
  ds_read_b128 v[76:79], v4 offset:6144
  ds_read_b128 v[80:83], v4 offset:7168
  ds_read_b128 v[84:87], v4 offset:8192
  ds_read_b128 v[88:91], v4 offset:9216
  ds_read_b128 v[92:95], v4 offset:10240
  ds_read_b128 v[96:99], v4 offset:11264
  ds_read_b128 v[100:103], v4 offset:12288
  ds_read_b128 v[104:107], v4 offset:13312
  v_mov_b64 v[40:41], 0
  v_mov_b64 v[42:43], 0
  s_waitcnt lgkmcnt(0)
  s_barrier
b_vw0_step:
  s_mov_b64 exec, s[56:57]
  global_load_dword v169, v165, s[12:13] sc1
  s_nop 15
  s_nop 4
  global_load_dword v170, v165, s[12:13] sc1
  s_nop 15
  s_nop 4
b_vw0_bell2:
  global_load_dword v171, v165, s[12:13] sc1
  s_waitcnt vmcnt(2)
  v_cmp_eq_u32 vcc, -1, v169
  s_cbranch_vccz b_vw0_bell2_ok
  global_load_dword v169, v165, s[12:13] sc1
  s_waitcnt vmcnt(2)
  v_cmp_eq_u32 vcc, -1, v170
  s_cbranch_vccz b_vw0_bell2_ok
  global_load_dword v170, v165, s[12:13] sc1
  s_waitcnt vmcnt(2)
  v_cmp_eq_u32 vcc, -1, v171
  s_sub_u32 s25, s25, 1
  s_cbranch_scc1 b_fail
  s_cbranch_vccz b_vw0_bell2_ok
  s_branch b_vw0_bell2
b_vw0_bell2_ok:
  s_mov_b64 exec, -1
b_vw0_poll:
  global_load_dwordx4 v[12:15], v2, s[12:13] offset:-3072 sc1
  global_load_dwordx4 v[28:31], v2, s[12:13] offset:1024 sc1
  s_sub_u32 s25, s25, 1
  s_cbranch_scc1 b_fail
  s_waitcnt vmcnt(0)
  v_max3_u32 v8, v12, v13, v14
  v_max3_u32 v8, v8, v15, v28
  v_max3_u32 v8, v8, v29, v30
  v_max_u32 v8, v8, v31
  v_cmp_eq_u32 vcc, -1, v8
  s_cbranch_vccnz b_vw0_poll
  ds_write_b128 v2, v[12:15] offset:0
  ds_write_b128 v2, v[28:31] offset:4096
  s_waitcnt lgkmcnt(0)
  s_barrier
  ds_read_b128 v[16:19], v2 offset:1024
  ds_read_b128 v[20:23], v2 offset:2048
  ds_read_b128 v[24:27], v2 offset:3072
  ds_read_b128 v[32:35], v2 offset:5120
  ds_read_b128 v[36:39], v2 offset:6144
  global_load_dwordx4 v[124:127], v159, s[10:11] offset:-4096 sc1
  global_load_dwordx4 v[128:131], v159, s[10:11] offset:-3072 sc1
  global_load_dwordx4 v[132:135], v159, s[10:11] offset:-2048 sc1
  global_load_dwordx4 v[136:139], v159, s[10:11] offset:-1024 sc1
  global_load_dwordx4 v[140:143], v159, s[10:11] offset:0 sc1
  global_load_dwordx4 v[144:147], v159, s[10:11] offset:1024 sc1
  global_load_dwordx4 v[148:151], v159, s[10:11] offset:2048 sc1
  global_load_dwordx4 v[152:155], v159, s[10:11] offset:3072 sc1
  v_smfmac_f32_16x16x64_bf16 v[40:43], v[12:15], v[52:59], v3
  ds_read_b128 v[52:55], v5 offset:0
  ds_read_b128 v[56:59], v5 offset:1024
  v_mov_b64 v[44:45], 0
  v_smfmac_f32_16x16x64_bf16 v[40:43], v[28:31], v[84:91], v3
  ds_read_b128 v[84:87], v5 offset:8192
  ds_read_b128 v[88:91], v5 offset:9216
  v_mov_b64 v[46:47], 0
  s_waitcnt lgkmcnt(8)
  v_smfmac_f32_16x16x64_bf16 v[40:43], v[16:19], v[60:67], v3
  ds_read_b128 v[60:63], v5 offset:2048
  ds_read_b128 v[64:67], v5 offset:3072
  s_waitcnt lgkmcnt(9)
  v_smfmac_f32_16x16x64_bf16 v[40:43], v[20:23], v[68:75], v3
  ds_read_b128 v[68:71], v5 offset:4096
  ds_read_b128 v[72:75], v5 offset:5120
  s_waitcnt lgkmcnt(10)
  v_smfmac_f32_16x16x64_bf16 v[40:43], v[24:27], v[76:83], v3
  ds_read_b128 v[76:79], v5 offset:6144
  ds_read_b128 v[80:83], v5 offset:7168
  s_waitcnt lgkmcnt(11)
  v_smfmac_f32_16x16x64_bf16 v[40:43], v[32:35], v[92:99], v3
  ds_read_b128 v[92:95], v5 offset:10240
  ds_read_b128 v[96:99], v5 offset:11264
  s_waitcnt lgkmcnt(12)
  v_smfmac_f32_16x16x64_bf16 v[40:43], v[36:39], v[100:107], v3
  ds_read_b128 v[100:103], v5 offset:12288
  ds_read_b128 v[104:107], v5 offset:13312
  s_waitcnt lgkmcnt(12)
  v_smfmac_f32_16x16x64_bf16 v[44:47], v[12:15], v[52:59], v3
  v_mov_b64 v[48:49], 0
  s_waitcnt lgkmcnt(8)
  v_smfmac_f32_16x16x64_bf16 v[44:47], v[16:19], v[60:67], v3
  v_mov_b64 v[50:51], 0
  s_waitcnt lgkmcnt(6)
  v_smfmac_f32_16x16x64_bf16 v[44:47], v[20:23], v[68:75], v3
  s_waitcnt lgkmcnt(4)
  v_smfmac_f32_16x16x64_bf16 v[44:47], v[24:27], v[76:83], v3
  v_cvt_pk_bf16_f32 v108, v40, v41
  v_smfmac_f32_16x16x64_bf16 v[44:47], v[28:31], v[84:91], v3
  v_cvt_pk_bf16_f32 v109, v42, v43
  s_waitcnt lgkmcnt(2)
  v_smfmac_f32_16x16x64_bf16 v[44:47], v[32:35], v[92:99], v3
  s_waitcnt lgkmcnt(0)
  v_smfmac_f32_16x16x64_bf16 v[44:47], v[36:39], v[100:107], v3
  v_smfmac_f32_16x16x64_bf16 v[48:51], v[12:15], a[0:7], v3
  v_mov_b64 v[40:41], 0
  v_smfmac_f32_16x16x64_bf16 v[48:51], v[16:19], a[8:15], v3
  v_mov_b64 v[42:43], 0
  v_smfmac_f32_16x16x64_bf16 v[48:51], v[20:23], a[16:23], v3
  v_smfmac_f32_16x16x64_bf16 v[48:51], v[24:27], a[24:31], v3
  v_cvt_pk_bf16_f32 v116, v44, v45
  v_smfmac_f32_16x16x64_bf16 v[48:51], v[28:31], a[32:39], v3
  v_cvt_pk_bf16_f32 v117, v46, v47
  v_smfmac_f32_16x16x64_bf16 v[48:51], v[32:35], a[40:47], v3
  v_smfmac_f32_16x16x64_bf16 v[48:51], v[36:39], a[48:55], v3
  v_smfmac_f32_16x16x64_bf16 v[40:43], v[12:15], a[56:63], v3
  v_mov_b64 v[44:45], 0
  v_smfmac_f32_16x16x64_bf16 v[40:43], v[16:19], a[64:71], v3
  v_mov_b64 v[46:47], 0
  v_smfmac_f32_16x16x64_bf16 v[40:43], v[20:23], a[72:79], v3
  v_smfmac_f32_16x16x64_bf16 v[40:43], v[24:27], a[80:87], v3
  v_cvt_pk_bf16_f32 v110, v48, v49
  v_smfmac_f32_16x16x64_bf16 v[40:43], v[28:31], a[88:95], v3
  v_cvt_pk_bf16_f32 v111, v50, v51
  v_smfmac_f32_16x16x64_bf16 v[40:43], v[32:35], a[96:103], v3
  v_smfmac_f32_16x16x64_bf16 v[40:43], v[36:39], a[104:111], v3
  v_smfmac_f32_16x16x64_bf16 v[44:47], v[12:15], a[112:119], v3
  v_mov_b64 v[48:49], 0
  v_smfmac_f32_16x16x64_bf16 v[44:47], v[16:19], a[120:127], v3
  v_mov_b64 v[50:51], 0
  v_smfmac_f32_16x16x64_bf16 v[44:47], v[20:23], a[128:135], v3
  v_smfmac_f32_16x16x64_bf16 v[44:47], v[24:27], a[136:143], v3
  v_cvt_pk_bf16_f32 v118, v40, v41
  v_smfmac_f32_16x16x64_bf16 v[44:47], v[28:31], a[144:151], v3
  v_cvt_pk_bf16_f32 v119, v42, v43
  v_smfmac_f32_16x16x64_bf16 v[44:47], v[32:35], a[152:159], v3
  v_smfmac_f32_16x16x64_bf16 v[44:47], v[36:39], a[160:167], v3
  v_smfmac_f32_16x16x64_bf16 v[48:51], v[12:15], a[168:175], v3
  v_mov_b64 v[40:41], 0
  v_smfmac_f32_16x16x64_bf16 v[48:51], v[16:19], a[176:183], v3
  v_mov_b64 v[42:43], 0
  v_smfmac_f32_16x16x64_bf16 v[48:51], v[20:23], a[184:191], v3
  v_smfmac_f32_16x16x64_bf16 v[48:51], v[24:27], a[192:199], v3
  v_cvt_pk_bf16_f32 v112, v44, v45
  v_smfmac_f32_16x16x64_bf16 v[48:51], v[28:31], a[200:207], v3
  v_cvt_pk_bf16_f32 v113, v46, v47
  v_smfmac_f32_16x16x64_bf16 v[48:51], v[32:35], a[208:215], v3
  v_smfmac_f32_16x16x64_bf16 v[48:51], v[36:39], a[216:223], v3
  v_smfmac_f32_16x16x64_bf16 v[40:43], v[12:15], a[224:231], v3
  v_mov_b64 v[44:45], 0
  v_smfmac_f32_16x16x64_bf16 v[40:43], v[16:19], a[232:239], v3
  v_mov_b64 v[46:47], 0
  v_smfmac_f32_16x16x64_bf16 v[40:43], v[20:23], a[240:247], v3
  v_smfmac_f32_16x16x64_bf16 v[40:43], v[24:27], a[248:255], v3
  v_cvt_pk_bf16_f32 v120, v48, v49
  v_smfmac_f32_16x16x64_bf16 v[40:43], v[28:31], v[176:183], v3
  v_cvt_pk_bf16_f32 v121, v50, v51
  v_smfmac_f32_16x16x64_bf16 v[40:43], v[32:35], v[184:191], v3
  v_smfmac_f32_16x16x64_bf16 v[40:43], v[36:39], v[192:199], v3
  v_smfmac_f32_16x16x64_bf16 v[44:47], v[12:15], v[200:207], v3
  v_smfmac_f32_16x16x64_bf16 v[44:47], v[16:19], v[208:215], v3
  v_smfmac_f32_16x16x64_bf16 v[44:47], v[20:23], v[216:223], v3
  v_smfmac_f32_16x16x64_bf16 v[44:47], v[24:27], v[224:231], v3
  v_cvt_pk_bf16_f32 v114, v40, v41
  v_smfmac_f32_16x16x64_bf16 v[44:47], v[28:31], v[232:239], v3
  v_cvt_pk_bf16_f32 v115, v42, v43
  v_smfmac_f32_16x16x64_bf16 v[44:47], v[32:35], v[240:247], v3
  v_smfmac_f32_16x16x64_bf16 v[44:47], v[36:39], v[248:255], v3
  s_nop 3
  v_mov_b64 v[12:13], 0
  v_mov_b64 v[14:15], 0
  v_mov_b64 v[16:17], 0
  v_mov_b64 v[18:19], 0
  v_cvt_pk_bf16_f32 v122, v44, v45
  v_cvt_pk_bf16_f32 v123, v46, v47
  s_mov_b64 exec, 0xf
  global_load_dword v169, v164, s[14:15] sc1
  s_nop 15
  s_nop 4
  global_load_dword v170, v164, s[14:15] sc1
  s_nop 15
  s_nop 4
b_vw0_bell1:
  global_load_dword v171, v164, s[14:15] sc1
  s_waitcnt vmcnt(2)
  v_cmp_eq_u32 vcc, -1, v169
  s_cbranch_vccz b_vw0_bell1_ok
  global_load_dword v169, v164, s[14:15] sc1
  s_waitcnt vmcnt(2)
  v_cmp_eq_u32 vcc, -1, v170
  s_cbranch_vccz b_vw0_bell1_ok
  global_load_dword v170, v164, s[14:15] sc1
  s_waitcnt vmcnt(2)
  v_cmp_eq_u32 vcc, -1, v171
  s_sub_u32 s25, s25, 1
  s_cbranch_scc1 b_fail
  s_cbranch_vccz b_vw0_bell1_ok
  s_branch b_vw0_bell1
b_vw0_bell1_ok:
  s_mov_b64 exec, -1
b_vw0_pollp:
  global_load_dwordx4 v[48:51], v161, s[14:15] sc1
  global_load_dwordx4 v[40:43], v160, s[14:15] sc1
  global_load_dwordx4 v[44:47], v160, s[14:15] offset:1024 sc1
  s_sub_u32 s25, s25, 1
  s_cbranch_scc1 b_fail
  s_waitcnt vmcnt(2)
  v_smfmac_f32_16x16x64_bf16 v[12:15], v[48:51], v[108:115], v3
  v_max3_u32 v8, v48, v49, v50
  v_smfmac_f32_16x16x64_bf16 v[16:19], v[48:51], v[116:123], v3
  s_waitcnt vmcnt(1)
  v_smfmac_f32_16x16x64_bf16 v[12:15], v[40:43], v[124:131], v3
  v_max3_u32 v8, v8, v51, v40
  v_smfmac_f32_16x16x64_bf16 v[16:19], v[40:43], v[132:139], v3
  v_max3_u32 v8, v8, v41, v42
  s_waitcnt vmcnt(0)
  v_smfmac_f32_16x16x64_bf16 v[12:15], v[44:47], v[140:147], v3
  v_max3_u32 v8, v8, v43, v44
  v_smfmac_f32_16x16x64_bf16 v[16:19], v[44:47], v[148:155], v3
  v_max3_u32 v8, v8, v45, v46
  v_max_u32 v8, v8, v47
  v_cmp_eq_u32 vcc, -1, v8
  s_nop 3
  ds_write_b128 v156, v[12:15]
  s_nop 0
  ds_write_b128 v156, v[16:19] offset:1024
  s_cbranch_vccnz b_vw0_pollp_retry
  s_waitcnt lgkmcnt(0)
  s_barrier
  s_mov_b64 exec, 0xff
  global_store_dword v166, v1, s[12:13]
  s_mov_b64 exec, -1
  ds_read2st64_b32 v[20:21], v157 offset0:0 offset1:2
  ds_read2st64_b32 v[22:23], v157 offset0:8 offset1:10
  ds_read2st64_b32 v[24:25], v157 offset0:16 offset1:18
  ds_read2st64_b32 v[26:27], v157 offset0:24 offset1:26
  s_waitcnt lgkmcnt(0)
  v_pk_add_f32 v[20:21], v[20:21], v[22:23]
  v_pk_add_f32 v[24:25], v[24:25], v[26:27]
  v_pk_add_f32 v[20:21], v[20:21], v[24:25]
  v_add_f32 v20, v20, v21
  s_nop 1
  v_mov_b32_dpp v21, v20 quad_perm:[1,0,3,2] row_mask:0xf bank_mask:0xf
  v_cvt_pk_bf16_f32 v22, v20, v21
  s_mov_b64 exec, s[32:33]
  global_store_dword v158, v22, s[12:13]
  s_mov_b64 exec, -1
  s_cmp_lg_u32 s24, 62
  s_cbranch_scc1 b_vw0_nolast
  s_mov_b64 exec, s[32:33]
  global_store_dword v167, v22, s[52:53] sc1
  global_store_dword v163, v22, s[18:19] sc1
  s_mov_b64 exec, -1
b_vw0_nolast:
  ds_read_b128 v[52:55], v4 offset:0
  ds_read_b128 v[56:59], v4 offset:1024
  ds_read_b128 v[60:63], v4 offset:2048
  ds_read_b128 v[64:67], v4 offset:3072
  ds_read_b128 v[68:71], v4 offset:4096
  ds_read_b128 v[72:75], v4 offset:5120
  ds_read_b128 v[76:79], v4 offset:6144
  ds_read_b128 v[80:83], v4 offset:7168
  ds_read_b128 v[84:87], v4 offset:8192
  ds_read_b128 v[88:91], v4 offset:9216
  ds_read_b128 v[92:95], v4 offset:10240
  ds_read_b128 v[96:99], v4 offset:11264
  ds_read_b128 v[100:103], v4 offset:12288
  ds_read_b128 v[104:107], v4 offset:13312
  v_mov_b64 v[40:41], 0
  v_mov_b64 v[42:43], 0
  s_add_u32 s12, s12, 16384
  s_addc_u32 s13, s13, 0
  s_add_u32 s14, s14, 12288
  s_addc_u32 s15, s15, 0
  s_add_u32 s10, s10, 458752
  s_addc_u32 s11, s11, 0
  s_add_u32 s24, s24, 1
  s_cmp_lt_u32 s24, 63
  s_waitcnt lgkmcnt(0)
  s_cbranch_scc1 b_vw0_step
  s_endpgm
b_vw0_pollp_retry:
  s_nop 7
  v_mov_b64 v[12:13], 0
  v_mov_b64 v[14:15], 0
  v_mov_b64 v[16:17], 0
  v_mov_b64 v[18:19], 0
  s_branch b_vw0_pollp
b_vw1:
  v_add_u32 v4, 1605632, v2
  global_load_dwordx4 v[52:55], v4, s[6:7]
  v_add_u32 v4, 1606656, v2
  global_load_dwordx4 v[56:59], v4, s[6:7]
  v_add_u32 v4, 1607680, v2
  global_load_dwordx4 v[60:63], v4, s[6:7]
  v_add_u32 v4, 1608704, v2
  global_load_dwordx4 v[64:67], v4, s[6:7]
  v_add_u32 v4, 1609728, v2
  global_load_dwordx4 v[68:71], v4, s[6:7]
  v_add_u32 v4, 1610752, v2
  global_load_dwordx4 v[72:75], v4, s[6:7]
  v_add_u32 v4, 1611776, v2
  global_load_dwordx4 v[76:79], v4, s[6:7]
  v_add_u32 v4, 1612800, v2
  global_load_dwordx4 v[80:83], v4, s[6:7]
  v_add_u32 v4, 1613824, v2
  global_load_dwordx4 v[84:87], v4, s[6:7]
  v_add_u32 v4, 1614848, v2
  global_load_dwordx4 v[88:91], v4, s[6:7]
  v_add_u32 v4, 1615872, v2
  global_load_dwordx4 v[92:95], v4, s[6:7]
  v_add_u32 v4, 1616896, v2
  global_load_dwordx4 v[96:99], v4, s[6:7]
  v_add_u32 v4, 1617920, v2
  global_load_dwordx4 v[100:103], v4, s[6:7]
  v_add_u32 v4, 1618944, v2
  global_load_dwordx4 v[104:107], v4, s[6:7]
  v_add_u32 v5, 45056, v2
  s_waitcnt vmcnt(0)
  ds_write_b128 v5, v[52:55] offset:0
  ds_write_b128 v5, v[56:59] offset:1024
  ds_write_b128 v5, v[60:63] offset:2048
  ds_write_b128 v5, v[64:67] offset:3072
  ds_write_b128 v5, v[68:71] offset:4096
  ds_write_b128 v5, v[72:75] offset:5120
  ds_write_b128 v5, v[76:79] offset:6144
  ds_write_b128 v5, v[80:83] offset:7168
  ds_write_b128 v5, v[84:87] offset:8192
  ds_write_b128 v5, v[88:91] offset:9216
  ds_write_b128 v5, v[92:95] offset:10240
  ds_write_b128 v5, v[96:99] offset:11264
  ds_write_b128 v5, v[100:103] offset:12288
  ds_write_b128 v5, v[104:107] offset:13312
  s_waitcnt lgkmcnt(0)
  v_add_u32 v4, 1619968, v2
  global_load_dwordx4 v[52:55], v4, s[6:7]
  v_add_u32 v4, 1620992, v2
  global_load_dwordx4 v[56:59], v4, s[6:7]
  v_add_u32 v4, 1622016, v2
  global_load_dwordx4 v[60:63], v4, s[6:7]
  v_add_u32 v4, 1623040, v2
  global_load_dwordx4 v[64:67], v4, s[6:7]
  v_add_u32 v4, 1624064, v2
  global_load_dwordx4 v[68:71], v4, s[6:7]
  v_add_u32 v4, 1625088, v2
  global_load_dwordx4 v[72:75], v4, s[6:7]
  v_add_u32 v4, 1626112, v2
  global_load_dwordx4 v[76:79], v4, s[6:7]
  v_add_u32 v4, 1627136, v2
  global_load_dwordx4 v[80:83], v4, s[6:7]
  v_add_u32 v4, 1628160, v2
  global_load_dwordx4 v[84:87], v4, s[6:7]
  v_add_u32 v4, 1629184, v2
  global_load_dwordx4 v[88:91], v4, s[6:7]
  v_add_u32 v4, 1630208, v2
  global_load_dwordx4 v[92:95], v4, s[6:7]
  v_add_u32 v4, 1631232, v2
  global_load_dwordx4 v[96:99], v4, s[6:7]
  v_add_u32 v4, 1632256, v2
  global_load_dwordx4 v[100:103], v4, s[6:7]
  v_add_u32 v4, 1633280, v2
  global_load_dwordx4 v[104:107], v4, s[6:7]
  v_add_u32 v5, 59392, v2
  s_waitcnt vmcnt(0)
  ds_write_b128 v5, v[52:55] offset:0
  ds_write_b128 v5, v[56:59] offset:1024
  ds_write_b128 v5, v[60:63] offset:2048
  ds_write_b128 v5, v[64:67] offset:3072
  ds_write_b128 v5, v[68:71] offset:4096
  ds_write_b128 v5, v[72:75] offset:5120
  ds_write_b128 v5, v[76:79] offset:6144
  ds_write_b128 v5, v[80:83] offset:7168
  ds_write_b128 v5, v[84:87] offset:8192
  ds_write_b128 v5, v[88:91] offset:9216
  ds_write_b128 v5, v[92:95] offset:10240
  ds_write_b128 v5, v[96:99] offset:11264
  ds_write_b128 v5, v[100:103] offset:12288
  ds_write_b128 v5, v[104:107] offset:13312
  s_waitcnt lgkmcnt(0)
  v_add_u32 v4, 2007040, v2
  global_load_dwordx4 a[0:3], v4, s[6:7]
  global_load_dwordx4 a[4:7], v4, s[6:7] offset:1024
  v_add_u32 v4, 2009088, v2
  global_load_dwordx4 a[8:11], v4, s[6:7]
  global_load_dwordx4 a[12:15], v4, s[6:7] offset:1024
  v_add_u32 v4, 2011136, v2
  global_load_dwordx4 a[16:19], v4, s[6:7]
  global_load_dwordx4 a[20:23], v4, s[6:7] offset:1024
  v_add_u32 v4, 2013184, v2
  global_load_dwordx4 a[24:27], v4, s[6:7]
  global_load_dwordx4 a[28:31], v4, s[6:7] offset:1024
  v_add_u32 v4, 2015232, v2
  global_load_dwordx4 a[32:35], v4, s[6:7]
  global_load_dwordx4 a[36:39], v4, s[6:7] offset:1024
  v_add_u32 v4, 2017280, v2
  global_load_dwordx4 a[40:43], v4, s[6:7]
  global_load_dwordx4 a[44:47], v4, s[6:7] offset:1024
  v_add_u32 v4, 2019328, v2
  global_load_dwordx4 a[48:51], v4, s[6:7]
  global_load_dwordx4 a[52:55], v4, s[6:7] offset:1024
  v_add_u32 v4, 2021376, v2
  global_load_dwordx4 a[56:59], v4, s[6:7]
  global_load_dwordx4 a[60:63], v4, s[6:7] offset:1024
  v_add_u32 v4, 2023424, v2
  global_load_dwordx4 a[64:67], v4, s[6:7]
  global_load_dwordx4 a[68:71], v4, s[6:7] offset:1024
  v_add_u32 v4, 2025472, v2
  global_load_dwordx4 a[72:75], v4, s[6:7]
  global_load_dwordx4 a[76:79], v4, s[6:7] offset:1024
  v_add_u32 v4, 2027520, v2
  global_load_dwordx4 a[80:83], v4, s[6:7]
  global_load_dwordx4 a[84:87], v4, s[6:7] offset:1024
  v_add_u32 v4, 2029568, v2
  global_load_dwordx4 a[88:91], v4, s[6:7]
  global_load_dwordx4 a[92:95], v4, s[6:7] offset:1024
  v_add_u32 v4, 2031616, v2
  global_load_dwordx4 a[96:99], v4, s[6:7]
  global_load_dwordx4 a[100:103], v4, s[6:7] offset:1024
  v_add_u32 v4, 2033664, v2
  global_load_dwordx4 a[104:107], v4, s[6:7]
  global_load_dwordx4 a[108:111], v4, s[6:7] offset:1024
  v_add_u32 v4, 2408448, v2
  global_load_dwordx4 a[112:115], v4, s[6:7]
  global_load_dwordx4 a[116:119], v4, s[6:7] offset:1024
  v_add_u32 v4, 2410496, v2
  global_load_dwordx4 a[120:123], v4, s[6:7]
  global_load_dwordx4 a[124:127], v4, s[6:7] offset:1024
  s_waitcnt vmcnt(32)
  v_add_u32 v4, 2412544, v2
  global_load_dwordx4 a[128:131], v4, s[6:7]
  global_load_dwordx4 a[132:135], v4, s[6:7] offset:1024
  v_add_u32 v4, 2414592, v2
  global_load_dwordx4 a[136:139], v4, s[6:7]
  global_load_dwordx4 a[140:143], v4, s[6:7] offset:1024
  v_add_u32 v4, 2416640, v2
  global_load_dwordx4 a[144:147], v4, s[6:7]
  global_load_dwordx4 a[148:151], v4, s[6:7] offset:1024
  v_add_u32 v4, 2418688, v2
  global_load_dwordx4 a[152:155], v4, s[6:7]
  global_load_dwordx4 a[156:159], v4, s[6:7] offset:1024
  v_add_u32 v4, 2420736, v2
  global_load_dwordx4 a[160:163], v4, s[6:7]
  global_load_dwordx4 a[164:167], v4, s[6:7] offset:1024
  v_add_u32 v4, 2422784, v2
  global_load_dwordx4 a[168:171], v4, s[6:7]
  global_load_dwordx4 a[172:175], v4, s[6:7] offset:1024
  v_add_u32 v4, 2424832, v2
  global_load_dwordx4 a[176:179], v4, s[6:7]
  global_load_dwordx4 a[180:183], v4, s[6:7] offset:1024
  v_add_u32 v4, 2426880, v2
  global_load_dwordx4 a[184:187], v4, s[6:7]
  global_load_dwordx4 a[188:191], v4, s[6:7] offset:1024
  v_add_u32 v4, 2428928, v2
  global_load_dwordx4 a[192:195], v4, s[6:7]
  global_load_dwordx4 a[196:199], v4, s[6:7] offset:1024
  v_add_u32 v4, 2430976, v2
  global_load_dwordx4 a[200:203], v4, s[6:7]
  global_load_dwordx4 a[204:207], v4, s[6:7] offset:1024
  v_add_u32 v4, 2433024, v2
  global_load_dwordx4 a[208:211], v4, s[6:7]
  global_load_dwordx4 a[212:215], v4, s[6:7] offset:1024
  v_add_u32 v4, 2435072, v2
  global_load_dwordx4 a[216:219], v4, s[6:7]
  global_load_dwordx4 a[220:223], v4, s[6:7] offset:1024
  v_add_u32 v4, 2809856, v2
  global_load_dwordx4 a[224:227], v4, s[6:7]
  global_load_dwordx4 a[228:231], v4, s[6:7] offset:1024
  v_add_u32 v4, 2811904, v2
  global_load_dwordx4 a[232:235], v4, s[6:7]
  global_load_dwordx4 a[236:239], v4, s[6:7] offset:1024
  v_add_u32 v4, 2813952, v2
  global_load_dwordx4 a[240:243], v4, s[6:7]
  global_load_dwordx4 a[244:247], v4, s[6:7] offset:1024
  v_add_u32 v4, 2816000, v2
  global_load_dwordx4 a[248:251], v4, s[6:7]
  global_load_dwordx4 a[252:255], v4, s[6:7] offset:1024
  s_waitcnt vmcnt(32)
  v_add_u32 v4, 2818048, v2
  global_load_dwordx4 v[176:179], v4, s[6:7]
  global_load_dwordx4 v[180:183], v4, s[6:7] offset:1024
  v_add_u32 v4, 2820096, v2
  global_load_dwordx4 v[184:187], v4, s[6:7]
  global_load_dwordx4 v[188:191], v4, s[6:7] offset:1024
  v_add_u32 v4, 2822144, v2
  global_load_dwordx4 v[192:195], v4, s[6:7]
  global_load_dwordx4 v[196:199], v4, s[6:7] offset:1024
  v_add_u32 v4, 2824192, v2
  global_load_dwordx4 v[200:203], v4, s[6:7]
  global_load_dwordx4 v[204:207], v4, s[6:7] offset:1024
  v_add_u32 v4, 2826240, v2
  global_load_dwordx4 v[208:211], v4, s[6:7]
  global_load_dwordx4 v[212:215], v4, s[6:7] offset:1024
  v_add_u32 v4, 2828288, v2
  global_load_dwordx4 v[216:219], v4, s[6:7]
  global_load_dwordx4 v[220:223], v4, s[6:7] offset:1024
  v_add_u32 v4, 2830336, v2
  global_load_dwordx4 v[224:227], v4, s[6:7]
  global_load_dwordx4 v[228:231], v4, s[6:7] offset:1024
  v_add_u32 v4, 2832384, v2
  global_load_dwordx4 v[232:235], v4, s[6:7]
  global_load_dwordx4 v[236:239], v4, s[6:7] offset:1024
  v_add_u32 v4, 2834432, v2
  global_load_dwordx4 v[240:243], v4, s[6:7]
  global_load_dwordx4 v[244:247], v4, s[6:7] offset:1024
  v_add_u32 v4, 2836480, v2
  global_load_dwordx4 v[248:251], v4, s[6:7]
  global_load_dwordx4 v[252:255], v4, s[6:7] offset:1024
  s_waitcnt vmcnt(0)
  v_add_u32 v4, 45056, v2
  v_add_u32 v5, 59392, v2
  v_add_u32 v156, 10240, v2
  v_lshrrev_b32 v8, 3, v1
  v_and_b32 v9, 7, v1
  v_lshrrev_b32 v10, 1, v9
  v_lshlrev_b32 v10, 2, v10
  v_and_b32 v9, 1, v9
  v_add_u32 v10, v10, v9
  v_add_u32 v10, 2, v10
  s_sub_u32 s26, s22, 16
  s_lshl_b32 s27, s26, 6
  s_add_u32 s27, s27, 516096
  v_mul_u32_u24 v163, 896, v8
  v_lshl_add_u32 v163, v10, 1, v163
  v_add_u32 v163, s27, v163
  v_lshrrev_b32 v11, 2, v8
  v_lshl_add_u32 v10, v11, 4, v10
  v_lshlrev_b32 v10, 4, v10
  v_and_b32 v8, 3, v8
  v_lshl_add_u32 v157, v8, 2, v10
  v_add_u32 v157, 8192, v157
  s_lshr_b32 s27, s26, 1
  s_lshl_b32 s27, s27, 10
  s_and_b32 s28, s26, 1
  s_lshl_b32 s28, s28, 9
  s_add_u32 s27, s27, s28
  s_add_u32 s27, s27, 13440
  v_lshl_add_u32 v158, v1, 1, s27
  v_add_u32 v167, 502784, v158
  s_lshl_b32 s27, s26, 15
  s_add_u32 s27, s27, 12288
  v_add_u32 v159, s27, v2
  v_add_u32 v160, 2048, v2
  v_lshrrev_b32 v8, 5, v1
  v_lshlrev_b32 v8, 8, v8
  v_and_b32 v9, 15, v1
  v_lshl_add_u32 v161, v9, 4, v8
  v_add_u32 v161, 8704, v161
  s_and_b32 s27, s26, 3
  s_lshl_b32 s27, s27, 7
  s_add_u32 s27, s27, 10752
  v_and_b32 v8, 3, v1
  v_lshl_add_u32 v164, v8, 2, s27
  v_min_u32 v165, 56, v1
  v_lshlrev_b32 v165, 2, v165
  s_and_b32 s26, s22, 7
  s_lshl_b32 s26, s26, 8
  s_add_u32 s26, s26, 5120
  v_add_u32 v165, s26, v165
  s_sub_u32 s26, s22, 16
  s_lshl_b32 s27, s26, 4
  s_add_u32 s27, s27, 21508
  v_and_b32 v8, 7, v1
  v_lshlrev_b32 v8, 8, v8
  v_add_u32 v166, s27, v8
  s_mov_b32 s32, 0x55555555
  s_mov_b32 s33, 0x55555555
  ds_read_b128 v[52:55], v4 offset:0
  ds_read_b128 v[56:59], v4 offset:1024
  ds_read_b128 v[60:63], v4 offset:2048
  ds_read_b128 v[64:67], v4 offset:3072
  ds_read_b128 v[68:71], v4 offset:4096
  ds_read_b128 v[72:75], v4 offset:5120
  ds_read_b128 v[76:79], v4 offset:6144
  ds_read_b128 v[80:83], v4 offset:7168
  ds_read_b128 v[84:87], v4 offset:8192
  ds_read_b128 v[88:91], v4 offset:9216
  ds_read_b128 v[92:95], v4 offset:10240
  ds_read_b128 v[96:99], v4 offset:11264
  ds_read_b128 v[100:103], v4 offset:12288
  ds_read_b128 v[104:107], v4 offset:13312
  v_mov_b64 v[40:41], 0
  v_mov_b64 v[42:43], 0
  s_waitcnt lgkmcnt(0)
  s_barrier
b_vw1_step:
  s_mov_b64 exec, s[56:57]
  global_load_dword v169, v165, s[12:13] sc1
  s_nop 15
  s_nop 4
  global_load_dword v170, v165, s[12:13] sc1
  s_nop 15
  s_nop 4
b_vw1_bell2:
  global_load_dword v171, v165, s[12:13] sc1
  s_waitcnt vmcnt(2)
  v_cmp_eq_u32 vcc, -1, v169
  s_cbranch_vccz b_vw1_bell2_ok
  global_load_dword v169, v165, s[12:13] sc1
  s_waitcnt vmcnt(2)
  v_cmp_eq_u32 vcc, -1, v170
  s_cbranch_vccz b_vw1_bell2_ok
  global_load_dword v170, v165, s[12:13] sc1
  s_waitcnt vmcnt(2)
  v_cmp_eq_u32 vcc, -1, v171
  s_sub_u32 s25, s25, 1
  s_cbranch_scc1 b_fail
  s_cbranch_vccz b_vw1_bell2_ok
  s_branch b_vw1_bell2
b_vw1_bell2_ok:
  s_mov_b64 exec, -1
b_vw1_poll:
  global_load_dwordx4 v[16:19], v2, s[12:13] offset:-2048 sc1
  global_load_dwordx4 v[32:35], v2, s[12:13] offset:2048 sc1
  s_sub_u32 s25, s25, 1
  s_cbranch_scc1 b_fail
  s_waitcnt vmcnt(0)
  v_max3_u32 v8, v16, v17, v18
  v_max3_u32 v8, v8, v19, v32
  v_max3_u32 v8, v8, v33, v34
  v_max_u32 v8, v8, v35
  v_cmp_eq_u32 vcc, -1, v8
  s_cbranch_vccnz b_vw1_poll
  ds_write_b128 v2, v[16:19] offset:1024
  ds_write_b128 v2, v[32:35] offset:5120
  s_waitcnt lgkmcnt(0)
  s_barrier
  ds_read_b128 v[12:15], v2 offset:0
  ds_read_b128 v[20:23], v2 offset:2048
  ds_read_b128 v[24:27], v2 offset:3072
  ds_read_b128 v[28:31], v2 offset:4096
  ds_read_b128 v[36:39], v2 offset:6144
  global_load_dwordx4 v[124:127], v159, s[10:11] offset:-4096 sc1
  global_load_dwordx4 v[128:131], v159, s[10:11] offset:-3072 sc1
  global_load_dwordx4 v[132:135], v159, s[10:11] offset:-2048 sc1
  global_load_dwordx4 v[136:139], v159, s[10:11] offset:-1024 sc1
  global_load_dwordx4 v[140:143], v159, s[10:11] offset:0 sc1
  global_load_dwordx4 v[144:147], v159, s[10:11] offset:1024 sc1
  global_load_dwordx4 v[148:151], v159, s[10:11] offset:2048 sc1
  global_load_dwordx4 v[152:155], v159, s[10:11] offset:3072 sc1
  v_smfmac_f32_16x16x64_bf16 v[40:43], v[16:19], v[60:67], v3
  ds_read_b128 v[60:63], v5 offset:2048
  ds_read_b128 v[64:67], v5 offset:3072
  v_mov_b64 v[44:45], 0
  v_smfmac_f32_16x16x64_bf16 v[40:43], v[32:35], v[92:99], v3
  ds_read_b128 v[92:95], v5 offset:10240
  ds_read_b128 v[96:99], v5 offset:11264
  v_mov_b64 v[46:47], 0
  s_waitcnt lgkmcnt(8)
  v_smfmac_f32_16x16x64_bf16 v[40:43], v[12:15], v[52:59], v3
  ds_read_b128 v[52:55], v5 offset:0
  ds_read_b128 v[56:59], v5 offset:1024
  s_waitcnt lgkmcnt(9)
  v_smfmac_f32_16x16x64_bf16 v[40:43], v[20:23], v[68:75], v3
  ds_read_b128 v[68:71], v5 offset:4096
  ds_read_b128 v[72:75], v5 offset:5120
  s_waitcnt lgkmcnt(10)
  v_smfmac_f32_16x16x64_bf16 v[40:43], v[24:27], v[76:83], v3
  ds_read_b128 v[76:79], v5 offset:6144
  ds_read_b128 v[80:83], v5 offset:7168
  s_waitcnt lgkmcnt(11)
  v_smfmac_f32_16x16x64_bf16 v[40:43], v[28:31], v[84:91], v3
  ds_read_b128 v[84:87], v5 offset:8192
  ds_read_b128 v[88:91], v5 offset:9216
  s_waitcnt lgkmcnt(12)
  v_smfmac_f32_16x16x64_bf16 v[40:43], v[36:39], v[100:107], v3
  ds_read_b128 v[100:103], v5 offset:12288
  ds_read_b128 v[104:107], v5 offset:13312
  s_waitcnt lgkmcnt(8)
  v_smfmac_f32_16x16x64_bf16 v[44:47], v[12:15], v[52:59], v3
  v_mov_b64 v[48:49], 0
  v_smfmac_f32_16x16x64_bf16 v[44:47], v[16:19], v[60:67], v3
  v_mov_b64 v[50:51], 0
  s_waitcnt lgkmcnt(6)
  v_smfmac_f32_16x16x64_bf16 v[44:47], v[20:23], v[68:75], v3
  s_waitcnt lgkmcnt(4)
  v_smfmac_f32_16x16x64_bf16 v[44:47], v[24:27], v[76:83], v3
  v_cvt_pk_bf16_f32 v108, v40, v41
  s_waitcnt lgkmcnt(2)
  v_smfmac_f32_16x16x64_bf16 v[44:47], v[28:31], v[84:91], v3
  v_cvt_pk_bf16_f32 v109, v42, v43
  v_smfmac_f32_16x16x64_bf16 v[44:47], v[32:35], v[92:99], v3
  s_waitcnt lgkmcnt(0)
  v_smfmac_f32_16x16x64_bf16 v[44:47], v[36:39], v[100:107], v3
  v_smfmac_f32_16x16x64_bf16 v[48:51], v[12:15], a[0:7], v3
  v_mov_b64 v[40:41], 0
  v_smfmac_f32_16x16x64_bf16 v[48:51], v[16:19], a[8:15], v3
  v_mov_b64 v[42:43], 0
  v_smfmac_f32_16x16x64_bf16 v[48:51], v[20:23], a[16:23], v3
  v_smfmac_f32_16x16x64_bf16 v[48:51], v[24:27], a[24:31], v3
  v_cvt_pk_bf16_f32 v116, v44, v45
  v_smfmac_f32_16x16x64_bf16 v[48:51], v[28:31], a[32:39], v3
  v_cvt_pk_bf16_f32 v117, v46, v47
  v_smfmac_f32_16x16x64_bf16 v[48:51], v[32:35], a[40:47], v3
  v_smfmac_f32_16x16x64_bf16 v[48:51], v[36:39], a[48:55], v3
  v_smfmac_f32_16x16x64_bf16 v[40:43], v[12:15], a[56:63], v3
  v_mov_b64 v[44:45], 0
  v_smfmac_f32_16x16x64_bf16 v[40:43], v[16:19], a[64:71], v3
  v_mov_b64 v[46:47], 0
  v_smfmac_f32_16x16x64_bf16 v[40:43], v[20:23], a[72:79], v3
  v_smfmac_f32_16x16x64_bf16 v[40:43], v[24:27], a[80:87], v3
  v_cvt_pk_bf16_f32 v110, v48, v49
  v_smfmac_f32_16x16x64_bf16 v[40:43], v[28:31], a[88:95], v3
  v_cvt_pk_bf16_f32 v111, v50, v51
  v_smfmac_f32_16x16x64_bf16 v[40:43], v[32:35], a[96:103], v3
  v_smfmac_f32_16x16x64_bf16 v[40:43], v[36:39], a[104:111], v3
  v_smfmac_f32_16x16x64_bf16 v[44:47], v[12:15], a[112:119], v3
  v_mov_b64 v[48:49], 0
  v_smfmac_f32_16x16x64_bf16 v[44:47], v[16:19], a[120:127], v3
  v_mov_b64 v[50:51], 0
  v_smfmac_f32_16x16x64_bf16 v[44:47], v[20:23], a[128:135], v3
  v_smfmac_f32_16x16x64_bf16 v[44:47], v[24:27], a[136:143], v3
  v_cvt_pk_bf16_f32 v118, v40, v41
  v_smfmac_f32_16x16x64_bf16 v[44:47], v[28:31], a[144:151], v3
  v_cvt_pk_bf16_f32 v119, v42, v43
  v_smfmac_f32_16x16x64_bf16 v[44:47], v[32:35], a[152:159], v3
  v_smfmac_f32_16x16x64_bf16 v[44:47], v[36:39], a[160:167], v3
  v_smfmac_f32_16x16x64_bf16 v[48:51], v[12:15], a[168:175], v3
  v_mov_b64 v[40:41], 0
  v_smfmac_f32_16x16x64_bf16 v[48:51], v[16:19], a[176:183], v3
  v_mov_b64 v[42:43], 0
  v_smfmac_f32_16x16x64_bf16 v[48:51], v[20:23], a[184:191], v3
  v_smfmac_f32_16x16x64_bf16 v[48:51], v[24:27], a[192:199], v3
  v_cvt_pk_bf16_f32 v112, v44, v45
  v_smfmac_f32_16x16x64_bf16 v[48:51], v[28:31], a[200:207], v3
  v_cvt_pk_bf16_f32 v113, v46, v47
  v_smfmac_f32_16x16x64_bf16 v[48:51], v[32:35], a[208:215], v3
  v_smfmac_f32_16x16x64_bf16 v[48:51], v[36:39], a[216:223], v3
  v_smfmac_f32_16x16x64_bf16 v[40:43], v[12:15], a[224:231], v3
  v_mov_b64 v[44:45], 0
  v_smfmac_f32_16x16x64_bf16 v[40:43], v[16:19], a[232:239], v3
  v_mov_b64 v[46:47], 0
  v_smfmac_f32_16x16x64_bf16 v[40:43], v[20:23], a[240:247], v3
  v_smfmac_f32_16x16x64_bf16 v[40:43], v[24:27], a[248:255], v3
  v_cvt_pk_bf16_f32 v120, v48, v49
  v_smfmac_f32_16x16x64_bf16 v[40:43], v[28:31], v[176:183], v3
  v_cvt_pk_bf16_f32 v121, v50, v51
  v_smfmac_f32_16x16x64_bf16 v[40:43], v[32:35], v[184:191], v3
  v_smfmac_f32_16x16x64_bf16 v[40:43], v[36:39], v[192:199], v3
  v_smfmac_f32_16x16x64_bf16 v[44:47], v[12:15], v[200:207], v3
  v_smfmac_f32_16x16x64_bf16 v[44:47], v[16:19], v[208:215], v3
  v_smfmac_f32_16x16x64_bf16 v[44:47], v[20:23], v[216:223], v3
  v_smfmac_f32_16x16x64_bf16 v[44:47], v[24:27], v[224:231], v3
  v_cvt_pk_bf16_f32 v114, v40, v41
  v_smfmac_f32_16x16x64_bf16 v[44:47], v[28:31], v[232:239], v3
  v_cvt_pk_bf16_f32 v115, v42, v43
  v_smfmac_f32_16x16x64_bf16 v[44:47], v[32:35], v[240:247], v3
  v_smfmac_f32_16x16x64_bf16 v[44:47], v[36:39], v[248:255], v3
  s_nop 3
  v_mov_b64 v[12:13], 0
  v_mov_b64 v[14:15], 0
  v_mov_b64 v[16:17], 0
  v_mov_b64 v[18:19], 0
  v_cvt_pk_bf16_f32 v122, v44, v45
  v_cvt_pk_bf16_f32 v123, v46, v47
  s_mov_b64 exec, 0xf
  global_load_dword v169, v164, s[14:15] sc1
  s_nop 15
  s_nop 4
  global_load_dword v170, v164, s[14:15] sc1
  s_nop 15
  s_nop 4
b_vw1_bell1:
  global_load_dword v171, v164, s[14:15] sc1
  s_waitcnt vmcnt(2)
  v_cmp_eq_u32 vcc, -1, v169
  s_cbranch_vccz b_vw1_bell1_ok
  global_load_dword v169, v164, s[14:15] sc1
  s_waitcnt vmcnt(2)
  v_cmp_eq_u32 vcc, -1, v170
  s_cbranch_vccz b_vw1_bell1_ok
  global_load_dword v170, v164, s[14:15] sc1
  s_waitcnt vmcnt(2)
  v_cmp_eq_u32 vcc, -1, v171
  s_sub_u32 s25, s25, 1
  s_cbranch_scc1 b_fail
  s_cbranch_vccz b_vw1_bell1_ok
  s_branch b_vw1_bell1
b_vw1_bell1_ok:
  s_mov_b64 exec, -1
b_vw1_pollp:
  global_load_dwordx4 v[48:51], v161, s[14:15] sc1
  global_load_dwordx4 v[40:43], v160, s[14:15] sc1
  global_load_dwordx4 v[44:47], v160, s[14:15] offset:1024 sc1
  s_sub_u32 s25, s25, 1
  s_cbranch_scc1 b_fail
  s_waitcnt vmcnt(2)
  v_smfmac_f32_16x16x64_bf16 v[12:15], v[48:51], v[108:115], v3
  v_max3_u32 v8, v48, v49, v50
  v_smfmac_f32_16x16x64_bf16 v[16:19], v[48:51], v[116:123], v3
  s_waitcnt vmcnt(1)
  v_smfmac_f32_16x16x64_bf16 v[12:15], v[40:43], v[124:131], v3
  v_max3_u32 v8, v8, v51, v40
  v_smfmac_f32_16x16x64_bf16 v[16:19], v[40:43], v[132:139], v3
  v_max3_u32 v8, v8, v41, v42
  s_waitcnt vmcnt(0)
  v_smfmac_f32_16x16x64_bf16 v[12:15], v[44:47], v[140:147], v3
  v_max3_u32 v8, v8, v43, v44
  v_smfmac_f32_16x16x64_bf16 v[16:19], v[44:47], v[148:155], v3
  v_max3_u32 v8, v8, v45, v46
  v_max_u32 v8, v8, v47
  v_cmp_eq_u32 vcc, -1, v8
  s_nop 3
  ds_write_b128 v156, v[12:15]
  s_nop 0
  ds_write_b128 v156, v[16:19] offset:1024
  s_cbranch_vccnz b_vw1_pollp_retry
  s_waitcnt lgkmcnt(0)
  s_barrier
  s_mov_b64 exec, 0xff
  global_store_dword v166, v1, s[12:13]
  s_mov_b64 exec, -1
  ds_read2st64_b32 v[20:21], v157 offset0:0 offset1:2
  ds_read2st64_b32 v[22:23], v157 offset0:8 offset1:10
  ds_read2st64_b32 v[24:25], v157 offset0:16 offset1:18
  ds_read2st64_b32 v[26:27], v157 offset0:24 offset1:26
  s_waitcnt lgkmcnt(0)
  v_pk_add_f32 v[20:21], v[20:21], v[22:23]
  v_pk_add_f32 v[24:25], v[24:25], v[26:27]
  v_pk_add_f32 v[20:21], v[20:21], v[24:25]
  v_add_f32 v20, v20, v21
  s_nop 1
  v_mov_b32_dpp v21, v20 quad_perm:[1,0,3,2] row_mask:0xf bank_mask:0xf
  v_cvt_pk_bf16_f32 v22, v20, v21
  s_mov_b64 exec, s[32:33]
  global_store_dword v158, v22, s[12:13]
  s_mov_b64 exec, -1
  s_cmp_lg_u32 s24, 62
  s_cbranch_scc1 b_vw1_nolast
  s_mov_b64 exec, s[32:33]
  global_store_dword v167, v22, s[52:53] sc1
  global_store_dword v163, v22, s[18:19] sc1
  s_mov_b64 exec, -1
b_vw1_nolast:
  ds_read_b128 v[52:55], v4 offset:0
  ds_read_b128 v[56:59], v4 offset:1024
  ds_read_b128 v[60:63], v4 offset:2048
  ds_read_b128 v[64:67], v4 offset:3072
  ds_read_b128 v[68:71], v4 offset:4096
  ds_read_b128 v[72:75], v4 offset:5120
  ds_read_b128 v[76:79], v4 offset:6144
  ds_read_b128 v[80:83], v4 offset:7168
  ds_read_b128 v[84:87], v4 offset:8192
  ds_read_b128 v[88:91], v4 offset:9216
  ds_read_b128 v[92:95], v4 offset:10240
  ds_read_b128 v[96:99], v4 offset:11264
  ds_read_b128 v[100:103], v4 offset:12288
  ds_read_b128 v[104:107], v4 offset:13312
  v_mov_b64 v[40:41], 0
  v_mov_b64 v[42:43], 0
  s_add_u32 s12, s12, 16384
  s_addc_u32 s13, s13, 0
  s_add_u32 s14, s14, 12288
  s_addc_u32 s15, s15, 0
  s_add_u32 s10, s10, 458752
  s_addc_u32 s11, s11, 0
  s_add_u32 s24, s24, 1
  s_cmp_lt_u32 s24, 63
  s_waitcnt lgkmcnt(0)
  s_cbranch_scc1 b_vw1_step
  s_endpgm
b_vw1_pollp_retry:
  s_nop 7
  v_mov_b64 v[12:13], 0
  v_mov_b64 v[14:15], 0
  v_mov_b64 v[16:17], 0
  v_mov_b64 v[18:19], 0
  s_branch b_vw1_pollp
b_vw2:
  v_add_u32 v4, 3211264, v2
  global_load_dwordx4 v[52:55], v4, s[6:7]
  v_add_u32 v4, 3212288, v2
  global_load_dwordx4 v[56:59], v4, s[6:7]
  v_add_u32 v4, 3213312, v2
  global_load_dwordx4 v[60:63], v4, s[6:7]
  v_add_u32 v4, 3214336, v2
  global_load_dwordx4 v[64:67], v4, s[6:7]
  v_add_u32 v4, 3215360, v2
  global_load_dwordx4 v[68:71], v4, s[6:7]
  v_add_u32 v4, 3216384, v2
  global_load_dwordx4 v[72:75], v4, s[6:7]
  v_add_u32 v4, 3217408, v2
  global_load_dwordx4 v[76:79], v4, s[6:7]
  v_add_u32 v4, 3218432, v2
  global_load_dwordx4 v[80:83], v4, s[6:7]
  v_add_u32 v4, 3219456, v2
  global_load_dwordx4 v[84:87], v4, s[6:7]
  v_add_u32 v4, 3220480, v2
  global_load_dwordx4 v[88:91], v4, s[6:7]
  v_add_u32 v4, 3221504, v2
  global_load_dwordx4 v[92:95], v4, s[6:7]
  v_add_u32 v4, 3222528, v2
  global_load_dwordx4 v[96:99], v4, s[6:7]
  v_add_u32 v4, 3223552, v2
  global_load_dwordx4 v[100:103], v4, s[6:7]
  v_add_u32 v4, 3224576, v2
  global_load_dwordx4 v[104:107], v4, s[6:7]
  v_add_u32 v5, 73728, v2
  s_waitcnt vmcnt(0)
  ds_write_b128 v5, v[52:55] offset:0
  ds_write_b128 v5, v[56:59] offset:1024
  ds_write_b128 v5, v[60:63] offset:2048
  ds_write_b128 v5, v[64:67] offset:3072
  ds_write_b128 v5, v[68:71] offset:4096
  ds_write_b128 v5, v[72:75] offset:5120
  ds_write_b128 v5, v[76:79] offset:6144
  ds_write_b128 v5, v[80:83] offset:7168
  ds_write_b128 v5, v[84:87] offset:8192
  ds_write_b128 v5, v[88:91] offset:9216
  ds_write_b128 v5, v[92:95] offset:10240
  ds_write_b128 v5, v[96:99] offset:11264
  ds_write_b128 v5, v[100:103] offset:12288
  ds_write_b128 v5, v[104:107] offset:13312
  s_waitcnt lgkmcnt(0)
  v_add_u32 v4, 3225600, v2
  global_load_dwordx4 v[52:55], v4, s[6:7]
  v_add_u32 v4, 3226624, v2
  global_load_dwordx4 v[56:59], v4, s[6:7]
  v_add_u32 v4, 3227648, v2
  global_load_dwordx4 v[60:63], v4, s[6:7]
  v_add_u32 v4, 3228672, v2
  global_load_dwordx4 v[64:67], v4, s[6:7]
  v_add_u32 v4, 3229696, v2
  global_load_dwordx4 v[68:71], v4, s[6:7]
  v_add_u32 v4, 3230720, v2
  global_load_dwordx4 v[72:75], v4, s[6:7]
  v_add_u32 v4, 3231744, v2
  global_load_dwordx4 v[76:79], v4, s[6:7]
  v_add_u32 v4, 3232768, v2
  global_load_dwordx4 v[80:83], v4, s[6:7]
  v_add_u32 v4, 3233792, v2
  global_load_dwordx4 v[84:87], v4, s[6:7]
  v_add_u32 v4, 3234816, v2
  global_load_dwordx4 v[88:91], v4, s[6:7]
  v_add_u32 v4, 3235840, v2
  global_load_dwordx4 v[92:95], v4, s[6:7]
  v_add_u32 v4, 3236864, v2
  global_load_dwordx4 v[96:99], v4, s[6:7]
  v_add_u32 v4, 3237888, v2
  global_load_dwordx4 v[100:103], v4, s[6:7]
  v_add_u32 v4, 3238912, v2
  global_load_dwordx4 v[104:107], v4, s[6:7]
  v_add_u32 v5, 88064, v2
  s_waitcnt vmcnt(0)
  ds_write_b128 v5, v[52:55] offset:0
  ds_write_b128 v5, v[56:59] offset:1024
  ds_write_b128 v5, v[60:63] offset:2048
  ds_write_b128 v5, v[64:67] offset:3072
  ds_write_b128 v5, v[68:71] offset:4096
  ds_write_b128 v5, v[72:75] offset:5120
  ds_write_b128 v5, v[76:79] offset:6144
  ds_write_b128 v5, v[80:83] offset:7168
  ds_write_b128 v5, v[84:87] offset:8192
  ds_write_b128 v5, v[88:91] offset:9216
  ds_write_b128 v5, v[92:95] offset:10240
  ds_write_b128 v5, v[96:99] offset:11264
  ds_write_b128 v5, v[100:103] offset:12288
  ds_write_b128 v5, v[104:107] offset:13312
  s_waitcnt lgkmcnt(0)
  v_add_u32 v4, 3612672, v2
  global_load_dwordx4 a[0:3], v4, s[6:7]
  global_load_dwordx4 a[4:7], v4, s[6:7] offset:1024
  v_add_u32 v4, 3614720, v2
  global_load_dwordx4 a[8:11], v4, s[6:7]
  global_load_dwordx4 a[12:15], v4, s[6:7] offset:1024
  v_add_u32 v4, 3616768, v2
  global_load_dwordx4 a[16:19], v4, s[6:7]
  global_load_dwordx4 a[20:23], v4, s[6:7] offset:1024
  v_add_u32 v4, 3618816, v2
  global_load_dwordx4 a[24:27], v4, s[6:7]
  global_load_dwordx4 a[28:31], v4, s[6:7] offset:1024
  v_add_u32 v4, 3620864, v2
  global_load_dwordx4 a[32:35], v4, s[6:7]
  global_load_dwordx4 a[36:39], v4, s[6:7] offset:1024
  v_add_u32 v4, 3622912, v2
  global_load_dwordx4 a[40:43], v4, s[6:7]
  global_load_dwordx4 a[44:47], v4, s[6:7] offset:1024
  v_add_u32 v4, 3624960, v2
  global_load_dwordx4 a[48:51], v4, s[6:7]
  global_load_dwordx4 a[52:55], v4, s[6:7] offset:1024
  v_add_u32 v4, 3627008, v2
  global_load_dwordx4 a[56:59], v4, s[6:7]
  global_load_dwordx4 a[60:63], v4, s[6:7] offset:1024
  v_add_u32 v4, 3629056, v2
  global_load_dwordx4 a[64:67], v4, s[6:7]
  global_load_dwordx4 a[68:71], v4, s[6:7] offset:1024
  v_add_u32 v4, 3631104, v2
  global_load_dwordx4 a[72:75], v4, s[6:7]
  global_load_dwordx4 a[76:79], v4, s[6:7] offset:1024
  v_add_u32 v4, 3633152, v2
  global_load_dwordx4 a[80:83], v4, s[6:7]
  global_load_dwordx4 a[84:87], v4, s[6:7] offset:1024
  v_add_u32 v4, 3635200, v2
  global_load_dwordx4 a[88:91], v4, s[6:7]
  global_load_dwordx4 a[92:95], v4, s[6:7] offset:1024
  v_add_u32 v4, 3637248, v2
  global_load_dwordx4 a[96:99], v4, s[6:7]
  global_load_dwordx4 a[100:103], v4, s[6:7] offset:1024
  v_add_u32 v4, 3639296, v2
  global_load_dwordx4 a[104:107], v4, s[6:7]
  global_load_dwordx4 a[108:111], v4, s[6:7] offset:1024
  v_add_u32 v4, 4014080, v2
  global_load_dwordx4 a[112:115], v4, s[6:7]
  global_load_dwordx4 a[116:119], v4, s[6:7] offset:1024
  v_add_u32 v4, 4016128, v2
  global_load_dwordx4 a[120:123], v4, s[6:7]
  global_load_dwordx4 a[124:127], v4, s[6:7] offset:1024
  s_waitcnt vmcnt(32)
  v_add_u32 v4, 4018176, v2
  global_load_dwordx4 a[128:131], v4, s[6:7]
  global_load_dwordx4 a[132:135], v4, s[6:7] offset:1024
  v_add_u32 v4, 4020224, v2
  global_load_dwordx4 a[136:139], v4, s[6:7]
  global_load_dwordx4 a[140:143], v4, s[6:7] offset:1024
  v_add_u32 v4, 4022272, v2
  global_load_dwordx4 a[144:147], v4, s[6:7]
  global_load_dwordx4 a[148:151], v4, s[6:7] offset:1024
  v_add_u32 v4, 4024320, v2
  global_load_dwordx4 a[152:155], v4, s[6:7]
  global_load_dwordx4 a[156:159], v4, s[6:7] offset:1024
  v_add_u32 v4, 4026368, v2
  global_load_dwordx4 a[160:163], v4, s[6:7]
  global_load_dwordx4 a[164:167], v4, s[6:7] offset:1024
  v_add_u32 v4, 4028416, v2
  global_load_dwordx4 a[168:171], v4, s[6:7]
  global_load_dwordx4 a[172:175], v4, s[6:7] offset:1024
  v_add_u32 v4, 4030464, v2
  global_load_dwordx4 a[176:179], v4, s[6:7]
  global_load_dwordx4 a[180:183], v4, s[6:7] offset:1024
  v_add_u32 v4, 4032512, v2
  global_load_dwordx4 a[184:187], v4, s[6:7]
  global_load_dwordx4 a[188:191], v4, s[6:7] offset:1024
  v_add_u32 v4, 4034560, v2
  global_load_dwordx4 a[192:195], v4, s[6:7]
  global_load_dwordx4 a[196:199], v4, s[6:7] offset:1024
  v_add_u32 v4, 4036608, v2
  global_load_dwordx4 a[200:203], v4, s[6:7]
  global_load_dwordx4 a[204:207], v4, s[6:7] offset:1024
  v_add_u32 v4, 4038656, v2
  global_load_dwordx4 a[208:211], v4, s[6:7]
  global_load_dwordx4 a[212:215], v4, s[6:7] offset:1024
  v_add_u32 v4, 4040704, v2
  global_load_dwordx4 a[216:219], v4, s[6:7]
  global_load_dwordx4 a[220:223], v4, s[6:7] offset:1024
  v_add_u32 v4, 4415488, v2
  global_load_dwordx4 a[224:227], v4, s[6:7]
  global_load_dwordx4 a[228:231], v4, s[6:7] offset:1024
  v_add_u32 v4, 4417536, v2
  global_load_dwordx4 a[232:235], v4, s[6:7]
  global_load_dwordx4 a[236:239], v4, s[6:7] offset:1024
  v_add_u32 v4, 4419584, v2
  global_load_dwordx4 a[240:243], v4, s[6:7]
  global_load_dwordx4 a[244:247], v4, s[6:7] offset:1024
  v_add_u32 v4, 4421632, v2
  global_load_dwordx4 a[248:251], v4, s[6:7]
  global_load_dwordx4 a[252:255], v4, s[6:7] offset:1024
  s_waitcnt vmcnt(32)
  v_add_u32 v4, 4423680, v2
  global_load_dwordx4 v[176:179], v4, s[6:7]
  global_load_dwordx4 v[180:183], v4, s[6:7] offset:1024
  v_add_u32 v4, 4425728, v2
  global_load_dwordx4 v[184:187], v4, s[6:7]
  global_load_dwordx4 v[188:191], v4, s[6:7] offset:1024
  v_add_u32 v4, 4427776, v2
  global_load_dwordx4 v[192:195], v4, s[6:7]
  global_load_dwordx4 v[196:199], v4, s[6:7] offset:1024
  v_add_u32 v4, 4429824, v2
  global_load_dwordx4 v[200:203], v4, s[6:7]
  global_load_dwordx4 v[204:207], v4, s[6:7] offset:1024
  v_add_u32 v4, 4431872, v2
  global_load_dwordx4 v[208:211], v4, s[6:7]
  global_load_dwordx4 v[212:215], v4, s[6:7] offset:1024
  v_add_u32 v4, 4433920, v2
  global_load_dwordx4 v[216:219], v4, s[6:7]
  global_load_dwordx4 v[220:223], v4, s[6:7] offset:1024
  v_add_u32 v4, 4435968, v2
  global_load_dwordx4 v[224:227], v4, s[6:7]
  global_load_dwordx4 v[228:231], v4, s[6:7] offset:1024
  v_add_u32 v4, 4438016, v2
  global_load_dwordx4 v[232:235], v4, s[6:7]
  global_load_dwordx4 v[236:239], v4, s[6:7] offset:1024
  v_add_u32 v4, 4440064, v2
  global_load_dwordx4 v[240:243], v4, s[6:7]
  global_load_dwordx4 v[244:247], v4, s[6:7] offset:1024
  v_add_u32 v4, 4442112, v2
  global_load_dwordx4 v[248:251], v4, s[6:7]
  global_load_dwordx4 v[252:255], v4, s[6:7] offset:1024
  s_waitcnt vmcnt(0)
  v_add_u32 v4, 73728, v2
  v_add_u32 v5, 88064, v2
  v_add_u32 v156, 12288, v2
  v_lshrrev_b32 v8, 3, v1
  v_and_b32 v9, 7, v1
  v_lshrrev_b32 v10, 1, v9
  v_lshlrev_b32 v10, 2, v10
  v_and_b32 v9, 1, v9
  v_add_u32 v10, v10, v9
  v_add_u32 v10, 0, v10
  s_sub_u32 s26, s22, 16
  s_lshl_b32 s27, s26, 6
  s_add_u32 s27, s27, 516128
  v_mul_u32_u24 v163, 896, v8
  v_lshl_add_u32 v163, v10, 1, v163
  v_add_u32 v163, s27, v163
  v_lshrrev_b32 v11, 2, v8
  v_lshl_add_u32 v10, v11, 4, v10
  v_lshlrev_b32 v10, 4, v10
  v_and_b32 v8, 3, v8
  v_lshl_add_u32 v157, v8, 2, v10
  v_add_u32 v157, 9216, v157
  s_lshr_b32 s27, s26, 1
  s_lshl_b32 s27, s27, 10
  s_and_b32 s28, s26, 1
  s_lshl_b32 s28, s28, 9
  s_add_u32 s27, s27, s28
  s_add_u32 s27, s27, 13568
  v_lshl_add_u32 v158, v1, 1, s27
  v_add_u32 v167, 502784, v158
  s_lshl_b32 s27, s26, 15
  s_add_u32 s27, s27, 20480
  v_add_u32 v159, s27, v2
  v_add_u32 v160, 4096, v2
  v_lshrrev_b32 v8, 5, v1
  v_lshlrev_b32 v8, 8, v8
  v_and_b32 v9, 15, v1
  v_lshl_add_u32 v161, v9, 4, v8
  v_add_u32 v161, 9216, v161
  s_and_b32 s27, s26, 3
  s_lshl_b32 s27, s27, 7
  s_add_u32 s27, s27, 11264
  v_and_b32 v8, 3, v1
  v_lshl_add_u32 v164, v8, 2, s27
  v_min_u32 v165, 56, v1
  v_lshlrev_b32 v165, 2, v165
  s_and_b32 s26, s22, 7
  s_lshl_b32 s26, s26, 8
  s_add_u32 s26, s26, 5120
  v_add_u32 v165, s26, v165
  s_sub_u32 s26, s22, 16
  s_lshl_b32 s27, s26, 4
  s_add_u32 s27, s27, 21512
  v_and_b32 v8, 7, v1
  v_lshlrev_b32 v8, 8, v8
  v_add_u32 v166, s27, v8
  s_mov_b32 s32, 0x55555555
  s_mov_b32 s33, 0x55555555
  ds_read_b128 v[52:55], v4 offset:0
  ds_read_b128 v[56:59], v4 offset:1024
  ds_read_b128 v[60:63], v4 offset:2048
  ds_read_b128 v[64:67], v4 offset:3072
  ds_read_b128 v[68:71], v4 offset:4096
  ds_read_b128 v[72:75], v4 offset:5120
  ds_read_b128 v[76:79], v4 offset:6144
  ds_read_b128 v[80:83], v4 offset:7168
  ds_read_b128 v[84:87], v4 offset:8192
  ds_read_b128 v[88:91], v4 offset:9216
  ds_read_b128 v[92:95], v4 offset:10240
  ds_read_b128 v[96:99], v4 offset:11264
  ds_read_b128 v[100:103], v4 offset:12288
  ds_read_b128 v[104:107], v4 offset:13312
  v_mov_b64 v[40:41], 0
  v_mov_b64 v[42:43], 0
  s_waitcnt lgkmcnt(0)
  s_barrier
b_vw2_step:
  s_mov_b64 exec, s[56:57]
  global_load_dword v169, v165, s[12:13] sc1
  s_nop 15
  s_nop 4
  global_load_dword v170, v165, s[12:13] sc1
  s_nop 15
  s_nop 4
b_vw2_bell2:
  global_load_dword v171, v165, s[12:13] sc1
  s_waitcnt vmcnt(2)
  v_cmp_eq_u32 vcc, -1, v169
  s_cbranch_vccz b_vw2_bell2_ok
  global_load_dword v169, v165, s[12:13] sc1
  s_waitcnt vmcnt(2)
  v_cmp_eq_u32 vcc, -1, v170
  s_cbranch_vccz b_vw2_bell2_ok
  global_load_dword v170, v165, s[12:13] sc1
  s_waitcnt vmcnt(2)
  v_cmp_eq_u32 vcc, -1, v171
  s_sub_u32 s25, s25, 1
  s_cbranch_scc1 b_fail
  s_cbranch_vccz b_vw2_bell2_ok
  s_branch b_vw2_bell2
b_vw2_bell2_ok:
  s_mov_b64 exec, -1
b_vw2_poll:
  global_load_dwordx4 v[20:23], v2, s[12:13] offset:-1024 sc1
  global_load_dwordx4 v[36:39], v2, s[12:13] offset:3072 sc1
  s_sub_u32 s25, s25, 1
  s_cbranch_scc1 b_fail
  s_waitcnt vmcnt(0)
  v_max3_u32 v8, v20, v21, v22
  v_max3_u32 v8, v8, v23, v36
  v_max3_u32 v8, v8, v37, v38
  v_max_u32 v8, v8, v39
  v_cmp_eq_u32 vcc, -1, v8
  s_cbranch_vccnz b_vw2_poll
  ds_write_b128 v2, v[20:23] offset:2048
  ds_write_b128 v2, v[36:39] offset:6144
  s_waitcnt lgkmcnt(0)
  s_barrier
  ds_read_b128 v[12:15], v2 offset:0
  ds_read_b128 v[16:19], v2 offset:1024
  ds_read_b128 v[24:27], v2 offset:3072
  ds_read_b128 v[28:31], v2 offset:4096
  ds_read_b128 v[32:35], v2 offset:5120
  global_load_dwordx4 v[124:127], v159, s[10:11] offset:-4096 sc1
  global_load_dwordx4 v[128:131], v159, s[10:11] offset:-3072 sc1
  global_load_dwordx4 v[132:135], v159, s[10:11] offset:-2048 sc1
  global_load_dwordx4 v[136:139], v159, s[10:11] offset:-1024 sc1
  global_load_dwordx4 v[140:143], v159, s[10:11] offset:0 sc1
  global_load_dwordx4 v[144:147], v159, s[10:11] offset:1024 sc1
  global_load_dwordx4 v[148:151], v159, s[10:11] offset:2048 sc1
  global_load_dwordx4 v[152:155], v159, s[10:11] offset:3072 sc1
  v_smfmac_f32_16x16x64_bf16 v[40:43], v[20:23], v[68:75], v3
  ds_read_b128 v[68:71], v5 offset:4096
  ds_read_b128 v[72:75], v5 offset:5120
  v_mov_b64 v[44:45], 0
  v_smfmac_f32_16x16x64_bf16 v[40:43], v[36:39], v[100:107], v3
  ds_read_b128 v[100:103], v5 offset:12288
  ds_read_b128 v[104:107], v5 offset:13312
  v_mov_b64 v[46:47], 0
  s_waitcnt lgkmcnt(8)
  v_smfmac_f32_16x16x64_bf16 v[40:43], v[12:15], v[52:59], v3
  ds_read_b128 v[52:55], v5 offset:0
  ds_read_b128 v[56:59], v5 offset:1024
  s_waitcnt lgkmcnt(9)
  v_smfmac_f32_16x16x64_bf16 v[40:43], v[16:19], v[60:67], v3
  ds_read_b128 v[60:63], v5 offset:2048
  ds_read_b128 v[64:67], v5 offset:3072
  s_waitcnt lgkmcnt(10)
  v_smfmac_f32_16x16x64_bf16 v[40:43], v[24:27], v[76:83], v3
  ds_read_b128 v[76:79], v5 offset:6144
  ds_read_b128 v[80:83], v5 offset:7168
  s_waitcnt lgkmcnt(11)
  v_smfmac_f32_16x16x64_bf16 v[40:43], v[28:31], v[84:91], v3
  ds_read_b128 v[84:87], v5 offset:8192
  ds_read_b128 v[88:91], v5 offset:9216
  s_waitcnt lgkmcnt(12)
  v_smfmac_f32_16x16x64_bf16 v[40:43], v[32:35], v[92:99], v3
  ds_read_b128 v[92:95], v5 offset:10240
  ds_read_b128 v[96:99], v5 offset:11264
  s_waitcnt lgkmcnt(8)
  v_smfmac_f32_16x16x64_bf16 v[44:47], v[12:15], v[52:59], v3
  v_mov_b64 v[48:49], 0
  s_waitcnt lgkmcnt(6)
  v_smfmac_f32_16x16x64_bf16 v[44:47], v[16:19], v[60:67], v3
  v_mov_b64 v[50:51], 0
  v_smfmac_f32_16x16x64_bf16 v[44:47], v[20:23], v[68:75], v3
  s_waitcnt lgkmcnt(4)
  v_smfmac_f32_16x16x64_bf16 v[44:47], v[24:27], v[76:83], v3
  v_cvt_pk_bf16_f32 v108, v40, v41
  s_waitcnt lgkmcnt(2)
  v_smfmac_f32_16x16x64_bf16 v[44:47], v[28:31], v[84:91], v3
  v_cvt_pk_bf16_f32 v109, v42, v43
  s_waitcnt lgkmcnt(0)
  v_smfmac_f32_16x16x64_bf16 v[44:47], v[32:35], v[92:99], v3
  v_smfmac_f32_16x16x64_bf16 v[44:47], v[36:39], v[100:107], v3
  v_smfmac_f32_16x16x64_bf16 v[48:51], v[12:15], a[0:7], v3
  v_mov_b64 v[40:41], 0
  v_smfmac_f32_16x16x64_bf16 v[48:51], v[16:19], a[8:15], v3
  v_mov_b64 v[42:43], 0
  v_smfmac_f32_16x16x64_bf16 v[48:51], v[20:23], a[16:23], v3
  v_smfmac_f32_16x16x64_bf16 v[48:51], v[24:27], a[24:31], v3
  v_cvt_pk_bf16_f32 v116, v44, v45
  v_smfmac_f32_16x16x64_bf16 v[48:51], v[28:31], a[32:39], v3
  v_cvt_pk_bf16_f32 v117, v46, v47
  v_smfmac_f32_16x16x64_bf16 v[48:51], v[32:35], a[40:47], v3
  v_smfmac_f32_16x16x64_bf16 v[48:51], v[36:39], a[48:55], v3
  v_smfmac_f32_16x16x64_bf16 v[40:43], v[12:15], a[56:63], v3
  v_mov_b64 v[44:45], 0
  v_smfmac_f32_16x16x64_bf16 v[40:43], v[16:19], a[64:71], v3
  v_mov_b64 v[46:47], 0
  v_smfmac_f32_16x16x64_bf16 v[40:43], v[20:23], a[72:79], v3
  v_smfmac_f32_16x16x64_bf16 v[40:43], v[24:27], a[80:87], v3
  v_cvt_pk_bf16_f32 v110, v48, v49
  v_smfmac_f32_16x16x64_bf16 v[40:43], v[28:31], a[88:95], v3
  v_cvt_pk_bf16_f32 v111, v50, v51
  v_smfmac_f32_16x16x64_bf16 v[40:43], v[32:35], a[96:103], v3
  v_smfmac_f32_16x16x64_bf16 v[40:43], v[36:39], a[104:111], v3
  v_smfmac_f32_16x16x64_bf16 v[44:47], v[12:15], a[112:119], v3
  v_mov_b64 v[48:49], 0
  v_smfmac_f32_16x16x64_bf16 v[44:47], v[16:19], a[120:127], v3
  v_mov_b64 v[50:51], 0
  v_smfmac_f32_16x16x64_bf16 v[44:47], v[20:23], a[128:135], v3
  v_smfmac_f32_16x16x64_bf16 v[44:47], v[24:27], a[136:143], v3
  v_cvt_pk_bf16_f32 v118, v40, v41
  v_smfmac_f32_16x16x64_bf16 v[44:47], v[28:31], a[144:151], v3
  v_cvt_pk_bf16_f32 v119, v42, v43
  v_smfmac_f32_16x16x64_bf16 v[44:47], v[32:35], a[152:159], v3
  v_smfmac_f32_16x16x64_bf16 v[44:47], v[36:39], a[160:167], v3
  v_smfmac_f32_16x16x64_bf16 v[48:51], v[12:15], a[168:175], v3
  v_mov_b64 v[40:41], 0
  v_smfmac_f32_16x16x64_bf16 v[48:51], v[16:19], a[176:183], v3
  v_mov_b64 v[42:43], 0
  v_smfmac_f32_16x16x64_bf16 v[48:51], v[20:23], a[184:191], v3
  v_smfmac_f32_16x16x64_bf16 v[48:51], v[24:27], a[192:199], v3
  v_cvt_pk_bf16_f32 v112, v44, v45
  v_smfmac_f32_16x16x64_bf16 v[48:51], v[28:31], a[200:207], v3
  v_cvt_pk_bf16_f32 v113, v46, v47
  v_smfmac_f32_16x16x64_bf16 v[48:51], v[32:35], a[208:215], v3
  v_smfmac_f32_16x16x64_bf16 v[48:51], v[36:39], a[216:223], v3
  v_smfmac_f32_16x16x64_bf16 v[40:43], v[12:15], a[224:231], v3
  v_mov_b64 v[44:45], 0
  v_smfmac_f32_16x16x64_bf16 v[40:43], v[16:19], a[232:239], v3
  v_mov_b64 v[46:47], 0
  v_smfmac_f32_16x16x64_bf16 v[40:43], v[20:23], a[240:247], v3
  v_smfmac_f32_16x16x64_bf16 v[40:43], v[24:27], a[248:255], v3
  v_cvt_pk_bf16_f32 v120, v48, v49
  v_smfmac_f32_16x16x64_bf16 v[40:43], v[28:31], v[176:183], v3
  v_cvt_pk_bf16_f32 v121, v50, v51
  v_smfmac_f32_16x16x64_bf16 v[40:43], v[32:35], v[184:191], v3
  v_smfmac_f32_16x16x64_bf16 v[40:43], v[36:39], v[192:199], v3
  v_smfmac_f32_16x16x64_bf16 v[44:47], v[12:15], v[200:207], v3
  v_smfmac_f32_16x16x64_bf16 v[44:47], v[16:19], v[208:215], v3
  v_smfmac_f32_16x16x64_bf16 v[44:47], v[20:23], v[216:223], v3
  v_smfmac_f32_16x16x64_bf16 v[44:47], v[24:27], v[224:231], v3
  v_cvt_pk_bf16_f32 v114, v40, v41
  v_smfmac_f32_16x16x64_bf16 v[44:47], v[28:31], v[232:239], v3
  v_cvt_pk_bf16_f32 v115, v42, v43
  v_smfmac_f32_16x16x64_bf16 v[44:47], v[32:35], v[240:247], v3
  v_smfmac_f32_16x16x64_bf16 v[44:47], v[36:39], v[248:255], v3
  s_nop 3
  v_mov_b64 v[12:13], 0
  v_mov_b64 v[14:15], 0
  v_mov_b64 v[16:17], 0
  v_mov_b64 v[18:19], 0
  v_cvt_pk_bf16_f32 v122, v44, v45
  v_cvt_pk_bf16_f32 v123, v46, v47
  s_mov_b64 exec, 0xf
  global_load_dword v169, v164, s[14:15] sc1
  s_nop 15
  s_nop 4
  global_load_dword v170, v164, s[14:15] sc1
  s_nop 15
  s_nop 4
b_vw2_bell1:
  global_load_dword v171, v164, s[14:15] sc1
  s_waitcnt vmcnt(2)
  v_cmp_eq_u32 vcc, -1, v169
  s_cbranch_vccz b_vw2_bell1_ok
  global_load_dword v169, v164, s[14:15] sc1
  s_waitcnt vmcnt(2)
  v_cmp_eq_u32 vcc, -1, v170
  s_cbranch_vccz b_vw2_bell1_ok
  global_load_dword v170, v164, s[14:15] sc1
  s_waitcnt vmcnt(2)
  v_cmp_eq_u32 vcc, -1, v171
  s_sub_u32 s25, s25, 1
  s_cbranch_scc1 b_fail
  s_cbranch_vccz b_vw2_bell1_ok
  s_branch b_vw2_bell1
b_vw2_bell1_ok:
  s_mov_b64 exec, -1
b_vw2_pollp:
  global_load_dwordx4 v[48:51], v161, s[14:15] sc1
  global_load_dwordx4 v[40:43], v160, s[14:15] sc1
  global_load_dwordx4 v[44:47], v160, s[14:15] offset:1024 sc1
  s_sub_u32 s25, s25, 1
  s_cbranch_scc1 b_fail
  s_waitcnt vmcnt(2)
  v_smfmac_f32_16x16x64_bf16 v[12:15], v[48:51], v[108:115], v3
  v_max3_u32 v8, v48, v49, v50
  v_smfmac_f32_16x16x64_bf16 v[16:19], v[48:51], v[116:123], v3
  s_waitcnt vmcnt(1)
  v_smfmac_f32_16x16x64_bf16 v[12:15], v[40:43], v[124:131], v3
  v_max3_u32 v8, v8, v51, v40
  v_smfmac_f32_16x16x64_bf16 v[16:19], v[40:43], v[132:139], v3
  v_max3_u32 v8, v8, v41, v42
  s_waitcnt vmcnt(0)
  v_smfmac_f32_16x16x64_bf16 v[12:15], v[44:47], v[140:147], v3
  v_max3_u32 v8, v8, v43, v44
  v_smfmac_f32_16x16x64_bf16 v[16:19], v[44:47], v[148:155], v3
  v_max3_u32 v8, v8, v45, v46
  v_max_u32 v8, v8, v47
  v_cmp_eq_u32 vcc, -1, v8
  s_nop 3
  ds_write_b128 v156, v[12:15]
  s_nop 0
  ds_write_b128 v156, v[16:19] offset:1024
  s_cbranch_vccnz b_vw2_pollp_retry
  s_waitcnt lgkmcnt(0)
  s_barrier
  s_mov_b64 exec, 0xff
  global_store_dword v166, v1, s[12:13]
  s_mov_b64 exec, -1
  ds_read2st64_b32 v[20:21], v157 offset0:0 offset1:2
  ds_read2st64_b32 v[22:23], v157 offset0:8 offset1:10
  ds_read2st64_b32 v[24:25], v157 offset0:16 offset1:18
  ds_read2st64_b32 v[26:27], v157 offset0:24 offset1:26
  s_waitcnt lgkmcnt(0)
  v_pk_add_f32 v[20:21], v[20:21], v[22:23]
  v_pk_add_f32 v[24:25], v[24:25], v[26:27]
  v_pk_add_f32 v[20:21], v[20:21], v[24:25]
  v_add_f32 v20, v20, v21
  s_nop 1
  v_mov_b32_dpp v21, v20 quad_perm:[1,0,3,2] row_mask:0xf bank_mask:0xf
  v_cvt_pk_bf16_f32 v22, v20, v21
  s_mov_b64 exec, s[32:33]
  global_store_dword v158, v22, s[12:13]
  s_mov_b64 exec, -1
  s_cmp_lg_u32 s24, 62
  s_cbranch_scc1 b_vw2_nolast
  s_mov_b64 exec, s[32:33]
  global_store_dword v167, v22, s[52:53] sc1
  global_store_dword v163, v22, s[18:19] sc1
  s_mov_b64 exec, -1
b_vw2_nolast:
  ds_read_b128 v[52:55], v4 offset:0
  ds_read_b128 v[56:59], v4 offset:1024
  ds_read_b128 v[60:63], v4 offset:2048
  ds_read_b128 v[64:67], v4 offset:3072
  ds_read_b128 v[68:71], v4 offset:4096
  ds_read_b128 v[72:75], v4 offset:5120
  ds_read_b128 v[76:79], v4 offset:6144
  ds_read_b128 v[80:83], v4 offset:7168
  ds_read_b128 v[84:87], v4 offset:8192
  ds_read_b128 v[88:91], v4 offset:9216
  ds_read_b128 v[92:95], v4 offset:10240
  ds_read_b128 v[96:99], v4 offset:11264
  ds_read_b128 v[100:103], v4 offset:12288
  ds_read_b128 v[104:107], v4 offset:13312
  v_mov_b64 v[40:41], 0
  v_mov_b64 v[42:43], 0
  s_add_u32 s12, s12, 16384
  s_addc_u32 s13, s13, 0
  s_add_u32 s14, s14, 12288
  s_addc_u32 s15, s15, 0
  s_add_u32 s10, s10, 458752
  s_addc_u32 s11, s11, 0
  s_add_u32 s24, s24, 1
  s_cmp_lt_u32 s24, 63
  s_waitcnt lgkmcnt(0)
  s_cbranch_scc1 b_vw2_step
  s_endpgm
b_vw2_pollp_retry:
  s_nop 7
  v_mov_b64 v[12:13], 0
  v_mov_b64 v[14:15], 0
  v_mov_b64 v[16:17], 0
  v_mov_b64 v[18:19], 0
  s_branch b_vw2_pollp
b_vw3:
  v_add_u32 v4, 4816896, v2
  global_load_dwordx4 v[52:55], v4, s[6:7]
  v_add_u32 v4, 4817920, v2
  global_load_dwordx4 v[56:59], v4, s[6:7]
  v_add_u32 v4, 4818944, v2
  global_load_dwordx4 v[60:63], v4, s[6:7]
  v_add_u32 v4, 4819968, v2
  global_load_dwordx4 v[64:67], v4, s[6:7]
  v_add_u32 v4, 4820992, v2
  global_load_dwordx4 v[68:71], v4, s[6:7]
  v_add_u32 v4, 4822016, v2
  global_load_dwordx4 v[72:75], v4, s[6:7]
  v_add_u32 v4, 4823040, v2
  global_load_dwordx4 v[76:79], v4, s[6:7]
  v_add_u32 v4, 4824064, v2
  global_load_dwordx4 v[80:83], v4, s[6:7]
  v_add_u32 v4, 4825088, v2
  global_load_dwordx4 v[84:87], v4, s[6:7]
  v_add_u32 v4, 4826112, v2
  global_load_dwordx4 v[88:91], v4, s[6:7]
  v_add_u32 v4, 4827136, v2
  global_load_dwordx4 v[92:95], v4, s[6:7]
  v_add_u32 v4, 4828160, v2
  global_load_dwordx4 v[96:99], v4, s[6:7]
  v_add_u32 v4, 4829184, v2
  global_load_dwordx4 v[100:103], v4, s[6:7]
  v_add_u32 v4, 4830208, v2
  global_load_dwordx4 v[104:107], v4, s[6:7]
  v_add_u32 v5, 102400, v2
  s_waitcnt vmcnt(0)
  ds_write_b128 v5, v[52:55] offset:0
  ds_write_b128 v5, v[56:59] offset:1024
  ds_write_b128 v5, v[60:63] offset:2048
  ds_write_b128 v5, v[64:67] offset:3072
  ds_write_b128 v5, v[68:71] offset:4096
  ds_write_b128 v5, v[72:75] offset:5120
  ds_write_b128 v5, v[76:79] offset:6144
  ds_write_b128 v5, v[80:83] offset:7168
  ds_write_b128 v5, v[84:87] offset:8192
  ds_write_b128 v5, v[88:91] offset:9216
  ds_write_b128 v5, v[92:95] offset:10240
  ds_write_b128 v5, v[96:99] offset:11264
  ds_write_b128 v5, v[100:103] offset:12288
  ds_write_b128 v5, v[104:107] offset:13312
  s_waitcnt lgkmcnt(0)
  v_add_u32 v4, 4831232, v2
  global_load_dwordx4 v[52:55], v4, s[6:7]
  v_add_u32 v4, 4832256, v2
  global_load_dwordx4 v[56:59], v4, s[6:7]
  v_add_u32 v4, 4833280, v2
  global_load_dwordx4 v[60:63], v4, s[6:7]
  v_add_u32 v4, 4834304, v2
  global_load_dwordx4 v[64:67], v4, s[6:7]
  v_add_u32 v4, 4835328, v2
  global_load_dwordx4 v[68:71], v4, s[6:7]
  v_add_u32 v4, 4836352, v2
  global_load_dwordx4 v[72:75], v4, s[6:7]
  v_add_u32 v4, 4837376, v2
  global_load_dwordx4 v[76:79], v4, s[6:7]
  v_add_u32 v4, 4838400, v2
  global_load_dwordx4 v[80:83], v4, s[6:7]
  v_add_u32 v4, 4839424, v2
  global_load_dwordx4 v[84:87], v4, s[6:7]
  v_add_u32 v4, 4840448, v2
  global_load_dwordx4 v[88:91], v4, s[6:7]
  v_add_u32 v4, 4841472, v2
  global_load_dwordx4 v[92:95], v4, s[6:7]
  v_add_u32 v4, 4842496, v2
  global_load_dwordx4 v[96:99], v4, s[6:7]
  v_add_u32 v4, 4843520, v2
  global_load_dwordx4 v[100:103], v4, s[6:7]
  v_add_u32 v4, 4844544, v2
  global_load_dwordx4 v[104:107], v4, s[6:7]
  v_add_u32 v5, 116736, v2
  s_waitcnt vmcnt(0)
  ds_write_b128 v5, v[52:55] offset:0
  ds_write_b128 v5, v[56:59] offset:1024
  ds_write_b128 v5, v[60:63] offset:2048
  ds_write_b128 v5, v[64:67] offset:3072
  ds_write_b128 v5, v[68:71] offset:4096
  ds_write_b128 v5, v[72:75] offset:5120
  ds_write_b128 v5, v[76:79] offset:6144
  ds_write_b128 v5, v[80:83] offset:7168
  ds_write_b128 v5, v[84:87] offset:8192
  ds_write_b128 v5, v[88:91] offset:9216
  ds_write_b128 v5, v[92:95] offset:10240
  ds_write_b128 v5, v[96:99] offset:11264
  ds_write_b128 v5, v[100:103] offset:12288
  ds_write_b128 v5, v[104:107] offset:13312
  s_waitcnt lgkmcnt(0)
  v_add_u32 v4, 5218304, v2
  global_load_dwordx4 a[0:3], v4, s[6:7]
  global_load_dwordx4 a[4:7], v4, s[6:7] offset:1024
  v_add_u32 v4, 5220352, v2
  global_load_dwordx4 a[8:11], v4, s[6:7]
  global_load_dwordx4 a[12:15], v4, s[6:7] offset:1024
  v_add_u32 v4, 5222400, v2
  global_load_dwordx4 a[16:19], v4, s[6:7]
  global_load_dwordx4 a[20:23], v4, s[6:7] offset:1024
  v_add_u32 v4, 5224448, v2
  global_load_dwordx4 a[24:27], v4, s[6:7]
  global_load_dwordx4 a[28:31], v4, s[6:7] offset:1024
  v_add_u32 v4, 5226496, v2
  global_load_dwordx4 a[32:35], v4, s[6:7]
  global_load_dwordx4 a[36:39], v4, s[6:7] offset:1024
  v_add_u32 v4, 5228544, v2
  global_load_dwordx4 a[40:43], v4, s[6:7]
  global_load_dwordx4 a[44:47], v4, s[6:7] offset:1024
  v_add_u32 v4, 5230592, v2
  global_load_dwordx4 a[48:51], v4, s[6:7]
  global_load_dwordx4 a[52:55], v4, s[6:7] offset:1024
  v_add_u32 v4, 5232640, v2
  global_load_dwordx4 a[56:59], v4, s[6:7]
  global_load_dwordx4 a[60:63], v4, s[6:7] offset:1024
  v_add_u32 v4, 5234688, v2
  global_load_dwordx4 a[64:67], v4, s[6:7]
  global_load_dwordx4 a[68:71], v4, s[6:7] offset:1024
  v_add_u32 v4, 5236736, v2
  global_load_dwordx4 a[72:75], v4, s[6:7]
  global_load_dwordx4 a[76:79], v4, s[6:7] offset:1024
  v_add_u32 v4, 5238784, v2
  global_load_dwordx4 a[80:83], v4, s[6:7]
  global_load_dwordx4 a[84:87], v4, s[6:7] offset:1024
  v_add_u32 v4, 5240832, v2
  global_load_dwordx4 a[88:91], v4, s[6:7]
  global_load_dwordx4 a[92:95], v4, s[6:7] offset:1024
  v_add_u32 v4, 5242880, v2
  global_load_dwordx4 a[96:99], v4, s[6:7]
  global_load_dwordx4 a[100:103], v4, s[6:7] offset:1024
  v_add_u32 v4, 5244928, v2
  global_load_dwordx4 a[104:107], v4, s[6:7]
  global_load_dwordx4 a[108:111], v4, s[6:7] offset:1024
  v_add_u32 v4, 5619712, v2
  global_load_dwordx4 a[112:115], v4, s[6:7]
  global_load_dwordx4 a[116:119], v4, s[6:7] offset:1024
  v_add_u32 v4, 5621760, v2
  global_load_dwordx4 a[120:123], v4, s[6:7]
  global_load_dwordx4 a[124:127], v4, s[6:7] offset:1024
  s_waitcnt vmcnt(32)
  v_add_u32 v4, 5623808, v2
  global_load_dwordx4 a[128:131], v4, s[6:7]
  global_load_dwordx4 a[132:135], v4, s[6:7] offset:1024
  v_add_u32 v4, 5625856, v2
  global_load_dwordx4 a[136:139], v4, s[6:7]
  global_load_dwordx4 a[140:143], v4, s[6:7] offset:1024
  v_add_u32 v4, 5627904, v2
  global_load_dwordx4 a[144:147], v4, s[6:7]
  global_load_dwordx4 a[148:151], v4, s[6:7] offset:1024
  v_add_u32 v4, 5629952, v2
  global_load_dwordx4 a[152:155], v4, s[6:7]
  global_load_dwordx4 a[156:159], v4, s[6:7] offset:1024
  v_add_u32 v4, 5632000, v2
  global_load_dwordx4 a[160:163], v4, s[6:7]
  global_load_dwordx4 a[164:167], v4, s[6:7] offset:1024
  v_add_u32 v4, 5634048, v2
  global_load_dwordx4 a[168:171], v4, s[6:7]
  global_load_dwordx4 a[172:175], v4, s[6:7] offset:1024
  v_add_u32 v4, 5636096, v2
  global_load_dwordx4 a[176:179], v4, s[6:7]
  global_load_dwordx4 a[180:183], v4, s[6:7] offset:1024
  v_add_u32 v4, 5638144, v2
  global_load_dwordx4 a[184:187], v4, s[6:7]
  global_load_dwordx4 a[188:191], v4, s[6:7] offset:1024
  v_add_u32 v4, 5640192, v2
  global_load_dwordx4 a[192:195], v4, s[6:7]
  global_load_dwordx4 a[196:199], v4, s[6:7] offset:1024
  v_add_u32 v4, 5642240, v2
  global_load_dwordx4 a[200:203], v4, s[6:7]
  global_load_dwordx4 a[204:207], v4, s[6:7] offset:1024
  v_add_u32 v4, 5644288, v2
  global_load_dwordx4 a[208:211], v4, s[6:7]
  global_load_dwordx4 a[212:215], v4, s[6:7] offset:1024
  v_add_u32 v4, 5646336, v2
  global_load_dwordx4 a[216:219], v4, s[6:7]
  global_load_dwordx4 a[220:223], v4, s[6:7] offset:1024
  v_add_u32 v4, 6021120, v2
  global_load_dwordx4 a[224:227], v4, s[6:7]
  global_load_dwordx4 a[228:231], v4, s[6:7] offset:1024
  v_add_u32 v4, 6023168, v2
  global_load_dwordx4 a[232:235], v4, s[6:7]
  global_load_dwordx4 a[236:239], v4, s[6:7] offset:1024
  v_add_u32 v4, 6025216, v2
  global_load_dwordx4 a[240:243], v4, s[6:7]
  global_load_dwordx4 a[244:247], v4, s[6:7] offset:1024
  v_add_u32 v4, 6027264, v2
  global_load_dwordx4 a[248:251], v4, s[6:7]
  global_load_dwordx4 a[252:255], v4, s[6:7] offset:1024
  s_waitcnt vmcnt(32)
  v_add_u32 v4, 6029312, v2
  global_load_dwordx4 v[176:179], v4, s[6:7]
  global_load_dwordx4 v[180:183], v4, s[6:7] offset:1024
  v_add_u32 v4, 6031360, v2
  global_load_dwordx4 v[184:187], v4, s[6:7]
  global_load_dwordx4 v[188:191], v4, s[6:7] offset:1024
  v_add_u32 v4, 6033408, v2
  global_load_dwordx4 v[192:195], v4, s[6:7]
  global_load_dwordx4 v[196:199], v4, s[6:7] offset:1024
  v_add_u32 v4, 6035456, v2
  global_load_dwordx4 v[200:203], v4, s[6:7]
  global_load_dwordx4 v[204:207], v4, s[6:7] offset:1024
  v_add_u32 v4, 6037504, v2
  global_load_dwordx4 v[208:211], v4, s[6:7]
  global_load_dwordx4 v[212:215], v4, s[6:7] offset:1024
  v_add_u32 v4, 6039552, v2
  global_load_dwordx4 v[216:219], v4, s[6:7]
  global_load_dwordx4 v[220:223], v4, s[6:7] offset:1024
  v_add_u32 v4, 6041600, v2
  global_load_dwordx4 v[224:227], v4, s[6:7]
  global_load_dwordx4 v[228:231], v4, s[6:7] offset:1024
  v_add_u32 v4, 6043648, v2
  global_load_dwordx4 v[232:235], v4, s[6:7]
  global_load_dwordx4 v[236:239], v4, s[6:7] offset:1024
  v_add_u32 v4, 6045696, v2
  global_load_dwordx4 v[240:243], v4, s[6:7]
  global_load_dwordx4 v[244:247], v4, s[6:7] offset:1024
  v_add_u32 v4, 6047744, v2
  global_load_dwordx4 v[248:251], v4, s[6:7]
  global_load_dwordx4 v[252:255], v4, s[6:7] offset:1024
  s_waitcnt vmcnt(0)
  v_add_u32 v4, 102400, v2
  v_add_u32 v5, 116736, v2
  v_add_u32 v156, 14336, v2
  v_lshrrev_b32 v8, 3, v1
  v_and_b32 v9, 7, v1
  v_lshrrev_b32 v10, 1, v9
  v_lshlrev_b32 v10, 2, v10
  v_and_b32 v9, 1, v9
  v_add_u32 v10, v10, v9
  v_add_u32 v10, 2, v10
  s_sub_u32 s26, s22, 16
  s_lshl_b32 s27, s26, 6
  s_add_u32 s27, s27, 516128
  v_mul_u32_u24 v163, 896, v8
  v_lshl_add_u32 v163, v10, 1, v163
  v_add_u32 v163, s27, v163
  v_lshrrev_b32 v11, 2, v8
  v_lshl_add_u32 v10, v11, 4, v10
  v_lshlrev_b32 v10, 4, v10
  v_and_b32 v8, 3, v8
  v_lshl_add_u32 v157, v8, 2, v10
  v_add_u32 v157, 9216, v157
  s_lshr_b32 s27, s26, 1
  s_lshl_b32 s27, s27, 10
  s_and_b32 s28, s26, 1
  s_lshl_b32 s28, s28, 9
  s_add_u32 s27, s27, s28
  s_add_u32 s27, s27, 13696
  v_lshl_add_u32 v158, v1, 1, s27
  v_add_u32 v167, 502784, v158
  s_lshl_b32 s27, s26, 15
  s_add_u32 s27, s27, 28672
  v_add_u32 v159, s27, v2
  v_add_u32 v160, 6144, v2
  v_lshrrev_b32 v8, 5, v1
  v_lshlrev_b32 v8, 8, v8
  v_and_b32 v9, 15, v1
  v_lshl_add_u32 v161, v9, 4, v8
  v_add_u32 v161, 9728, v161
  s_and_b32 s27, s26, 3
  s_lshl_b32 s27, s27, 7
  s_add_u32 s27, s27, 11776
  v_and_b32 v8, 3, v1
  v_lshl_add_u32 v164, v8, 2, s27
  v_min_u32 v165, 56, v1
  v_lshlrev_b32 v165, 2, v165
  s_and_b32 s26, s22, 7
  s_lshl_b32 s26, s26, 8
  s_add_u32 s26, s26, 5120
  v_add_u32 v165, s26, v165
  s_sub_u32 s26, s22, 16
  s_lshl_b32 s27, s26, 4
  s_add_u32 s27, s27, 21516
  v_and_b32 v8, 7, v1
  v_lshlrev_b32 v8, 8, v8
  v_add_u32 v166, s27, v8
  s_mov_b32 s32, 0x55555555
  s_mov_b32 s33, 0x55555555
  ds_read_b128 v[52:55], v4 offset:0
  ds_read_b128 v[56:59], v4 offset:1024
  ds_read_b128 v[60:63], v4 offset:2048
  ds_read_b128 v[64:67], v4 offset:3072
  ds_read_b128 v[68:71], v4 offset:4096
  ds_read_b128 v[72:75], v4 offset:5120
  ds_read_b128 v[76:79], v4 offset:6144
  ds_read_b128 v[80:83], v4 offset:7168
  ds_read_b128 v[84:87], v4 offset:8192
  ds_read_b128 v[88:91], v4 offset:9216
  ds_read_b128 v[92:95], v4 offset:10240
  ds_read_b128 v[96:99], v4 offset:11264
  ds_read_b128 v[100:103], v4 offset:12288
  ds_read_b128 v[104:107], v4 offset:13312
  v_mov_b64 v[40:41], 0
  v_mov_b64 v[42:43], 0
  s_waitcnt lgkmcnt(0)
  s_barrier
b_vw3_step:
  s_mov_b64 exec, s[56:57]
  global_load_dword v169, v165, s[12:13] sc1
  s_nop 15
  s_nop 4
  global_load_dword v170, v165, s[12:13] sc1
  s_nop 15
  s_nop 4
b_vw3_bell2:
  global_load_dword v171, v165, s[12:13] sc1
  s_waitcnt vmcnt(2)
  v_cmp_eq_u32 vcc, -1, v169
  s_cbranch_vccz b_vw3_bell2_ok
  global_load_dword v169, v165, s[12:13] sc1
  s_waitcnt vmcnt(2)
  v_cmp_eq_u32 vcc, -1, v170
  s_cbranch_vccz b_vw3_bell2_ok
  global_load_dword v170, v165, s[12:13] sc1
  s_waitcnt vmcnt(2)
  v_cmp_eq_u32 vcc, -1, v171
  s_sub_u32 s25, s25, 1
  s_cbranch_scc1 b_fail
  s_cbranch_vccz b_vw3_bell2_ok
  s_branch b_vw3_bell2
b_vw3_bell2_ok:
  s_mov_b64 exec, -1
b_vw3_poll:
  global_load_dwordx4 v[24:27], v2, s[12:13] offset:0 sc1
  s_sub_u32 s25, s25, 1
  s_cbranch_scc1 b_fail
  s_waitcnt vmcnt(0)
  v_max3_u32 v8, v24, v25, v26
  v_max_u32 v8, v8, v27
  v_cmp_eq_u32 vcc, -1, v8
  s_cbranch_vccnz b_vw3_poll
  ds_write_b128 v2, v[24:27] offset:3072
  s_waitcnt lgkmcnt(0)
  s_barrier
  ds_read_b128 v[12:15], v2 offset:0
  ds_read_b128 v[16:19], v2 offset:1024
  ds_read_b128 v[20:23], v2 offset:2048
  ds_read_b128 v[28:31], v2 offset:4096
  ds_read_b128 v[32:35], v2 offset:5120
  ds_read_b128 v[36:39], v2 offset:6144
  global_load_dwordx4 v[124:127], v159, s[10:11] offset:-4096 sc1
  global_load_dwordx4 v[128:131], v159, s[10:11] offset:-3072 sc1
  global_load_dwordx4 v[132:135], v159, s[10:11] offset:-2048 sc1
  global_load_dwordx4 v[136:139], v159, s[10:11] offset:-1024 sc1
  global_load_dwordx4 v[140:143], v159, s[10:11] offset:0 sc1
  global_load_dwordx4 v[144:147], v159, s[10:11] offset:1024 sc1
  global_load_dwordx4 v[148:151], v159, s[10:11] offset:2048 sc1
  global_load_dwordx4 v[152:155], v159, s[10:11] offset:3072 sc1
  v_smfmac_f32_16x16x64_bf16 v[40:43], v[24:27], v[76:83], v3
  ds_read_b128 v[76:79], v5 offset:6144
  ds_read_b128 v[80:83], v5 offset:7168
  v_mov_b64 v[44:45], 0
  s_waitcnt lgkmcnt(7)
  v_smfmac_f32_16x16x64_bf16 v[40:43], v[12:15], v[52:59], v3
  ds_read_b128 v[52:55], v5 offset:0
  ds_read_b128 v[56:59], v5 offset:1024
  v_mov_b64 v[46:47], 0
  s_waitcnt lgkmcnt(8)
  v_smfmac_f32_16x16x64_bf16 v[40:43], v[16:19], v[60:67], v3
  ds_read_b128 v[60:63], v5 offset:2048
  ds_read_b128 v[64:67], v5 offset:3072
  s_waitcnt lgkmcnt(9)
  v_smfmac_f32_16x16x64_bf16 v[40:43], v[20:23], v[68:75], v3
  ds_read_b128 v[68:71], v5 offset:4096
  ds_read_b128 v[72:75], v5 offset:5120
  s_waitcnt lgkmcnt(10)
  v_smfmac_f32_16x16x64_bf16 v[40:43], v[28:31], v[84:91], v3
  ds_read_b128 v[84:87], v5 offset:8192
  ds_read_b128 v[88:91], v5 offset:9216
  s_waitcnt lgkmcnt(11)
  v_smfmac_f32_16x16x64_bf16 v[40:43], v[32:35], v[92:99], v3
  ds_read_b128 v[92:95], v5 offset:10240
  ds_read_b128 v[96:99], v5 offset:11264
  s_waitcnt lgkmcnt(12)
  v_smfmac_f32_16x16x64_bf16 v[40:43], v[36:39], v[100:107], v3
  ds_read_b128 v[100:103], v5 offset:12288
  ds_read_b128 v[104:107], v5 offset:13312
  s_waitcnt lgkmcnt(10)
  v_smfmac_f32_16x16x64_bf16 v[44:47], v[12:15], v[52:59], v3
  v_mov_b64 v[48:49], 0
  s_waitcnt lgkmcnt(8)
  v_smfmac_f32_16x16x64_bf16 v[44:47], v[16:19], v[60:67], v3
  v_mov_b64 v[50:51], 0
  s_waitcnt lgkmcnt(6)
  v_smfmac_f32_16x16x64_bf16 v[44:47], v[20:23], v[68:75], v3
  v_smfmac_f32_16x16x64_bf16 v[44:47], v[24:27], v[76:83], v3
  v_cvt_pk_bf16_f32 v108, v40, v41
  s_waitcnt lgkmcnt(4)
  v_smfmac_f32_16x16x64_bf16 v[44:47], v[28:31], v[84:91], v3
  v_cvt_pk_bf16_f32 v109, v42, v43
  s_waitcnt lgkmcnt(2)
  v_smfmac_f32_16x16x64_bf16 v[44:47], v[32:35], v[92:99], v3
  s_waitcnt lgkmcnt(0)
  v_smfmac_f32_16x16x64_bf16 v[44:47], v[36:39], v[100:107], v3
  v_smfmac_f32_16x16x64_bf16 v[48:51], v[12:15], a[0:7], v3
  v_mov_b64 v[40:41], 0
  v_smfmac_f32_16x16x64_bf16 v[48:51], v[16:19], a[8:15], v3
  v_mov_b64 v[42:43], 0
  v_smfmac_f32_16x16x64_bf16 v[48:51], v[20:23], a[16:23], v3
  v_smfmac_f32_16x16x64_bf16 v[48:51], v[24:27], a[24:31], v3
  v_cvt_pk_bf16_f32 v116, v44, v45
  v_smfmac_f32_16x16x64_bf16 v[48:51], v[28:31], a[32:39], v3
  v_cvt_pk_bf16_f32 v117, v46, v47
  v_smfmac_f32_16x16x64_bf16 v[48:51], v[32:35], a[40:47], v3
  v_smfmac_f32_16x16x64_bf16 v[48:51], v[36:39], a[48:55], v3
  v_smfmac_f32_16x16x64_bf16 v[40:43], v[12:15], a[56:63], v3
  v_mov_b64 v[44:45], 0
  v_smfmac_f32_16x16x64_bf16 v[40:43], v[16:19], a[64:71], v3
  v_mov_b64 v[46:47], 0
  v_smfmac_f32_16x16x64_bf16 v[40:43], v[20:23], a[72:79], v3
  v_smfmac_f32_16x16x64_bf16 v[40:43], v[24:27], a[80:87], v3
  v_cvt_pk_bf16_f32 v110, v48, v49
  v_smfmac_f32_16x16x64_bf16 v[40:43], v[28:31], a[88:95], v3
  v_cvt_pk_bf16_f32 v111, v50, v51
  v_smfmac_f32_16x16x64_bf16 v[40:43], v[32:35], a[96:103], v3
  v_smfmac_f32_16x16x64_bf16 v[40:43], v[36:39], a[104:111], v3
  v_smfmac_f32_16x16x64_bf16 v[44:47], v[12:15], a[112:119], v3
  v_mov_b64 v[48:49], 0
  v_smfmac_f32_16x16x64_bf16 v[44:47], v[16:19], a[120:127], v3
  v_mov_b64 v[50:51], 0
  v_smfmac_f32_16x16x64_bf16 v[44:47], v[20:23], a[128:135], v3
  v_smfmac_f32_16x16x64_bf16 v[44:47], v[24:27], a[136:143], v3
  v_cvt_pk_bf16_f32 v118, v40, v41
  v_smfmac_f32_16x16x64_bf16 v[44:47], v[28:31], a[144:151], v3
  v_cvt_pk_bf16_f32 v119, v42, v43
  v_smfmac_f32_16x16x64_bf16 v[44:47], v[32:35], a[152:159], v3
  v_smfmac_f32_16x16x64_bf16 v[44:47], v[36:39], a[160:167], v3
  v_smfmac_f32_16x16x64_bf16 v[48:51], v[12:15], a[168:175], v3
  v_mov_b64 v[40:41], 0
  v_smfmac_f32_16x16x64_bf16 v[48:51], v[16:19], a[176:183], v3
  v_mov_b64 v[42:43], 0
  v_smfmac_f32_16x16x64_bf16 v[48:51], v[20:23], a[184:191], v3
  v_smfmac_f32_16x16x64_bf16 v[48:51], v[24:27], a[192:199], v3
  v_cvt_pk_bf16_f32 v112, v44, v45
  v_smfmac_f32_16x16x64_bf16 v[48:51], v[28:31], a[200:207], v3
  v_cvt_pk_bf16_f32 v113, v46, v47
  v_smfmac_f32_16x16x64_bf16 v[48:51], v[32:35], a[208:215], v3
  v_smfmac_f32_16x16x64_bf16 v[48:51], v[36:39], a[216:223], v3
  v_smfmac_f32_16x16x64_bf16 v[40:43], v[12:15], a[224:231], v3
  v_mov_b64 v[44:45], 0
  v_smfmac_f32_16x16x64_bf16 v[40:43], v[16:19], a[232:239], v3
  v_mov_b64 v[46:47], 0
  v_smfmac_f32_16x16x64_bf16 v[40:43], v[20:23], a[240:247], v3
  v_smfmac_f32_16x16x64_bf16 v[40:43], v[24:27], a[248:255], v3
  v_cvt_pk_bf16_f32 v120, v48, v49
  v_smfmac_f32_16x16x64_bf16 v[40:43], v[28:31], v[176:183], v3
  v_cvt_pk_bf16_f32 v121, v50, v51
  v_smfmac_f32_16x16x64_bf16 v[40:43], v[32:35], v[184:191], v3
  v_smfmac_f32_16x16x64_bf16 v[40:43], v[36:39], v[192:199], v3
  v_smfmac_f32_16x16x64_bf16 v[44:47], v[12:15], v[200:207], v3
  v_smfmac_f32_16x16x64_bf16 v[44:47], v[16:19], v[208:215], v3
  v_smfmac_f32_16x16x64_bf16 v[44:47], v[20:23], v[216:223], v3
  v_smfmac_f32_16x16x64_bf16 v[44:47], v[24:27], v[224:231], v3
  v_cvt_pk_bf16_f32 v114, v40, v41
  v_smfmac_f32_16x16x64_bf16 v[44:47], v[28:31], v[232:239], v3
  v_cvt_pk_bf16_f32 v115, v42, v43
  v_smfmac_f32_16x16x64_bf16 v[44:47], v[32:35], v[240:247], v3
  v_smfmac_f32_16x16x64_bf16 v[44:47], v[36:39], v[248:255], v3
  s_nop 3
  v_mov_b64 v[12:13], 0
  v_mov_b64 v[14:15], 0
  v_mov_b64 v[16:17], 0
  v_mov_b64 v[18:19], 0
  v_cvt_pk_bf16_f32 v122, v44, v45
  v_cvt_pk_bf16_f32 v123, v46, v47
  s_mov_b64 exec, 0xf
  global_load_dword v169, v164, s[14:15] sc1
  s_nop 15
  s_nop 4
  global_load_dword v170, v164, s[14:15] sc1
  s_nop 15
  s_nop 4
b_vw3_bell1:
  global_load_dword v171, v164, s[14:15] sc1
  s_waitcnt vmcnt(2)
  v_cmp_eq_u32 vcc, -1, v169
  s_cbranch_vccz b_vw3_bell1_ok
  global_load_dword v169, v164, s[14:15] sc1
  s_waitcnt vmcnt(2)
  v_cmp_eq_u32 vcc, -1, v170
  s_cbranch_vccz b_vw3_bell1_ok
  global_load_dword v170, v164, s[14:15] sc1
  s_waitcnt vmcnt(2)
  v_cmp_eq_u32 vcc, -1, v171
  s_sub_u32 s25, s25, 1
  s_cbranch_scc1 b_fail
  s_cbranch_vccz b_vw3_bell1_ok
  s_branch b_vw3_bell1
b_vw3_bell1_ok:
  s_mov_b64 exec, -1
b_vw3_pollp:
  global_load_dwordx4 v[48:51], v161, s[14:15] sc1
  global_load_dwordx4 v[40:43], v160, s[14:15] sc1
  global_load_dwordx4 v[44:47], v160, s[14:15] offset:1024 sc1
  s_sub_u32 s25, s25, 1
  s_cbranch_scc1 b_fail
  s_waitcnt vmcnt(2)
  v_smfmac_f32_16x16x64_bf16 v[12:15], v[48:51], v[108:115], v3
  v_max3_u32 v8, v48, v49, v50
  v_smfmac_f32_16x16x64_bf16 v[16:19], v[48:51], v[116:123], v3
  s_waitcnt vmcnt(1)
  v_smfmac_f32_16x16x64_bf16 v[12:15], v[40:43], v[124:131], v3
  v_max3_u32 v8, v8, v51, v40
  v_smfmac_f32_16x16x64_bf16 v[16:19], v[40:43], v[132:139], v3
  v_max3_u32 v8, v8, v41, v42
  s_waitcnt vmcnt(0)
  v_smfmac_f32_16x16x64_bf16 v[12:15], v[44:47], v[140:147], v3
  v_max3_u32 v8, v8, v43, v44
  v_smfmac_f32_16x16x64_bf16 v[16:19], v[44:47], v[148:155], v3
  v_max3_u32 v8, v8, v45, v46
  v_max_u32 v8, v8, v47
  v_cmp_eq_u32 vcc, -1, v8
  s_nop 3
  ds_write_b128 v156, v[12:15]
  s_nop 0
  ds_write_b128 v156, v[16:19] offset:1024
  s_cbranch_vccnz b_vw3_pollp_retry
  s_waitcnt lgkmcnt(0)
  s_barrier
  s_mov_b64 exec, 0xff
  global_store_dword v166, v1, s[12:13]
  s_mov_b64 exec, -1
  ds_read2st64_b32 v[20:21], v157 offset0:0 offset1:2
  ds_read2st64_b32 v[22:23], v157 offset0:8 offset1:10
  ds_read2st64_b32 v[24:25], v157 offset0:16 offset1:18
  ds_read2st64_b32 v[26:27], v157 offset0:24 offset1:26
  s_waitcnt lgkmcnt(0)
  v_pk_add_f32 v[20:21], v[20:21], v[22:23]
  v_pk_add_f32 v[24:25], v[24:25], v[26:27]
  v_pk_add_f32 v[20:21], v[20:21], v[24:25]
  v_add_f32 v20, v20, v21
  s_nop 1
  v_mov_b32_dpp v21, v20 quad_perm:[1,0,3,2] row_mask:0xf bank_mask:0xf
  v_cvt_pk_bf16_f32 v22, v20, v21
  s_mov_b64 exec, s[32:33]
  global_store_dword v158, v22, s[12:13]
  s_mov_b64 exec, -1
  s_cmp_lg_u32 s24, 62
  s_cbranch_scc1 b_vw3_nolast
  s_mov_b64 exec, s[32:33]
  global_store_dword v167, v22, s[52:53] sc1
  global_store_dword v163, v22, s[18:19] sc1
  s_mov_b64 exec, -1
b_vw3_nolast:
  ds_read_b128 v[52:55], v4 offset:0
  ds_read_b128 v[56:59], v4 offset:1024
  ds_read_b128 v[60:63], v4 offset:2048
  ds_read_b128 v[64:67], v4 offset:3072
  ds_read_b128 v[68:71], v4 offset:4096
  ds_read_b128 v[72:75], v4 offset:5120
  ds_read_b128 v[76:79], v4 offset:6144
  ds_read_b128 v[80:83], v4 offset:7168
  ds_read_b128 v[84:87], v4 offset:8192
  ds_read_b128 v[88:91], v4 offset:9216
  ds_read_b128 v[92:95], v4 offset:10240
  ds_read_b128 v[96:99], v4 offset:11264
  ds_read_b128 v[100:103], v4 offset:12288
  ds_read_b128 v[104:107], v4 offset:13312
  v_mov_b64 v[40:41], 0
  v_mov_b64 v[42:43], 0
  s_add_u32 s12, s12, 16384
  s_addc_u32 s13, s13, 0
  s_add_u32 s14, s14, 12288
  s_addc_u32 s15, s15, 0
  s_add_u32 s10, s10, 458752
  s_addc_u32 s11, s11, 0
  s_add_u32 s24, s24, 1
  s_cmp_lt_u32 s24, 63
  s_waitcnt lgkmcnt(0)
  s_cbranch_scc1 b_vw3_step
  s_endpgm
b_vw3_pollp_retry:
  s_nop 7
  v_mov_b64 v[12:13], 0
  v_mov_b64 v[14:15], 0
  v_mov_b64 v[16:17], 0
  v_mov_b64 v[18:19], 0
  s_branch b_vw3_pollp
b_helper:
  s_lshl_b32 s26, s23, 13
  v_lshlrev_b32 v8, 7, v1
  v_add_u32 v8, s26, v8
  v_min_u32 v8, 16256, v8
  s_lshl_b32 s26, s23, 12
  v_and_b32 v9, 31, v1
  v_lshlrev_b32 v9, 7, v9
  v_add_u32 v9, s26, v9
  v_min_u32 v9, 12160, v9
  s_mul_i32 s26, s23, 9600
  v_lshlrev_b32 v5, 7, v1
  v_add_u32 v5, s26, v5
  v_add_u32 v7, 8192, v5
  v_min_u32 v5, 28544, v5
  v_min_u32 v7, 28544, v7
  v_mov_b32 v6, 0
  s_sub_u32 s64, s12, 3072
  s_subb_u32 s65, s13, 0
  s_mov_b64 s[66:67], s[14:15]
  s_mov_b64 s[68:69], s[8:9]
  v_and_b32 v12, 7, v1
  v_lshlrev_b32 v12, 8, v12
  v_add_u32 v12, 8416, v12
  s_cmp_eq_u32 s23, 3
  s_cbranch_scc1 b_hp_relay
  global_load_dword v41, v8, s[64:65]
  global_load_dword v42, v9, s[66:67]
  s_add_u32 s64, s64, 16384
  s_addc_u32 s65, s65, 0
  s_add_u32 s66, s66, 12288
  s_addc_u32 s67, s67, 0
  global_load_dword v41, v8, s[64:65]
  global_load_dword v42, v9, s[66:67]
  s_add_u32 s64, s64, 16384
  s_addc_u32 s65, s65, 0
  s_add_u32 s66, s66, 12288
  s_addc_u32 s67, s67, 0
  global_load_dword v41, v8, s[64:65]
  global_load_dword v42, v9, s[66:67]
  s_add_u32 s64, s64, 16384
  s_addc_u32 s65, s65, 0
  s_add_u32 s66, s66, 12288
  s_addc_u32 s67, s67, 0
  v_mov_b32 v10, 1280
  s_mov_b64 exec, 1
b_hp_xall:
  global_load_dword v11, v10, s[16:17] sc1
  s_sub_u32 s25, s25, 1
  s_cbranch_scc1 b_fail
  s_waitcnt vmcnt(0)
  v_cmp_ne_u32 vcc, 64, v11
  s_cbranch_vccz b_hp_xall_got
  s_sleep 4
  s_branch b_hp_xall
b_hp_xall_got:
  s_mov_b64 exec, -1
  global_load_dword v40, v5, s[68:69]
  s_mov_b64 exec, 0xfff
  global_load_dword v43, v7, s[68:69]
  s_mov_b64 exec, -1
  s_add_u32 s68, s68, 28672
  s_addc_u32 s69, s69, 0
  global_load_dword v40, v5, s[68:69]
  s_mov_b64 exec, 0xfff
  global_load_dword v43, v7, s[68:69]
  s_mov_b64 exec, -1
  s_add_u32 s68, s68, 28672
  s_addc_u32 s69, s69, 0
  s_waitcnt vmcnt(0)
b_hp_step:
  global_load_dword v2, v6, s[12:13] offset:-3072 sc1
  s_sub_u32 s25, s25, 1
  s_cbranch_scc1 b_fail
  s_waitcnt vmcnt(0)
  v_cmp_eq_u32 vcc, -1, v2
  s_cbranch_vccz b_hp_go
  s_sleep 4
  s_branch b_hp_step
b_hp_go:
  s_add_u32 s27, s24, 2
  s_cmp_ge_u32 s27, 64
  s_cbranch_scc1 b_hp_skip
  global_load_dword v41, v8, s[64:65]
  global_load_dword v42, v9, s[66:67]
  s_add_u32 s64, s64, 16384
  s_addc_u32 s65, s65, 0
  s_add_u32 s66, s66, 12288
  s_addc_u32 s67, s67, 0
  global_load_dword v40, v5, s[68:69]
  s_mov_b64 exec, 0xfff
  global_load_dword v43, v7, s[68:69]
  s_mov_b64 exec, -1
  s_add_u32 s68, s68, 28672
  s_addc_u32 s69, s69, 0
b_hp_skip:
  s_add_u32 s12, s12, 16384
  s_addc_u32 s13, s13, 0
  s_add_u32 s24, s24, 1
  s_cmp_lt_u32 s24, 63
  s_cbranch_scc1 b_hp_step
  s_endpgm
b_hp_relay:
  v_mov_b32 v13, 2048
  v_mov_b32 v14, 1
  s_sub_u32 s64, s12, 3072
  s_subb_u32 s65, s13, 0
b_hp_rl:
  global_load_dword v15, v13, s[16:17] sc1
  s_sub_u32 s25, s25, 1
  s_cbranch_scc1 b_fail
  s_waitcnt vmcnt(0)
  v_cmp_ne_u32 vcc, 16, v15
  s_cbranch_vccz b_hp_rl1
  s_sleep 4
  s_branch b_hp_rl
b_hp_rl1:
  s_mov_b64 exec, 0xff
  global_load_dword v16, v12, s[64:65]
  s_waitcnt vmcnt(0)
  global_store_dword v12, v14, s[64:65]
  s_mov_b64 exec, -1
  s_add_u32 s64, s64, 16384
  s_addc_u32 s65, s65, 0
  v_add_u32 v13, 4, v13
  s_add_u32 s24, s24, 1
  s_cmp_lt_u32 s24, 4
  s_cbranch_scc1 b_hp_rl2
b_hp_rl3:
  global_load_dword v16, v6, s[12:13] offset:-3072 sc1
  s_sub_u32 s25, s25, 1
  s_cbranch_scc1 b_fail
  s_waitcnt vmcnt(0)
  v_cmp_eq_u32 vcc, -1, v16
  s_cbranch_vccz b_hp_rl4
  s_sleep 6
  s_branch b_hp_rl3
b_hp_rl4:
  s_add_u32 s12, s12, 16384
  s_addc_u32 s13, s13, 0
b_hp_rl2:
  s_cmp_lt_u32 s24, 63
  s_cbranch_scc1 b_hp_rl
  s_endpgm
b_pub:
  v_mov_b32 v20, v0
  s_mov_b32 s27, 76695845
  v_mul_hi_u32 v21, v20, s27
  v_mul_u32_u24 v22, 56, v21
  v_sub_u32 v22, v20, v22
  v_lshlrev_b32 v31, 4, v20
  v_lshrrev_b32 v23, 3, v22
  v_lshlrev_b32 v23, 10, v23
  v_and_b32 v24, 7, v22
  v_lshrrev_b32 v24, 1, v24
  v_lshl_add_u32 v23, v24, 8, v23
  v_lshl_add_u32 v23, v21, 4, v23
  v_and_b32 v24, 1, v22
  v_lshl_add_u32 v30, v24, 3, v23
  v_add_u32 v20, 256, v0
  v_min_u32 v20, 447, v20
  s_mov_b32 s27, 76695845
  v_mul_hi_u32 v21, v20, s27
  v_mul_u32_u24 v22, 56, v21
  v_sub_u32 v22, v20, v22
  v_lshlrev_b32 v33, 4, v20
  v_lshrrev_b32 v23, 3, v22
  v_lshlrev_b32 v23, 10, v23
  v_and_b32 v24, 7, v22
  v_lshrrev_b32 v24, 1, v24
  v_lshl_add_u32 v23, v24, 8, v23
  v_lshl_add_u32 v23, v21, 4, v23
  v_and_b32 v24, 1, v22
  v_lshl_add_u32 v32, v24, 3, v23
  s_add_u32 s12, s12, 16384
  s_addc_u32 s13, s13, 0
  s_add_u32 s18, s18, 8192
  s_addc_u32 s19, s19, 0
  s_add_u32 s52, s52, 8192
  s_addc_u32 s53, s53, 0
  s_mov_b32 s24, 1
b_pb_step:
  s_cmp_eq_u32 s23, 0
  s_cbranch_scc0 b_pb_w0_n
b_pb_w0:
  global_load_dwordx4 v[8:11], v2, s[12:13] offset:-3072 sc1
  global_load_dwordx4 v[12:15], v2, s[12:13] offset:1024 sc1
  s_sub_u32 s25, s25, 1
  s_cbranch_scc1 b_fail
  s_waitcnt vmcnt(0)
  v_max3_u32 v16, v8, v9, v10
  v_max3_u32 v16, v16, v11, v12
  v_max3_u32 v16, v16, v13, v14
  v_max_u32 v16, v16, v15
  v_cmp_eq_u32 vcc, -1, v16
  s_cbranch_vccz b_pb_w0_ok
  s_sleep 2
  s_branch b_pb_w0
b_pb_w0_ok:
  ds_write_b128 v2, v[8:11] offset:0
  v_add_u32 v17, 0, v2
  global_store_dwordx4 v17, v[8:11], s[52:53] sc1
  ds_write_b128 v2, v[12:15] offset:4096
  v_add_u32 v17, 4096, v2
  global_store_dwordx4 v17, v[12:15], s[52:53] sc1
  s_branch b_pb_j
b_pb_w0_n:
  s_cmp_eq_u32 s23, 1
  s_cbranch_scc0 b_pb_w1_n
b_pb_w1:
  global_load_dwordx4 v[8:11], v2, s[12:13] offset:-2048 sc1
  global_load_dwordx4 v[12:15], v2, s[12:13] offset:2048 sc1
  s_sub_u32 s25, s25, 1
  s_cbranch_scc1 b_fail
  s_waitcnt vmcnt(0)
  v_max3_u32 v16, v8, v9, v10
  v_max3_u32 v16, v16, v11, v12
  v_max3_u32 v16, v16, v13, v14
  v_max_u32 v16, v16, v15
  v_cmp_eq_u32 vcc, -1, v16
  s_cbranch_vccz b_pb_w1_ok
  s_sleep 2
  s_branch b_pb_w1
b_pb_w1_ok:
  ds_write_b128 v2, v[8:11] offset:1024
  v_add_u32 v17, 1024, v2
  global_store_dwordx4 v17, v[8:11], s[52:53] sc1
  ds_write_b128 v2, v[12:15] offset:5120
  v_add_u32 v17, 5120, v2
  global_store_dwordx4 v17, v[12:15], s[52:53] sc1
  s_branch b_pb_j
b_pb_w1_n:
  s_cmp_eq_u32 s23, 2
  s_cbranch_scc0 b_pb_w2_n
b_pb_w2:
  global_load_dwordx4 v[8:11], v2, s[12:13] offset:-1024 sc1
  global_load_dwordx4 v[12:15], v2, s[12:13] offset:3072 sc1
  s_sub_u32 s25, s25, 1
  s_cbranch_scc1 b_fail
  s_waitcnt vmcnt(0)
  v_max3_u32 v16, v8, v9, v10
  v_max3_u32 v16, v16, v11, v12
  v_max3_u32 v16, v16, v13, v14
  v_max_u32 v16, v16, v15
  v_cmp_eq_u32 vcc, -1, v16
  s_cbranch_vccz b_pb_w2_ok
  s_sleep 2
  s_branch b_pb_w2
b_pb_w2_ok:
  ds_write_b128 v2, v[8:11] offset:2048
  v_add_u32 v17, 2048, v2
  global_store_dwordx4 v17, v[8:11], s[52:53] sc1
  ds_write_b128 v2, v[12:15] offset:6144
  v_add_u32 v17, 6144, v2
  global_store_dwordx4 v17, v[12:15], s[52:53] sc1
  s_branch b_pb_j
b_pb_w2_n:
b_pb_w3:
  global_load_dwordx4 v[8:11], v2, s[12:13] offset:0 sc1
  s_sub_u32 s25, s25, 1
  s_cbranch_scc1 b_fail
  s_waitcnt vmcnt(0)
  v_max3_u32 v16, v8, v9, v10
  v_max_u32 v16, v16, v11
  v_cmp_eq_u32 vcc, -1, v16
  s_cbranch_vccz b_pb_w3_ok
  s_sleep 2
  s_branch b_pb_w3
b_pb_w3_ok:
  ds_write_b128 v2, v[8:11] offset:3072
  v_add_u32 v17, 3072, v2
  global_store_dwordx4 v17, v[8:11], s[52:53] sc1
b_pb_j:
  s_waitcnt lgkmcnt(0)
  s_barrier
  ds_read_b32 v40, v30
  ds_read_b32 v41, v30 offset:128
  ds_read_b32 v42, v30 offset:4
  ds_read_b32 v43, v30 offset:132
  ds_read_b32 v44, v32
  ds_read_b32 v45, v32 offset:128
  ds_read_b32 v46, v32 offset:4
  ds_read_b32 v47, v32 offset:132
  s_waitcnt lgkmcnt(0)
  global_store_dwordx4 v31, v[40:43], s[18:19] sc1
  global_store_dwordx4 v33, v[44:47], s[18:19] sc1
  s_barrier
  s_add_u32 s12, s12, 16384
  s_addc_u32 s13, s13, 0
  s_add_u32 s18, s18, 8192
  s_addc_u32 s19, s19, 0
  s_add_u32 s52, s52, 8192
  s_addc_u32 s53, s53, 0
  s_add_u32 s24, s24, 1
  s_cmp_lt_u32 s24, 63
  s_cbranch_scc1 b_pb_step
  s_endpgm
b_uw:
  s_and_b32 s43, s22, 15
  s_lshr_b32 s44, s22, 4
  s_mul_i32 s26, s43, 401408
  s_add_u32 s26, s26, 6422528
  s_mul_i32 s27, s23, 100352
  s_add_u32 s26, s26, s27
  s_add_u32 s6, s6, s26
  s_addc_u32 s7, s7, 0
  v_add_u32 v4, 0, v2
  global_load_dwordx4 a[0:3], v4, s[6:7]
  global_load_dwordx4 a[4:7], v4, s[6:7] offset:1024
  v_add_u32 v4, 2048, v2
  global_load_dwordx4 a[8:11], v4, s[6:7]
  global_load_dwordx4 a[12:15], v4, s[6:7] offset:1024
  v_add_u32 v4, 4096, v2
  global_load_dwordx4 a[16:19], v4, s[6:7]
  global_load_dwordx4 a[20:23], v4, s[6:7] offset:1024
  v_add_u32 v4, 6144, v2
  global_load_dwordx4 a[24:27], v4, s[6:7]
  global_load_dwordx4 a[28:31], v4, s[6:7] offset:1024
  v_add_u32 v4, 8192, v2
  global_load_dwordx4 a[32:35], v4, s[6:7]
  global_load_dwordx4 a[36:39], v4, s[6:7] offset:1024
  v_add_u32 v4, 10240, v2
  global_load_dwordx4 a[40:43], v4, s[6:7]
  global_load_dwordx4 a[44:47], v4, s[6:7] offset:1024
  v_add_u32 v4, 12288, v2
  global_load_dwordx4 a[48:51], v4, s[6:7]
  global_load_dwordx4 a[52:55], v4, s[6:7] offset:1024
  v_add_u32 v4, 14336, v2
  global_load_dwordx4 a[56:59], v4, s[6:7]
  global_load_dwordx4 a[60:63], v4, s[6:7] offset:1024
  v_add_u32 v4, 16384, v2
  global_load_dwordx4 a[64:67], v4, s[6:7]
  global_load_dwordx4 a[68:71], v4, s[6:7] offset:1024
  v_add_u32 v4, 18432, v2
  global_load_dwordx4 a[72:75], v4, s[6:7]
  global_load_dwordx4 a[76:79], v4, s[6:7] offset:1024
  v_add_u32 v4, 20480, v2
  global_load_dwordx4 a[80:83], v4, s[6:7]
  global_load_dwordx4 a[84:87], v4, s[6:7] offset:1024
  v_add_u32 v4, 22528, v2
  global_load_dwordx4 a[88:91], v4, s[6:7]
  global_load_dwordx4 a[92:95], v4, s[6:7] offset:1024
  v_add_u32 v4, 24576, v2
  global_load_dwordx4 a[96:99], v4, s[6:7]
  global_load_dwordx4 a[100:103], v4, s[6:7] offset:1024
  v_add_u32 v4, 26624, v2
  global_load_dwordx4 a[104:107], v4, s[6:7]
  global_load_dwordx4 a[108:111], v4, s[6:7] offset:1024
  v_add_u32 v4, 28672, v2
  global_load_dwordx4 a[112:115], v4, s[6:7]
  global_load_dwordx4 a[116:119], v4, s[6:7] offset:1024
  v_add_u32 v4, 30720, v2
  global_load_dwordx4 a[120:123], v4, s[6:7]
  global_load_dwordx4 a[124:127], v4, s[6:7] offset:1024
  s_waitcnt vmcnt(32)
  v_add_u32 v4, 32768, v2
  global_load_dwordx4 a[128:131], v4, s[6:7]
  global_load_dwordx4 a[132:135], v4, s[6:7] offset:1024
  v_add_u32 v4, 34816, v2
  global_load_dwordx4 a[136:139], v4, s[6:7]
  global_load_dwordx4 a[140:143], v4, s[6:7] offset:1024
  v_add_u32 v4, 36864, v2
  global_load_dwordx4 a[144:147], v4, s[6:7]
  global_load_dwordx4 a[148:151], v4, s[6:7] offset:1024
  v_add_u32 v4, 38912, v2
  global_load_dwordx4 a[152:155], v4, s[6:7]
  global_load_dwordx4 a[156:159], v4, s[6:7] offset:1024
  v_add_u32 v4, 40960, v2
  global_load_dwordx4 a[160:163], v4, s[6:7]
  global_load_dwordx4 a[164:167], v4, s[6:7] offset:1024
  v_add_u32 v4, 43008, v2
  global_load_dwordx4 a[168:171], v4, s[6:7]
  global_load_dwordx4 a[172:175], v4, s[6:7] offset:1024
  v_add_u32 v4, 45056, v2
  global_load_dwordx4 a[176:179], v4, s[6:7]
  global_load_dwordx4 a[180:183], v4, s[6:7] offset:1024
  v_add_u32 v4, 47104, v2
  global_load_dwordx4 a[184:187], v4, s[6:7]
  global_load_dwordx4 a[188:191], v4, s[6:7] offset:1024
  v_add_u32 v4, 49152, v2
  global_load_dwordx4 a[192:195], v4, s[6:7]
  global_load_dwordx4 a[196:199], v4, s[6:7] offset:1024
  v_add_u32 v4, 51200, v2
  global_load_dwordx4 a[200:203], v4, s[6:7]
  global_load_dwordx4 a[204:207], v4, s[6:7] offset:1024
  v_add_u32 v4, 53248, v2
  global_load_dwordx4 a[208:211], v4, s[6:7]
  global_load_dwordx4 a[212:215], v4, s[6:7] offset:1024
  v_add_u32 v4, 55296, v2
  global_load_dwordx4 a[216:219], v4, s[6:7]
  global_load_dwordx4 a[220:223], v4, s[6:7] offset:1024
  v_add_u32 v4, 57344, v2
  global_load_dwordx4 a[224:227], v4, s[6:7]
  global_load_dwordx4 a[228:231], v4, s[6:7] offset:1024
  v_add_u32 v4, 59392, v2
  global_load_dwordx4 a[232:235], v4, s[6:7]
  global_load_dwordx4 a[236:239], v4, s[6:7] offset:1024
  v_add_u32 v4, 61440, v2
  global_load_dwordx4 a[240:243], v4, s[6:7]
  global_load_dwordx4 a[244:247], v4, s[6:7] offset:1024
  v_add_u32 v4, 63488, v2
  global_load_dwordx4 a[248:251], v4, s[6:7]
  global_load_dwordx4 a[252:255], v4, s[6:7] offset:1024
  s_waitcnt vmcnt(32)
  v_add_u32 v4, 65536, v2
  global_load_dwordx4 v[120:123], v4, s[6:7]
  global_load_dwordx4 v[124:127], v4, s[6:7] offset:1024
  v_add_u32 v4, 67584, v2
  global_load_dwordx4 v[128:131], v4, s[6:7]
  global_load_dwordx4 v[132:135], v4, s[6:7] offset:1024
  v_add_u32 v4, 69632, v2
  global_load_dwordx4 v[136:139], v4, s[6:7]
  global_load_dwordx4 v[140:143], v4, s[6:7] offset:1024
  v_add_u32 v4, 71680, v2
  global_load_dwordx4 v[144:147], v4, s[6:7]
  global_load_dwordx4 v[148:151], v4, s[6:7] offset:1024
  v_add_u32 v4, 73728, v2
  global_load_dwordx4 v[152:155], v4, s[6:7]
  global_load_dwordx4 v[156:159], v4, s[6:7] offset:1024
  v_add_u32 v4, 75776, v2
  global_load_dwordx4 v[160:163], v4, s[6:7]
  global_load_dwordx4 v[164:167], v4, s[6:7] offset:1024
  v_add_u32 v4, 77824, v2
  global_load_dwordx4 v[168:171], v4, s[6:7]
  global_load_dwordx4 v[172:175], v4, s[6:7] offset:1024
  v_add_u32 v4, 79872, v2
  global_load_dwordx4 v[176:179], v4, s[6:7]
  global_load_dwordx4 v[180:183], v4, s[6:7] offset:1024
  v_add_u32 v4, 81920, v2
  global_load_dwordx4 v[184:187], v4, s[6:7]
  global_load_dwordx4 v[188:191], v4, s[6:7] offset:1024
  v_add_u32 v4, 83968, v2
  global_load_dwordx4 v[192:195], v4, s[6:7]
  global_load_dwordx4 v[196:199], v4, s[6:7] offset:1024
  v_add_u32 v4, 86016, v2
  global_load_dwordx4 v[200:203], v4, s[6:7]
  global_load_dwordx4 v[204:207], v4, s[6:7] offset:1024
  v_add_u32 v4, 88064, v2
  global_load_dwordx4 v[208:211], v4, s[6:7]
  global_load_dwordx4 v[212:215], v4, s[6:7] offset:1024
  v_add_u32 v4, 90112, v2
  global_load_dwordx4 v[216:219], v4, s[6:7]
  global_load_dwordx4 v[220:223], v4, s[6:7] offset:1024
  v_add_u32 v4, 92160, v2
  global_load_dwordx4 v[224:227], v4, s[6:7]
  global_load_dwordx4 v[228:231], v4, s[6:7] offset:1024
  v_add_u32 v4, 94208, v2
  global_load_dwordx4 v[232:235], v4, s[6:7]
  global_load_dwordx4 v[236:239], v4, s[6:7] offset:1024
  v_add_u32 v4, 96256, v2
  global_load_dwordx4 v[240:243], v4, s[6:7]
  global_load_dwordx4 v[244:247], v4, s[6:7] offset:1024
  s_waitcnt vmcnt(32)
  v_add_u32 v4, 98304, v2
  global_load_dwordx4 v[248:251], v4, s[6:7]
  global_load_dwordx4 v[252:255], v4, s[6:7] offset:1024
  s_waitcnt vmcnt(0)
  s_lshl_b32 s26, s44, 7
  s_add_u32 s26, s26, 16384
  s_cmp_lg_u32 s23, 0
  s_cbranch_scc1 b_uw_x0_ok
  v_mov_b32 v4, s26
  s_mov_b64 exec, 1
b_uw_x0:
  global_load_dword v5, v4, s[16:17] sc1
  s_sub_u32 s25, s25, 1
  s_cbranch_scc1 b_fail
  s_waitcnt vmcnt(0)
  v_cmp_ne_u32 vcc, 2, v5
  s_cbranch_vccz b_uw_x0_got
  s_sleep 2
  s_branch b_uw_x0
b_uw_x0_got:
  s_mov_b64 exec, -1
b_uw_x0_ok:
  s_barrier
  s_mov_b32 s54, 255
  s_mov_b32 s41, s44
  s_mov_b32 s42, 0
  s_mov_b32 s45, s41
  s_mov_b32 s46, 0
  s_mul_i32 s26, s45, 28672
  s_mul_i32 s27, s23, 7168
  s_add_u32 s26, s26, s27
  v_add_u32 v4, s26, v2
  s_add_u32 s27, s27, s46
  s_add_u32 m0, s27, 0
  s_nop 0
  global_load_lds_dwordx4 v4, s[8:9] sc1
  v_add_u32 v4, 1024, v4
  s_add_u32 m0, s27, 1024
  s_nop 0
  global_load_lds_dwordx4 v4, s[8:9] sc1
  v_add_u32 v4, 1024, v4
  s_add_u32 m0, s27, 2048
  s_nop 0
  global_load_lds_dwordx4 v4, s[8:9] sc1
  v_add_u32 v4, 1024, v4
  s_add_u32 m0, s27, 3072
  s_nop 0
  global_load_lds_dwordx4 v4, s[8:9] sc1
  v_add_u32 v4, 1024, v4
  s_add_u32 m0, s27, 4096
  s_nop 0
  global_load_lds_dwordx4 v4, s[8:9] sc1
  v_add_u32 v4, 1024, v4
  s_add_u32 m0, s27, 5120
  s_nop 0
  global_load_lds_dwordx4 v4, s[8:9] sc1
  v_add_u32 v4, 1024, v4
  s_add_u32 m0, s27, 6144
  s_nop 0
  global_load_lds_dwordx4 v4, s[8:9] sc1
  v_add_u32 v4, 1024, v4
  s_waitcnt vmcnt(0)
b_uw_seg:
  s_barrier
  s_add_u32 s45, s41, 2
  s_cmp_ge_u32 s45, 64
  s_cbranch_scc1 b_uw_nopf
  s_cmp_lt_u32 s41, 2
  s_cbranch_scc1 b_uw_nopf
  s_cmp_ge_u32 s41, 6
  s_cbranch_scc1 b_uw_xok
  s_lshl_b32 s26, s45, 7
  s_add_u32 s26, s26, 16384
  s_cmp_lg_u32 s23, 0
  s_cbranch_scc1 b_uw_x1_ok
  v_mov_b32 v4, s26
  s_mov_b64 exec, 1
b_uw_x1:
  global_load_dword v5, v4, s[16:17] sc1
  s_sub_u32 s25, s25, 1
  s_cbranch_scc1 b_fail
  s_waitcnt vmcnt(0)
  v_cmp_ne_u32 vcc, 2, v5
  s_cbranch_vccz b_uw_x1_got
  s_sleep 2
  s_branch b_uw_x1
b_uw_x1_got:
  s_mov_b64 exec, -1
b_uw_x1_ok:
  s_barrier
  s_branch b_uw_xok2
b_uw_xok:
  s_cmp_ge_u32 s41, 8
  s_cbranch_scc1 b_uw_xok2
  s_mov_b32 s26, 1280
  s_cmp_lg_u32 s23, 0
  s_cbranch_scc1 b_uw_x2_ok
  v_mov_b32 v4, s26
  s_mov_b64 exec, 1
b_uw_x2:
  global_load_dword v5, v4, s[16:17] sc1
  s_sub_u32 s25, s25, 1
  s_cbranch_scc1 b_fail
  s_waitcnt vmcnt(0)
  v_cmp_ne_u32 vcc, 64, v5
  s_cbranch_vccz b_uw_x2_got
  s_sleep 8
  s_branch b_uw_x2
b_uw_x2_got:
  s_mov_b64 exec, -1
b_uw_x2_ok:
  s_barrier
b_uw_xok2:
  s_xor_b32 s46, s42, 28672
  s_mul_i32 s26, s45, 28672
  s_mul_i32 s27, s23, 7168
  s_add_u32 s26, s26, s27
  v_add_u32 v4, s26, v2
  s_add_u32 s27, s27, s46
  s_add_u32 m0, s27, 0
  s_nop 0
  global_load_lds_dwordx4 v4, s[8:9] sc1
  v_add_u32 v4, 1024, v4
  s_add_u32 m0, s27, 1024
  s_nop 0
  global_load_lds_dwordx4 v4, s[8:9] sc1
  v_add_u32 v4, 1024, v4
  s_add_u32 m0, s27, 2048
  s_nop 0
  global_load_lds_dwordx4 v4, s[8:9] sc1
  v_add_u32 v4, 1024, v4
  s_add_u32 m0, s27, 3072
  s_nop 0
  global_load_lds_dwordx4 v4, s[8:9] sc1
  v_add_u32 v4, 1024, v4
  s_add_u32 m0, s27, 4096
  s_nop 0
  global_load_lds_dwordx4 v4, s[8:9] sc1
  v_add_u32 v4, 1024, v4
  s_add_u32 m0, s27, 5120
  s_nop 0
  global_load_lds_dwordx4 v4, s[8:9] sc1
  v_add_u32 v4, 1024, v4
  s_add_u32 m0, s27, 6144
  s_nop 0
  global_load_lds_dwordx4 v4, s[8:9] sc1
  v_add_u32 v4, 1024, v4
b_uw_nopf:
  v_add_u32 v5, s42, v2
  ds_read_b128 v[64:67], v5 offset:0
  ds_read_b128 v[68:71], v5 offset:14336
  ds_read_b128 v[72:75], v5 offset:1024
  ds_read_b128 v[76:79], v5 offset:15360
  s_waitcnt lgkmcnt(3)
  v_mfma_f32_16x16x32_bf16 v[8:11], v[64:67], a[0:3], 0
  v_mfma_f32_16x16x32_bf16 v[12:15], v[64:67], a[56:59], 0
  v_mfma_f32_16x16x32_bf16 v[16:19], v[64:67], a[112:115], 0
  v_mfma_f32_16x16x32_bf16 v[20:23], v[64:67], a[168:171], 0
  v_mfma_f32_16x16x32_bf16 v[24:27], v[64:67], a[224:227], 0
  v_mfma_f32_16x16x32_bf16 v[28:31], v[64:67], v[144:147], 0
  v_mfma_f32_16x16x32_bf16 v[32:35], v[64:67], v[200:203], 0
  ds_read_b128 v[64:67], v5 offset:2048
  s_waitcnt lgkmcnt(3)
  v_mfma_f32_16x16x32_bf16 v[36:39], v[68:71], a[0:3], 0
  v_mfma_f32_16x16x32_bf16 v[40:43], v[68:71], a[56:59], 0
  v_mfma_f32_16x16x32_bf16 v[44:47], v[68:71], a[112:115], 0
  v_mfma_f32_16x16x32_bf16 v[48:51], v[68:71], a[168:171], 0
  v_mfma_f32_16x16x32_bf16 v[52:55], v[68:71], a[224:227], 0
  v_mfma_f32_16x16x32_bf16 v[56:59], v[68:71], v[144:147], 0
  v_mfma_f32_16x16x32_bf16 v[60:63], v[68:71], v[200:203], 0
  ds_read_b128 v[68:71], v5 offset:16384
  s_waitcnt lgkmcnt(3)
  v_mfma_f32_16x16x32_bf16 v[8:11], v[72:75], a[4:7], v[8:11]
  v_mfma_f32_16x16x32_bf16 v[12:15], v[72:75], a[60:63], v[12:15]
  v_mfma_f32_16x16x32_bf16 v[16:19], v[72:75], a[116:119], v[16:19]
  v_mfma_f32_16x16x32_bf16 v[20:23], v[72:75], a[172:175], v[20:23]
  v_mfma_f32_16x16x32_bf16 v[24:27], v[72:75], a[228:231], v[24:27]
  v_mfma_f32_16x16x32_bf16 v[28:31], v[72:75], v[148:151], v[28:31]
  v_mfma_f32_16x16x32_bf16 v[32:35], v[72:75], v[204:207], v[32:35]
  ds_read_b128 v[72:75], v5 offset:3072
  s_waitcnt lgkmcnt(3)
  v_mfma_f32_16x16x32_bf16 v[36:39], v[76:79], a[4:7], v[36:39]
  v_mfma_f32_16x16x32_bf16 v[40:43], v[76:79], a[60:63], v[40:43]
  v_mfma_f32_16x16x32_bf16 v[44:47], v[76:79], a[116:119], v[44:47]
  v_mfma_f32_16x16x32_bf16 v[48:51], v[76:79], a[172:175], v[48:51]
  v_mfma_f32_16x16x32_bf16 v[52:55], v[76:79], a[228:231], v[52:55]
  v_mfma_f32_16x16x32_bf16 v[56:59], v[76:79], v[148:151], v[56:59]
  v_mfma_f32_16x16x32_bf16 v[60:63], v[76:79], v[204:207], v[60:63]
  ds_read_b128 v[76:79], v5 offset:17408
  s_waitcnt lgkmcnt(3)
  v_mfma_f32_16x16x32_bf16 v[8:11], v[64:67], a[8:11], v[8:11]
  v_mfma_f32_16x16x32_bf16 v[12:15], v[64:67], a[64:67], v[12:15]
  v_mfma_f32_16x16x32_bf16 v[16:19], v[64:67], a[120:123], v[16:19]
  v_mfma_f32_16x16x32_bf16 v[20:23], v[64:67], a[176:179], v[20:23]
  v_mfma_f32_16x16x32_bf16 v[24:27], v[64:67], a[232:235], v[24:27]
  v_mfma_f32_16x16x32_bf16 v[28:31], v[64:67], v[152:155], v[28:31]
  v_mfma_f32_16x16x32_bf16 v[32:35], v[64:67], v[208:211], v[32:35]
  ds_read_b128 v[64:67], v5 offset:4096
  s_waitcnt lgkmcnt(3)
  v_mfma_f32_16x16x32_bf16 v[36:39], v[68:71], a[8:11], v[36:39]
  v_mfma_f32_16x16x32_bf16 v[40:43], v[68:71], a[64:67], v[40:43]
  v_mfma_f32_16x16x32_bf16 v[44:47], v[68:71], a[120:123], v[44:47]
  v_mfma_f32_16x16x32_bf16 v[48:51], v[68:71], a[176:179], v[48:51]
  v_mfma_f32_16x16x32_bf16 v[52:55], v[68:71], a[232:235], v[52:55]
  v_mfma_f32_16x16x32_bf16 v[56:59], v[68:71], v[152:155], v[56:59]
  v_mfma_f32_16x16x32_bf16 v[60:63], v[68:71], v[208:211], v[60:63]
  ds_read_b128 v[68:71], v5 offset:18432
  s_waitcnt lgkmcnt(3)
  v_mfma_f32_16x16x32_bf16 v[8:11], v[72:75], a[12:15], v[8:11]
  v_mfma_f32_16x16x32_bf16 v[12:15], v[72:75], a[68:71], v[12:15]
  v_mfma_f32_16x16x32_bf16 v[16:19], v[72:75], a[124:127], v[16:19]
  v_mfma_f32_16x16x32_bf16 v[20:23], v[72:75], a[180:183], v[20:23]
  v_mfma_f32_16x16x32_bf16 v[24:27], v[72:75], a[236:239], v[24:27]
  v_mfma_f32_16x16x32_bf16 v[28:31], v[72:75], v[156:159], v[28:31]
  v_mfma_f32_16x16x32_bf16 v[32:35], v[72:75], v[212:215], v[32:35]
  ds_read_b128 v[72:75], v5 offset:5120
  s_waitcnt lgkmcnt(3)
  v_mfma_f32_16x16x32_bf16 v[36:39], v[76:79], a[12:15], v[36:39]
  v_mfma_f32_16x16x32_bf16 v[40:43], v[76:79], a[68:71], v[40:43]
  v_mfma_f32_16x16x32_bf16 v[44:47], v[76:79], a[124:127], v[44:47]
  v_mfma_f32_16x16x32_bf16 v[48:51], v[76:79], a[180:183], v[48:51]
  v_mfma_f32_16x16x32_bf16 v[52:55], v[76:79], a[236:239], v[52:55]
  v_mfma_f32_16x16x32_bf16 v[56:59], v[76:79], v[156:159], v[56:59]
  v_mfma_f32_16x16x32_bf16 v[60:63], v[76:79], v[212:215], v[60:63]
  ds_read_b128 v[76:79], v5 offset:19456
  s_waitcnt lgkmcnt(3)
  v_mfma_f32_16x16x32_bf16 v[8:11], v[64:67], a[16:19], v[8:11]
  v_mfma_f32_16x16x32_bf16 v[12:15], v[64:67], a[72:75], v[12:15]
  v_mfma_f32_16x16x32_bf16 v[16:19], v[64:67], a[128:131], v[16:19]
  v_mfma_f32_16x16x32_bf16 v[20:23], v[64:67], a[184:187], v[20:23]
  v_mfma_f32_16x16x32_bf16 v[24:27], v[64:67], a[240:243], v[24:27]
  v_mfma_f32_16x16x32_bf16 v[28:31], v[64:67], v[160:163], v[28:31]
  v_mfma_f32_16x16x32_bf16 v[32:35], v[64:67], v[216:219], v[32:35]
  ds_read_b128 v[64:67], v5 offset:6144
  s_waitcnt lgkmcnt(3)
  v_mfma_f32_16x16x32_bf16 v[36:39], v[68:71], a[16:19], v[36:39]
  v_mfma_f32_16x16x32_bf16 v[40:43], v[68:71], a[72:75], v[40:43]
  v_mfma_f32_16x16x32_bf16 v[44:47], v[68:71], a[128:131], v[44:47]
  v_mfma_f32_16x16x32_bf16 v[48:51], v[68:71], a[184:187], v[48:51]
  v_mfma_f32_16x16x32_bf16 v[52:55], v[68:71], a[240:243], v[52:55]
  v_mfma_f32_16x16x32_bf16 v[56:59], v[68:71], v[160:163], v[56:59]
  v_mfma_f32_16x16x32_bf16 v[60:63], v[68:71], v[216:219], v[60:63]
  ds_read_b128 v[68:71], v5 offset:20480
  s_waitcnt lgkmcnt(3)
  v_mfma_f32_16x16x32_bf16 v[8:11], v[72:75], a[20:23], v[8:11]
  v_mfma_f32_16x16x32_bf16 v[12:15], v[72:75], a[76:79], v[12:15]
  v_mfma_f32_16x16x32_bf16 v[16:19], v[72:75], a[132:135], v[16:19]
  v_mfma_f32_16x16x32_bf16 v[20:23], v[72:75], a[188:191], v[20:23]
  v_mfma_f32_16x16x32_bf16 v[24:27], v[72:75], a[244:247], v[24:27]
  v_mfma_f32_16x16x32_bf16 v[28:31], v[72:75], v[164:167], v[28:31]
  v_mfma_f32_16x16x32_bf16 v[32:35], v[72:75], v[220:223], v[32:35]
  ds_read_b128 v[72:75], v5 offset:7168
  s_waitcnt lgkmcnt(3)
  v_mfma_f32_16x16x32_bf16 v[36:39], v[76:79], a[20:23], v[36:39]
  v_mfma_f32_16x16x32_bf16 v[40:43], v[76:79], a[76:79], v[40:43]
  v_mfma_f32_16x16x32_bf16 v[44:47], v[76:79], a[132:135], v[44:47]
  v_mfma_f32_16x16x32_bf16 v[48:51], v[76:79], a[188:191], v[48:51]
  v_mfma_f32_16x16x32_bf16 v[52:55], v[76:79], a[244:247], v[52:55]
  v_mfma_f32_16x16x32_bf16 v[56:59], v[76:79], v[164:167], v[56:59]
  v_mfma_f32_16x16x32_bf16 v[60:63], v[76:79], v[220:223], v[60:63]
  ds_read_b128 v[76:79], v5 offset:21504
  s_waitcnt lgkmcnt(3)
  v_mfma_f32_16x16x32_bf16 v[8:11], v[64:67], a[24:27], v[8:11]
  v_mfma_f32_16x16x32_bf16 v[12:15], v[64:67], a[80:83], v[12:15]
  v_mfma_f32_16x16x32_bf16 v[16:19], v[64:67], a[136:139], v[16:19]
  v_mfma_f32_16x16x32_bf16 v[20:23], v[64:67], a[192:195], v[20:23]
  v_mfma_f32_16x16x32_bf16 v[24:27], v[64:67], a[248:251], v[24:27]
  v_mfma_f32_16x16x32_bf16 v[28:31], v[64:67], v[168:171], v[28:31]
  v_mfma_f32_16x16x32_bf16 v[32:35], v[64:67], v[224:227], v[32:35]
  ds_read_b128 v[64:67], v5 offset:8192
  s_waitcnt lgkmcnt(3)
  v_mfma_f32_16x16x32_bf16 v[36:39], v[68:71], a[24:27], v[36:39]
  v_mfma_f32_16x16x32_bf16 v[40:43], v[68:71], a[80:83], v[40:43]
  v_mfma_f32_16x16x32_bf16 v[44:47], v[68:71], a[136:139], v[44:47]
  v_mfma_f32_16x16x32_bf16 v[48:51], v[68:71], a[192:195], v[48:51]
  v_mfma_f32_16x16x32_bf16 v[52:55], v[68:71], a[248:251], v[52:55]
  v_mfma_f32_16x16x32_bf16 v[56:59], v[68:71], v[168:171], v[56:59]
  v_mfma_f32_16x16x32_bf16 v[60:63], v[68:71], v[224:227], v[60:63]
  ds_read_b128 v[68:71], v5 offset:22528
  s_waitcnt lgkmcnt(3)
  v_mfma_f32_16x16x32_bf16 v[8:11], v[72:75], a[28:31], v[8:11]
  v_mfma_f32_16x16x32_bf16 v[12:15], v[72:75], a[84:87], v[12:15]
  v_mfma_f32_16x16x32_bf16 v[16:19], v[72:75], a[140:143], v[16:19]
  v_mfma_f32_16x16x32_bf16 v[20:23], v[72:75], a[196:199], v[20:23]
  v_mfma_f32_16x16x32_bf16 v[24:27], v[72:75], a[252:255], v[24:27]
  v_mfma_f32_16x16x32_bf16 v[28:31], v[72:75], v[172:175], v[28:31]
  v_mfma_f32_16x16x32_bf16 v[32:35], v[72:75], v[228:231], v[32:35]
  ds_read_b128 v[72:75], v5 offset:9216
  s_waitcnt lgkmcnt(3)
  v_mfma_f32_16x16x32_bf16 v[36:39], v[76:79], a[28:31], v[36:39]
  v_mfma_f32_16x16x32_bf16 v[40:43], v[76:79], a[84:87], v[40:43]
  v_mfma_f32_16x16x32_bf16 v[44:47], v[76:79], a[140:143], v[44:47]
  v_mfma_f32_16x16x32_bf16 v[48:51], v[76:79], a[196:199], v[48:51]
  v_mfma_f32_16x16x32_bf16 v[52:55], v[76:79], a[252:255], v[52:55]
  v_mfma_f32_16x16x32_bf16 v[56:59], v[76:79], v[172:175], v[56:59]
  v_mfma_f32_16x16x32_bf16 v[60:63], v[76:79], v[228:231], v[60:63]
  ds_read_b128 v[76:79], v5 offset:23552
  s_waitcnt lgkmcnt(3)
  v_mfma_f32_16x16x32_bf16 v[8:11], v[64:67], a[32:35], v[8:11]
  v_mfma_f32_16x16x32_bf16 v[12:15], v[64:67], a[88:91], v[12:15]
  v_mfma_f32_16x16x32_bf16 v[16:19], v[64:67], a[144:147], v[16:19]
  v_mfma_f32_16x16x32_bf16 v[20:23], v[64:67], a[200:203], v[20:23]
  v_mfma_f32_16x16x32_bf16 v[24:27], v[64:67], v[120:123], v[24:27]
  v_mfma_f32_16x16x32_bf16 v[28:31], v[64:67], v[176:179], v[28:31]
  v_mfma_f32_16x16x32_bf16 v[32:35], v[64:67], v[232:235], v[32:35]
  ds_read_b128 v[64:67], v5 offset:10240
  s_waitcnt lgkmcnt(3)
  v_mfma_f32_16x16x32_bf16 v[36:39], v[68:71], a[32:35], v[36:39]
  v_mfma_f32_16x16x32_bf16 v[40:43], v[68:71], a[88:91], v[40:43]
  v_mfma_f32_16x16x32_bf16 v[44:47], v[68:71], a[144:147], v[44:47]
  v_mfma_f32_16x16x32_bf16 v[48:51], v[68:71], a[200:203], v[48:51]
  v_mfma_f32_16x16x32_bf16 v[52:55], v[68:71], v[120:123], v[52:55]
  v_mfma_f32_16x16x32_bf16 v[56:59], v[68:71], v[176:179], v[56:59]
  v_mfma_f32_16x16x32_bf16 v[60:63], v[68:71], v[232:235], v[60:63]
  ds_read_b128 v[68:71], v5 offset:24576
  s_waitcnt lgkmcnt(3)
  v_mfma_f32_16x16x32_bf16 v[8:11], v[72:75], a[36:39], v[8:11]
  v_mfma_f32_16x16x32_bf16 v[12:15], v[72:75], a[92:95], v[12:15]
  v_mfma_f32_16x16x32_bf16 v[16:19], v[72:75], a[148:151], v[16:19]
  v_mfma_f32_16x16x32_bf16 v[20:23], v[72:75], a[204:207], v[20:23]
  v_mfma_f32_16x16x32_bf16 v[24:27], v[72:75], v[124:127], v[24:27]
  v_mfma_f32_16x16x32_bf16 v[28:31], v[72:75], v[180:183], v[28:31]
  v_mfma_f32_16x16x32_bf16 v[32:35], v[72:75], v[236:239], v[32:35]
  ds_read_b128 v[72:75], v5 offset:11264
  s_waitcnt lgkmcnt(3)
  v_mfma_f32_16x16x32_bf16 v[36:39], v[76:79], a[36:39], v[36:39]
  v_mfma_f32_16x16x32_bf16 v[40:43], v[76:79], a[92:95], v[40:43]
  v_mfma_f32_16x16x32_bf16 v[44:47], v[76:79], a[148:151], v[44:47]
  v_mfma_f32_16x16x32_bf16 v[48:51], v[76:79], a[204:207], v[48:51]
  v_mfma_f32_16x16x32_bf16 v[52:55], v[76:79], v[124:127], v[52:55]
  v_mfma_f32_16x16x32_bf16 v[56:59], v[76:79], v[180:183], v[56:59]
  v_mfma_f32_16x16x32_bf16 v[60:63], v[76:79], v[236:239], v[60:63]
  ds_read_b128 v[76:79], v5 offset:25600
  s_waitcnt lgkmcnt(3)
  v_mfma_f32_16x16x32_bf16 v[8:11], v[64:67], a[40:43], v[8:11]
  v_mfma_f32_16x16x32_bf16 v[12:15], v[64:67], a[96:99], v[12:15]
  v_mfma_f32_16x16x32_bf16 v[16:19], v[64:67], a[152:155], v[16:19]
  v_mfma_f32_16x16x32_bf16 v[20:23], v[64:67], a[208:211], v[20:23]
  v_mfma_f32_16x16x32_bf16 v[24:27], v[64:67], v[128:131], v[24:27]
  v_mfma_f32_16x16x32_bf16 v[28:31], v[64:67], v[184:187], v[28:31]
  v_mfma_f32_16x16x32_bf16 v[32:35], v[64:67], v[240:243], v[32:35]
  ds_read_b128 v[64:67], v5 offset:12288
  s_waitcnt lgkmcnt(3)
  v_mfma_f32_16x16x32_bf16 v[36:39], v[68:71], a[40:43], v[36:39]
  v_mfma_f32_16x16x32_bf16 v[40:43], v[68:71], a[96:99], v[40:43]
  v_mfma_f32_16x16x32_bf16 v[44:47], v[68:71], a[152:155], v[44:47]
  v_mfma_f32_16x16x32_bf16 v[48:51], v[68:71], a[208:211], v[48:51]
  v_mfma_f32_16x16x32_bf16 v[52:55], v[68:71], v[128:131], v[52:55]
  v_mfma_f32_16x16x32_bf16 v[56:59], v[68:71], v[184:187], v[56:59]
  v_mfma_f32_16x16x32_bf16 v[60:63], v[68:71], v[240:243], v[60:63]
  ds_read_b128 v[68:71], v5 offset:26624
  s_waitcnt lgkmcnt(3)
  v_mfma_f32_16x16x32_bf16 v[8:11], v[72:75], a[44:47], v[8:11]
  v_mfma_f32_16x16x32_bf16 v[12:15], v[72:75], a[100:103], v[12:15]
  v_mfma_f32_16x16x32_bf16 v[16:19], v[72:75], a[156:159], v[16:19]
  v_mfma_f32_16x16x32_bf16 v[20:23], v[72:75], a[212:215], v[20:23]
  v_mfma_f32_16x16x32_bf16 v[24:27], v[72:75], v[132:135], v[24:27]
  v_mfma_f32_16x16x32_bf16 v[28:31], v[72:75], v[188:191], v[28:31]
  v_mfma_f32_16x16x32_bf16 v[32:35], v[72:75], v[244:247], v[32:35]
  ds_read_b128 v[72:75], v5 offset:13312
  s_waitcnt lgkmcnt(3)
  v_mfma_f32_16x16x32_bf16 v[36:39], v[76:79], a[44:47], v[36:39]
  v_mfma_f32_16x16x32_bf16 v[40:43], v[76:79], a[100:103], v[40:43]
  v_mfma_f32_16x16x32_bf16 v[44:47], v[76:79], a[156:159], v[44:47]
  v_mfma_f32_16x16x32_bf16 v[48:51], v[76:79], a[212:215], v[48:51]
  v_mfma_f32_16x16x32_bf16 v[52:55], v[76:79], v[132:135], v[52:55]
  v_mfma_f32_16x16x32_bf16 v[56:59], v[76:79], v[188:191], v[56:59]
  v_mfma_f32_16x16x32_bf16 v[60:63], v[76:79], v[244:247], v[60:63]
  ds_read_b128 v[76:79], v5 offset:27648
  s_waitcnt lgkmcnt(3)
  v_mfma_f32_16x16x32_bf16 v[8:11], v[64:67], a[48:51], v[8:11]
  v_mfma_f32_16x16x32_bf16 v[12:15], v[64:67], a[104:107], v[12:15]
  v_mfma_f32_16x16x32_bf16 v[16:19], v[64:67], a[160:163], v[16:19]
  v_mfma_f32_16x16x32_bf16 v[20:23], v[64:67], a[216:219], v[20:23]
  v_mfma_f32_16x16x32_bf16 v[24:27], v[64:67], v[136:139], v[24:27]
  v_mfma_f32_16x16x32_bf16 v[28:31], v[64:67], v[192:195], v[28:31]
  v_mfma_f32_16x16x32_bf16 v[32:35], v[64:67], v[248:251], v[32:35]
  s_waitcnt lgkmcnt(2)
  v_mfma_f32_16x16x32_bf16 v[36:39], v[68:71], a[48:51], v[36:39]
  v_mfma_f32_16x16x32_bf16 v[40:43], v[68:71], a[104:107], v[40:43]
  v_mfma_f32_16x16x32_bf16 v[44:47], v[68:71], a[160:163], v[44:47]
  v_mfma_f32_16x16x32_bf16 v[48:51], v[68:71], a[216:219], v[48:51]
  v_mfma_f32_16x16x32_bf16 v[52:55], v[68:71], v[136:139], v[52:55]
  v_mfma_f32_16x16x32_bf16 v[56:59], v[68:71], v[192:195], v[56:59]
  v_mfma_f32_16x16x32_bf16 v[60:63], v[68:71], v[248:251], v[60:63]
  s_waitcnt lgkmcnt(1)
  v_mfma_f32_16x16x32_bf16 v[8:11], v[72:75], a[52:55], v[8:11]
  v_mfma_f32_16x16x32_bf16 v[12:15], v[72:75], a[108:111], v[12:15]
  v_mfma_f32_16x16x32_bf16 v[16:19], v[72:75], a[164:167], v[16:19]
  v_mfma_f32_16x16x32_bf16 v[20:23], v[72:75], a[220:223], v[20:23]
  v_mfma_f32_16x16x32_bf16 v[24:27], v[72:75], v[140:143], v[24:27]
  v_mfma_f32_16x16x32_bf16 v[28:31], v[72:75], v[196:199], v[28:31]
  v_mfma_f32_16x16x32_bf16 v[32:35], v[72:75], v[252:255], v[32:35]
  s_waitcnt lgkmcnt(0)
  v_mfma_f32_16x16x32_bf16 v[36:39], v[76:79], a[52:55], v[36:39]
  v_mfma_f32_16x16x32_bf16 v[40:43], v[76:79], a[108:111], v[40:43]
  v_mfma_f32_16x16x32_bf16 v[44:47], v[76:79], a[164:167], v[44:47]
  v_mfma_f32_16x16x32_bf16 v[48:51], v[76:79], a[220:223], v[48:51]
  v_mfma_f32_16x16x32_bf16 v[52:55], v[76:79], v[140:143], v[52:55]
  v_mfma_f32_16x16x32_bf16 v[56:59], v[76:79], v[196:199], v[56:59]
  v_mfma_f32_16x16x32_bf16 v[60:63], v[76:79], v[252:255], v[60:63]
  s_waitcnt vmcnt(0)
  s_barrier
  s_cmp_eq_u32 s54, 255
  s_cbranch_scc1 b_uw_nosig
  s_lshl_b32 s26, s54, 2
  s_add_u32 s26, s26, 2048
  s_cmp_lg_u32 s23, 0
  s_cbranch_scc1 .Lsig1
  v_mov_b32 v80, s26
  v_mov_b32 v81, 1
  s_mov_b64 exec, 1
  global_atomic_add v80, v81, s[16:17] sc1
  s_mov_b64 exec, -1
.Lsig1:
  s_lshl_b32 s26, s54, 7
  s_add_u32 s26, s26, 4096
  s_cmp_lg_u32 s23, 0
  s_cbranch_scc1 .Lsig2
  v_mov_b32 v80, s26
  v_mov_b32 v81, 1
  s_mov_b64 exec, 1
  global_atomic_add v80, v81, s[16:17] sc1
  s_mov_b64 exec, -1
.Lsig2:
b_uw_nosig:
  s_mul_i32 s26, s41, 458752
  s_lshr_b32 s27, s43, 1
  s_lshl_b32 s27, s27, 12
  s_add_u32 s26, s26, s27
  s_and_b32 s27, s43, 1
  s_lshl_b32 s27, s27, 10
  s_add_u32 s26, s26, s27
  s_mul_i32 s28, s23, 7
  s_add_u32 s27, s28, 0
  s_lshr_b32 s45, s27, 1
  s_lshl_b32 s45, s45, 15
  s_and_b32 s27, s27, 1
  s_lshl_b32 s27, s27, 11
  s_add_u32 s45, s45, s27
  s_add_u32 s45, s45, s26
  v_add_u32 v6, s45, v2
  v_cvt_pk_bf16_f32 v80, v8, v9
  v_cvt_pk_bf16_f32 v81, v10, v11
  v_cvt_pk_bf16_f32 v82, v36, v37
  v_cvt_pk_bf16_f32 v83, v38, v39
  global_store_dwordx4 v6, v[80:83], s[10:11] sc1
  s_add_u32 s27, s28, 1
  s_lshr_b32 s45, s27, 1
  s_lshl_b32 s45, s45, 15
  s_and_b32 s27, s27, 1
  s_lshl_b32 s27, s27, 11
  s_add_u32 s45, s45, s27
  s_add_u32 s45, s45, s26
  v_add_u32 v6, s45, v2
  v_cvt_pk_bf16_f32 v84, v12, v13
  v_cvt_pk_bf16_f32 v85, v14, v15
  v_cvt_pk_bf16_f32 v86, v40, v41
  v_cvt_pk_bf16_f32 v87, v42, v43
  global_store_dwordx4 v6, v[84:87], s[10:11] sc1
  s_add_u32 s27, s28, 2
  s_lshr_b32 s45, s27, 1
  s_lshl_b32 s45, s45, 15
  s_and_b32 s27, s27, 1
  s_lshl_b32 s27, s27, 11
  s_add_u32 s45, s45, s27
  s_add_u32 s45, s45, s26
  v_add_u32 v6, s45, v2
  v_cvt_pk_bf16_f32 v80, v16, v17
  v_cvt_pk_bf16_f32 v81, v18, v19
  v_cvt_pk_bf16_f32 v82, v44, v45
  v_cvt_pk_bf16_f32 v83, v46, v47
  global_store_dwordx4 v6, v[80:83], s[10:11] sc1
  s_add_u32 s27, s28, 3
  s_lshr_b32 s45, s27, 1
  s_lshl_b32 s45, s45, 15
  s_and_b32 s27, s27, 1
  s_lshl_b32 s27, s27, 11
  s_add_u32 s45, s45, s27
  s_add_u32 s45, s45, s26
  v_add_u32 v6, s45, v2
  v_cvt_pk_bf16_f32 v84, v20, v21
  v_cvt_pk_bf16_f32 v85, v22, v23
  v_cvt_pk_bf16_f32 v86, v48, v49
  v_cvt_pk_bf16_f32 v87, v50, v51
  global_store_dwordx4 v6, v[84:87], s[10:11] sc1
  s_add_u32 s27, s28, 4
  s_lshr_b32 s45, s27, 1
  s_lshl_b32 s45, s45, 15
  s_and_b32 s27, s27, 1
  s_lshl_b32 s27, s27, 11
  s_add_u32 s45, s45, s27
  s_add_u32 s45, s45, s26
  v_add_u32 v6, s45, v2
  v_cvt_pk_bf16_f32 v80, v24, v25
  v_cvt_pk_bf16_f32 v81, v26, v27
  v_cvt_pk_bf16_f32 v82, v52, v53
  v_cvt_pk_bf16_f32 v83, v54, v55
  global_store_dwordx4 v6, v[80:83], s[10:11] sc1
  s_add_u32 s27, s28, 5
  s_lshr_b32 s45, s27, 1
  s_lshl_b32 s45, s45, 15
  s_and_b32 s27, s27, 1
  s_lshl_b32 s27, s27, 11
  s_add_u32 s45, s45, s27
  s_add_u32 s45, s45, s26
  v_add_u32 v6, s45, v2
  v_cvt_pk_bf16_f32 v84, v28, v29
  v_cvt_pk_bf16_f32 v85, v30, v31
  v_cvt_pk_bf16_f32 v86, v56, v57
  v_cvt_pk_bf16_f32 v87, v58, v59
  global_store_dwordx4 v6, v[84:87], s[10:11] sc1
  s_add_u32 s27, s28, 6
  s_lshr_b32 s45, s27, 1
  s_lshl_b32 s45, s45, 15
  s_and_b32 s27, s27, 1
  s_lshl_b32 s27, s27, 11
  s_add_u32 s45, s45, s27
  s_add_u32 s45, s45, s26
  v_add_u32 v6, s45, v2
  v_cvt_pk_bf16_f32 v80, v32, v33
  v_cvt_pk_bf16_f32 v81, v34, v35
  v_cvt_pk_bf16_f32 v82, v60, v61
  v_cvt_pk_bf16_f32 v83, v62, v63
  global_store_dwordx4 v6, v[80:83], s[10:11] sc1
  s_mov_b32 s54, s41
  s_cmp_ge_u32 s41, 4
  s_cbranch_scc1 b_uw_lazy
  s_waitcnt vmcnt(0)
  s_barrier
  s_lshl_b32 s26, s54, 2
  s_add_u32 s26, s26, 2048
  s_cmp_lg_u32 s23, 0
  s_cbranch_scc1 .Lsig3
  v_mov_b32 v80, s26
  v_mov_b32 v81, 1
  s_mov_b64 exec, 1
  global_atomic_add v80, v81, s[16:17] sc1
  s_mov_b64 exec, -1
.Lsig3:
  s_lshl_b32 s26, s54, 7
  s_add_u32 s26, s26, 4096
  s_cmp_lg_u32 s23, 0
  s_cbranch_scc1 .Lsig4
  v_mov_b32 v80, s26
  v_mov_b32 v81, 1
  s_mov_b64 exec, 1
  global_atomic_add v80, v81, s[16:17] sc1
  s_mov_b64 exec, -1
.Lsig4:
  s_mov_b32 s54, 255
  s_cmp_ge_u32 s41, 2
  s_cbranch_scc1 b_uw_lazy
  s_add_u32 s45, s41, 2
  s_lshl_b32 s26, s45, 7
  s_add_u32 s26, s26, 16384
  s_cmp_lg_u32 s23, 0
  s_cbranch_scc1 b_uw_x3_ok
  v_mov_b32 v4, s26
  s_mov_b64 exec, 1
b_uw_x3:
  global_load_dword v5, v4, s[16:17] sc1
  s_sub_u32 s25, s25, 1
  s_cbranch_scc1 b_fail
  s_waitcnt vmcnt(0)
  v_cmp_ne_u32 vcc, 2, v5
  s_cbranch_vccz b_uw_x3_got
  s_sleep 2
  s_branch b_uw_x3
b_uw_x3_got:
  s_mov_b64 exec, -1
b_uw_x3_ok:
  s_barrier
  s_add_u32 s45, s41, 2
  s_xor_b32 s46, s42, 28672
  s_mul_i32 s26, s45, 28672
  s_mul_i32 s27, s23, 7168
  s_add_u32 s26, s26, s27
  v_add_u32 v4, s26, v2
  s_add_u32 s27, s27, s46
  s_add_u32 m0, s27, 0
  s_nop 0
  global_load_lds_dwordx4 v4, s[8:9] sc1
  v_add_u32 v4, 1024, v4
  s_add_u32 m0, s27, 1024
  s_nop 0
  global_load_lds_dwordx4 v4, s[8:9] sc1
  v_add_u32 v4, 1024, v4
  s_add_u32 m0, s27, 2048
  s_nop 0
  global_load_lds_dwordx4 v4, s[8:9] sc1
  v_add_u32 v4, 1024, v4
  s_add_u32 m0, s27, 3072
  s_nop 0
  global_load_lds_dwordx4 v4, s[8:9] sc1
  v_add_u32 v4, 1024, v4
  s_add_u32 m0, s27, 4096
  s_nop 0
  global_load_lds_dwordx4 v4, s[8:9] sc1
  v_add_u32 v4, 1024, v4
  s_add_u32 m0, s27, 5120
  s_nop 0
  global_load_lds_dwordx4 v4, s[8:9] sc1
  v_add_u32 v4, 1024, v4
  s_add_u32 m0, s27, 6144
  s_nop 0
  global_load_lds_dwordx4 v4, s[8:9] sc1
  v_add_u32 v4, 1024, v4
  s_waitcnt vmcnt(0)
b_uw_lazy:
  s_add_u32 s41, s41, 2
  s_xor_b32 s42, s42, 28672
  s_cmp_lt_u32 s41, 64
  s_cbranch_scc1 b_uw_seg
  s_waitcnt vmcnt(0)
  s_barrier
  s_cmp_eq_u32 s54, 255
  s_cbranch_scc1 b_uw_fin
  s_lshl_b32 s26, s54, 2
  s_add_u32 s26, s26, 2048
  s_cmp_lg_u32 s23, 0
  s_cbranch_scc1 .Lsig5
  v_mov_b32 v80, s26
  v_mov_b32 v81, 1
  s_mov_b64 exec, 1
  global_atomic_add v80, v81, s[16:17] sc1
  s_mov_b64 exec, -1
.Lsig5:
  s_lshl_b32 s26, s54, 7
  s_add_u32 s26, s26, 4096
  s_cmp_lg_u32 s23, 0
  s_cbranch_scc1 .Lsig6
  v_mov_b32 v80, s26
  v_mov_b32 v81, 1
  s_mov_b64 exec, 1
  global_atomic_add v80, v81, s[16:17] sc1
  s_mov_b64 exec, -1
.Lsig6:
b_uw_fin:
  s_endpgm
b_zw:
  s_and_b32 s43, s22, 15
  s_lshr_b32 s44, s22, 4
  s_mul_i32 s26, s43, 401408
  s_add_u32 s26, s26, 6422528
  s_mul_i32 s27, s23, 100352
  s_add_u32 s26, s26, s27
  s_add_u32 s6, s6, s26
  s_addc_u32 s7, s7, 0
  s_mov_b32 s26, 1280
  s_cmp_lg_u32 s23, 0
  s_cbranch_scc1 b_zw_xall_ok
  v_mov_b32 v4, s26
  s_mov_b64 exec, 1
b_zw_xall:
  global_load_dword v5, v4, s[16:17] sc1
  s_sub_u32 s25, s25, 1
  s_cbranch_scc1 b_fail
  s_waitcnt vmcnt(0)
  v_cmp_ne_u32 vcc, 64, v5
  s_cbranch_vccz b_zw_xall_got
  s_sleep 8
  s_branch b_zw_xall
b_zw_xall_got:
  s_mov_b64 exec, -1
b_zw_xall_ok:
  s_barrier
  v_add_u32 v4, 0, v2
  global_load_dwordx4 a[0:3], v4, s[6:7]
  global_load_dwordx4 a[4:7], v4, s[6:7] offset:1024
  v_add_u32 v4, 2048, v2
  global_load_dwordx4 a[8:11], v4, s[6:7]
  global_load_dwordx4 a[12:15], v4, s[6:7] offset:1024
  v_add_u32 v4, 4096, v2
  global_load_dwordx4 a[16:19], v4, s[6:7]
  global_load_dwordx4 a[20:23], v4, s[6:7] offset:1024
  v_add_u32 v4, 6144, v2
  global_load_dwordx4 a[24:27], v4, s[6:7]
  global_load_dwordx4 a[28:31], v4, s[6:7] offset:1024
  v_add_u32 v4, 8192, v2
  global_load_dwordx4 a[32:35], v4, s[6:7]
  global_load_dwordx4 a[36:39], v4, s[6:7] offset:1024
  v_add_u32 v4, 10240, v2
  global_load_dwordx4 a[40:43], v4, s[6:7]
  global_load_dwordx4 a[44:47], v4, s[6:7] offset:1024
  v_add_u32 v4, 12288, v2
  global_load_dwordx4 a[48:51], v4, s[6:7]
  global_load_dwordx4 a[52:55], v4, s[6:7] offset:1024
  v_add_u32 v4, 14336, v2
  global_load_dwordx4 a[56:59], v4, s[6:7]
  global_load_dwordx4 a[60:63], v4, s[6:7] offset:1024
  v_add_u32 v4, 16384, v2
  global_load_dwordx4 a[64:67], v4, s[6:7]
  global_load_dwordx4 a[68:71], v4, s[6:7] offset:1024
  v_add_u32 v4, 18432, v2
  global_load_dwordx4 a[72:75], v4, s[6:7]
  global_load_dwordx4 a[76:79], v4, s[6:7] offset:1024
  v_add_u32 v4, 20480, v2
  global_load_dwordx4 a[80:83], v4, s[6:7]
  global_load_dwordx4 a[84:87], v4, s[6:7] offset:1024
  v_add_u32 v4, 22528, v2
  global_load_dwordx4 a[88:91], v4, s[6:7]
  global_load_dwordx4 a[92:95], v4, s[6:7] offset:1024
  v_add_u32 v4, 24576, v2
  global_load_dwordx4 a[96:99], v4, s[6:7]
  global_load_dwordx4 a[100:103], v4, s[6:7] offset:1024
  v_add_u32 v4, 26624, v2
  global_load_dwordx4 a[104:107], v4, s[6:7]
  global_load_dwordx4 a[108:111], v4, s[6:7] offset:1024
  v_add_u32 v4, 28672, v2
  global_load_dwordx4 a[112:115], v4, s[6:7]
  global_load_dwordx4 a[116:119], v4, s[6:7] offset:1024
  v_add_u32 v4, 30720, v2
  global_load_dwordx4 a[120:123], v4, s[6:7]
  global_load_dwordx4 a[124:127], v4, s[6:7] offset:1024
  s_waitcnt vmcnt(32)
  v_add_u32 v4, 32768, v2
  global_load_dwordx4 a[128:131], v4, s[6:7]
  global_load_dwordx4 a[132:135], v4, s[6:7] offset:1024
  v_add_u32 v4, 34816, v2
  global_load_dwordx4 a[136:139], v4, s[6:7]
  global_load_dwordx4 a[140:143], v4, s[6:7] offset:1024
  v_add_u32 v4, 36864, v2
  global_load_dwordx4 a[144:147], v4, s[6:7]
  global_load_dwordx4 a[148:151], v4, s[6:7] offset:1024
  v_add_u32 v4, 38912, v2
  global_load_dwordx4 a[152:155], v4, s[6:7]
  global_load_dwordx4 a[156:159], v4, s[6:7] offset:1024
  v_add_u32 v4, 40960, v2
  global_load_dwordx4 a[160:163], v4, s[6:7]
  global_load_dwordx4 a[164:167], v4, s[6:7] offset:1024
  v_add_u32 v4, 43008, v2
  global_load_dwordx4 a[168:171], v4, s[6:7]
  global_load_dwordx4 a[172:175], v4, s[6:7] offset:1024
  v_add_u32 v4, 45056, v2
  global_load_dwordx4 a[176:179], v4, s[6:7]
  global_load_dwordx4 a[180:183], v4, s[6:7] offset:1024
  v_add_u32 v4, 47104, v2
  global_load_dwordx4 a[184:187], v4, s[6:7]
  global_load_dwordx4 a[188:191], v4, s[6:7] offset:1024
  v_add_u32 v4, 49152, v2
  global_load_dwordx4 a[192:195], v4, s[6:7]
  global_load_dwordx4 a[196:199], v4, s[6:7] offset:1024
  v_add_u32 v4, 51200, v2
  global_load_dwordx4 a[200:203], v4, s[6:7]
  global_load_dwordx4 a[204:207], v4, s[6:7] offset:1024
  v_add_u32 v4, 53248, v2
  global_load_dwordx4 a[208:211], v4, s[6:7]
  global_load_dwordx4 a[212:215], v4, s[6:7] offset:1024
  v_add_u32 v4, 55296, v2
  global_load_dwordx4 a[216:219], v4, s[6:7]
  global_load_dwordx4 a[220:223], v4, s[6:7] offset:1024
  v_add_u32 v4, 57344, v2
  global_load_dwordx4 a[224:227], v4, s[6:7]
  global_load_dwordx4 a[228:231], v4, s[6:7] offset:1024
  v_add_u32 v4, 59392, v2
  global_load_dwordx4 a[232:235], v4, s[6:7]
  global_load_dwordx4 a[236:239], v4, s[6:7] offset:1024
  v_add_u32 v4, 61440, v2
  global_load_dwordx4 a[240:243], v4, s[6:7]
  global_load_dwordx4 a[244:247], v4, s[6:7] offset:1024
  v_add_u32 v4, 63488, v2
  global_load_dwordx4 a[248:251], v4, s[6:7]
  global_load_dwordx4 a[252:255], v4, s[6:7] offset:1024
  s_waitcnt vmcnt(32)
  v_add_u32 v4, 65536, v2
  global_load_dwordx4 v[120:123], v4, s[6:7]
  global_load_dwordx4 v[124:127], v4, s[6:7] offset:1024
  v_add_u32 v4, 67584, v2
  global_load_dwordx4 v[128:131], v4, s[6:7]
  global_load_dwordx4 v[132:135], v4, s[6:7] offset:1024
  v_add_u32 v4, 69632, v2
  global_load_dwordx4 v[136:139], v4, s[6:7]
  global_load_dwordx4 v[140:143], v4, s[6:7] offset:1024
  v_add_u32 v4, 71680, v2
  global_load_dwordx4 v[144:147], v4, s[6:7]
  global_load_dwordx4 v[148:151], v4, s[6:7] offset:1024
  v_add_u32 v4, 73728, v2
  global_load_dwordx4 v[152:155], v4, s[6:7]
  global_load_dwordx4 v[156:159], v4, s[6:7] offset:1024
  v_add_u32 v4, 75776, v2
  global_load_dwordx4 v[160:163], v4, s[6:7]
  global_load_dwordx4 v[164:167], v4, s[6:7] offset:1024
  v_add_u32 v4, 77824, v2
  global_load_dwordx4 v[168:171], v4, s[6:7]
  global_load_dwordx4 v[172:175], v4, s[6:7] offset:1024
  v_add_u32 v4, 79872, v2
  global_load_dwordx4 v[176:179], v4, s[6:7]
  global_load_dwordx4 v[180:183], v4, s[6:7] offset:1024
  v_add_u32 v4, 81920, v2
  global_load_dwordx4 v[184:187], v4, s[6:7]
  global_load_dwordx4 v[188:191], v4, s[6:7] offset:1024
  v_add_u32 v4, 83968, v2
  global_load_dwordx4 v[192:195], v4, s[6:7]
  global_load_dwordx4 v[196:199], v4, s[6:7] offset:1024
  v_add_u32 v4, 86016, v2
  global_load_dwordx4 v[200:203], v4, s[6:7]
  global_load_dwordx4 v[204:207], v4, s[6:7] offset:1024
  v_add_u32 v4, 88064, v2
  global_load_dwordx4 v[208:211], v4, s[6:7]
  global_load_dwordx4 v[212:215], v4, s[6:7] offset:1024
  v_add_u32 v4, 90112, v2
  global_load_dwordx4 v[216:219], v4, s[6:7]
  global_load_dwordx4 v[220:223], v4, s[6:7] offset:1024
  v_add_u32 v4, 92160, v2
  global_load_dwordx4 v[224:227], v4, s[6:7]
  global_load_dwordx4 v[228:231], v4, s[6:7] offset:1024
  v_add_u32 v4, 94208, v2
  global_load_dwordx4 v[232:235], v4, s[6:7]
  global_load_dwordx4 v[236:239], v4, s[6:7] offset:1024
  v_add_u32 v4, 96256, v2
  global_load_dwordx4 v[240:243], v4, s[6:7]
  global_load_dwordx4 v[244:247], v4, s[6:7] offset:1024
  s_waitcnt vmcnt(32)
  v_add_u32 v4, 98304, v2
  global_load_dwordx4 v[248:251], v4, s[6:7]
  global_load_dwordx4 v[252:255], v4, s[6:7] offset:1024
  s_waitcnt vmcnt(0)
  s_mov_b32 s41, s44
b_zw_seg:
  s_mul_i32 s26, s41, 8192
  s_add_u32 s27, s26, 7164
  s_cmp_lg_u32 s23, 0
  s_cbranch_scc1 b_zw_pre_ok
  v_mov_b32 v6, s27
  s_mov_b64 exec, 1
b_zw_pre:
  global_load_dword v7, v6, s[52:53] sc1
  s_sub_u32 s25, s25, 1
  s_cbranch_scc1 b_fail
  s_waitcnt vmcnt(0)
  v_cmp_eq_u32 vcc, -1, v7
  s_cbranch_vccz b_zw_pre_got
  s_cmp_ge_u32 s41, 61
  s_cbranch_scc1 b_zw_pre
  s_sleep 8
  s_branch b_zw_pre
b_zw_pre_got:
  s_mov_b64 exec, -1
b_zw_pre_ok:
  s_barrier
  v_add_u32 v5, s26, v2
  v_add_u32 v6, 4096, v5
b_zw_poll:
  global_load_dwordx4 v[12:15], v5, s[52:53] offset:0 sc1
  global_load_dwordx4 v[16:19], v5, s[52:53] offset:1024 sc1
  global_load_dwordx4 v[20:23], v5, s[52:53] offset:2048 sc1
  global_load_dwordx4 v[24:27], v5, s[52:53] offset:3072 sc1
  global_load_dwordx4 v[28:31], v6, s[52:53] offset:0 sc1
  global_load_dwordx4 v[32:35], v6, s[52:53] offset:1024 sc1
  global_load_dwordx4 v[36:39], v6, s[52:53] offset:2048 sc1
  s_sub_u32 s25, s25, 1
  s_cbranch_scc1 b_fail
  v_mov_b64 v[40:41], 0
  v_mov_b64 v[42:43], 0
  v_mov_b64 v[44:45], 0
  v_mov_b64 v[46:47], 0
  v_mov_b64 v[48:49], 0
  v_mov_b64 v[50:51], 0
  v_mov_b64 v[52:53], 0
  v_mov_b64 v[54:55], 0
  v_mov_b64 v[56:57], 0
  v_mov_b64 v[58:59], 0
  v_mov_b64 v[60:61], 0
  v_mov_b64 v[62:63], 0
  v_mov_b64 v[64:65], 0
  v_mov_b64 v[66:67], 0
  s_waitcnt vmcnt(0)
  v_max3_u32 v7, v12, v13, v14
  v_max3_u32 v7, v7, v15, v16
  v_max3_u32 v7, v7, v17, v18
  v_max3_u32 v7, v7, v19, v20
  v_max3_u32 v7, v7, v21, v22
  v_max3_u32 v7, v7, v23, v24
  v_max3_u32 v7, v7, v25, v26
  v_max3_u32 v7, v7, v27, v28
  v_max3_u32 v7, v7, v29, v30
  v_max3_u32 v7, v7, v31, v32
  v_max3_u32 v7, v7, v33, v34
  v_max3_u32 v7, v7, v35, v36
  v_max3_u32 v7, v7, v37, v38
  v_max_u32 v7, v7, v39
  v_cmp_eq_u32 vcc, -1, v7
  s_cbranch_vccz b_zw_ok
  s_sleep 2
  s_branch b_zw_poll
b_zw_ok:
  v_smfmac_f32_16x16x64_bf16 v[40:43], v[12:15], a[0:7], v3
  v_smfmac_f32_16x16x64_bf16 v[44:47], v[12:15], a[56:63], v3
  v_smfmac_f32_16x16x64_bf16 v[48:51], v[12:15], a[112:119], v3
  v_smfmac_f32_16x16x64_bf16 v[52:55], v[12:15], a[168:175], v3
  v_smfmac_f32_16x16x64_bf16 v[56:59], v[12:15], a[224:231], v3
  v_smfmac_f32_16x16x64_bf16 v[60:63], v[12:15], v[144:151], v3
  v_smfmac_f32_16x16x64_bf16 v[64:67], v[12:15], v[200:207], v3
  v_smfmac_f32_16x16x64_bf16 v[40:43], v[16:19], a[8:15], v3
  v_smfmac_f32_16x16x64_bf16 v[44:47], v[16:19], a[64:71], v3
  v_smfmac_f32_16x16x64_bf16 v[48:51], v[16:19], a[120:127], v3
  v_smfmac_f32_16x16x64_bf16 v[52:55], v[16:19], a[176:183], v3
  v_smfmac_f32_16x16x64_bf16 v[56:59], v[16:19], a[232:239], v3
  v_smfmac_f32_16x16x64_bf16 v[60:63], v[16:19], v[152:159], v3
  v_smfmac_f32_16x16x64_bf16 v[64:67], v[16:19], v[208:215], v3
  v_smfmac_f32_16x16x64_bf16 v[40:43], v[20:23], a[16:23], v3
  v_smfmac_f32_16x16x64_bf16 v[44:47], v[20:23], a[72:79], v3
  v_smfmac_f32_16x16x64_bf16 v[48:51], v[20:23], a[128:135], v3
  v_smfmac_f32_16x16x64_bf16 v[52:55], v[20:23], a[184:191], v3
  v_smfmac_f32_16x16x64_bf16 v[56:59], v[20:23], a[240:247], v3
  v_smfmac_f32_16x16x64_bf16 v[60:63], v[20:23], v[160:167], v3
  v_smfmac_f32_16x16x64_bf16 v[64:67], v[20:23], v[216:223], v3
  v_smfmac_f32_16x16x64_bf16 v[40:43], v[24:27], a[24:31], v3
  v_smfmac_f32_16x16x64_bf16 v[44:47], v[24:27], a[80:87], v3
  v_smfmac_f32_16x16x64_bf16 v[48:51], v[24:27], a[136:143], v3
  v_smfmac_f32_16x16x64_bf16 v[52:55], v[24:27], a[192:199], v3
  v_smfmac_f32_16x16x64_bf16 v[56:59], v[24:27], a[248:255], v3
  v_smfmac_f32_16x16x64_bf16 v[60:63], v[24:27], v[168:175], v3
  v_smfmac_f32_16x16x64_bf16 v[64:67], v[24:27], v[224:231], v3
  v_smfmac_f32_16x16x64_bf16 v[40:43], v[28:31], a[32:39], v3
  v_smfmac_f32_16x16x64_bf16 v[44:47], v[28:31], a[88:95], v3
  v_smfmac_f32_16x16x64_bf16 v[48:51], v[28:31], a[144:151], v3
  v_smfmac_f32_16x16x64_bf16 v[52:55], v[28:31], a[200:207], v3
  v_smfmac_f32_16x16x64_bf16 v[56:59], v[28:31], v[120:127], v3
  v_smfmac_f32_16x16x64_bf16 v[60:63], v[28:31], v[176:183], v3
  v_smfmac_f32_16x16x64_bf16 v[64:67], v[28:31], v[232:239], v3
  v_smfmac_f32_16x16x64_bf16 v[40:43], v[32:35], a[40:47], v3
  v_smfmac_f32_16x16x64_bf16 v[44:47], v[32:35], a[96:103], v3
  v_smfmac_f32_16x16x64_bf16 v[48:51], v[32:35], a[152:159], v3
  v_smfmac_f32_16x16x64_bf16 v[52:55], v[32:35], a[208:215], v3
  v_smfmac_f32_16x16x64_bf16 v[56:59], v[32:35], v[128:135], v3
  v_smfmac_f32_16x16x64_bf16 v[60:63], v[32:35], v[184:191], v3
  v_smfmac_f32_16x16x64_bf16 v[64:67], v[32:35], v[240:247], v3
  v_smfmac_f32_16x16x64_bf16 v[40:43], v[36:39], a[48:55], v3
  v_smfmac_f32_16x16x64_bf16 v[44:47], v[36:39], a[104:111], v3
  v_smfmac_f32_16x16x64_bf16 v[48:51], v[36:39], a[160:167], v3
  v_smfmac_f32_16x16x64_bf16 v[52:55], v[36:39], a[216:223], v3
  v_smfmac_f32_16x16x64_bf16 v[56:59], v[36:39], v[136:143], v3
  v_smfmac_f32_16x16x64_bf16 v[60:63], v[36:39], v[192:199], v3
  v_smfmac_f32_16x16x64_bf16 v[64:67], v[36:39], v[248:255], v3
  s_mul_i32 s26, s41, 229376
  s_lshr_b32 s27, s43, 2
  s_lshl_b32 s27, s27, 12
  s_add_u32 s26, s26, s27
  s_lshr_b32 s27, s43, 1
  s_and_b32 s27, s27, 1
  s_lshl_b32 s27, s27, 10
  s_add_u32 s26, s26, s27
  s_and_b32 s27, s43, 1
  s_lshl_b32 s27, s27, 3
  s_add_u32 s26, s26, s27
  s_mul_i32 s28, s23, 7
  s_nop 1
  s_add_u32 s27, s28, 0
  s_lshr_b32 s45, s27, 1
  s_lshl_b32 s45, s45, 14
  s_and_b32 s27, s27, 1
  s_lshl_b32 s27, s27, 11
  s_add_u32 s45, s45, s27
  s_add_u32 s45, s45, s26
  v_add_u32 v4, s45, v2
  v_cvt_pk_bf16_f32 v8, v40, v41
  v_cvt_pk_bf16_f32 v9, v42, v43
  global_store_dwordx2 v4, v[8:9], s[20:21] sc1
  s_add_u32 s27, s28, 1
  s_lshr_b32 s45, s27, 1
  s_lshl_b32 s45, s45, 14
  s_and_b32 s27, s27, 1
  s_lshl_b32 s27, s27, 11
  s_add_u32 s45, s45, s27
  s_add_u32 s45, s45, s26
  v_add_u32 v4, s45, v2
  v_cvt_pk_bf16_f32 v10, v44, v45
  v_cvt_pk_bf16_f32 v11, v46, v47
  global_store_dwordx2 v4, v[10:11], s[20:21] sc1
  s_add_u32 s27, s28, 2
  s_lshr_b32 s45, s27, 1
  s_lshl_b32 s45, s45, 14
  s_and_b32 s27, s27, 1
  s_lshl_b32 s27, s27, 11
  s_add_u32 s45, s45, s27
  s_add_u32 s45, s45, s26
  v_add_u32 v4, s45, v2
  v_cvt_pk_bf16_f32 v8, v48, v49
  v_cvt_pk_bf16_f32 v9, v50, v51
  global_store_dwordx2 v4, v[8:9], s[20:21] sc1
  s_add_u32 s27, s28, 3
  s_lshr_b32 s45, s27, 1
  s_lshl_b32 s45, s45, 14
  s_and_b32 s27, s27, 1
  s_lshl_b32 s27, s27, 11
  s_add_u32 s45, s45, s27
  s_add_u32 s45, s45, s26
  v_add_u32 v4, s45, v2
  v_cvt_pk_bf16_f32 v10, v52, v53
  v_cvt_pk_bf16_f32 v11, v54, v55
  global_store_dwordx2 v4, v[10:11], s[20:21] sc1
  s_add_u32 s27, s28, 4
  s_lshr_b32 s45, s27, 1
  s_lshl_b32 s45, s45, 14
  s_and_b32 s27, s27, 1
  s_lshl_b32 s27, s27, 11
  s_add_u32 s45, s45, s27
  s_add_u32 s45, s45, s26
  v_add_u32 v4, s45, v2
  v_cvt_pk_bf16_f32 v8, v56, v57
  v_cvt_pk_bf16_f32 v9, v58, v59
  global_store_dwordx2 v4, v[8:9], s[20:21] sc1
  s_add_u32 s27, s28, 5
  s_lshr_b32 s45, s27, 1
  s_lshl_b32 s45, s45, 14
  s_and_b32 s27, s27, 1
  s_lshl_b32 s27, s27, 11
  s_add_u32 s45, s45, s27
  s_add_u32 s45, s45, s26
  v_add_u32 v4, s45, v2
  v_cvt_pk_bf16_f32 v10, v60, v61
  v_cvt_pk_bf16_f32 v11, v62, v63
  global_store_dwordx2 v4, v[10:11], s[20:21] sc1
  s_add_u32 s27, s28, 6
  s_lshr_b32 s45, s27, 1
  s_lshl_b32 s45, s45, 14
  s_and_b32 s27, s27, 1
  s_lshl_b32 s27, s27, 11
  s_add_u32 s45, s45, s27
  s_add_u32 s45, s45, s26
  v_add_u32 v4, s45, v2
  v_cvt_pk_bf16_f32 v8, v64, v65
  v_cvt_pk_bf16_f32 v9, v66, v67
  global_store_dwordx2 v4, v[8:9], s[20:21] sc1
  s_waitcnt vmcnt(0)
  s_barrier
  s_lshl_b32 s26, s41, 7
  s_add_u32 s26, s26, 4096
  s_cmp_lg_u32 s23, 0
  s_cbranch_scc1 .Lsig7
  v_mov_b32 v80, s26
  v_mov_b32 v81, 1
  s_mov_b64 exec, 1
  global_atomic_add v80, v81, s[16:17] sc1
  s_mov_b64 exec, -1
.Lsig7:
  s_add_u32 s41, s41, 2
  s_cmp_lt_u32 s41, 64
  s_cbranch_scc1 b_zw_seg
  s_endpgm
b_pw:
  s_and_b32 s43, s22, 15
  s_lshr_b32 s44, s22, 4
  s_mul_i32 s26, s43, 401408
  s_add_u32 s26, s26, 0
  s_mul_i32 s27, s23, 100352
  s_add_u32 s26, s26, s27
  s_add_u32 s6, s6, s26
  s_addc_u32 s7, s7, 0
  s_mov_b32 s26, 1280
  s_cmp_lg_u32 s23, 0
  s_cbranch_scc1 b_pw_xall_ok
  v_mov_b32 v4, s26
  s_mov_b64 exec, 1
b_pw_xall:
  global_load_dword v5, v4, s[16:17] sc1
  s_sub_u32 s25, s25, 1
  s_cbranch_scc1 b_fail
  s_waitcnt vmcnt(0)
  v_cmp_ne_u32 vcc, 64, v5
  s_cbranch_vccz b_pw_xall_got
  s_sleep 8
  s_branch b_pw_xall
b_pw_xall_got:
  s_mov_b64 exec, -1
b_pw_xall_ok:
  s_barrier
  v_add_u32 v4, 0, v2
  global_load_dwordx4 a[0:3], v4, s[6:7]
  global_load_dwordx4 a[4:7], v4, s[6:7] offset:1024
  v_add_u32 v4, 2048, v2
  global_load_dwordx4 a[8:11], v4, s[6:7]
  global_load_dwordx4 a[12:15], v4, s[6:7] offset:1024
  v_add_u32 v4, 4096, v2
  global_load_dwordx4 a[16:19], v4, s[6:7]
  global_load_dwordx4 a[20:23], v4, s[6:7] offset:1024
  v_add_u32 v4, 6144, v2
  global_load_dwordx4 a[24:27], v4, s[6:7]
  global_load_dwordx4 a[28:31], v4, s[6:7] offset:1024
  v_add_u32 v4, 8192, v2
  global_load_dwordx4 a[32:35], v4, s[6:7]
  global_load_dwordx4 a[36:39], v4, s[6:7] offset:1024
  v_add_u32 v4, 10240, v2
  global_load_dwordx4 a[40:43], v4, s[6:7]
  global_load_dwordx4 a[44:47], v4, s[6:7] offset:1024
  v_add_u32 v4, 12288, v2
  global_load_dwordx4 a[48:51], v4, s[6:7]
  global_load_dwordx4 a[52:55], v4, s[6:7] offset:1024
  v_add_u32 v4, 14336, v2
  global_load_dwordx4 a[56:59], v4, s[6:7]
  global_load_dwordx4 a[60:63], v4, s[6:7] offset:1024
  v_add_u32 v4, 16384, v2
  global_load_dwordx4 a[64:67], v4, s[6:7]
  global_load_dwordx4 a[68:71], v4, s[6:7] offset:1024
  v_add_u32 v4, 18432, v2
  global_load_dwordx4 a[72:75], v4, s[6:7]
  global_load_dwordx4 a[76:79], v4, s[6:7] offset:1024
  v_add_u32 v4, 20480, v2
  global_load_dwordx4 a[80:83], v4, s[6:7]
  global_load_dwordx4 a[84:87], v4, s[6:7] offset:1024
  v_add_u32 v4, 22528, v2
  global_load_dwordx4 a[88:91], v4, s[6:7]
  global_load_dwordx4 a[92:95], v4, s[6:7] offset:1024
  v_add_u32 v4, 24576, v2
  global_load_dwordx4 a[96:99], v4, s[6:7]
  global_load_dwordx4 a[100:103], v4, s[6:7] offset:1024
  v_add_u32 v4, 26624, v2
  global_load_dwordx4 a[104:107], v4, s[6:7]
  global_load_dwordx4 a[108:111], v4, s[6:7] offset:1024
  v_add_u32 v4, 28672, v2
  global_load_dwordx4 a[112:115], v4, s[6:7]
  global_load_dwordx4 a[116:119], v4, s[6:7] offset:1024
  v_add_u32 v4, 30720, v2
  global_load_dwordx4 a[120:123], v4, s[6:7]
  global_load_dwordx4 a[124:127], v4, s[6:7] offset:1024
  s_waitcnt vmcnt(32)
  v_add_u32 v4, 32768, v2
  global_load_dwordx4 a[128:131], v4, s[6:7]
  global_load_dwordx4 a[132:135], v4, s[6:7] offset:1024
  v_add_u32 v4, 34816, v2
  global_load_dwordx4 a[136:139], v4, s[6:7]
  global_load_dwordx4 a[140:143], v4, s[6:7] offset:1024
  v_add_u32 v4, 36864, v2
  global_load_dwordx4 a[144:147], v4, s[6:7]
  global_load_dwordx4 a[148:151], v4, s[6:7] offset:1024
  v_add_u32 v4, 38912, v2
  global_load_dwordx4 a[152:155], v4, s[6:7]
  global_load_dwordx4 a[156:159], v4, s[6:7] offset:1024
  v_add_u32 v4, 40960, v2
  global_load_dwordx4 a[160:163], v4, s[6:7]
  global_load_dwordx4 a[164:167], v4, s[6:7] offset:1024
  v_add_u32 v4, 43008, v2
  global_load_dwordx4 a[168:171], v4, s[6:7]
  global_load_dwordx4 a[172:175], v4, s[6:7] offset:1024
  v_add_u32 v4, 45056, v2
  global_load_dwordx4 a[176:179], v4, s[6:7]
  global_load_dwordx4 a[180:183], v4, s[6:7] offset:1024
  v_add_u32 v4, 47104, v2
  global_load_dwordx4 a[184:187], v4, s[6:7]
  global_load_dwordx4 a[188:191], v4, s[6:7] offset:1024
  v_add_u32 v4, 49152, v2
  global_load_dwordx4 a[192:195], v4, s[6:7]
  global_load_dwordx4 a[196:199], v4, s[6:7] offset:1024
  v_add_u32 v4, 51200, v2
  global_load_dwordx4 a[200:203], v4, s[6:7]
  global_load_dwordx4 a[204:207], v4, s[6:7] offset:1024
  v_add_u32 v4, 53248, v2
  global_load_dwordx4 a[208:211], v4, s[6:7]
  global_load_dwordx4 a[212:215], v4, s[6:7] offset:1024
  v_add_u32 v4, 55296, v2
  global_load_dwordx4 a[216:219], v4, s[6:7]
  global_load_dwordx4 a[220:223], v4, s[6:7] offset:1024
  v_add_u32 v4, 57344, v2
  global_load_dwordx4 a[224:227], v4, s[6:7]
  global_load_dwordx4 a[228:231], v4, s[6:7] offset:1024
  v_add_u32 v4, 59392, v2
  global_load_dwordx4 a[232:235], v4, s[6:7]
  global_load_dwordx4 a[236:239], v4, s[6:7] offset:1024
  v_add_u32 v4, 61440, v2
  global_load_dwordx4 a[240:243], v4, s[6:7]
  global_load_dwordx4 a[244:247], v4, s[6:7] offset:1024
  v_add_u32 v4, 63488, v2
  global_load_dwordx4 a[248:251], v4, s[6:7]
  global_load_dwordx4 a[252:255], v4, s[6:7] offset:1024
  s_waitcnt vmcnt(32)
  v_add_u32 v4, 65536, v2
  global_load_dwordx4 v[120:123], v4, s[6:7]
  global_load_dwordx4 v[124:127], v4, s[6:7] offset:1024
  v_add_u32 v4, 67584, v2
  global_load_dwordx4 v[128:131], v4, s[6:7]
  global_load_dwordx4 v[132:135], v4, s[6:7] offset:1024
  v_add_u32 v4, 69632, v2
  global_load_dwordx4 v[136:139], v4, s[6:7]
  global_load_dwordx4 v[140:143], v4, s[6:7] offset:1024
  v_add_u32 v4, 71680, v2
  global_load_dwordx4 v[144:147], v4, s[6:7]
  global_load_dwordx4 v[148:151], v4, s[6:7] offset:1024
  v_add_u32 v4, 73728, v2
  global_load_dwordx4 v[152:155], v4, s[6:7]
  global_load_dwordx4 v[156:159], v4, s[6:7] offset:1024
  v_add_u32 v4, 75776, v2
  global_load_dwordx4 v[160:163], v4, s[6:7]
  global_load_dwordx4 v[164:167], v4, s[6:7] offset:1024
  v_add_u32 v4, 77824, v2
  global_load_dwordx4 v[168:171], v4, s[6:7]
  global_load_dwordx4 v[172:175], v4, s[6:7] offset:1024
  v_add_u32 v4, 79872, v2
  global_load_dwordx4 v[176:179], v4, s[6:7]
  global_load_dwordx4 v[180:183], v4, s[6:7] offset:1024
  v_add_u32 v4, 81920, v2
  global_load_dwordx4 v[184:187], v4, s[6:7]
  global_load_dwordx4 v[188:191], v4, s[6:7] offset:1024
  v_add_u32 v4, 83968, v2
  global_load_dwordx4 v[192:195], v4, s[6:7]
  global_load_dwordx4 v[196:199], v4, s[6:7] offset:1024
  v_add_u32 v4, 86016, v2
  global_load_dwordx4 v[200:203], v4, s[6:7]
  global_load_dwordx4 v[204:207], v4, s[6:7] offset:1024
  v_add_u32 v4, 88064, v2
  global_load_dwordx4 v[208:211], v4, s[6:7]
  global_load_dwordx4 v[212:215], v4, s[6:7] offset:1024
  v_add_u32 v4, 90112, v2
  global_load_dwordx4 v[216:219], v4, s[6:7]
  global_load_dwordx4 v[220:223], v4, s[6:7] offset:1024
  v_add_u32 v4, 92160, v2
  global_load_dwordx4 v[224:227], v4, s[6:7]
  global_load_dwordx4 v[228:231], v4, s[6:7] offset:1024
  v_add_u32 v4, 94208, v2
  global_load_dwordx4 v[232:235], v4, s[6:7]
  global_load_dwordx4 v[236:239], v4, s[6:7] offset:1024
  v_add_u32 v4, 96256, v2
  global_load_dwordx4 v[240:243], v4, s[6:7]
  global_load_dwordx4 v[244:247], v4, s[6:7] offset:1024
  s_waitcnt vmcnt(32)
  v_add_u32 v4, 98304, v2
  global_load_dwordx4 v[248:251], v4, s[6:7]
  global_load_dwordx4 v[252:255], v4, s[6:7] offset:1024
  s_waitcnt vmcnt(0)
  v_and_b32 v112, 15, v1
  v_lshrrev_b32 v113, 4, v1
  v_lshlrev_b32 v6, 4, v112
  v_lshrrev_b32 v114, 1, v113
  v_lshl_add_u32 v6, v114, 8, v6
  v_and_b32 v114, 1, v113
  v_lshl_add_u32 v6, v114, 3, v6
  s_mul_i32 s26, s23, 3584
  v_add_u32 v6, s26, v6
  v_and_b32 v7, 7, v112
  v_mul_u32_u24 v7, 912, v7
  v_lshl_add_u32 v7, v113, 3, v7
  s_mul_i32 s26, s23, 224
  s_add_u32 s26, s26, 81920
  v_add_u32 v7, s26, v7
  s_mov_b32 s41, s44
  s_mov_b32 s42, 0
  s_mov_b32 s45, s41
  s_mov_b32 s46, 0
  s_mul_i32 s26, s45, 28672
  s_mul_i32 s27, s23, 7168
  s_add_u32 s26, s26, s27
  v_add_u32 v4, s26, v2
  s_add_u32 s27, s27, s46
  s_add_u32 m0, s27, 0
  s_nop 0
  global_load_lds_dwordx4 v4, s[8:9] sc1
  v_add_u32 v4, 1024, v4
  s_add_u32 m0, s27, 1024
  s_nop 0
  global_load_lds_dwordx4 v4, s[8:9] sc1
  v_add_u32 v4, 1024, v4
  s_add_u32 m0, s27, 2048
  s_nop 0
  global_load_lds_dwordx4 v4, s[8:9] sc1
  v_add_u32 v4, 1024, v4
  s_add_u32 m0, s27, 3072
  s_nop 0
  global_load_lds_dwordx4 v4, s[8:9] sc1
  v_add_u32 v4, 1024, v4
  s_add_u32 m0, s27, 4096
  s_nop 0
  global_load_lds_dwordx4 v4, s[8:9] sc1
  v_add_u32 v4, 1024, v4
  s_add_u32 m0, s27, 5120
  s_nop 0
  global_load_lds_dwordx4 v4, s[8:9] sc1
  v_add_u32 v4, 1024, v4
  s_add_u32 m0, s27, 6144
  s_nop 0
  global_load_lds_dwordx4 v4, s[8:9] sc1
  v_add_u32 v4, 1024, v4
b_pw_seg:
  s_waitcnt vmcnt(0)
  s_barrier
  s_add_u32 s45, s41, 3
  s_cmp_ge_u32 s45, 64
  s_cbranch_scc1 b_pw_nopf
  s_xor_b32 s46, s42, 28672
  s_mul_i32 s26, s45, 28672
  s_mul_i32 s27, s23, 7168
  s_add_u32 s26, s26, s27
  v_add_u32 v4, s26, v2
  s_add_u32 s27, s27, s46
  s_add_u32 m0, s27, 0
  s_nop 0
  global_load_lds_dwordx4 v4, s[8:9] sc1
  v_add_u32 v4, 1024, v4
  s_add_u32 m0, s27, 1024
  s_nop 0
  global_load_lds_dwordx4 v4, s[8:9] sc1
  v_add_u32 v4, 1024, v4
  s_add_u32 m0, s27, 2048
  s_nop 0
  global_load_lds_dwordx4 v4, s[8:9] sc1
  v_add_u32 v4, 1024, v4
  s_add_u32 m0, s27, 3072
  s_nop 0
  global_load_lds_dwordx4 v4, s[8:9] sc1
  v_add_u32 v4, 1024, v4
  s_add_u32 m0, s27, 4096
  s_nop 0
  global_load_lds_dwordx4 v4, s[8:9] sc1
  v_add_u32 v4, 1024, v4
  s_add_u32 m0, s27, 5120
  s_nop 0
  global_load_lds_dwordx4 v4, s[8:9] sc1
  v_add_u32 v4, 1024, v4
  s_add_u32 m0, s27, 6144
  s_nop 0
  global_load_lds_dwordx4 v4, s[8:9] sc1
  v_add_u32 v4, 1024, v4
b_pw_nopf:
  v_add_u32 v5, s42, v2
  ds_read_b128 v[64:67], v5 offset:0
  ds_read_b128 v[68:71], v5 offset:14336
  ds_read_b128 v[72:75], v5 offset:1024
  ds_read_b128 v[76:79], v5 offset:15360
  s_waitcnt lgkmcnt(3)
  v_mfma_f32_16x16x32_bf16 v[8:11], a[0:3], v[64:67], 0
  v_mfma_f32_16x16x32_bf16 v[12:15], a[56:59], v[64:67], 0
  v_mfma_f32_16x16x32_bf16 v[16:19], a[112:115], v[64:67], 0
  v_mfma_f32_16x16x32_bf16 v[20:23], a[168:171], v[64:67], 0
  v_mfma_f32_16x16x32_bf16 v[24:27], a[224:227], v[64:67], 0
  v_mfma_f32_16x16x32_bf16 v[28:31], v[144:147], v[64:67], 0
  v_mfma_f32_16x16x32_bf16 v[32:35], v[200:203], v[64:67], 0
  ds_read_b128 v[64:67], v5 offset:2048
  s_waitcnt lgkmcnt(3)
  v_mfma_f32_16x16x32_bf16 v[36:39], a[0:3], v[68:71], 0
  v_mfma_f32_16x16x32_bf16 v[40:43], a[56:59], v[68:71], 0
  v_mfma_f32_16x16x32_bf16 v[44:47], a[112:115], v[68:71], 0
  v_mfma_f32_16x16x32_bf16 v[48:51], a[168:171], v[68:71], 0
  v_mfma_f32_16x16x32_bf16 v[52:55], a[224:227], v[68:71], 0
  v_mfma_f32_16x16x32_bf16 v[56:59], v[144:147], v[68:71], 0
  v_mfma_f32_16x16x32_bf16 v[60:63], v[200:203], v[68:71], 0
  ds_read_b128 v[68:71], v5 offset:16384
  s_waitcnt lgkmcnt(3)
  v_mfma_f32_16x16x32_bf16 v[8:11], a[4:7], v[72:75], v[8:11]
  v_mfma_f32_16x16x32_bf16 v[12:15], a[60:63], v[72:75], v[12:15]
  v_mfma_f32_16x16x32_bf16 v[16:19], a[116:119], v[72:75], v[16:19]
  v_mfma_f32_16x16x32_bf16 v[20:23], a[172:175], v[72:75], v[20:23]
  v_mfma_f32_16x16x32_bf16 v[24:27], a[228:231], v[72:75], v[24:27]
  v_mfma_f32_16x16x32_bf16 v[28:31], v[148:151], v[72:75], v[28:31]
  v_mfma_f32_16x16x32_bf16 v[32:35], v[204:207], v[72:75], v[32:35]
  ds_read_b128 v[72:75], v5 offset:3072
  s_waitcnt lgkmcnt(3)
  v_mfma_f32_16x16x32_bf16 v[36:39], a[4:7], v[76:79], v[36:39]
  v_mfma_f32_16x16x32_bf16 v[40:43], a[60:63], v[76:79], v[40:43]
  v_mfma_f32_16x16x32_bf16 v[44:47], a[116:119], v[76:79], v[44:47]
  v_mfma_f32_16x16x32_bf16 v[48:51], a[172:175], v[76:79], v[48:51]
  v_mfma_f32_16x16x32_bf16 v[52:55], a[228:231], v[76:79], v[52:55]
  v_mfma_f32_16x16x32_bf16 v[56:59], v[148:151], v[76:79], v[56:59]
  v_mfma_f32_16x16x32_bf16 v[60:63], v[204:207], v[76:79], v[60:63]
  ds_read_b128 v[76:79], v5 offset:17408
  s_waitcnt lgkmcnt(3)
  v_mfma_f32_16x16x32_bf16 v[8:11], a[8:11], v[64:67], v[8:11]
  v_mfma_f32_16x16x32_bf16 v[12:15], a[64:67], v[64:67], v[12:15]
  v_mfma_f32_16x16x32_bf16 v[16:19], a[120:123], v[64:67], v[16:19]
  v_mfma_f32_16x16x32_bf16 v[20:23], a[176:179], v[64:67], v[20:23]
  v_mfma_f32_16x16x32_bf16 v[24:27], a[232:235], v[64:67], v[24:27]
  v_mfma_f32_16x16x32_bf16 v[28:31], v[152:155], v[64:67], v[28:31]
  v_mfma_f32_16x16x32_bf16 v[32:35], v[208:211], v[64:67], v[32:35]
  ds_read_b128 v[64:67], v5 offset:4096
  s_waitcnt lgkmcnt(3)
  v_mfma_f32_16x16x32_bf16 v[36:39], a[8:11], v[68:71], v[36:39]
  v_mfma_f32_16x16x32_bf16 v[40:43], a[64:67], v[68:71], v[40:43]
  v_mfma_f32_16x16x32_bf16 v[44:47], a[120:123], v[68:71], v[44:47]
  v_mfma_f32_16x16x32_bf16 v[48:51], a[176:179], v[68:71], v[48:51]
  v_mfma_f32_16x16x32_bf16 v[52:55], a[232:235], v[68:71], v[52:55]
  v_mfma_f32_16x16x32_bf16 v[56:59], v[152:155], v[68:71], v[56:59]
  v_mfma_f32_16x16x32_bf16 v[60:63], v[208:211], v[68:71], v[60:63]
  ds_read_b128 v[68:71], v5 offset:18432
  s_waitcnt lgkmcnt(3)
  v_mfma_f32_16x16x32_bf16 v[8:11], a[12:15], v[72:75], v[8:11]
  v_mfma_f32_16x16x32_bf16 v[12:15], a[68:71], v[72:75], v[12:15]
  v_mfma_f32_16x16x32_bf16 v[16:19], a[124:127], v[72:75], v[16:19]
  v_mfma_f32_16x16x32_bf16 v[20:23], a[180:183], v[72:75], v[20:23]
  v_mfma_f32_16x16x32_bf16 v[24:27], a[236:239], v[72:75], v[24:27]
  v_mfma_f32_16x16x32_bf16 v[28:31], v[156:159], v[72:75], v[28:31]
  v_mfma_f32_16x16x32_bf16 v[32:35], v[212:215], v[72:75], v[32:35]
  ds_read_b128 v[72:75], v5 offset:5120
  s_waitcnt lgkmcnt(3)
  v_mfma_f32_16x16x32_bf16 v[36:39], a[12:15], v[76:79], v[36:39]
  v_mfma_f32_16x16x32_bf16 v[40:43], a[68:71], v[76:79], v[40:43]
  v_mfma_f32_16x16x32_bf16 v[44:47], a[124:127], v[76:79], v[44:47]
  v_mfma_f32_16x16x32_bf16 v[48:51], a[180:183], v[76:79], v[48:51]
  v_mfma_f32_16x16x32_bf16 v[52:55], a[236:239], v[76:79], v[52:55]
  v_mfma_f32_16x16x32_bf16 v[56:59], v[156:159], v[76:79], v[56:59]
  v_mfma_f32_16x16x32_bf16 v[60:63], v[212:215], v[76:79], v[60:63]
  ds_read_b128 v[76:79], v5 offset:19456
  s_waitcnt lgkmcnt(3)
  v_mfma_f32_16x16x32_bf16 v[8:11], a[16:19], v[64:67], v[8:11]
  v_mfma_f32_16x16x32_bf16 v[12:15], a[72:75], v[64:67], v[12:15]
  v_mfma_f32_16x16x32_bf16 v[16:19], a[128:131], v[64:67], v[16:19]
  v_mfma_f32_16x16x32_bf16 v[20:23], a[184:187], v[64:67], v[20:23]
  v_mfma_f32_16x16x32_bf16 v[24:27], a[240:243], v[64:67], v[24:27]
  v_mfma_f32_16x16x32_bf16 v[28:31], v[160:163], v[64:67], v[28:31]
  v_mfma_f32_16x16x32_bf16 v[32:35], v[216:219], v[64:67], v[32:35]
  ds_read_b128 v[64:67], v5 offset:6144
  s_waitcnt lgkmcnt(3)
  v_mfma_f32_16x16x32_bf16 v[36:39], a[16:19], v[68:71], v[36:39]
  v_mfma_f32_16x16x32_bf16 v[40:43], a[72:75], v[68:71], v[40:43]
  v_mfma_f32_16x16x32_bf16 v[44:47], a[128:131], v[68:71], v[44:47]
  v_mfma_f32_16x16x32_bf16 v[48:51], a[184:187], v[68:71], v[48:51]
  v_mfma_f32_16x16x32_bf16 v[52:55], a[240:243], v[68:71], v[52:55]
  v_mfma_f32_16x16x32_bf16 v[56:59], v[160:163], v[68:71], v[56:59]
  v_mfma_f32_16x16x32_bf16 v[60:63], v[216:219], v[68:71], v[60:63]
  ds_read_b128 v[68:71], v5 offset:20480
  s_waitcnt lgkmcnt(3)
  v_mfma_f32_16x16x32_bf16 v[8:11], a[20:23], v[72:75], v[8:11]
  v_mfma_f32_16x16x32_bf16 v[12:15], a[76:79], v[72:75], v[12:15]
  v_mfma_f32_16x16x32_bf16 v[16:19], a[132:135], v[72:75], v[16:19]
  v_mfma_f32_16x16x32_bf16 v[20:23], a[188:191], v[72:75], v[20:23]
  v_mfma_f32_16x16x32_bf16 v[24:27], a[244:247], v[72:75], v[24:27]
  v_mfma_f32_16x16x32_bf16 v[28:31], v[164:167], v[72:75], v[28:31]
  v_mfma_f32_16x16x32_bf16 v[32:35], v[220:223], v[72:75], v[32:35]
  ds_read_b128 v[72:75], v5 offset:7168
  s_waitcnt lgkmcnt(3)
  v_mfma_f32_16x16x32_bf16 v[36:39], a[20:23], v[76:79], v[36:39]
  v_mfma_f32_16x16x32_bf16 v[40:43], a[76:79], v[76:79], v[40:43]
  v_mfma_f32_16x16x32_bf16 v[44:47], a[132:135], v[76:79], v[44:47]
  v_mfma_f32_16x16x32_bf16 v[48:51], a[188:191], v[76:79], v[48:51]
  v_mfma_f32_16x16x32_bf16 v[52:55], a[244:247], v[76:79], v[52:55]
  v_mfma_f32_16x16x32_bf16 v[56:59], v[164:167], v[76:79], v[56:59]
  v_mfma_f32_16x16x32_bf16 v[60:63], v[220:223], v[76:79], v[60:63]
  ds_read_b128 v[76:79], v5 offset:21504
  s_waitcnt lgkmcnt(3)
  v_mfma_f32_16x16x32_bf16 v[8:11], a[24:27], v[64:67], v[8:11]
  v_mfma_f32_16x16x32_bf16 v[12:15], a[80:83], v[64:67], v[12:15]
  v_mfma_f32_16x16x32_bf16 v[16:19], a[136:139], v[64:67], v[16:19]
  v_mfma_f32_16x16x32_bf16 v[20:23], a[192:195], v[64:67], v[20:23]
  v_mfma_f32_16x16x32_bf16 v[24:27], a[248:251], v[64:67], v[24:27]
  v_mfma_f32_16x16x32_bf16 v[28:31], v[168:171], v[64:67], v[28:31]
  v_mfma_f32_16x16x32_bf16 v[32:35], v[224:227], v[64:67], v[32:35]
  ds_read_b128 v[64:67], v5 offset:8192
  s_waitcnt lgkmcnt(3)
  v_mfma_f32_16x16x32_bf16 v[36:39], a[24:27], v[68:71], v[36:39]
  v_mfma_f32_16x16x32_bf16 v[40:43], a[80:83], v[68:71], v[40:43]
  v_mfma_f32_16x16x32_bf16 v[44:47], a[136:139], v[68:71], v[44:47]
  v_mfma_f32_16x16x32_bf16 v[48:51], a[192:195], v[68:71], v[48:51]
  v_mfma_f32_16x16x32_bf16 v[52:55], a[248:251], v[68:71], v[52:55]
  v_mfma_f32_16x16x32_bf16 v[56:59], v[168:171], v[68:71], v[56:59]
  v_mfma_f32_16x16x32_bf16 v[60:63], v[224:227], v[68:71], v[60:63]
  ds_read_b128 v[68:71], v5 offset:22528
  s_waitcnt lgkmcnt(3)
  v_mfma_f32_16x16x32_bf16 v[8:11], a[28:31], v[72:75], v[8:11]
  v_mfma_f32_16x16x32_bf16 v[12:15], a[84:87], v[72:75], v[12:15]
  v_mfma_f32_16x16x32_bf16 v[16:19], a[140:143], v[72:75], v[16:19]
  v_mfma_f32_16x16x32_bf16 v[20:23], a[196:199], v[72:75], v[20:23]
  v_mfma_f32_16x16x32_bf16 v[24:27], a[252:255], v[72:75], v[24:27]
  v_mfma_f32_16x16x32_bf16 v[28:31], v[172:175], v[72:75], v[28:31]
  v_mfma_f32_16x16x32_bf16 v[32:35], v[228:231], v[72:75], v[32:35]
  ds_read_b128 v[72:75], v5 offset:9216
  s_waitcnt lgkmcnt(3)
  v_mfma_f32_16x16x32_bf16 v[36:39], a[28:31], v[76:79], v[36:39]
  v_mfma_f32_16x16x32_bf16 v[40:43], a[84:87], v[76:79], v[40:43]
  v_mfma_f32_16x16x32_bf16 v[44:47], a[140:143], v[76:79], v[44:47]
  v_mfma_f32_16x16x32_bf16 v[48:51], a[196:199], v[76:79], v[48:51]
  v_mfma_f32_16x16x32_bf16 v[52:55], a[252:255], v[76:79], v[52:55]
  v_mfma_f32_16x16x32_bf16 v[56:59], v[172:175], v[76:79], v[56:59]
  v_mfma_f32_16x16x32_bf16 v[60:63], v[228:231], v[76:79], v[60:63]
  ds_read_b128 v[76:79], v5 offset:23552
  s_waitcnt lgkmcnt(3)
  v_mfma_f32_16x16x32_bf16 v[8:11], a[32:35], v[64:67], v[8:11]
  v_mfma_f32_16x16x32_bf16 v[12:15], a[88:91], v[64:67], v[12:15]
  v_mfma_f32_16x16x32_bf16 v[16:19], a[144:147], v[64:67], v[16:19]
  v_mfma_f32_16x16x32_bf16 v[20:23], a[200:203], v[64:67], v[20:23]
  v_mfma_f32_16x16x32_bf16 v[24:27], v[120:123], v[64:67], v[24:27]
  v_mfma_f32_16x16x32_bf16 v[28:31], v[176:179], v[64:67], v[28:31]
  v_mfma_f32_16x16x32_bf16 v[32:35], v[232:235], v[64:67], v[32:35]
  ds_read_b128 v[64:67], v5 offset:10240
  s_waitcnt lgkmcnt(3)
  v_mfma_f32_16x16x32_bf16 v[36:39], a[32:35], v[68:71], v[36:39]
  v_mfma_f32_16x16x32_bf16 v[40:43], a[88:91], v[68:71], v[40:43]
  v_mfma_f32_16x16x32_bf16 v[44:47], a[144:147], v[68:71], v[44:47]
  v_mfma_f32_16x16x32_bf16 v[48:51], a[200:203], v[68:71], v[48:51]
  v_mfma_f32_16x16x32_bf16 v[52:55], v[120:123], v[68:71], v[52:55]
  v_mfma_f32_16x16x32_bf16 v[56:59], v[176:179], v[68:71], v[56:59]
  v_mfma_f32_16x16x32_bf16 v[60:63], v[232:235], v[68:71], v[60:63]
  ds_read_b128 v[68:71], v5 offset:24576
  s_waitcnt lgkmcnt(3)
  v_mfma_f32_16x16x32_bf16 v[8:11], a[36:39], v[72:75], v[8:11]
  v_mfma_f32_16x16x32_bf16 v[12:15], a[92:95], v[72:75], v[12:15]
  v_mfma_f32_16x16x32_bf16 v[16:19], a[148:151], v[72:75], v[16:19]
  v_mfma_f32_16x16x32_bf16 v[20:23], a[204:207], v[72:75], v[20:23]
  v_mfma_f32_16x16x32_bf16 v[24:27], v[124:127], v[72:75], v[24:27]
  v_mfma_f32_16x16x32_bf16 v[28:31], v[180:183], v[72:75], v[28:31]
  v_mfma_f32_16x16x32_bf16 v[32:35], v[236:239], v[72:75], v[32:35]
  ds_read_b128 v[72:75], v5 offset:11264
  s_waitcnt lgkmcnt(3)
  v_mfma_f32_16x16x32_bf16 v[36:39], a[36:39], v[76:79], v[36:39]
  v_mfma_f32_16x16x32_bf16 v[40:43], a[92:95], v[76:79], v[40:43]
  v_mfma_f32_16x16x32_bf16 v[44:47], a[148:151], v[76:79], v[44:47]
  v_mfma_f32_16x16x32_bf16 v[48:51], a[204:207], v[76:79], v[48:51]
  v_mfma_f32_16x16x32_bf16 v[52:55], v[124:127], v[76:79], v[52:55]
  v_mfma_f32_16x16x32_bf16 v[56:59], v[180:183], v[76:79], v[56:59]
  v_mfma_f32_16x16x32_bf16 v[60:63], v[236:239], v[76:79], v[60:63]
  ds_read_b128 v[76:79], v5 offset:25600
  s_waitcnt lgkmcnt(3)
  v_mfma_f32_16x16x32_bf16 v[8:11], a[40:43], v[64:67], v[8:11]
  v_mfma_f32_16x16x32_bf16 v[12:15], a[96:99], v[64:67], v[12:15]
  v_mfma_f32_16x16x32_bf16 v[16:19], a[152:155], v[64:67], v[16:19]
  v_mfma_f32_16x16x32_bf16 v[20:23], a[208:211], v[64:67], v[20:23]
  v_mfma_f32_16x16x32_bf16 v[24:27], v[128:131], v[64:67], v[24:27]
  v_mfma_f32_16x16x32_bf16 v[28:31], v[184:187], v[64:67], v[28:31]
  v_mfma_f32_16x16x32_bf16 v[32:35], v[240:243], v[64:67], v[32:35]
  ds_read_b128 v[64:67], v5 offset:12288
  s_waitcnt lgkmcnt(3)
  v_mfma_f32_16x16x32_bf16 v[36:39], a[40:43], v[68:71], v[36:39]
  v_mfma_f32_16x16x32_bf16 v[40:43], a[96:99], v[68:71], v[40:43]
  v_mfma_f32_16x16x32_bf16 v[44:47], a[152:155], v[68:71], v[44:47]
  v_mfma_f32_16x16x32_bf16 v[48:51], a[208:211], v[68:71], v[48:51]
  v_mfma_f32_16x16x32_bf16 v[52:55], v[128:131], v[68:71], v[52:55]
  v_mfma_f32_16x16x32_bf16 v[56:59], v[184:187], v[68:71], v[56:59]
  v_mfma_f32_16x16x32_bf16 v[60:63], v[240:243], v[68:71], v[60:63]
  ds_read_b128 v[68:71], v5 offset:26624
  s_waitcnt lgkmcnt(3)
  v_mfma_f32_16x16x32_bf16 v[8:11], a[44:47], v[72:75], v[8:11]
  v_mfma_f32_16x16x32_bf16 v[12:15], a[100:103], v[72:75], v[12:15]
  v_mfma_f32_16x16x32_bf16 v[16:19], a[156:159], v[72:75], v[16:19]
  v_mfma_f32_16x16x32_bf16 v[20:23], a[212:215], v[72:75], v[20:23]
  v_mfma_f32_16x16x32_bf16 v[24:27], v[132:135], v[72:75], v[24:27]
  v_mfma_f32_16x16x32_bf16 v[28:31], v[188:191], v[72:75], v[28:31]
  v_mfma_f32_16x16x32_bf16 v[32:35], v[244:247], v[72:75], v[32:35]
  ds_read_b128 v[72:75], v5 offset:13312
  s_waitcnt lgkmcnt(3)
  v_mfma_f32_16x16x32_bf16 v[36:39], a[44:47], v[76:79], v[36:39]
  v_mfma_f32_16x16x32_bf16 v[40:43], a[100:103], v[76:79], v[40:43]
  v_mfma_f32_16x16x32_bf16 v[44:47], a[156:159], v[76:79], v[44:47]
  v_mfma_f32_16x16x32_bf16 v[48:51], a[212:215], v[76:79], v[48:51]
  v_mfma_f32_16x16x32_bf16 v[52:55], v[132:135], v[76:79], v[52:55]
  v_mfma_f32_16x16x32_bf16 v[56:59], v[188:191], v[76:79], v[56:59]
  v_mfma_f32_16x16x32_bf16 v[60:63], v[244:247], v[76:79], v[60:63]
  ds_read_b128 v[76:79], v5 offset:27648
  s_waitcnt lgkmcnt(3)
  v_mfma_f32_16x16x32_bf16 v[8:11], a[48:51], v[64:67], v[8:11]
  v_mfma_f32_16x16x32_bf16 v[12:15], a[104:107], v[64:67], v[12:15]
  v_mfma_f32_16x16x32_bf16 v[16:19], a[160:163], v[64:67], v[16:19]
  v_mfma_f32_16x16x32_bf16 v[20:23], a[216:219], v[64:67], v[20:23]
  v_mfma_f32_16x16x32_bf16 v[24:27], v[136:139], v[64:67], v[24:27]
  v_mfma_f32_16x16x32_bf16 v[28:31], v[192:195], v[64:67], v[28:31]
  v_mfma_f32_16x16x32_bf16 v[32:35], v[248:251], v[64:67], v[32:35]
  s_waitcnt lgkmcnt(2)
  v_mfma_f32_16x16x32_bf16 v[36:39], a[48:51], v[68:71], v[36:39]
  v_mfma_f32_16x16x32_bf16 v[40:43], a[104:107], v[68:71], v[40:43]
  v_mfma_f32_16x16x32_bf16 v[44:47], a[160:163], v[68:71], v[44:47]
  v_mfma_f32_16x16x32_bf16 v[48:51], a[216:219], v[68:71], v[48:51]
  v_mfma_f32_16x16x32_bf16 v[52:55], v[136:139], v[68:71], v[52:55]
  v_mfma_f32_16x16x32_bf16 v[56:59], v[192:195], v[68:71], v[56:59]
  v_mfma_f32_16x16x32_bf16 v[60:63], v[248:251], v[68:71], v[60:63]
  s_waitcnt lgkmcnt(1)
  v_mfma_f32_16x16x32_bf16 v[8:11], a[52:55], v[72:75], v[8:11]
  v_mfma_f32_16x16x32_bf16 v[12:15], a[108:111], v[72:75], v[12:15]
  v_mfma_f32_16x16x32_bf16 v[16:19], a[164:167], v[72:75], v[16:19]
  v_mfma_f32_16x16x32_bf16 v[20:23], a[220:223], v[72:75], v[20:23]
  v_mfma_f32_16x16x32_bf16 v[24:27], v[140:143], v[72:75], v[24:27]
  v_mfma_f32_16x16x32_bf16 v[28:31], v[196:199], v[72:75], v[28:31]
  v_mfma_f32_16x16x32_bf16 v[32:35], v[252:255], v[72:75], v[32:35]
  s_waitcnt lgkmcnt(0)
  v_mfma_f32_16x16x32_bf16 v[36:39], a[52:55], v[76:79], v[36:39]
  v_mfma_f32_16x16x32_bf16 v[40:43], a[108:111], v[76:79], v[40:43]
  v_mfma_f32_16x16x32_bf16 v[44:47], a[164:167], v[76:79], v[44:47]
  v_mfma_f32_16x16x32_bf16 v[48:51], a[220:223], v[76:79], v[48:51]
  v_mfma_f32_16x16x32_bf16 v[52:55], v[140:143], v[76:79], v[52:55]
  v_mfma_f32_16x16x32_bf16 v[56:59], v[196:199], v[76:79], v[56:59]
  v_mfma_f32_16x16x32_bf16 v[60:63], v[252:255], v[76:79], v[60:63]
  s_nop 7
  v_cvt_pk_bf16_f32 v80, v8, v9
  v_cvt_pk_bf16_f32 v81, v10, v11
  v_cvt_pk_bf16_f32 v82, v12, v13
  v_cvt_pk_bf16_f32 v83, v14, v15
  v_cvt_pk_bf16_f32 v84, v16, v17
  v_cvt_pk_bf16_f32 v85, v18, v19
  v_cvt_pk_bf16_f32 v86, v20, v21
  v_cvt_pk_bf16_f32 v87, v22, v23
  v_cvt_pk_bf16_f32 v88, v24, v25
  v_cvt_pk_bf16_f32 v89, v26, v27
  v_cvt_pk_bf16_f32 v90, v28, v29
  v_cvt_pk_bf16_f32 v91, v30, v31
  v_cvt_pk_bf16_f32 v92, v32, v33
  v_cvt_pk_bf16_f32 v93, v34, v35
  v_mov_b64 v[94:95], 0
  v_cvt_pk_bf16_f32 v96, v36, v37
  v_cvt_pk_bf16_f32 v97, v38, v39
  v_cvt_pk_bf16_f32 v98, v40, v41
  v_cvt_pk_bf16_f32 v99, v42, v43
  v_cvt_pk_bf16_f32 v100, v44, v45
  v_cvt_pk_bf16_f32 v101, v46, v47
  v_cvt_pk_bf16_f32 v102, v48, v49
  v_cvt_pk_bf16_f32 v103, v50, v51
  v_cvt_pk_bf16_f32 v104, v52, v53
  v_cvt_pk_bf16_f32 v105, v54, v55
  v_cvt_pk_bf16_f32 v106, v56, v57
  v_cvt_pk_bf16_f32 v107, v58, v59
  v_cvt_pk_bf16_f32 v108, v60, v61
  v_cvt_pk_bf16_f32 v109, v62, v63
  v_mov_b64 v[110:111], 0
  v_add_u32 v112, s42, v6
  ds_read_b64 v[32:33], v112 offset:0
  ds_read_b64 v[34:35], v112 offset:512
  ds_read_b64 v[36:37], v112 offset:1024
  ds_read_b64 v[38:39], v112 offset:1536
  ds_read_b64 v[40:41], v112 offset:2048
  ds_read_b64 v[42:43], v112 offset:2560
  ds_read_b64 v[44:45], v112 offset:3072
  ds_read_b64 v[46:47], v112 offset:3072
  s_waitcnt lgkmcnt(0)
  v_mfma_f32_16x16x32_bf16 v[16:19], v[32:35], v[80:83], 0
  v_mfma_f32_16x16x32_bf16 v[20:23], v[32:35], v[96:99], 0
  v_mfma_f32_16x16x32_bf16 v[16:19], v[36:39], v[84:87], v[16:19]
  v_mfma_f32_16x16x32_bf16 v[20:23], v[36:39], v[100:103], v[20:23]
  v_mfma_f32_16x16x32_bf16 v[16:19], v[40:43], v[88:91], v[16:19]
  v_mfma_f32_16x16x32_bf16 v[20:23], v[40:43], v[104:107], v[20:23]
  v_mfma_f32_16x16x32_bf16 v[16:19], v[44:47], v[92:95], v[16:19]
  v_mfma_f32_16x16x32_bf16 v[20:23], v[44:47], v[108:111], v[20:23]
  s_nop 1
  ds_read_b64 v[32:33], v112 offset:14336
  ds_read_b64 v[34:35], v112 offset:14848
  ds_read_b64 v[36:37], v112 offset:15360
  ds_read_b64 v[38:39], v112 offset:15872
  ds_read_b64 v[40:41], v112 offset:16384
  ds_read_b64 v[42:43], v112 offset:16896
  ds_read_b64 v[44:45], v112 offset:17408
  ds_read_b64 v[46:47], v112 offset:17408
  s_waitcnt lgkmcnt(0)
  v_mfma_f32_16x16x32_bf16 v[24:27], v[32:35], v[80:83], 0
  v_mfma_f32_16x16x32_bf16 v[28:31], v[32:35], v[96:99], 0
  v_mfma_f32_16x16x32_bf16 v[24:27], v[36:39], v[84:87], v[24:27]
  v_mfma_f32_16x16x32_bf16 v[28:31], v[36:39], v[100:103], v[28:31]
  v_mfma_f32_16x16x32_bf16 v[24:27], v[40:43], v[88:91], v[24:27]
  v_mfma_f32_16x16x32_bf16 v[28:31], v[40:43], v[104:107], v[28:31]
  v_mfma_f32_16x16x32_bf16 v[24:27], v[44:47], v[92:95], v[24:27]
  v_mfma_f32_16x16x32_bf16 v[28:31], v[44:47], v[108:111], v[28:31]
  s_nop 1
  s_mul_i32 s26, s41, 8192
  s_add_u32 s27, s26, 7164
  s_cmp_lg_u32 s23, 0
  s_cbranch_scc1 b_pw_pre_ok
  v_mov_b32 v56, s27
  s_mov_b64 exec, 1
b_pw_pre:
  global_load_dword v57, v56, s[18:19] sc1
  s_sub_u32 s25, s25, 1
  s_cbranch_scc1 b_fail
  s_waitcnt vmcnt(0)
  v_cmp_eq_u32 vcc, -1, v57
  s_cbranch_vccz b_pw_pre_got
  s_cmp_ge_u32 s41, 61
  s_cbranch_scc1 b_pw_pre
  s_sleep 8
  s_branch b_pw_pre
b_pw_pre_got:
  s_mov_b64 exec, -1
b_pw_pre_ok:
  s_barrier
  v_lshlrev_b32 v113, 4, v0
  v_add_u32 v113, s26, v113
  v_add_u32 v114, 256, v0
  v_min_u32 v114, 447, v114
  v_lshlrev_b32 v114, 4, v114
  v_add_u32 v114, s26, v114
b_pw_wm:
  global_load_dwordx4 v[48:51], v113, s[18:19] sc1
  global_load_dwordx4 v[52:55], v114, s[18:19] sc1
  s_sub_u32 s25, s25, 1
  s_cbranch_scc1 b_fail
  s_waitcnt vmcnt(0)
  v_max3_u32 v56, v48, v49, v50
  v_max3_u32 v56, v56, v51, v52
  v_max3_u32 v56, v56, v53, v54
  v_max_u32 v56, v56, v55
  v_cmp_eq_u32 vcc, -1, v56
  s_cbranch_vccz b_pw_wm_ok
  s_sleep 2
  s_branch b_pw_wm
b_pw_wm_ok:
  v_mov_b32 v56, v0
  s_mov_b32 s27, 76695845
  v_mul_hi_u32 v57, v56, s27
  v_mul_u32_u24 v58, 56, v57
  v_sub_u32 v58, v56, v58
  v_mul_u32_u24 v57, 912, v57
  v_lshl_add_u32 v57, v58, 4, v57
  v_add_u32 v57, 81920, v57
  ds_write_b128 v57, v[48:51]
  v_add_u32 v56, 256, v0
  v_min_u32 v56, 447, v56
  s_mov_b32 s27, 76695845
  v_mul_hi_u32 v57, v56, s27
  v_mul_u32_u24 v58, 56, v57
  v_sub_u32 v58, v56, v58
  v_mul_u32_u24 v57, 912, v57
  v_lshl_add_u32 v57, v58, 4, v57
  v_add_u32 v57, 81920, v57
  ds_write_b128 v57, v[52:55]
  s_waitcnt lgkmcnt(0)
  s_barrier
  ds_read_b64 v[32:33], v7 offset:0
  ds_read_b64 v[34:35], v7 offset:32
  ds_read_b64 v[36:37], v7 offset:64
  ds_read_b64 v[38:39], v7 offset:96
  ds_read_b64 v[40:41], v7 offset:128
  ds_read_b64 v[42:43], v7 offset:160
  ds_read_b64 v[44:45], v7 offset:192
  ds_read_b64 v[46:47], v7 offset:192
  s_waitcnt lgkmcnt(0)
  v_mfma_f32_16x16x32_bf16 v[8:11], v[32:35], v[80:83], 0
  v_mfma_f32_16x16x32_bf16 v[12:15], v[32:35], v[96:99], 0
  v_mfma_f32_16x16x32_bf16 v[8:11], v[36:39], v[84:87], v[8:11]
  v_mfma_f32_16x16x32_bf16 v[12:15], v[36:39], v[100:103], v[12:15]
  v_mfma_f32_16x16x32_bf16 v[8:11], v[40:43], v[88:91], v[8:11]
  v_mfma_f32_16x16x32_bf16 v[12:15], v[40:43], v[104:107], v[12:15]
  v_mfma_f32_16x16x32_bf16 v[8:11], v[44:47], v[92:95], v[8:11]
  v_mfma_f32_16x16x32_bf16 v[12:15], v[44:47], v[108:111], v[12:15]
  s_nop 1
  s_mul_i32 s26, s23, 6144
  s_add_u32 s26, s26, 57344
  v_add_u32 v113, s26, v2
  s_nop 5
  ds_write_b128 v113, v[8:11] offset:0
  ds_write_b128 v113, v[12:15] offset:1024
  ds_write_b128 v113, v[16:19] offset:2048
  ds_write_b128 v113, v[20:23] offset:3072
  ds_write_b128 v113, v[24:27] offset:4096
  ds_write_b128 v113, v[28:31] offset:5120
  s_waitcnt lgkmcnt(0)
  s_barrier
  s_cmp_ge_u32 s23, 2
  s_cbranch_scc1 b_pw_fin
  s_lshl_b32 s26, s23, 10
  s_add_u32 s26, s26, 57344
  v_add_u32 v113, s26, v2
  ds_read_b128 v[64:67], v113 offset:0
  ds_read_b128 v[68:71], v113 offset:2048
  ds_read_b128 v[72:75], v113 offset:4096
  ds_read_b128 v[76:79], v113 offset:6144
  ds_read_b128 v[80:83], v113 offset:8192
  ds_read_b128 v[84:87], v113 offset:10240
  ds_read_b128 v[88:91], v113 offset:12288
  ds_read_b128 v[92:95], v113 offset:14336
  ds_read_b128 v[96:99], v113 offset:16384
  ds_read_b128 v[100:103], v113 offset:18432
  ds_read_b128 v[104:107], v113 offset:20480
  ds_read_b128 v[108:111], v113 offset:22528
  s_waitcnt lgkmcnt(0)
  v_add_f32 v8, v64, v76
  v_add_f32 v24, v88, v100
  v_add_f32 v8, v8, v24
  v_add_f32 v9, v65, v77
  v_add_f32 v25, v89, v101
  v_add_f32 v9, v9, v25
  v_add_f32 v10, v66, v78
  v_add_f32 v26, v90, v102
  v_add_f32 v10, v10, v26
  v_add_f32 v11, v67, v79
  v_add_f32 v27, v91, v103
  v_add_f32 v11, v11, v27
  v_add_f32 v12, v68, v80
  v_add_f32 v28, v92, v104
  v_add_f32 v12, v12, v28
  v_add_f32 v13, v69, v81
  v_add_f32 v29, v93, v105
  v_add_f32 v13, v13, v29
  v_add_f32 v14, v70, v82
  v_add_f32 v30, v94, v106
  v_add_f32 v14, v14, v30
  v_add_f32 v15, v71, v83
  v_add_f32 v31, v95, v107
  v_add_f32 v15, v15, v31
  v_add_f32 v16, v72, v84
  v_add_f32 v32, v96, v108
  v_add_f32 v16, v16, v32
  v_add_f32 v17, v73, v85
  v_add_f32 v33, v97, v109
  v_add_f32 v17, v17, v33
  v_add_f32 v18, v74, v86
  v_add_f32 v34, v98, v110
  v_add_f32 v18, v18, v34
  v_add_f32 v19, v75, v87
  v_add_f32 v35, v99, v111
  v_add_f32 v19, v19, v35
  v_and_b32 v40, 15, v1
  v_lshrrev_b32 v41, 4, v1
  v_lshlrev_b32 v41, 2, v41
  v_mov_b32 v42, 0xf149f2ca
  s_cmp_eq_u32 s23, 0
  s_cbranch_scc0 b_pw_q1
  v_add_u32 v43, 0, v41
  v_cmp_le_u32 vcc, v43, v40
  s_nop 1
  v_cndmask_b32 v12, v42, v12, vcc
  v_mov_b32 v16, v42
  v_add_u32 v43, 1, v41
  v_cmp_le_u32 vcc, v43, v40
  s_nop 1
  v_cndmask_b32 v13, v42, v13, vcc
  v_mov_b32 v17, v42
  v_add_u32 v43, 2, v41
  v_cmp_le_u32 vcc, v43, v40
  s_nop 1
  v_cndmask_b32 v14, v42, v14, vcc
  v_mov_b32 v18, v42
  v_add_u32 v43, 3, v41
  v_cmp_le_u32 vcc, v43, v40
  s_nop 1
  v_cndmask_b32 v15, v42, v15, vcc
  v_mov_b32 v19, v42
  s_branch b_pw_sm
b_pw_q1:
  v_add_u32 v43, 0, v41
  v_cmp_le_u32 vcc, v43, v40
  s_nop 1
  v_cndmask_b32 v16, v42, v16, vcc
  v_add_u32 v43, 1, v41
  v_cmp_le_u32 vcc, v43, v40
  s_nop 1
  v_cndmask_b32 v17, v42, v17, vcc
  v_add_u32 v43, 2, v41
  v_cmp_le_u32 vcc, v43, v40
  s_nop 1
  v_cndmask_b32 v18, v42, v18, vcc
  v_add_u32 v43, 3, v41
  v_cmp_le_u32 vcc, v43, v40
  s_nop 1
  v_cndmask_b32 v19, v42, v19, vcc
b_pw_sm:
  v_max3_f32 v44, v8, v9, v10
  v_max3_f32 v44, v44, v11, v12
  v_max3_f32 v44, v44, v13, v14
  v_max3_f32 v44, v44, v15, v16
  v_max3_f32 v44, v44, v17, v18
  v_max_f32 v44, v44, v19
  v_mov_b32 v45, v44
  s_nop 1
  v_permlane16_swap_b32 v44, v45
  v_max_f32 v44, v44, v45
  v_mov_b32 v45, v44
  s_nop 1
  v_permlane32_swap_b32 v44, v45
  v_max_f32 v44, v44, v45
  v_sub_f32 v8, v8, v44
  v_sub_f32 v9, v9, v44
  v_sub_f32 v10, v10, v44
  v_sub_f32 v11, v11, v44
  v_sub_f32 v12, v12, v44
  v_sub_f32 v13, v13, v44
  v_sub_f32 v14, v14, v44
  v_sub_f32 v15, v15, v44
  v_sub_f32 v16, v16, v44
  v_sub_f32 v17, v17, v44
  v_sub_f32 v18, v18, v44
  v_sub_f32 v19, v19, v44
  v_exp_f32 v8, v8
  v_exp_f32 v9, v9
  v_exp_f32 v10, v10
  v_exp_f32 v11, v11
  v_exp_f32 v12, v12
  v_exp_f32 v13, v13
  v_exp_f32 v14, v14
  v_exp_f32 v15, v15
  v_exp_f32 v16, v16
  v_exp_f32 v17, v17
  v_exp_f32 v18, v18
  v_exp_f32 v19, v19
  s_nop 0
  v_add_f32 v46, v8, v9
  v_add_f32 v47, v10, v11
  v_add_f32 v46, v46, v47
  v_mul_f32 v46, 0.5, v46
  v_add_f32 v46, v46, v12
  v_add_f32 v46, v46, v13
  v_add_f32 v46, v46, v14
  v_add_f32 v46, v46, v15
  v_add_f32 v46, v46, v16
  v_add_f32 v46, v46, v17
  v_add_f32 v46, v46, v18
  v_add_f32 v46, v46, v19
  v_mov_b32 v45, v46
  s_nop 1
  v_permlane16_swap_b32 v46, v45
  v_add_f32 v46, v46, v45
  v_mov_b32 v45, v46
  s_nop 1
  v_permlane32_swap_b32 v46, v45
  v_add_f32 v46, v46, v45
  v_rcp_f32 v46, v46
  s_nop 0
  v_mul_f32 v8, v8, v46
  v_mul_f32 v9, v9, v46
  v_mul_f32 v10, v10, v46
  v_mul_f32 v11, v11, v46
  v_mul_f32 v12, v12, v46
  v_mul_f32 v13, v13, v46
  v_mul_f32 v14, v14, v46
  v_mul_f32 v15, v15, v46
  v_mul_f32 v16, v16, v46
  v_mul_f32 v17, v17, v46
  v_mul_f32 v18, v18, v46
  v_mul_f32 v19, v19, v46
  v_cvt_pk_bf16_f32 v48, v8, v9
  v_cvt_pk_bf16_f32 v49, v10, v11
  v_cvt_pk_bf16_f32 v50, v12, v13
  v_cvt_pk_bf16_f32 v51, v14, v15
  v_cvt_pk_bf16_f32 v52, v16, v17
  v_cvt_pk_bf16_f32 v53, v18, v19
  s_mul_i32 s26, s41, 65536
  s_lshl_b32 s27, s23, 10
  s_add_u32 s26, s26, s27
  s_lshl_b32 s27, s43, 11
  s_add_u32 s27, s27, s26
  v_add_u32 v113, s27, v2
  v_mov_b32 v54, v50
  v_mov_b32 v55, v51
  v_mov_b32 v56, v52
  v_mov_b32 v57, v53
  global_store_dwordx4 v113, v[54:57], s[38:39] sc1
  s_lshr_b32 s27, s43, 1
  s_lshl_b32 s27, s27, 11
  s_add_u32 s27, s27, s26
  s_and_b32 s28, s43, 1
  s_lshl_b32 s28, s28, 3
  s_add_u32 s27, s27, s28
  s_add_u32 s27, s27, 32768
  v_add_u32 v114, s27, v2
  global_store_dwordx2 v114, v[48:49], s[38:39] sc1
b_pw_fin:
  s_waitcnt vmcnt(0)
  s_barrier
  s_lshl_b32 s26, s41, 7
  s_add_u32 s26, s26, 4096
  s_cmp_lg_u32 s23, 0
  s_cbranch_scc1 .Lsig8
  v_mov_b32 v48, s26
  v_mov_b32 v49, 1
  s_mov_b64 exec, 1
  global_atomic_add v48, v49, s[16:17] sc1
  s_mov_b64 exec, -1
.Lsig8:
  s_add_u32 s41, s41, 3
  s_xor_b32 s42, s42, 28672
  s_cmp_lt_u32 s41, 64
  s_cbranch_scc1 b_pw_seg
  s_endpgm
b_fcpv:
  s_load_dwordx2 s[76:77], s[0:1], 0
  s_waitcnt lgkmcnt(0)
  s_add_u32 s78, s4, 21131264
  s_addc_u32 s79, s5, 0
  s_cmp_eq_u32 s60, 0
  s_cselect_b32 s76, s76, s78
  s_cselect_b32 s77, s77, s79
  s_mov_b32 s84, 22966272
  s_cselect_b32 s85, 19296256, s84
  s_lshr_b32 s80, s22, 2
  s_lshr_b32 s81, s22, 1
  s_and_b32 s81, s81, 1
  s_and_b32 s82, s22, 1
  s_lshl_b32 s86, s80, 7
  s_lshl_b32 s87, s81, 5
  s_add_u32 s86, s86, s87
  s_lshl_b32 s87, s82, 4
  s_add_u32 s86, s86, s87
  v_mov_b64 v[4:5], 0
  v_mov_b64 v[6:7], 0
  v_lshlrev_b32 v2, 4, v1
  ds_write_b128 v2, v[4:7] offset:14336
  ds_write_b128 v2, v[4:7] offset:29696
  v_lshrrev_b32 v10, 3, v0
  v_and_b32 v11, 7, v0
  v_lshrrev_b32 v12, 1, v10
  v_and_b32 v13, 1, v10
  v_lshl_add_u32 v12, v13, 6, v12
  v_add_u32 v12, s86, v12
  v_mul_u32_u24 v12, 896, v12
  v_lshl_add_u32 v240, v11, 4, v12
  global_load_dwordx4 v[200:203], v240, s[76:77] offset:0
  global_load_dwordx4 v[204:207], v240, s[76:77] offset:128
  global_load_dwordx4 v[208:211], v240, s[76:77] offset:256
  global_load_dwordx4 v[212:215], v240, s[76:77] offset:384
  global_load_dwordx4 v[216:219], v240, s[76:77] offset:512
  global_load_dwordx4 v[220:223], v240, s[76:77] offset:640
  global_load_dwordx4 v[224:227], v240, s[76:77] offset:768
  s_waitcnt lgkmcnt(0)
  s_barrier
  s_lshl_b32 s83, s80, 8
  s_lshl_b32 s84, s81, 7
  s_add_u32 s83, s83, s84
  s_lshl_b32 s84, s82, 6
  s_add_u32 s83, s83, s84
  s_add_u32 s83, s83, 17395712
  v_lshrrev_b32 v2, 2, v1
  v_lshlrev_b32 v2, 12, v2
  v_and_b32 v3, 3, v1
  v_lshl_add_u32 v2, v3, 4, v2
  v_add_u32 v2, s83, v2
  s_cmp_eq_u32 s23, 0
  s_cbranch_scc0 fc_dm0
  v_add_u32 v3, 0, v2
  s_mov_b32 m0, 0
  s_nop 0
  global_load_lds_dwordx4 v3, s[4:5]
  v_add_u32 v3, 262144, v2
  s_mov_b32 m0, 4096
  s_nop 0
  global_load_lds_dwordx4 v3, s[4:5]
  v_add_u32 v3, 524288, v2
  s_mov_b32 m0, 8192
  s_nop 0
  global_load_lds_dwordx4 v3, s[4:5]
  v_add_u32 v3, 786432, v2
  s_mov_b32 m0, 12288
  s_nop 0
  global_load_lds_dwordx4 v3, s[4:5]
  v_add_u32 v3, 987136, v2
  s_mov_b32 m0, 16384
  s_nop 0
  global_load_lds_dwordx4 v3, s[4:5]
  v_add_u32 v3, 1249280, v2
  s_mov_b32 m0, 20480
  s_nop 0
  global_load_lds_dwordx4 v3, s[4:5]
  v_add_u32 v3, 1511424, v2
  s_mov_b32 m0, 24576
  s_nop 0
  global_load_lds_dwordx4 v3, s[4:5]
  v_add_u32 v3, 1773568, v2
  s_mov_b32 m0, 28672
  s_nop 0
  global_load_lds_dwordx4 v3, s[4:5]
  s_branch fc_dmj
fc_dm0:
  s_cmp_eq_u32 s23, 1
  s_cbranch_scc0 fc_dm1
  v_add_u32 v3, 65536, v2
  s_mov_b32 m0, 1024
  s_nop 0
  global_load_lds_dwordx4 v3, s[4:5]
  v_add_u32 v3, 327680, v2
  s_mov_b32 m0, 5120
  s_nop 0
  global_load_lds_dwordx4 v3, s[4:5]
  v_add_u32 v3, 589824, v2
  s_mov_b32 m0, 9216
  s_nop 0
  global_load_lds_dwordx4 v3, s[4:5]
  v_add_u32 v3, 851968, v2
  s_mov_b32 m0, 13312
  s_nop 0
  global_load_lds_dwordx4 v3, s[4:5]
  v_add_u32 v3, 1052672, v2
  s_mov_b32 m0, 17408
  s_nop 0
  global_load_lds_dwordx4 v3, s[4:5]
  v_add_u32 v3, 1314816, v2
  s_mov_b32 m0, 21504
  s_nop 0
  global_load_lds_dwordx4 v3, s[4:5]
  v_add_u32 v3, 1576960, v2
  s_mov_b32 m0, 25600
  s_nop 0
  global_load_lds_dwordx4 v3, s[4:5]
  s_mov_b64 exec, 15
  v_add_u32 v3, 1839104, v2
  s_mov_b32 m0, 29696
  s_nop 0
  global_load_lds_dwordx4 v3, s[4:5]
  s_mov_b64 exec, -1
  s_branch fc_dmj
fc_dm1:
  s_cmp_eq_u32 s23, 2
  s_cbranch_scc0 fc_dm2
  v_add_u32 v3, 131072, v2
  s_mov_b32 m0, 2048
  s_nop 0
  global_load_lds_dwordx4 v3, s[4:5]
  v_add_u32 v3, 393216, v2
  s_mov_b32 m0, 6144
  s_nop 0
  global_load_lds_dwordx4 v3, s[4:5]
  v_add_u32 v3, 655360, v2
  s_mov_b32 m0, 10240
  s_nop 0
  global_load_lds_dwordx4 v3, s[4:5]
  s_mov_b64 exec, 15
  v_add_u32 v3, 917504, v2
  s_mov_b32 m0, 14336
  s_nop 0
  global_load_lds_dwordx4 v3, s[4:5]
  s_mov_b64 exec, -1
  v_add_u32 v3, 1118208, v2
  s_mov_b32 m0, 18432
  s_nop 0
  global_load_lds_dwordx4 v3, s[4:5]
  v_add_u32 v3, 1380352, v2
  s_mov_b32 m0, 22528
  s_nop 0
  global_load_lds_dwordx4 v3, s[4:5]
  v_add_u32 v3, 1642496, v2
  s_mov_b32 m0, 26624
  s_nop 0
  global_load_lds_dwordx4 v3, s[4:5]
  s_branch fc_dmj
fc_dm2:
  v_add_u32 v3, 196608, v2
  s_mov_b32 m0, 3072
  s_nop 0
  global_load_lds_dwordx4 v3, s[4:5]
  v_add_u32 v3, 458752, v2
  s_mov_b32 m0, 7168
  s_nop 0
  global_load_lds_dwordx4 v3, s[4:5]
  v_add_u32 v3, 720896, v2
  s_mov_b32 m0, 11264
  s_nop 0
  global_load_lds_dwordx4 v3, s[4:5]
  v_add_u32 v3, 921600, v2
  s_mov_b32 m0, 15360
  s_nop 0
  global_load_lds_dwordx4 v3, s[4:5]
  v_add_u32 v3, 1183744, v2
  s_mov_b32 m0, 19456
  s_nop 0
  global_load_lds_dwordx4 v3, s[4:5]
  v_add_u32 v3, 1445888, v2
  s_mov_b32 m0, 23552
  s_nop 0
  global_load_lds_dwordx4 v3, s[4:5]
  v_add_u32 v3, 1708032, v2
  s_mov_b32 m0, 27648
  s_nop 0
  global_load_lds_dwordx4 v3, s[4:5]
fc_dmj:
  s_mul_i32 s87, s23, 15360
  s_add_u32 s87, s87, 13275136
  v_lshl_add_u32 v8, v1, 4, s87
  v_add_u32 v9, 0, v8
  global_load_dwordx4 a[0:3], v9, s[4:5]
  v_add_u32 v9, 1024, v8
  global_load_dwordx4 a[4:7], v9, s[4:5]
  v_add_u32 v9, 2048, v8
  global_load_dwordx4 a[8:11], v9, s[4:5]
  v_add_u32 v9, 3072, v8
  global_load_dwordx4 a[12:15], v9, s[4:5]
  v_add_u32 v9, 4096, v8
  global_load_dwordx4 a[16:19], v9, s[4:5]
  v_add_u32 v9, 5120, v8
  global_load_dwordx4 a[20:23], v9, s[4:5]
  v_add_u32 v9, 6144, v8
  global_load_dwordx4 a[24:27], v9, s[4:5]
  v_add_u32 v9, 7168, v8
  global_load_dwordx4 a[28:31], v9, s[4:5]
  v_add_u32 v9, 8192, v8
  global_load_dwordx4 a[32:35], v9, s[4:5]
  v_add_u32 v9, 9216, v8
  global_load_dwordx4 a[36:39], v9, s[4:5]
  v_add_u32 v9, 10240, v8
  global_load_dwordx4 a[40:43], v9, s[4:5]
  v_add_u32 v9, 11264, v8
  global_load_dwordx4 a[44:47], v9, s[4:5]
  v_add_u32 v9, 12288, v8
  global_load_dwordx4 a[48:51], v9, s[4:5]
  v_add_u32 v9, 13312, v8
  global_load_dwordx4 a[52:55], v9, s[4:5]
  v_add_u32 v9, 14336, v8
  global_load_dwordx4 a[56:59], v9, s[4:5]
  v_add_u32 v9, 122880, v8
  global_load_dwordx4 a[60:63], v9, s[4:5]
  v_add_u32 v9, 123904, v8
  global_load_dwordx4 a[64:67], v9, s[4:5]
  v_add_u32 v9, 124928, v8
  global_load_dwordx4 a[68:71], v9, s[4:5]
  v_add_u32 v9, 125952, v8
  global_load_dwordx4 a[72:75], v9, s[4:5]
  v_add_u32 v9, 126976, v8
  global_load_dwordx4 a[76:79], v9, s[4:5]
  v_add_u32 v9, 128000, v8
  global_load_dwordx4 a[80:83], v9, s[4:5]
  v_add_u32 v9, 129024, v8
  global_load_dwordx4 a[84:87], v9, s[4:5]
  v_add_u32 v9, 130048, v8
  global_load_dwordx4 a[88:91], v9, s[4:5]
  v_add_u32 v9, 131072, v8
  global_load_dwordx4 a[92:95], v9, s[4:5]
  v_add_u32 v9, 132096, v8
  global_load_dwordx4 a[96:99], v9, s[4:5]
  v_add_u32 v9, 133120, v8
  global_load_dwordx4 a[100:103], v9, s[4:5]
  v_add_u32 v9, 134144, v8
  global_load_dwordx4 a[104:107], v9, s[4:5]
  v_add_u32 v9, 135168, v8
  global_load_dwordx4 a[108:111], v9, s[4:5]
  v_add_u32 v9, 136192, v8
  global_load_dwordx4 a[112:115], v9, s[4:5]
  v_add_u32 v9, 137216, v8
  global_load_dwordx4 a[116:119], v9, s[4:5]
  v_add_u32 v9, 61440, v8
  global_load_dwordx4 a[120:123], v9, s[4:5]
  v_add_u32 v9, 62464, v8
  global_load_dwordx4 a[124:127], v9, s[4:5]
  v_add_u32 v9, 63488, v8
  global_load_dwordx4 a[128:131], v9, s[4:5]
  v_add_u32 v9, 64512, v8
  global_load_dwordx4 a[132:135], v9, s[4:5]
  v_add_u32 v9, 65536, v8
  global_load_dwordx4 a[136:139], v9, s[4:5]
  v_add_u32 v9, 66560, v8
  global_load_dwordx4 a[140:143], v9, s[4:5]
  v_add_u32 v9, 67584, v8
  global_load_dwordx4 a[144:147], v9, s[4:5]
  v_add_u32 v9, 68608, v8
  global_load_dwordx4 a[148:151], v9, s[4:5]
  v_add_u32 v9, 69632, v8
  global_load_dwordx4 a[152:155], v9, s[4:5]
  v_add_u32 v9, 70656, v8
  global_load_dwordx4 a[156:159], v9, s[4:5]
  s_waitcnt vmcnt(40)
  s_barrier
  v_lshrrev_b32 v2, 5, v1
  v_lshlrev_b32 v2, 3, v2
  v_and_b32 v3, 15, v1
  v_lshrrev_b32 v4, 2, v3
  v_add_u32 v2, v2, v4
  v_lshlrev_b32 v2, 6, v2
  v_lshrrev_b32 v4, 4, v1
  v_and_b32 v4, 1, v4
  v_lshl_add_u32 v2, v4, 5, v2
  v_and_b32 v3, 3, v3
  v_lshl_add_u32 v2, v3, 3, v2
  ds_read_b64_tr_b16 v[16:17], v2 offset:0
  ds_read_b64_tr_b16 v[18:19], v2 offset:256
  ds_read_b64_tr_b16 v[20:21], v2 offset:1024
  ds_read_b64_tr_b16 v[22:23], v2 offset:1280
  ds_read_b64_tr_b16 v[24:25], v2 offset:2048
  ds_read_b64_tr_b16 v[26:27], v2 offset:2304
  ds_read_b64_tr_b16 v[28:29], v2 offset:3072
  ds_read_b64_tr_b16 v[30:31], v2 offset:3328
  ds_read_b64_tr_b16 v[32:33], v2 offset:4096
  ds_read_b64_tr_b16 v[34:35], v2 offset:4352
  ds_read_b64_tr_b16 v[36:37], v2 offset:5120
  ds_read_b64_tr_b16 v[38:39], v2 offset:5376
  ds_read_b64_tr_b16 v[40:41], v2 offset:6144
  ds_read_b64_tr_b16 v[42:43], v2 offset:6400
  ds_read_b64_tr_b16 v[44:45], v2 offset:7168
  ds_read_b64_tr_b16 v[46:47], v2 offset:7424
  ds_read_b64_tr_b16 v[48:49], v2 offset:8192
  ds_read_b64_tr_b16 v[50:51], v2 offset:8448
  ds_read_b64_tr_b16 v[52:53], v2 offset:9216
  ds_read_b64_tr_b16 v[54:55], v2 offset:9472
  ds_read_b64_tr_b16 v[56:57], v2 offset:10240
  ds_read_b64_tr_b16 v[58:59], v2 offset:10496
  ds_read_b64_tr_b16 v[60:61], v2 offset:11264
  ds_read_b64_tr_b16 v[62:63], v2 offset:11520
  ds_read_b64_tr_b16 v[64:65], v2 offset:12288
  ds_read_b64_tr_b16 v[66:67], v2 offset:12544
  ds_read_b64_tr_b16 v[68:69], v2 offset:13312
  ds_read_b64_tr_b16 v[70:71], v2 offset:13568
  ds_read_b64_tr_b16 v[72:73], v2 offset:14336
  ds_read_b64_tr_b16 v[74:75], v2 offset:14592
  ds_read_b64_tr_b16 v[76:77], v2 offset:15360
  ds_read_b64_tr_b16 v[78:79], v2 offset:15616
  ds_read_b64_tr_b16 v[80:81], v2 offset:16384
  ds_read_b64_tr_b16 v[82:83], v2 offset:16640
  ds_read_b64_tr_b16 v[84:85], v2 offset:17408
  ds_read_b64_tr_b16 v[86:87], v2 offset:17664
  ds_read_b64_tr_b16 v[88:89], v2 offset:18432
  ds_read_b64_tr_b16 v[90:91], v2 offset:18688
  ds_read_b64_tr_b16 v[92:93], v2 offset:19456
  ds_read_b64_tr_b16 v[94:95], v2 offset:19712
  ds_read_b64_tr_b16 v[96:97], v2 offset:20480
  ds_read_b64_tr_b16 v[98:99], v2 offset:20736
  ds_read_b64_tr_b16 v[100:101], v2 offset:21504
  ds_read_b64_tr_b16 v[102:103], v2 offset:21760
  ds_read_b64_tr_b16 v[104:105], v2 offset:22528
  ds_read_b64_tr_b16 v[106:107], v2 offset:22784
  ds_read_b64_tr_b16 v[108:109], v2 offset:23552
  ds_read_b64_tr_b16 v[110:111], v2 offset:23808
  ds_read_b64_tr_b16 v[112:113], v2 offset:24576
  ds_read_b64_tr_b16 v[114:115], v2 offset:24832
  ds_read_b64_tr_b16 v[116:117], v2 offset:25600
  ds_read_b64_tr_b16 v[118:119], v2 offset:25856
  ds_read_b64_tr_b16 v[120:121], v2 offset:26624
  ds_read_b64_tr_b16 v[122:123], v2 offset:26880
  ds_read_b64_tr_b16 v[124:125], v2 offset:27648
  ds_read_b64_tr_b16 v[126:127], v2 offset:27904
  ds_read_b64_tr_b16 v[128:129], v2 offset:28672
  ds_read_b64_tr_b16 v[130:131], v2 offset:28928
  ds_read_b64_tr_b16 v[132:133], v2 offset:29696
  ds_read_b64_tr_b16 v[134:135], v2 offset:29952
  s_waitcnt lgkmcnt(0)
  s_waitcnt vmcnt(39)
  v_mfma_f32_32x32x16_bf16 v[136:151], a[0:3], v[16:19], 0
  v_add_u32 v9, 71680, v8
  global_load_dwordx4 a[0:3], v9, s[4:5]
  s_waitcnt vmcnt(39)
  v_mfma_f32_32x32x16_bf16 v[136:151], a[4:7], v[20:23], v[136:151]
  v_add_u32 v9, 72704, v8
  global_load_dwordx4 a[4:7], v9, s[4:5]
  s_waitcnt vmcnt(39)
  v_mfma_f32_32x32x16_bf16 v[136:151], a[8:11], v[24:27], v[136:151]
  v_add_u32 v9, 73728, v8
  global_load_dwordx4 a[8:11], v9, s[4:5]
  s_waitcnt vmcnt(39)
  v_mfma_f32_32x32x16_bf16 v[136:151], a[12:15], v[28:31], v[136:151]
  v_add_u32 v9, 74752, v8
  global_load_dwordx4 a[12:15], v9, s[4:5]
  s_waitcnt vmcnt(39)
  v_mfma_f32_32x32x16_bf16 v[136:151], a[16:19], v[32:35], v[136:151]
  v_add_u32 v9, 75776, v8
  global_load_dwordx4 a[16:19], v9, s[4:5]
  s_waitcnt vmcnt(39)
  v_mfma_f32_32x32x16_bf16 v[136:151], a[20:23], v[36:39], v[136:151]
  v_add_u32 v9, 184320, v8
  global_load_dwordx4 a[20:23], v9, s[4:5]
  s_waitcnt vmcnt(39)
  v_mfma_f32_32x32x16_bf16 v[136:151], a[24:27], v[40:43], v[136:151]
  v_add_u32 v9, 185344, v8
  global_load_dwordx4 a[24:27], v9, s[4:5]
  s_waitcnt vmcnt(39)
  v_mfma_f32_32x32x16_bf16 v[136:151], a[28:31], v[44:47], v[136:151]
  v_add_u32 v9, 186368, v8
  global_load_dwordx4 a[28:31], v9, s[4:5]
  s_waitcnt vmcnt(39)
  v_mfma_f32_32x32x16_bf16 v[136:151], a[32:35], v[48:51], v[136:151]
  v_add_u32 v9, 187392, v8
  global_load_dwordx4 a[32:35], v9, s[4:5]
  s_waitcnt vmcnt(39)
  v_mfma_f32_32x32x16_bf16 v[136:151], a[36:39], v[52:55], v[136:151]
  v_add_u32 v9, 188416, v8
  global_load_dwordx4 a[36:39], v9, s[4:5]
  s_waitcnt vmcnt(39)
  v_mfma_f32_32x32x16_bf16 v[136:151], a[40:43], v[56:59], v[136:151]
  v_add_u32 v9, 189440, v8
  global_load_dwordx4 a[40:43], v9, s[4:5]
  s_waitcnt vmcnt(39)
  v_mfma_f32_32x32x16_bf16 v[136:151], a[44:47], v[60:63], v[136:151]
  v_add_u32 v9, 190464, v8
  global_load_dwordx4 a[44:47], v9, s[4:5]
  s_waitcnt vmcnt(39)
  v_mfma_f32_32x32x16_bf16 v[136:151], a[48:51], v[64:67], v[136:151]
  v_add_u32 v9, 191488, v8
  global_load_dwordx4 a[48:51], v9, s[4:5]
  s_waitcnt vmcnt(39)
  v_mfma_f32_32x32x16_bf16 v[136:151], a[52:55], v[68:71], v[136:151]
  v_add_u32 v9, 192512, v8
  global_load_dwordx4 a[52:55], v9, s[4:5]
  s_waitcnt vmcnt(39)
  v_mfma_f32_32x32x16_bf16 v[136:151], a[56:59], v[72:75], v[136:151]
  v_add_u32 v9, 193536, v8
  global_load_dwordx4 a[56:59], v9, s[4:5]
  s_waitcnt vmcnt(39)
  v_mfma_f32_32x32x16_bf16 v[152:167], a[60:63], v[76:79], 0
  v_add_u32 v9, 194560, v8
  global_load_dwordx4 a[60:63], v9, s[4:5]
  s_waitcnt vmcnt(39)
  v_mfma_f32_32x32x16_bf16 v[152:167], a[64:67], v[80:83], v[152:167]
  v_add_u32 v9, 195584, v8
  global_load_dwordx4 a[64:67], v9, s[4:5]
  s_waitcnt vmcnt(39)
  v_mfma_f32_32x32x16_bf16 v[152:167], a[68:71], v[84:87], v[152:167]
  v_add_u32 v9, 196608, v8
  global_load_dwordx4 a[68:71], v9, s[4:5]
  s_waitcnt vmcnt(39)
  v_mfma_f32_32x32x16_bf16 v[152:167], a[72:75], v[88:91], v[152:167]
  v_add_u32 v9, 197632, v8
  global_load_dwordx4 a[72:75], v9, s[4:5]
  s_waitcnt vmcnt(39)
  v_mfma_f32_32x32x16_bf16 v[152:167], a[76:79], v[92:95], v[152:167]
  v_add_u32 v9, 198656, v8
  global_load_dwordx4 a[76:79], v9, s[4:5]
  s_waitcnt vmcnt(39)
  v_mfma_f32_32x32x16_bf16 v[152:167], a[80:83], v[96:99], v[152:167]
  s_waitcnt vmcnt(38)
  v_mfma_f32_32x32x16_bf16 v[152:167], a[84:87], v[100:103], v[152:167]
  s_waitcnt vmcnt(37)
  v_mfma_f32_32x32x16_bf16 v[152:167], a[88:91], v[104:107], v[152:167]
  s_waitcnt vmcnt(36)
  v_mfma_f32_32x32x16_bf16 v[152:167], a[92:95], v[108:111], v[152:167]
  s_waitcnt vmcnt(35)
  v_mfma_f32_32x32x16_bf16 v[152:167], a[96:99], v[112:115], v[152:167]
  s_waitcnt vmcnt(34)
  v_mfma_f32_32x32x16_bf16 v[152:167], a[100:103], v[116:119], v[152:167]
  s_waitcnt vmcnt(33)
  v_mfma_f32_32x32x16_bf16 v[152:167], a[104:107], v[120:123], v[152:167]
  s_waitcnt vmcnt(32)
  v_mfma_f32_32x32x16_bf16 v[152:167], a[108:111], v[124:127], v[152:167]
  s_waitcnt vmcnt(31)
  v_mfma_f32_32x32x16_bf16 v[152:167], a[112:115], v[128:131], v[152:167]
  s_waitcnt vmcnt(30)
  v_mfma_f32_32x32x16_bf16 v[152:167], a[116:119], v[132:135], v[152:167]
  s_waitcnt vmcnt(29)
  v_mfma_f32_32x32x16_bf16 v[168:183], a[120:123], v[16:19], 0
  s_waitcnt vmcnt(28)
  v_mfma_f32_32x32x16_bf16 v[168:183], a[124:127], v[20:23], v[168:183]
  s_waitcnt vmcnt(27)
  v_mfma_f32_32x32x16_bf16 v[168:183], a[128:131], v[24:27], v[168:183]
  s_waitcnt vmcnt(26)
  v_mfma_f32_32x32x16_bf16 v[168:183], a[132:135], v[28:31], v[168:183]
  s_waitcnt vmcnt(25)
  v_mfma_f32_32x32x16_bf16 v[168:183], a[136:139], v[32:35], v[168:183]
  s_waitcnt vmcnt(24)
  v_mfma_f32_32x32x16_bf16 v[168:183], a[140:143], v[36:39], v[168:183]
  s_waitcnt vmcnt(23)
  v_mfma_f32_32x32x16_bf16 v[168:183], a[144:147], v[40:43], v[168:183]
  s_waitcnt vmcnt(22)
  v_mfma_f32_32x32x16_bf16 v[168:183], a[148:151], v[44:47], v[168:183]
  s_waitcnt vmcnt(21)
  v_mfma_f32_32x32x16_bf16 v[168:183], a[152:155], v[48:51], v[168:183]
  s_waitcnt vmcnt(20)
  v_mfma_f32_32x32x16_bf16 v[168:183], a[156:159], v[52:55], v[168:183]
  s_waitcnt vmcnt(19)
  v_mfma_f32_32x32x16_bf16 v[168:183], a[0:3], v[56:59], v[168:183]
  s_waitcnt vmcnt(18)
  v_mfma_f32_32x32x16_bf16 v[168:183], a[4:7], v[60:63], v[168:183]
  s_waitcnt vmcnt(17)
  v_mfma_f32_32x32x16_bf16 v[168:183], a[8:11], v[64:67], v[168:183]
  s_waitcnt vmcnt(16)
  v_mfma_f32_32x32x16_bf16 v[168:183], a[12:15], v[68:71], v[168:183]
  s_waitcnt vmcnt(15)
  v_mfma_f32_32x32x16_bf16 v[168:183], a[16:19], v[72:75], v[168:183]
  s_waitcnt vmcnt(14)
  v_mfma_f32_32x32x16_bf16 v[184:199], a[20:23], v[76:79], 0
  s_waitcnt vmcnt(13)
  v_mfma_f32_32x32x16_bf16 v[184:199], a[24:27], v[80:83], v[184:199]
  s_waitcnt vmcnt(12)
  v_mfma_f32_32x32x16_bf16 v[184:199], a[28:31], v[84:87], v[184:199]
  s_waitcnt vmcnt(11)
  v_mfma_f32_32x32x16_bf16 v[184:199], a[32:35], v[88:91], v[184:199]
  s_waitcnt vmcnt(10)
  v_mfma_f32_32x32x16_bf16 v[184:199], a[36:39], v[92:95], v[184:199]
  s_waitcnt vmcnt(9)
  v_mfma_f32_32x32x16_bf16 v[184:199], a[40:43], v[96:99], v[184:199]
  s_waitcnt vmcnt(8)
  v_mfma_f32_32x32x16_bf16 v[184:199], a[44:47], v[100:103], v[184:199]
  s_waitcnt vmcnt(7)
  v_mfma_f32_32x32x16_bf16 v[184:199], a[48:51], v[104:107], v[184:199]
  s_waitcnt vmcnt(6)
  v_mfma_f32_32x32x16_bf16 v[184:199], a[52:55], v[108:111], v[184:199]
  s_waitcnt vmcnt(5)
  v_mfma_f32_32x32x16_bf16 v[184:199], a[56:59], v[112:115], v[184:199]
  s_waitcnt vmcnt(4)
  v_mfma_f32_32x32x16_bf16 v[184:199], a[60:63], v[116:119], v[184:199]
  s_waitcnt vmcnt(3)
  v_mfma_f32_32x32x16_bf16 v[184:199], a[64:67], v[120:123], v[184:199]
  s_waitcnt vmcnt(2)
  v_mfma_f32_32x32x16_bf16 v[184:199], a[68:71], v[124:127], v[184:199]
  s_waitcnt vmcnt(1)
  v_mfma_f32_32x32x16_bf16 v[184:199], a[72:75], v[128:131], v[184:199]
  s_waitcnt vmcnt(0)
  v_mfma_f32_32x32x16_bf16 v[184:199], a[76:79], v[132:135], v[184:199]
  v_and_b32 v2, 31, v1
  v_mul_u32_u24 v2, 912, v2
  v_add_u32 v2, 32768, v2
  v_lshrrev_b32 v3, 5, v1
  s_lshl_b32 s87, s23, 6
  v_lshl_add_u32 v4, v3, 3, v2
  v_add_u32 v4, s87, v4
  v_lshlrev_b32 v5, 3, v3
  v_sub_u32 v5, v2, v5
  v_subrev_u32 v5, s87, v5
  v_add_u32 v5, 384, v5
  s_nop 7
  v_pk_add_f32 v[10:11], v[136:137], v[152:153] neg_lo:[0,1] neg_hi:[0,1]
  v_pk_add_f32 v[12:13], v[136:137], v[152:153]
  v_cvt_pk_bf16_f32 v14, v10, v11
  v_cvt_pk_bf16_f32 v6, v12, v13
  v_pk_add_f32 v[10:11], v[138:139], v[154:155] neg_lo:[0,1] neg_hi:[0,1]
  v_pk_add_f32 v[12:13], v[138:139], v[154:155]
  v_cvt_pk_bf16_f32 v15, v10, v11
  v_cvt_pk_bf16_f32 v7, v12, v13
  ds_write_b64 v4, v[14:15] offset:0
  ds_write_b16 v5, v6 offset:512
  ds_write_b16_d16_hi v5, v6 offset:510
  ds_write_b16 v5, v7 offset:508
  ds_write_b16_d16_hi v5, v7 offset:506
  v_pk_add_f32 v[10:11], v[140:141], v[156:157] neg_lo:[0,1] neg_hi:[0,1]
  v_pk_add_f32 v[12:13], v[140:141], v[156:157]
  v_cvt_pk_bf16_f32 v14, v10, v11
  v_cvt_pk_bf16_f32 v6, v12, v13
  v_pk_add_f32 v[10:11], v[142:143], v[158:159] neg_lo:[0,1] neg_hi:[0,1]
  v_pk_add_f32 v[12:13], v[142:143], v[158:159]
  v_cvt_pk_bf16_f32 v15, v10, v11
  v_cvt_pk_bf16_f32 v7, v12, v13
  ds_write_b64 v4, v[14:15] offset:16
  ds_write_b16 v5, v6 offset:496
  ds_write_b16_d16_hi v5, v6 offset:494
  ds_write_b16 v5, v7 offset:492
  ds_write_b16_d16_hi v5, v7 offset:490
  v_pk_add_f32 v[10:11], v[144:145], v[160:161] neg_lo:[0,1] neg_hi:[0,1]
  v_pk_add_f32 v[12:13], v[144:145], v[160:161]
  v_cvt_pk_bf16_f32 v14, v10, v11
  v_cvt_pk_bf16_f32 v6, v12, v13
  v_pk_add_f32 v[10:11], v[146:147], v[162:163] neg_lo:[0,1] neg_hi:[0,1]
  v_pk_add_f32 v[12:13], v[146:147], v[162:163]
  v_cvt_pk_bf16_f32 v15, v10, v11
  v_cvt_pk_bf16_f32 v7, v12, v13
  ds_write_b64 v4, v[14:15] offset:32
  ds_write_b16 v5, v6 offset:480
  ds_write_b16_d16_hi v5, v6 offset:478
  ds_write_b16 v5, v7 offset:476
  ds_write_b16_d16_hi v5, v7 offset:474
  v_pk_add_f32 v[10:11], v[148:149], v[164:165] neg_lo:[0,1] neg_hi:[0,1]
  v_pk_add_f32 v[12:13], v[148:149], v[164:165]
  v_cvt_pk_bf16_f32 v14, v10, v11
  v_cvt_pk_bf16_f32 v6, v12, v13
  v_pk_add_f32 v[10:11], v[150:151], v[166:167] neg_lo:[0,1] neg_hi:[0,1]
  v_pk_add_f32 v[12:13], v[150:151], v[166:167]
  v_cvt_pk_bf16_f32 v15, v10, v11
  v_cvt_pk_bf16_f32 v7, v12, v13
  ds_write_b64 v4, v[14:15] offset:48
  ds_write_b16 v5, v6 offset:464
  ds_write_b16_d16_hi v5, v6 offset:462
  ds_write_b16 v5, v7 offset:460
  ds_write_b16_d16_hi v5, v7 offset:458
  s_cmp_eq_u32 s23, 3
  s_cbranch_scc1 fc_t7
  v_pk_add_f32 v[10:11], v[168:169], v[184:185] neg_lo:[0,1] neg_hi:[0,1]
  v_pk_add_f32 v[12:13], v[168:169], v[184:185]
  v_cvt_pk_bf16_f32 v14, v10, v11
  v_cvt_pk_bf16_f32 v6, v12, v13
  v_pk_add_f32 v[10:11], v[170:171], v[186:187] neg_lo:[0,1] neg_hi:[0,1]
  v_pk_add_f32 v[12:13], v[170:171], v[186:187]
  v_cvt_pk_bf16_f32 v15, v10, v11
  v_cvt_pk_bf16_f32 v7, v12, v13
  ds_write_b64 v4, v[14:15] offset:256
  ds_write_b16 v5, v6 offset:256
  ds_write_b16_d16_hi v5, v6 offset:254
  ds_write_b16 v5, v7 offset:252
  ds_write_b16_d16_hi v5, v7 offset:250
  v_pk_add_f32 v[10:11], v[172:173], v[188:189] neg_lo:[0,1] neg_hi:[0,1]
  v_pk_add_f32 v[12:13], v[172:173], v[188:189]
  v_cvt_pk_bf16_f32 v14, v10, v11
  v_cvt_pk_bf16_f32 v6, v12, v13
  v_pk_add_f32 v[10:11], v[174:175], v[190:191] neg_lo:[0,1] neg_hi:[0,1]
  v_pk_add_f32 v[12:13], v[174:175], v[190:191]
  v_cvt_pk_bf16_f32 v15, v10, v11
  v_cvt_pk_bf16_f32 v7, v12, v13
  ds_write_b64 v4, v[14:15] offset:272
  ds_write_b16 v5, v6 offset:240
  ds_write_b16_d16_hi v5, v6 offset:238
  ds_write_b16 v5, v7 offset:236
  ds_write_b16_d16_hi v5, v7 offset:234
  v_pk_add_f32 v[10:11], v[176:177], v[192:193] neg_lo:[0,1] neg_hi:[0,1]
  v_pk_add_f32 v[12:13], v[176:177], v[192:193]
  v_cvt_pk_bf16_f32 v14, v10, v11
  v_cvt_pk_bf16_f32 v6, v12, v13
  v_pk_add_f32 v[10:11], v[178:179], v[194:195] neg_lo:[0,1] neg_hi:[0,1]
  v_pk_add_f32 v[12:13], v[178:179], v[194:195]
  v_cvt_pk_bf16_f32 v15, v10, v11
  v_cvt_pk_bf16_f32 v7, v12, v13
  ds_write_b64 v4, v[14:15] offset:288
  ds_write_b16 v5, v6 offset:224
  ds_write_b16_d16_hi v5, v6 offset:222
  ds_write_b16 v5, v7 offset:220
  ds_write_b16_d16_hi v5, v7 offset:218
  v_pk_add_f32 v[10:11], v[180:181], v[196:197] neg_lo:[0,1] neg_hi:[0,1]
  v_pk_add_f32 v[12:13], v[180:181], v[196:197]
  v_cvt_pk_bf16_f32 v14, v10, v11
  v_cvt_pk_bf16_f32 v6, v12, v13
  v_pk_add_f32 v[10:11], v[182:183], v[198:199] neg_lo:[0,1] neg_hi:[0,1]
  v_pk_add_f32 v[12:13], v[182:183], v[198:199]
  v_cvt_pk_bf16_f32 v15, v10, v11
  v_cvt_pk_bf16_f32 v7, v12, v13
  ds_write_b64 v4, v[14:15] offset:304
  ds_write_b16 v5, v6 offset:208
  ds_write_b16_d16_hi v5, v6 offset:206
  ds_write_b16 v5, v7 offset:204
  ds_write_b16_d16_hi v5, v7 offset:202
  s_branch fc_t7d
fc_t7:
  v_sub_f32 v10, v168, v184
  v_cvt_pk_bf16_f32 v14, v10, v10
  s_mov_b32 s90, -1
  s_mov_b32 s91, 0
  s_mov_b64 exec, s[90:91]
  ds_write_b16 v4, v14 offset:256
  s_mov_b64 exec, -1
fc_t7d:
  s_waitcnt lgkmcnt(0)
  s_barrier
  v_lshrrev_b32 v10, 3, v0
  v_and_b32 v11, 7, v0
  v_mul_u32_u24 v2, 912, v10
  v_lshl_add_u32 v2, v11, 4, v2
  v_add_u32 v2, 32768, v2
  ds_read_b128 v[16:19], v2 offset:0
  ds_read_b128 v[20:23], v2 offset:128
  ds_read_b128 v[24:27], v2 offset:256
  ds_read_b128 v[28:31], v2 offset:384
  ds_read_b128 v[32:35], v2 offset:512
  ds_read_b128 v[36:39], v2 offset:640
  ds_read_b128 v[40:43], v2 offset:768
  s_waitcnt vmcnt(0) lgkmcnt(0)
  v_lshlrev_b32 v48, 16, v200
  v_and_b32 v49, 0xffff0000, v200
  v_lshlrev_b32 v104, 16, v16
  v_and_b32 v105, 0xffff0000, v16
  v_pk_add_f32 v[48:49], v[48:49], v[104:105]
  v_cvt_pk_bf16_f32 v200, v48, v49
  v_lshlrev_b32 v48, 16, v200
  v_and_b32 v49, 0xffff0000, v200
  v_lshlrev_b32 v50, 16, v201
  v_and_b32 v51, 0xffff0000, v201
  v_lshlrev_b32 v104, 16, v17
  v_and_b32 v105, 0xffff0000, v17
  v_pk_add_f32 v[50:51], v[50:51], v[104:105]
  v_cvt_pk_bf16_f32 v201, v50, v51
  v_lshlrev_b32 v50, 16, v201
  v_and_b32 v51, 0xffff0000, v201
  v_lshlrev_b32 v52, 16, v202
  v_and_b32 v53, 0xffff0000, v202
  v_lshlrev_b32 v104, 16, v18
  v_and_b32 v105, 0xffff0000, v18
  v_pk_add_f32 v[52:53], v[52:53], v[104:105]
  v_cvt_pk_bf16_f32 v202, v52, v53
  v_lshlrev_b32 v52, 16, v202
  v_and_b32 v53, 0xffff0000, v202
  v_lshlrev_b32 v54, 16, v203
  v_and_b32 v55, 0xffff0000, v203
  v_lshlrev_b32 v104, 16, v19
  v_and_b32 v105, 0xffff0000, v19
  v_pk_add_f32 v[54:55], v[54:55], v[104:105]
  v_cvt_pk_bf16_f32 v203, v54, v55
  v_lshlrev_b32 v54, 16, v203
  v_and_b32 v55, 0xffff0000, v203
  v_lshlrev_b32 v56, 16, v204
  v_and_b32 v57, 0xffff0000, v204
  v_lshlrev_b32 v104, 16, v20
  v_and_b32 v105, 0xffff0000, v20
  v_pk_add_f32 v[56:57], v[56:57], v[104:105]
  v_cvt_pk_bf16_f32 v204, v56, v57
  v_lshlrev_b32 v56, 16, v204
  v_and_b32 v57, 0xffff0000, v204
  v_lshlrev_b32 v58, 16, v205
  v_and_b32 v59, 0xffff0000, v205
  v_lshlrev_b32 v104, 16, v21
  v_and_b32 v105, 0xffff0000, v21
  v_pk_add_f32 v[58:59], v[58:59], v[104:105]
  v_cvt_pk_bf16_f32 v205, v58, v59
  v_lshlrev_b32 v58, 16, v205
  v_and_b32 v59, 0xffff0000, v205
  v_lshlrev_b32 v60, 16, v206
  v_and_b32 v61, 0xffff0000, v206
  v_lshlrev_b32 v104, 16, v22
  v_and_b32 v105, 0xffff0000, v22
  v_pk_add_f32 v[60:61], v[60:61], v[104:105]
  v_cvt_pk_bf16_f32 v206, v60, v61
  v_lshlrev_b32 v60, 16, v206
  v_and_b32 v61, 0xffff0000, v206
  v_lshlrev_b32 v62, 16, v207
  v_and_b32 v63, 0xffff0000, v207
  v_lshlrev_b32 v104, 16, v23
  v_and_b32 v105, 0xffff0000, v23
  v_pk_add_f32 v[62:63], v[62:63], v[104:105]
  v_cvt_pk_bf16_f32 v207, v62, v63
  v_lshlrev_b32 v62, 16, v207
  v_and_b32 v63, 0xffff0000, v207
  v_lshlrev_b32 v64, 16, v208
  v_and_b32 v65, 0xffff0000, v208
  v_lshlrev_b32 v104, 16, v24
  v_and_b32 v105, 0xffff0000, v24
  v_pk_add_f32 v[64:65], v[64:65], v[104:105]
  v_cvt_pk_bf16_f32 v208, v64, v65
  v_lshlrev_b32 v64, 16, v208
  v_and_b32 v65, 0xffff0000, v208
  v_lshlrev_b32 v66, 16, v209
  v_and_b32 v67, 0xffff0000, v209
  v_lshlrev_b32 v104, 16, v25
  v_and_b32 v105, 0xffff0000, v25
  v_pk_add_f32 v[66:67], v[66:67], v[104:105]
  v_cvt_pk_bf16_f32 v209, v66, v67
  v_lshlrev_b32 v66, 16, v209
  v_and_b32 v67, 0xffff0000, v209
  v_lshlrev_b32 v68, 16, v210
  v_and_b32 v69, 0xffff0000, v210
  v_lshlrev_b32 v104, 16, v26
  v_and_b32 v105, 0xffff0000, v26
  v_pk_add_f32 v[68:69], v[68:69], v[104:105]
  v_cvt_pk_bf16_f32 v210, v68, v69
  v_lshlrev_b32 v68, 16, v210
  v_and_b32 v69, 0xffff0000, v210
  v_lshlrev_b32 v70, 16, v211
  v_and_b32 v71, 0xffff0000, v211
  v_lshlrev_b32 v104, 16, v27
  v_and_b32 v105, 0xffff0000, v27
  v_pk_add_f32 v[70:71], v[70:71], v[104:105]
  v_cvt_pk_bf16_f32 v211, v70, v71
  v_lshlrev_b32 v70, 16, v211
  v_and_b32 v71, 0xffff0000, v211
  v_lshlrev_b32 v72, 16, v212
  v_and_b32 v73, 0xffff0000, v212
  v_lshlrev_b32 v104, 16, v28
  v_and_b32 v105, 0xffff0000, v28
  v_pk_add_f32 v[72:73], v[72:73], v[104:105]
  v_cvt_pk_bf16_f32 v212, v72, v73
  v_lshlrev_b32 v72, 16, v212
  v_and_b32 v73, 0xffff0000, v212
  v_lshlrev_b32 v74, 16, v213
  v_and_b32 v75, 0xffff0000, v213
  v_lshlrev_b32 v104, 16, v29
  v_and_b32 v105, 0xffff0000, v29
  v_pk_add_f32 v[74:75], v[74:75], v[104:105]
  v_cvt_pk_bf16_f32 v213, v74, v75
  v_lshlrev_b32 v74, 16, v213
  v_and_b32 v75, 0xffff0000, v213
  v_lshlrev_b32 v76, 16, v214
  v_and_b32 v77, 0xffff0000, v214
  v_lshlrev_b32 v104, 16, v30
  v_and_b32 v105, 0xffff0000, v30
  v_pk_add_f32 v[76:77], v[76:77], v[104:105]
  v_cvt_pk_bf16_f32 v214, v76, v77
  v_lshlrev_b32 v76, 16, v214
  v_and_b32 v77, 0xffff0000, v214
  v_lshlrev_b32 v78, 16, v215
  v_and_b32 v79, 0xffff0000, v215
  v_lshlrev_b32 v104, 16, v31
  v_and_b32 v105, 0xffff0000, v31
  v_pk_add_f32 v[78:79], v[78:79], v[104:105]
  v_cvt_pk_bf16_f32 v215, v78, v79
  v_lshlrev_b32 v78, 16, v215
  v_and_b32 v79, 0xffff0000, v215
  v_lshlrev_b32 v80, 16, v216
  v_and_b32 v81, 0xffff0000, v216
  v_lshlrev_b32 v104, 16, v32
  v_and_b32 v105, 0xffff0000, v32
  v_pk_add_f32 v[80:81], v[80:81], v[104:105]
  v_cvt_pk_bf16_f32 v216, v80, v81
  v_lshlrev_b32 v80, 16, v216
  v_and_b32 v81, 0xffff0000, v216
  v_lshlrev_b32 v82, 16, v217
  v_and_b32 v83, 0xffff0000, v217
  v_lshlrev_b32 v104, 16, v33
  v_and_b32 v105, 0xffff0000, v33
  v_pk_add_f32 v[82:83], v[82:83], v[104:105]
  v_cvt_pk_bf16_f32 v217, v82, v83
  v_lshlrev_b32 v82, 16, v217
  v_and_b32 v83, 0xffff0000, v217
  v_lshlrev_b32 v84, 16, v218
  v_and_b32 v85, 0xffff0000, v218
  v_lshlrev_b32 v104, 16, v34
  v_and_b32 v105, 0xffff0000, v34
  v_pk_add_f32 v[84:85], v[84:85], v[104:105]
  v_cvt_pk_bf16_f32 v218, v84, v85
  v_lshlrev_b32 v84, 16, v218
  v_and_b32 v85, 0xffff0000, v218
  v_lshlrev_b32 v86, 16, v219
  v_and_b32 v87, 0xffff0000, v219
  v_lshlrev_b32 v104, 16, v35
  v_and_b32 v105, 0xffff0000, v35
  v_pk_add_f32 v[86:87], v[86:87], v[104:105]
  v_cvt_pk_bf16_f32 v219, v86, v87
  v_lshlrev_b32 v86, 16, v219
  v_and_b32 v87, 0xffff0000, v219
  v_lshlrev_b32 v88, 16, v220
  v_and_b32 v89, 0xffff0000, v220
  v_lshlrev_b32 v104, 16, v36
  v_and_b32 v105, 0xffff0000, v36
  v_pk_add_f32 v[88:89], v[88:89], v[104:105]
  v_cvt_pk_bf16_f32 v220, v88, v89
  v_lshlrev_b32 v88, 16, v220
  v_and_b32 v89, 0xffff0000, v220
  v_lshlrev_b32 v90, 16, v221
  v_and_b32 v91, 0xffff0000, v221
  v_lshlrev_b32 v104, 16, v37
  v_and_b32 v105, 0xffff0000, v37
  v_pk_add_f32 v[90:91], v[90:91], v[104:105]
  v_cvt_pk_bf16_f32 v221, v90, v91
  v_lshlrev_b32 v90, 16, v221
  v_and_b32 v91, 0xffff0000, v221
  v_lshlrev_b32 v92, 16, v222
  v_and_b32 v93, 0xffff0000, v222
  v_lshlrev_b32 v104, 16, v38
  v_and_b32 v105, 0xffff0000, v38
  v_pk_add_f32 v[92:93], v[92:93], v[104:105]
  v_cvt_pk_bf16_f32 v222, v92, v93
  v_lshlrev_b32 v92, 16, v222
  v_and_b32 v93, 0xffff0000, v222
  v_lshlrev_b32 v94, 16, v223
  v_and_b32 v95, 0xffff0000, v223
  v_lshlrev_b32 v104, 16, v39
  v_and_b32 v105, 0xffff0000, v39
  v_pk_add_f32 v[94:95], v[94:95], v[104:105]
  v_cvt_pk_bf16_f32 v223, v94, v95
  v_lshlrev_b32 v94, 16, v223
  v_and_b32 v95, 0xffff0000, v223
  v_lshlrev_b32 v96, 16, v224
  v_and_b32 v97, 0xffff0000, v224
  v_lshlrev_b32 v104, 16, v40
  v_and_b32 v105, 0xffff0000, v40
  v_pk_add_f32 v[96:97], v[96:97], v[104:105]
  v_cvt_pk_bf16_f32 v224, v96, v97
  v_lshlrev_b32 v96, 16, v224
  v_and_b32 v97, 0xffff0000, v224
  v_lshlrev_b32 v98, 16, v225
  v_and_b32 v99, 0xffff0000, v225
  v_lshlrev_b32 v104, 16, v41
  v_and_b32 v105, 0xffff0000, v41
  v_pk_add_f32 v[98:99], v[98:99], v[104:105]
  v_cvt_pk_bf16_f32 v225, v98, v99
  v_lshlrev_b32 v98, 16, v225
  v_and_b32 v99, 0xffff0000, v225
  v_lshlrev_b32 v100, 16, v226
  v_and_b32 v101, 0xffff0000, v226
  v_lshlrev_b32 v104, 16, v42
  v_and_b32 v105, 0xffff0000, v42
  v_pk_add_f32 v[100:101], v[100:101], v[104:105]
  v_cvt_pk_bf16_f32 v226, v100, v101
  v_lshlrev_b32 v100, 16, v226
  v_and_b32 v101, 0xffff0000, v226
  v_lshlrev_b32 v102, 16, v227
  v_and_b32 v103, 0xffff0000, v227
  v_lshlrev_b32 v104, 16, v43
  v_and_b32 v105, 0xffff0000, v43
  v_pk_add_f32 v[102:103], v[102:103], v[104:105]
  v_cvt_pk_bf16_f32 v227, v102, v103
  v_lshlrev_b32 v102, 16, v227
  v_and_b32 v103, 0xffff0000, v227
  v_add_u32 v13, s85, v240
  global_store_dwordx4 v13, v[200:203], s[4:5] offset:0 sc1
  global_store_dwordx4 v13, v[204:207], s[4:5] offset:128 sc1
  global_store_dwordx4 v13, v[208:211], s[4:5] offset:256 sc1
  global_store_dwordx4 v13, v[212:215], s[4:5] offset:384 sc1
  global_store_dwordx4 v13, v[216:219], s[4:5] offset:512 sc1
  global_store_dwordx4 v13, v[220:223], s[4:5] offset:640 sc1
  global_store_dwordx4 v13, v[224:227], s[4:5] offset:768 sc1
  v_pk_add_f32 v[106:107], v[48:49], v[50:51]
  v_pk_add_f32 v[108:109], v[52:53], v[54:55]
  v_pk_add_f32 v[106:107], v[106:107], v[56:57]
  v_pk_add_f32 v[108:109], v[108:109], v[58:59]
  v_pk_add_f32 v[106:107], v[106:107], v[60:61]
  v_pk_add_f32 v[108:109], v[108:109], v[62:63]
  v_pk_add_f32 v[106:107], v[106:107], v[64:65]
  v_pk_add_f32 v[108:109], v[108:109], v[66:67]
  v_pk_add_f32 v[106:107], v[106:107], v[68:69]
  v_pk_add_f32 v[108:109], v[108:109], v[70:71]
  v_pk_add_f32 v[106:107], v[106:107], v[72:73]
  v_pk_add_f32 v[108:109], v[108:109], v[74:75]
  v_pk_add_f32 v[106:107], v[106:107], v[76:77]
  v_pk_add_f32 v[108:109], v[108:109], v[78:79]
  v_pk_add_f32 v[106:107], v[106:107], v[80:81]
  v_pk_add_f32 v[108:109], v[108:109], v[82:83]
  v_pk_add_f32 v[106:107], v[106:107], v[84:85]
  v_pk_add_f32 v[108:109], v[108:109], v[86:87]
  v_pk_add_f32 v[106:107], v[106:107], v[88:89]
  v_pk_add_f32 v[108:109], v[108:109], v[90:91]
  v_pk_add_f32 v[106:107], v[106:107], v[92:93]
  v_pk_add_f32 v[108:109], v[108:109], v[94:95]
  v_pk_add_f32 v[106:107], v[106:107], v[96:97]
  v_pk_add_f32 v[108:109], v[108:109], v[98:99]
  v_pk_add_f32 v[106:107], v[106:107], v[100:101]
  v_pk_add_f32 v[108:109], v[108:109], v[102:103]
  v_pk_add_f32 v[106:107], v[106:107], v[108:109]
  v_add_f32 v110, v106, v107
  s_nop 1
  v_add_f32_dpp v110, v110, v110 quad_perm:[1,0,3,2] row_mask:0xf bank_mask:0xf
  s_nop 1
  v_add_f32_dpp v110, v110, v110 quad_perm:[2,3,0,1] row_mask:0xf bank_mask:0xf
  s_nop 1
  v_add_f32_dpp v110, v110, v110 row_half_mirror row_mask:0xf bank_mask:0xf
  v_mul_f32 v110, 0x3b124925, v110
  v_mov_b64 v[106:107], 0
  v_mov_b64 v[108:109], 0
  v_pk_add_f32 v[114:115], v[48:49], v[110:111] op_sel_hi:[1,0] neg_lo:[0,1] neg_hi:[0,1]
  v_pk_fma_f32 v[106:107], v[114:115], v[114:115], v[106:107]
  v_pk_add_f32 v[116:117], v[50:51], v[110:111] op_sel_hi:[1,0] neg_lo:[0,1] neg_hi:[0,1]
  v_pk_fma_f32 v[108:109], v[116:117], v[116:117], v[108:109]
  v_pk_add_f32 v[114:115], v[52:53], v[110:111] op_sel_hi:[1,0] neg_lo:[0,1] neg_hi:[0,1]
  v_pk_fma_f32 v[106:107], v[114:115], v[114:115], v[106:107]
  v_pk_add_f32 v[116:117], v[54:55], v[110:111] op_sel_hi:[1,0] neg_lo:[0,1] neg_hi:[0,1]
  v_pk_fma_f32 v[108:109], v[116:117], v[116:117], v[108:109]
  v_pk_add_f32 v[114:115], v[56:57], v[110:111] op_sel_hi:[1,0] neg_lo:[0,1] neg_hi:[0,1]
  v_pk_fma_f32 v[106:107], v[114:115], v[114:115], v[106:107]
  v_pk_add_f32 v[116:117], v[58:59], v[110:111] op_sel_hi:[1,0] neg_lo:[0,1] neg_hi:[0,1]
  v_pk_fma_f32 v[108:109], v[116:117], v[116:117], v[108:109]
  v_pk_add_f32 v[114:115], v[60:61], v[110:111] op_sel_hi:[1,0] neg_lo:[0,1] neg_hi:[0,1]
  v_pk_fma_f32 v[106:107], v[114:115], v[114:115], v[106:107]
  v_pk_add_f32 v[116:117], v[62:63], v[110:111] op_sel_hi:[1,0] neg_lo:[0,1] neg_hi:[0,1]
  v_pk_fma_f32 v[108:109], v[116:117], v[116:117], v[108:109]
  v_pk_add_f32 v[114:115], v[64:65], v[110:111] op_sel_hi:[1,0] neg_lo:[0,1] neg_hi:[0,1]
  v_pk_fma_f32 v[106:107], v[114:115], v[114:115], v[106:107]
  v_pk_add_f32 v[116:117], v[66:67], v[110:111] op_sel_hi:[1,0] neg_lo:[0,1] neg_hi:[0,1]
  v_pk_fma_f32 v[108:109], v[116:117], v[116:117], v[108:109]
  v_pk_add_f32 v[114:115], v[68:69], v[110:111] op_sel_hi:[1,0] neg_lo:[0,1] neg_hi:[0,1]
  v_pk_fma_f32 v[106:107], v[114:115], v[114:115], v[106:107]
  v_pk_add_f32 v[116:117], v[70:71], v[110:111] op_sel_hi:[1,0] neg_lo:[0,1] neg_hi:[0,1]
  v_pk_fma_f32 v[108:109], v[116:117], v[116:117], v[108:109]
  v_pk_add_f32 v[114:115], v[72:73], v[110:111] op_sel_hi:[1,0] neg_lo:[0,1] neg_hi:[0,1]
  v_pk_fma_f32 v[106:107], v[114:115], v[114:115], v[106:107]
  v_pk_add_f32 v[116:117], v[74:75], v[110:111] op_sel_hi:[1,0] neg_lo:[0,1] neg_hi:[0,1]
  v_pk_fma_f32 v[108:109], v[116:117], v[116:117], v[108:109]
  v_pk_add_f32 v[114:115], v[76:77], v[110:111] op_sel_hi:[1,0] neg_lo:[0,1] neg_hi:[0,1]
  v_pk_fma_f32 v[106:107], v[114:115], v[114:115], v[106:107]
  v_pk_add_f32 v[116:117], v[78:79], v[110:111] op_sel_hi:[1,0] neg_lo:[0,1] neg_hi:[0,1]
  v_pk_fma_f32 v[108:109], v[116:117], v[116:117], v[108:109]
  v_pk_add_f32 v[114:115], v[80:81], v[110:111] op_sel_hi:[1,0] neg_lo:[0,1] neg_hi:[0,1]
  v_pk_fma_f32 v[106:107], v[114:115], v[114:115], v[106:107]
  v_pk_add_f32 v[116:117], v[82:83], v[110:111] op_sel_hi:[1,0] neg_lo:[0,1] neg_hi:[0,1]
  v_pk_fma_f32 v[108:109], v[116:117], v[116:117], v[108:109]
  v_pk_add_f32 v[114:115], v[84:85], v[110:111] op_sel_hi:[1,0] neg_lo:[0,1] neg_hi:[0,1]
  v_pk_fma_f32 v[106:107], v[114:115], v[114:115], v[106:107]
  v_pk_add_f32 v[116:117], v[86:87], v[110:111] op_sel_hi:[1,0] neg_lo:[0,1] neg_hi:[0,1]
  v_pk_fma_f32 v[108:109], v[116:117], v[116:117], v[108:109]
  v_pk_add_f32 v[114:115], v[88:89], v[110:111] op_sel_hi:[1,0] neg_lo:[0,1] neg_hi:[0,1]
  v_pk_fma_f32 v[106:107], v[114:115], v[114:115], v[106:107]
  v_pk_add_f32 v[116:117], v[90:91], v[110:111] op_sel_hi:[1,0] neg_lo:[0,1] neg_hi:[0,1]
  v_pk_fma_f32 v[108:109], v[116:117], v[116:117], v[108:109]
  v_pk_add_f32 v[114:115], v[92:93], v[110:111] op_sel_hi:[1,0] neg_lo:[0,1] neg_hi:[0,1]
  v_pk_fma_f32 v[106:107], v[114:115], v[114:115], v[106:107]
  v_pk_add_f32 v[116:117], v[94:95], v[110:111] op_sel_hi:[1,0] neg_lo:[0,1] neg_hi:[0,1]
  v_pk_fma_f32 v[108:109], v[116:117], v[116:117], v[108:109]
  v_pk_add_f32 v[114:115], v[96:97], v[110:111] op_sel_hi:[1,0] neg_lo:[0,1] neg_hi:[0,1]
  v_pk_fma_f32 v[106:107], v[114:115], v[114:115], v[106:107]
  v_pk_add_f32 v[116:117], v[98:99], v[110:111] op_sel_hi:[1,0] neg_lo:[0,1] neg_hi:[0,1]
  v_pk_fma_f32 v[108:109], v[116:117], v[116:117], v[108:109]
  v_pk_add_f32 v[114:115], v[100:101], v[110:111] op_sel_hi:[1,0] neg_lo:[0,1] neg_hi:[0,1]
  v_pk_fma_f32 v[106:107], v[114:115], v[114:115], v[106:107]
  v_pk_add_f32 v[116:117], v[102:103], v[110:111] op_sel_hi:[1,0] neg_lo:[0,1] neg_hi:[0,1]
  v_pk_fma_f32 v[108:109], v[116:117], v[116:117], v[108:109]
  v_pk_add_f32 v[106:107], v[106:107], v[108:109]
  v_add_f32 v106, v106, v107
  s_nop 1
  v_add_f32_dpp v106, v106, v106 quad_perm:[1,0,3,2] row_mask:0xf bank_mask:0xf
  s_nop 1
  v_add_f32_dpp v106, v106, v106 quad_perm:[2,3,0,1] row_mask:0xf bank_mask:0xf
  s_nop 1
  v_add_f32_dpp v106, v106, v106 row_half_mirror row_mask:0xf bank_mask:0xf
  v_mul_f32 v106, 0x3b124925, v106
  v_cvt_pk_bf16_f32 v108, v110, v110
  v_lshlrev_b32 v108, 16, v108
  v_cvt_pk_bf16_f32 v109, v106, v106
  v_lshlrev_b32 v109, 16, v109
  v_add_f32 v109, 0x3727c5ac, v109
  v_cvt_pk_bf16_f32 v109, v109, v109
  v_lshlrev_b32 v109, 16, v109
  v_sqrt_f32 v109, v109
  s_nop 0
  v_cvt_pk_bf16_f32 v109, v109, v109
  v_lshlrev_b32 v109, 16, v109
  v_rcp_f32 v112, v109
  s_nop 0
  v_fma_f32 v109, -v109, v112, 2.0
  v_mul_f32 v112, v112, v109
  v_pk_add_f32 v[114:115], v[48:49], v[108:109] op_sel_hi:[1,0] neg_lo:[0,1] neg_hi:[0,1]
  v_cvt_pk_bf16_f32 v106, v114, v115
  v_lshlrev_b32 v114, 16, v106
  v_and_b32 v115, 0xffff0000, v106
  v_pk_mul_f32 v[114:115], v[114:115], v[112:113] op_sel_hi:[1,0]
  v_cvt_pk_bf16_f32 v16, v114, v115
  v_pk_add_f32 v[116:117], v[50:51], v[108:109] op_sel_hi:[1,0] neg_lo:[0,1] neg_hi:[0,1]
  v_cvt_pk_bf16_f32 v106, v116, v117
  v_lshlrev_b32 v116, 16, v106
  v_and_b32 v117, 0xffff0000, v106
  v_pk_mul_f32 v[116:117], v[116:117], v[112:113] op_sel_hi:[1,0]
  v_cvt_pk_bf16_f32 v17, v116, v117
  v_pk_add_f32 v[114:115], v[52:53], v[108:109] op_sel_hi:[1,0] neg_lo:[0,1] neg_hi:[0,1]
  v_cvt_pk_bf16_f32 v106, v114, v115
  v_lshlrev_b32 v114, 16, v106
  v_and_b32 v115, 0xffff0000, v106
  v_pk_mul_f32 v[114:115], v[114:115], v[112:113] op_sel_hi:[1,0]
  v_cvt_pk_bf16_f32 v18, v114, v115
  v_pk_add_f32 v[116:117], v[54:55], v[108:109] op_sel_hi:[1,0] neg_lo:[0,1] neg_hi:[0,1]
  v_cvt_pk_bf16_f32 v106, v116, v117
  v_lshlrev_b32 v116, 16, v106
  v_and_b32 v117, 0xffff0000, v106
  v_pk_mul_f32 v[116:117], v[116:117], v[112:113] op_sel_hi:[1,0]
  v_cvt_pk_bf16_f32 v19, v116, v117
  v_pk_add_f32 v[114:115], v[56:57], v[108:109] op_sel_hi:[1,0] neg_lo:[0,1] neg_hi:[0,1]
  v_cvt_pk_bf16_f32 v106, v114, v115
  v_lshlrev_b32 v114, 16, v106
  v_and_b32 v115, 0xffff0000, v106
  v_pk_mul_f32 v[114:115], v[114:115], v[112:113] op_sel_hi:[1,0]
  v_cvt_pk_bf16_f32 v20, v114, v115
  v_pk_add_f32 v[116:117], v[58:59], v[108:109] op_sel_hi:[1,0] neg_lo:[0,1] neg_hi:[0,1]
  v_cvt_pk_bf16_f32 v106, v116, v117
  v_lshlrev_b32 v116, 16, v106
  v_and_b32 v117, 0xffff0000, v106
  v_pk_mul_f32 v[116:117], v[116:117], v[112:113] op_sel_hi:[1,0]
  v_cvt_pk_bf16_f32 v21, v116, v117
  v_pk_add_f32 v[114:115], v[60:61], v[108:109] op_sel_hi:[1,0] neg_lo:[0,1] neg_hi:[0,1]
  v_cvt_pk_bf16_f32 v106, v114, v115
  v_lshlrev_b32 v114, 16, v106
  v_and_b32 v115, 0xffff0000, v106
  v_pk_mul_f32 v[114:115], v[114:115], v[112:113] op_sel_hi:[1,0]
  v_cvt_pk_bf16_f32 v22, v114, v115
  v_pk_add_f32 v[116:117], v[62:63], v[108:109] op_sel_hi:[1,0] neg_lo:[0,1] neg_hi:[0,1]
  v_cvt_pk_bf16_f32 v106, v116, v117
  v_lshlrev_b32 v116, 16, v106
  v_and_b32 v117, 0xffff0000, v106
  v_pk_mul_f32 v[116:117], v[116:117], v[112:113] op_sel_hi:[1,0]
  v_cvt_pk_bf16_f32 v23, v116, v117
  v_pk_add_f32 v[114:115], v[64:65], v[108:109] op_sel_hi:[1,0] neg_lo:[0,1] neg_hi:[0,1]
  v_cvt_pk_bf16_f32 v106, v114, v115
  v_lshlrev_b32 v114, 16, v106
  v_and_b32 v115, 0xffff0000, v106
  v_pk_mul_f32 v[114:115], v[114:115], v[112:113] op_sel_hi:[1,0]
  v_cvt_pk_bf16_f32 v24, v114, v115
  v_pk_add_f32 v[116:117], v[66:67], v[108:109] op_sel_hi:[1,0] neg_lo:[0,1] neg_hi:[0,1]
  v_cvt_pk_bf16_f32 v106, v116, v117
  v_lshlrev_b32 v116, 16, v106
  v_and_b32 v117, 0xffff0000, v106
  v_pk_mul_f32 v[116:117], v[116:117], v[112:113] op_sel_hi:[1,0]
  v_cvt_pk_bf16_f32 v25, v116, v117
  v_pk_add_f32 v[114:115], v[68:69], v[108:109] op_sel_hi:[1,0] neg_lo:[0,1] neg_hi:[0,1]
  v_cvt_pk_bf16_f32 v106, v114, v115
  v_lshlrev_b32 v114, 16, v106
  v_and_b32 v115, 0xffff0000, v106
  v_pk_mul_f32 v[114:115], v[114:115], v[112:113] op_sel_hi:[1,0]
  v_cvt_pk_bf16_f32 v26, v114, v115
  v_pk_add_f32 v[116:117], v[70:71], v[108:109] op_sel_hi:[1,0] neg_lo:[0,1] neg_hi:[0,1]
  v_cvt_pk_bf16_f32 v106, v116, v117
  v_lshlrev_b32 v116, 16, v106
  v_and_b32 v117, 0xffff0000, v106
  v_pk_mul_f32 v[116:117], v[116:117], v[112:113] op_sel_hi:[1,0]
  v_cvt_pk_bf16_f32 v27, v116, v117
  v_pk_add_f32 v[114:115], v[72:73], v[108:109] op_sel_hi:[1,0] neg_lo:[0,1] neg_hi:[0,1]
  v_cvt_pk_bf16_f32 v106, v114, v115
  v_lshlrev_b32 v114, 16, v106
  v_and_b32 v115, 0xffff0000, v106
  v_pk_mul_f32 v[114:115], v[114:115], v[112:113] op_sel_hi:[1,0]
  v_cvt_pk_bf16_f32 v28, v114, v115
  v_pk_add_f32 v[116:117], v[74:75], v[108:109] op_sel_hi:[1,0] neg_lo:[0,1] neg_hi:[0,1]
  v_cvt_pk_bf16_f32 v106, v116, v117
  v_lshlrev_b32 v116, 16, v106
  v_and_b32 v117, 0xffff0000, v106
  v_pk_mul_f32 v[116:117], v[116:117], v[112:113] op_sel_hi:[1,0]
  v_cvt_pk_bf16_f32 v29, v116, v117
  v_pk_add_f32 v[114:115], v[76:77], v[108:109] op_sel_hi:[1,0] neg_lo:[0,1] neg_hi:[0,1]
  v_cvt_pk_bf16_f32 v106, v114, v115
  v_lshlrev_b32 v114, 16, v106
  v_and_b32 v115, 0xffff0000, v106
  v_pk_mul_f32 v[114:115], v[114:115], v[112:113] op_sel_hi:[1,0]
  v_cvt_pk_bf16_f32 v30, v114, v115
  v_pk_add_f32 v[116:117], v[78:79], v[108:109] op_sel_hi:[1,0] neg_lo:[0,1] neg_hi:[0,1]
  v_cvt_pk_bf16_f32 v106, v116, v117
  v_lshlrev_b32 v116, 16, v106
  v_and_b32 v117, 0xffff0000, v106
  v_pk_mul_f32 v[116:117], v[116:117], v[112:113] op_sel_hi:[1,0]
  v_cvt_pk_bf16_f32 v31, v116, v117
  v_pk_add_f32 v[114:115], v[80:81], v[108:109] op_sel_hi:[1,0] neg_lo:[0,1] neg_hi:[0,1]
  v_cvt_pk_bf16_f32 v106, v114, v115
  v_lshlrev_b32 v114, 16, v106
  v_and_b32 v115, 0xffff0000, v106
  v_pk_mul_f32 v[114:115], v[114:115], v[112:113] op_sel_hi:[1,0]
  v_cvt_pk_bf16_f32 v32, v114, v115
  v_pk_add_f32 v[116:117], v[82:83], v[108:109] op_sel_hi:[1,0] neg_lo:[0,1] neg_hi:[0,1]
  v_cvt_pk_bf16_f32 v106, v116, v117
  v_lshlrev_b32 v116, 16, v106
  v_and_b32 v117, 0xffff0000, v106
  v_pk_mul_f32 v[116:117], v[116:117], v[112:113] op_sel_hi:[1,0]
  v_cvt_pk_bf16_f32 v33, v116, v117
  v_pk_add_f32 v[114:115], v[84:85], v[108:109] op_sel_hi:[1,0] neg_lo:[0,1] neg_hi:[0,1]
  v_cvt_pk_bf16_f32 v106, v114, v115
  v_lshlrev_b32 v114, 16, v106
  v_and_b32 v115, 0xffff0000, v106
  v_pk_mul_f32 v[114:115], v[114:115], v[112:113] op_sel_hi:[1,0]
  v_cvt_pk_bf16_f32 v34, v114, v115
  v_pk_add_f32 v[116:117], v[86:87], v[108:109] op_sel_hi:[1,0] neg_lo:[0,1] neg_hi:[0,1]
  v_cvt_pk_bf16_f32 v106, v116, v117
  v_lshlrev_b32 v116, 16, v106
  v_and_b32 v117, 0xffff0000, v106
  v_pk_mul_f32 v[116:117], v[116:117], v[112:113] op_sel_hi:[1,0]
  v_cvt_pk_bf16_f32 v35, v116, v117
  v_pk_add_f32 v[114:115], v[88:89], v[108:109] op_sel_hi:[1,0] neg_lo:[0,1] neg_hi:[0,1]
  v_cvt_pk_bf16_f32 v106, v114, v115
  v_lshlrev_b32 v114, 16, v106
  v_and_b32 v115, 0xffff0000, v106
  v_pk_mul_f32 v[114:115], v[114:115], v[112:113] op_sel_hi:[1,0]
  v_cvt_pk_bf16_f32 v36, v114, v115
  v_pk_add_f32 v[116:117], v[90:91], v[108:109] op_sel_hi:[1,0] neg_lo:[0,1] neg_hi:[0,1]
  v_cvt_pk_bf16_f32 v106, v116, v117
  v_lshlrev_b32 v116, 16, v106
  v_and_b32 v117, 0xffff0000, v106
  v_pk_mul_f32 v[116:117], v[116:117], v[112:113] op_sel_hi:[1,0]
  v_cvt_pk_bf16_f32 v37, v116, v117
  v_pk_add_f32 v[114:115], v[92:93], v[108:109] op_sel_hi:[1,0] neg_lo:[0,1] neg_hi:[0,1]
  v_cvt_pk_bf16_f32 v106, v114, v115
  v_lshlrev_b32 v114, 16, v106
  v_and_b32 v115, 0xffff0000, v106
  v_pk_mul_f32 v[114:115], v[114:115], v[112:113] op_sel_hi:[1,0]
  v_cvt_pk_bf16_f32 v38, v114, v115
  v_pk_add_f32 v[116:117], v[94:95], v[108:109] op_sel_hi:[1,0] neg_lo:[0,1] neg_hi:[0,1]
  v_cvt_pk_bf16_f32 v106, v116, v117
  v_lshlrev_b32 v116, 16, v106
  v_and_b32 v117, 0xffff0000, v106
  v_pk_mul_f32 v[116:117], v[116:117], v[112:113] op_sel_hi:[1,0]
  v_cvt_pk_bf16_f32 v39, v116, v117
  v_pk_add_f32 v[114:115], v[96:97], v[108:109] op_sel_hi:[1,0] neg_lo:[0,1] neg_hi:[0,1]
  v_cvt_pk_bf16_f32 v106, v114, v115
  v_lshlrev_b32 v114, 16, v106
  v_and_b32 v115, 0xffff0000, v106
  v_pk_mul_f32 v[114:115], v[114:115], v[112:113] op_sel_hi:[1,0]
  v_cvt_pk_bf16_f32 v40, v114, v115
  v_pk_add_f32 v[116:117], v[98:99], v[108:109] op_sel_hi:[1,0] neg_lo:[0,1] neg_hi:[0,1]
  v_cvt_pk_bf16_f32 v106, v116, v117
  v_lshlrev_b32 v116, 16, v106
  v_and_b32 v117, 0xffff0000, v106
  v_pk_mul_f32 v[116:117], v[116:117], v[112:113] op_sel_hi:[1,0]
  v_cvt_pk_bf16_f32 v41, v116, v117
  v_pk_add_f32 v[114:115], v[100:101], v[108:109] op_sel_hi:[1,0] neg_lo:[0,1] neg_hi:[0,1]
  v_cvt_pk_bf16_f32 v106, v114, v115
  v_lshlrev_b32 v114, 16, v106
  v_and_b32 v115, 0xffff0000, v106
  v_pk_mul_f32 v[114:115], v[114:115], v[112:113] op_sel_hi:[1,0]
  v_cvt_pk_bf16_f32 v42, v114, v115
  v_pk_add_f32 v[116:117], v[102:103], v[108:109] op_sel_hi:[1,0] neg_lo:[0,1] neg_hi:[0,1]
  v_cvt_pk_bf16_f32 v106, v116, v117
  v_lshlrev_b32 v116, 16, v106
  v_and_b32 v117, 0xffff0000, v106
  v_pk_mul_f32 v[116:117], v[116:117], v[112:113] op_sel_hi:[1,0]
  v_cvt_pk_bf16_f32 v43, v116, v117
  ds_write_b128 v2, v[16:19] offset:0
  ds_write_b128 v2, v[20:23] offset:128
  ds_write_b128 v2, v[24:27] offset:256
  ds_write_b128 v2, v[28:31] offset:384
  ds_write_b128 v2, v[32:35] offset:512
  ds_write_b128 v2, v[36:39] offset:640
  ds_write_b128 v2, v[40:43] offset:768
  s_waitcnt lgkmcnt(0)
  s_barrier
  v_and_b32 v5, 15, v0
  v_lshrrev_b32 v6, 4, v0
  v_mul_u32_u24 v7, 1824, v5
  v_lshl_add_u32 v7, v6, 4, v7
  v_add_u32 v7, 32768, v7
  ds_read_b128 v[48:51], v7 offset:0
  ds_read_b128 v[52:55], v7 offset:256
  ds_read_b128 v[56:59], v7 offset:512
  ds_read_b128 v[60:63], v7 offset:768
  ds_read_b128 v[64:67], v7 offset:912
  ds_read_b128 v[68:71], v7 offset:1168
  ds_read_b128 v[72:75], v7 offset:1424
  ds_read_b128 v[76:79], v7 offset:1680
  s_waitcnt lgkmcnt(0)
  s_add_u32 s87, s86, 0
  s_lshr_b32 s87, s87, 5
  s_mul_i32 s87, s87, 28672
  s_mul_i32 s88, s82, 14336
  s_add_u32 s87, s87, s88
  s_add_u32 s87, s87, 24801280
  v_lshl_add_u32 v10, v0, 4, s87
  v_add_u32 v11, 0, v10
  global_store_dwordx4 v11, v[48:51], s[4:5] sc1
  v_add_u32 v11, 4096, v10
  global_store_dwordx4 v11, v[52:55], s[4:5] sc1
  v_add_u32 v11, 8192, v10
  global_store_dwordx4 v11, v[56:59], s[4:5] sc1
  s_cmp_ge_u32 s23, 2
  s_cbranch_scc1 fc_xa0
  v_add_u32 v11, 12288, v10
  global_store_dwordx4 v11, v[60:63], s[4:5] sc1
fc_xa0:
  s_add_u32 s87, s86, 64
  s_lshr_b32 s87, s87, 5
  s_mul_i32 s87, s87, 28672
  s_mul_i32 s88, s82, 14336
  s_add_u32 s87, s87, s88
  s_add_u32 s87, s87, 24801280
  v_lshl_add_u32 v10, v0, 4, s87
  v_add_u32 v11, 0, v10
  global_store_dwordx4 v11, v[64:67], s[4:5] sc1
  v_add_u32 v11, 4096, v10
  global_store_dwordx4 v11, v[68:71], s[4:5] sc1
  v_add_u32 v11, 8192, v10
  global_store_dwordx4 v11, v[72:75], s[4:5] sc1
  s_cmp_ge_u32 s23, 2
  s_cbranch_scc1 fc_xa1
  v_add_u32 v11, 12288, v10
  global_store_dwordx4 v11, v[76:79], s[4:5] sc1
fc_xa1:
  s_waitcnt vmcnt(0)
  s_barrier
  s_lshr_b32 s26, s22, 2
  s_lshl_b32 s26, s26, 2
  s_lshr_b32 s27, s22, 1
  s_and_b32 s27, s27, 1
  s_add_u32 s26, s26, s27
  s_add_u32 s26, s26, 0
  s_lshl_b32 s26, s26, 7
  s_add_u32 s26, s26, 16384
  s_cmp_lg_u32 s23, 0
  s_cbranch_scc1 .Lsig9
  v_mov_b32 v4, s26
  v_mov_b32 v5, 1
  s_mov_b64 exec, 1
  global_atomic_add v4, v5, s[16:17] sc1
  s_mov_b64 exec, -1
.Lsig9:
  s_lshr_b32 s26, s22, 2
  s_lshl_b32 s26, s26, 2
  s_lshr_b32 s27, s22, 1
  s_and_b32 s27, s27, 1
  s_add_u32 s26, s26, s27
  s_add_u32 s26, s26, 2
  s_lshl_b32 s26, s26, 7
  s_add_u32 s26, s26, 16384
  s_cmp_lg_u32 s23, 0
  s_cbranch_scc1 .Lsig10
  v_mov_b32 v4, s26
  v_mov_b32 v5, 1
  s_mov_b64 exec, 1
  global_atomic_add v4, v5, s[16:17] sc1
  s_mov_b64 exec, -1
.Lsig10:
  s_mov_b32 s26, 1280
  s_cmp_lg_u32 s23, 0
  s_cbranch_scc1 .Lsig11
  v_mov_b32 v4, s26
  v_mov_b32 v5, 1
  s_mov_b64 exec, 1
  global_atomic_add v4, v5, s[16:17] sc1
  s_mov_b64 exec, -1
.Lsig11:
  v_lshlrev_b32 v2, 4, v1
  s_mov_b32 s54, s22
  s_lshl_b32 s26, s23, 12
  v_add_u32 v128, s26, v2
  v_lshrrev_b32 v10, 3, v0
  v_and_b32 v11, 7, v0
  v_lshrrev_b32 v12, 4, v10
  v_lshlrev_b32 v12, 11, v12
  v_lshrrev_b32 v13, 2, v11
  v_lshl_add_u32 v12, v13, 10, v12
  v_and_b32 v13, 15, v10
  v_lshrrev_b32 v13, 2, v13
  v_lshl_add_u32 v12, v13, 8, v12
  v_and_b32 v13, 3, v11
  v_lshl_add_u32 v12, v13, 6, v12
  v_and_b32 v13, 3, v10
  v_lshl_add_u32 v129, v13, 2, v12
  v_mul_u32_u24 v130, 896, v10
  v_lshl_add_u32 v130, v11, 3, v130
b_pv_task:
  s_mul_hi_u32 s41, s54, 306783379
  s_mul_i32 s26, s41, 14
  s_sub_u32 s44, s54, s26
  s_lshl_b32 s26, s41, 2
  s_add_u32 s26, s26, 2048
  s_cmp_lg_u32 s23, 0
  s_cbranch_scc1 b_pv_wu_ok
  v_mov_b32 v4, s26
  s_mov_b64 exec, 1
b_pv_wu:
  global_load_dword v5, v4, s[16:17] sc1
  s_sub_u32 s25, s25, 1
  s_cbranch_scc1 b_fail
  s_waitcnt vmcnt(0)
  v_cmp_ne_u32 vcc, 16, v5
  s_cbranch_vccz b_pv_wu_got
  s_sleep 10
  s_branch b_pv_wu
b_pv_wu_got:
  s_mov_b64 exec, -1
b_pv_wu_ok:
  s_barrier
  s_mul_i32 s26, s41, 458752
  s_lshl_b32 s27, s44, 15
  s_add_u32 s26, s26, s27
  s_lshl_b32 s27, s23, 13
  s_add_u32 s26, s26, s27
  v_add_u32 v6, s26, v2
  global_load_dwordx4 v[64:67], v6, s[10:11] offset:0 sc1
  global_load_dwordx4 v[68:71], v6, s[10:11] offset:1024 sc1
  global_load_dwordx4 v[72:75], v6, s[10:11] offset:2048 sc1
  global_load_dwordx4 v[76:79], v6, s[10:11] offset:3072 sc1
  v_add_u32 v6, 4096, v6
  global_load_dwordx4 v[80:83], v6, s[10:11] offset:0 sc1
  global_load_dwordx4 v[84:87], v6, s[10:11] offset:1024 sc1
  global_load_dwordx4 v[88:91], v6, s[10:11] offset:2048 sc1
  global_load_dwordx4 v[92:95], v6, s[10:11] offset:3072 sc1
  s_mul_i32 s26, s41, 28672
  s_lshl_b32 s27, s44, 6
  s_add_u32 s26, s26, s27
  v_add_u32 v131, s26, v130
  global_load_dwordx2 v[8:9], v131, s[36:37] sc1
  s_lshl_b32 s26, s41, 7
  s_add_u32 s26, s26, 4096
  s_cmp_lg_u32 s23, 0
  s_cbranch_scc1 b_pv_wp_ok
  v_mov_b32 v4, s26
  s_mov_b64 exec, 1
b_pv_wp:
  global_load_dword v5, v4, s[16:17] sc1
  s_sub_u32 s25, s25, 1
  s_cbranch_scc1 b_fail
  s_waitcnt vmcnt(0)
  v_cmp_ne_u32 vcc, 48, v5
  s_cbranch_vccz b_pv_wp_got
  s_cmp_ge_u32 s41, 61
  s_cbranch_scc1 b_pv_wp
  s_sleep 10
  s_branch b_pv_wp
b_pv_wp_got:
  s_mov_b64 exec, -1
b_pv_wp_ok:
  s_barrier
  s_mul_i32 s26, s41, 65536
  s_lshl_b32 s27, s23, 13
  s_add_u32 s27, s27, s26
  v_add_u32 v6, s27, v2
  global_load_dwordx4 v[16:19], v6, s[38:39] offset:0 sc1
  global_load_dwordx4 v[20:23], v6, s[38:39] offset:1024 sc1
  global_load_dwordx4 v[24:27], v6, s[38:39] offset:2048 sc1
  global_load_dwordx4 v[28:31], v6, s[38:39] offset:3072 sc1
  v_add_u32 v6, 4096, v6
  global_load_dwordx4 v[32:35], v6, s[38:39] offset:0 sc1
  global_load_dwordx4 v[36:39], v6, s[38:39] offset:1024 sc1
  global_load_dwordx4 v[40:43], v6, s[38:39] offset:2048 sc1
  global_load_dwordx4 v[44:47], v6, s[38:39] offset:3072 sc1
  s_lshl_b32 s27, s23, 12
  s_add_u32 s27, s27, s26
  s_add_u32 s27, s27, 32768
  v_add_u32 v6, s27, v2
  global_load_dwordx4 v[48:51], v6, s[38:39] offset:0 sc1
  global_load_dwordx4 v[52:55], v6, s[38:39] offset:1024 sc1
  global_load_dwordx4 v[56:59], v6, s[38:39] offset:2048 sc1
  global_load_dwordx4 v[60:63], v6, s[38:39] offset:3072 sc1
  s_mul_i32 s26, s41, 229376
  s_lshl_b32 s27, s44, 14
  s_add_u32 s26, s26, s27
  s_lshl_b32 s27, s23, 12
  s_add_u32 s26, s26, s27
  v_add_u32 v6, s26, v2
  global_load_dwordx4 v[96:99], v6, s[20:21] offset:0 sc1
  global_load_dwordx4 v[100:103], v6, s[20:21] offset:1024 sc1
  global_load_dwordx4 v[104:107], v6, s[20:21] offset:2048 sc1
  global_load_dwordx4 v[108:111], v6, s[20:21] offset:3072 sc1
  s_waitcnt vmcnt(0)
  v_mfma_f32_16x16x32_bf16 v[112:115], v[16:19], v[64:67], 0
  v_mfma_f32_16x16x32_bf16 v[112:115], v[24:27], v[68:71], v[112:115]
  v_mfma_f32_16x16x32_bf16 v[112:115], v[32:35], v[80:83], v[112:115]
  v_mfma_f32_16x16x32_bf16 v[112:115], v[40:43], v[84:87], v[112:115]
  v_mfma_f32_16x16x32_bf16 v[112:115], v[48:51], v[96:99], v[112:115]
  v_mfma_f32_16x16x32_bf16 v[112:115], v[56:59], v[100:103], v[112:115]
  v_mfma_f32_16x16x32_bf16 v[116:119], v[16:19], v[72:75], 0
  v_mfma_f32_16x16x32_bf16 v[116:119], v[24:27], v[76:79], v[116:119]
  v_mfma_f32_16x16x32_bf16 v[116:119], v[32:35], v[88:91], v[116:119]
  v_mfma_f32_16x16x32_bf16 v[116:119], v[40:43], v[92:95], v[116:119]
  v_mfma_f32_16x16x32_bf16 v[116:119], v[48:51], v[104:107], v[116:119]
  v_mfma_f32_16x16x32_bf16 v[116:119], v[56:59], v[108:111], v[116:119]
  v_mfma_f32_16x16x32_bf16 v[120:123], v[20:23], v[64:67], 0
  v_mfma_f32_16x16x32_bf16 v[120:123], v[28:31], v[68:71], v[120:123]
  v_mfma_f32_16x16x32_bf16 v[120:123], v[36:39], v[80:83], v[120:123]
  v_mfma_f32_16x16x32_bf16 v[120:123], v[44:47], v[84:87], v[120:123]
  v_mfma_f32_16x16x32_bf16 v[120:123], v[52:55], v[96:99], v[120:123]
  v_mfma_f32_16x16x32_bf16 v[120:123], v[60:63], v[100:103], v[120:123]
  v_mfma_f32_16x16x32_bf16 v[124:127], v[20:23], v[72:75], 0
  v_mfma_f32_16x16x32_bf16 v[124:127], v[28:31], v[76:79], v[124:127]
  v_mfma_f32_16x16x32_bf16 v[124:127], v[36:39], v[88:91], v[124:127]
  v_mfma_f32_16x16x32_bf16 v[124:127], v[44:47], v[92:95], v[124:127]
  v_mfma_f32_16x16x32_bf16 v[124:127], v[52:55], v[104:107], v[124:127]
  v_mfma_f32_16x16x32_bf16 v[124:127], v[60:63], v[108:111], v[124:127]
  s_nop 7
  ds_write_b128 v128, v[112:115] offset:0
  ds_write_b128 v128, v[116:119] offset:1024
  ds_write_b128 v128, v[120:123] offset:2048
  ds_write_b128 v128, v[124:127] offset:3072
  s_waitcnt lgkmcnt(0)
  s_barrier
  ds_read_b32 v16, v129 offset:0
  ds_read_b32 v17, v129 offset:16
  ds_read_b32 v18, v129 offset:32
  ds_read_b32 v19, v129 offset:48
  ds_read_b32 v20, v129 offset:4096
  ds_read_b32 v21, v129 offset:4112
  ds_read_b32 v22, v129 offset:4128
  ds_read_b32 v23, v129 offset:4144
  ds_read_b32 v24, v129 offset:8192
  ds_read_b32 v25, v129 offset:8208
  ds_read_b32 v26, v129 offset:8224
  ds_read_b32 v27, v129 offset:8240
  ds_read_b32 v28, v129 offset:12288
  ds_read_b32 v29, v129 offset:12304
  ds_read_b32 v30, v129 offset:12320
  ds_read_b32 v31, v129 offset:12336
  s_waitcnt lgkmcnt(0)
  v_add_f32 v16, v16, v20
  v_add_f32 v24, v24, v28
  v_add_f32 v16, v16, v24
  v_add_f32 v17, v17, v21
  v_add_f32 v25, v25, v29
  v_add_f32 v17, v17, v25
  v_add_f32 v18, v18, v22
  v_add_f32 v26, v26, v30
  v_add_f32 v18, v18, v26
  v_add_f32 v19, v19, v23
  v_add_f32 v27, v27, v31
  v_add_f32 v19, v19, v27
  v_cvt_pk_bf16_f32 v32, v16, v17
  v_lshlrev_b32 v33, 16, v32
  v_and_b32 v34, 0xffff0000, v32
  v_lshlrev_b32 v35, 16, v8
  v_and_b32 v36, 0xffff0000, v8
  v_add_f32 v33, v33, v35
  v_add_f32 v34, v34, v36
  v_cvt_pk_bf16_f32 v38, v33, v34
  v_cvt_pk_bf16_f32 v32, v18, v19
  v_lshlrev_b32 v33, 16, v32
  v_and_b32 v34, 0xffff0000, v32
  v_lshlrev_b32 v35, 16, v9
  v_and_b32 v36, 0xffff0000, v9
  v_add_f32 v33, v33, v35
  v_add_f32 v34, v34, v36
  v_cvt_pk_bf16_f32 v39, v33, v34
  global_store_dwordx2 v131, v[38:39], s[34:35]
  s_add_u32 s54, s54, 64
  s_cmp_lt_u32 s54, 896
  s_cbranch_scc1 b_pv_task
  s_endpgm
b_fail:
b_end:
  s_endpgm
.section .rodata,"a"
.p2align 6
.amdhsa_kernel b0_kernel
  .amdhsa_next_free_vgpr 512
  .amdhsa_next_free_sgpr 102
  .amdhsa_accum_offset 256
  .amdhsa_group_segment_fixed_size 0
  .amdhsa_kernarg_size 104
  .amdhsa_user_sgpr_count 2
  .amdhsa_user_sgpr_kernarg_segment_ptr 1
  .amdhsa_system_sgpr_workgroup_id_x 1
.end_amdhsa_kernel
.text

.section .rodata,"a"
.p2align 6
.amdhsa_kernel b1_kernel
  .amdhsa_next_free_vgpr 512
  .amdhsa_next_free_sgpr 102
  .amdhsa_accum_offset 256
  .amdhsa_group_segment_fixed_size 0
  .amdhsa_kernarg_size 104
  .amdhsa_user_sgpr_count 2
  .amdhsa_user_sgpr_kernarg_segment_ptr 1
  .amdhsa_system_sgpr_workgroup_id_x 1
.end_amdhsa_kernel
.text
```
